```python
import torch

def _softmax(x, axis=-1):
    return torch.softmax(x, dim=axis)
def _gelu(x):
    return torch.nn.functional.gelu(x, approximate="tanh")
def _silu(x):
    return torch.nn.functional.silu(x)
def _sigmoid(x):
    return torch.sigmoid(x)
def _layernorm(x, axis=-1, eps=1e-5):
    m = x.mean(dim=axis, keepdim=True)
    v = x.var(dim=axis, keepdim=True, unbiased=False)
    return (x - m) / torch.sqrt(v + eps)
def _scatter_add(tgt, idx, src, axis=0):
    return tgt.clone().index_add_(axis, idx, src)
def _segment_sum(src, seg, n):
    out = torch.zeros((n,) + src.shape[1:], dtype=src.dtype)
    return out.index_add_(0, seg, src)
def _pad(x, pw):
    flat = tuple(v for pair in reversed(pw) for v in pair)
    return torch.nn.functional.pad(x, flat)

kernel_name = 'standalone__mha_block_cached__near_ridge'

def setup_inputs():

    _w = (lambda a: (lambda t: t.to(torch.bfloat16) if t.is_floating_point() else t)(torch.as_tensor(a)))
    B, Sq, D = 16, 192, 640
    H, Sk, Dh = 32, 512, 192
    return {
        "x": _w((lambda *s: torch.randn(*s, dtype=torch.bfloat16) * 0.8)(B, Sq, D)),
        "k_cache": _w((lambda *s: torch.randn(*s, dtype=torch.bfloat16) * 0.8)(B, H, Sk, Dh)),
        "v_cache": _w((lambda *s: torch.randn(*s, dtype=torch.bfloat16) * 0.05)(B, H, Sk, Dh)),
        "wq": _w((lambda *s: torch.randn(*s, dtype=torch.bfloat16) * 0.8)(D, H * Dh) * (D ** -0.5)),
        "wo": _w((lambda *s: torch.randn(*s, dtype=torch.bfloat16) * 0.05)(H * Dh, D) * ((H * Dh) ** -0.5)),
    }

def reference(x, k_cache, v_cache, wq, wo):
    B, Sq, D = x.shape
    H, Dh = 32, 192
    q = (lambda x, *d: x.permute(*d))((x @ wq).reshape(B, Sq, H, Dh), 0, 2, 1, 3)
    scores = torch.einsum("bhqd,bhkd->bhqk", q, k_cache) * (Dh ** -0.5)
    p = _softmax(scores, axis=-1)
    o = torch.einsum("bhqk,bhkd->bhqd", p, v_cache)
    return (lambda x, *d: x.permute(*d))(o, 0, 2, 1, 3).reshape(B, Sq, H * Dh) @ wo
```

```asm
; @launch grid=(256,1,1) block=(256,1,1) lds=159744
.amdgcn_target "amdgcn-amd-amdhsa--gfx950"
.macro MF d,a,b,c
v_mfma_f32_16x16x32_bf16 \d,\a,\b,\c
.endm
.macro TR d,a,o
ds_read_b64_tr_b16 \d,\a offset:\o
.endm
.macro RD d,a,o
ds_read_b128 \d,\a offset:\o
.endm
.text
.globl standalone__mha_block_cached__near_ridge_kernel
.p2align 8
.type standalone__mha_block_cached__near_ridge_kernel,@function
standalone__mha_block_cached__near_ridge_kernel:
s_cmp_ge_u32 s2,256
s_cbranch_scc1 L_main_exit
s_load_dwordx16 s[64:79],s[0:1],0
s_and_b32 s54,s2,7
s_lshr_b32 s55,s2,3
s_and_b32 s52,s55,3
s_lshr_b32 s51,s55,2
s_and_b32 s55,s54,3
s_lshl_b32 s55,s55,2
s_add_u32 s52,s52,s55
s_lshr_b32 s54,s54,2
s_lshl_b32 s54,s54,3
s_add_u32 s51,s51,s54
s_lshl_b32 s50,s52,1
s_mul_i32 s34,s50,384
s_mul_i32 s37,s51,245760
v_mov_b32 v244,v0
v_and_b32 v101,63,v244
v_lshrrev_b32 v102,6,v244
v_add_u32 v107,0,v101
v_mul_u32_u24 v108,2731,v107
v_lshrrev_b32 v108,16,v108
v_and_b32 v109,2,v108
v_and_b32 v110,1,v102
v_lshlrev_b32 v110,2,v110
v_or_b32 v109,v109,v110
v_and_b32 v110,7,v101
v_xor_b32 v109,v109,v110
v_lshlrev_b32 v109,4,v109
v_mul_u32_u24 v110,24,v108
v_sub_u32 v110,v107,v110
v_and_b32 v110,24,v110
v_lshlrev_b32 v110,4,v110
v_add_u32 v109,v109,v110
v_lshlrev_b32 v110,3,v102
v_add_u32 v110,v110,v108
v_mul_u32_u24 v110,12288,v110
v_add_u32 v109,v109,v110
v_mov_b32 v236,v109
v_add_u32 v107,64,v101
v_mul_u32_u24 v108,2731,v107
v_lshrrev_b32 v108,16,v108
v_and_b32 v109,2,v108
v_and_b32 v110,1,v102
v_lshlrev_b32 v110,2,v110
v_or_b32 v109,v109,v110
v_and_b32 v110,7,v101
v_xor_b32 v109,v109,v110
v_lshlrev_b32 v109,4,v109
v_mul_u32_u24 v110,24,v108
v_sub_u32 v110,v107,v110
v_and_b32 v110,24,v110
v_lshlrev_b32 v110,4,v110
v_add_u32 v109,v109,v110
v_lshlrev_b32 v110,3,v102
v_add_u32 v110,v110,v108
v_mul_u32_u24 v110,12288,v110
v_add_u32 v109,v109,v110
v_subrev_u32 v237,1024,v109
v_add_u32 v107,128,v101
v_mul_u32_u24 v108,2731,v107
v_lshrrev_b32 v108,16,v108
v_and_b32 v109,2,v108
v_and_b32 v110,1,v102
v_lshlrev_b32 v110,2,v110
v_or_b32 v109,v109,v110
v_and_b32 v110,7,v101
v_xor_b32 v109,v109,v110
v_lshlrev_b32 v109,4,v109
v_mul_u32_u24 v110,24,v108
v_sub_u32 v110,v107,v110
v_and_b32 v110,24,v110
v_lshlrev_b32 v110,4,v110
v_add_u32 v109,v109,v110
v_lshlrev_b32 v110,3,v102
v_add_u32 v110,v110,v108
v_mul_u32_u24 v110,12288,v110
v_add_u32 v109,v109,v110
v_subrev_u32 v238,2048,v109
v_lshrrev_b32 v107,3,v101
v_and_b32 v108,6,v107
v_and_b32 v109,7,v101
v_xor_b32 v108,v108,v109
v_lshlrev_b32 v108,4,v108
v_mul_u32_u24 v109,48,v102
v_add_u32 v107,v107,v109
v_mul_u32_u24 v107,1280,v107
v_add_u32 v233,v107,v108
v_add_u32 v234,9216,v233
v_add_u32 v235,18432,v233
s_nop 0
v_readfirstlane_b32 s53,v102
s_waitcnt lgkmcnt(0)
s_mov_b32 s4,s64
s_and_b32 s5,s65,65535
s_mov_b32 s6,3932160
s_mov_b32 s7,131072
s_mov_b32 s28,s70
s_and_b32 s29,s71,65535
s_mov_b32 s30,7864320
s_mov_b32 s31,131072
s_mul_i32 s32,s53,3072
s_lshl_b32 s41,s32,1
s_add_u32 m0,s41,0
s_add_u32 s35,s37,0
s_nop 0
buffer_load_dwordx4 v233,s[4:7],s35 offen offset:0 lds
buffer_load_dwordx4 v234,s[4:7],s35 offen offset:1024 lds
buffer_load_dwordx4 v235,s[4:7],s35 offen offset:2048 lds
s_add_u32 m0,s41,3072
s_add_u32 s36,s37,30720
s_nop 0
buffer_load_dwordx4 v233,s[4:7],s36 offen offset:0 lds
buffer_load_dwordx4 v234,s[4:7],s36 offen offset:1024 lds
buffer_load_dwordx4 v235,s[4:7],s36 offen offset:2048 lds
s_add_u32 m0,s32,49152
s_add_u32 s35,s34,0
s_nop 0
buffer_load_dwordx4 v236,s[28:31],s35 offen offset:0 lds
buffer_load_dwordx4 v237,s[28:31],s35 offen offset:1024 lds
buffer_load_dwordx4 v238,s[28:31],s35 offen offset:2048 lds
s_add_u32 m0,s32,61440
s_add_u32 s36,s34,393216
s_nop 0
buffer_load_dwordx4 v236,s[28:31],s36 offen offset:0 lds
buffer_load_dwordx4 v237,s[28:31],s36 offen offset:1024 lds
buffer_load_dwordx4 v238,s[28:31],s36 offen offset:2048 lds
s_add_u32 m0,s41,24576
s_add_u32 s35,s37,128
s_nop 0
buffer_load_dwordx4 v233,s[4:7],s35 offen offset:0 lds
buffer_load_dwordx4 v234,s[4:7],s35 offen offset:1024 lds
buffer_load_dwordx4 v235,s[4:7],s35 offen offset:2048 lds
s_add_u32 m0,s41,27648
s_add_u32 s36,s37,30848
s_nop 0
buffer_load_dwordx4 v233,s[4:7],s36 offen offset:0 lds
buffer_load_dwordx4 v234,s[4:7],s36 offen offset:1024 lds
buffer_load_dwordx4 v235,s[4:7],s36 offen offset:2048 lds
s_add_u32 m0,s32,73728
s_add_u32 s35,s34,786432
s_nop 0
buffer_load_dwordx4 v236,s[28:31],s35 offen offset:0 lds
buffer_load_dwordx4 v237,s[28:31],s35 offen offset:1024 lds
buffer_load_dwordx4 v238,s[28:31],s35 offen offset:2048 lds
s_lshl_b32 s59,s2,2
s_add_u32 s59,s59,s53
v_and_b32 v103,63,v244
v_lshlrev_b32 v102,7,v103
v_mul_u32_u24 v105,21846,v103
v_lshrrev_b32 v105,16,v105
v_mul_u32_u24 v106,3,v105
v_sub_u32 v106,v103,v106
v_mul_u32_u24 v105,12288,v105
v_lshlrev_b32 v106,7,v106
v_add_u32 v105,v105,v106
v_mov_b32 v247,2147483392
v_cmp_gt_u32 vcc,30,v103
s_nop 1
v_cndmask_b32 v247,v247,v105,vcc
v_mov_b32 v251,2147483392
v_cmp_gt_u32 vcc,60,v103
s_nop 1
v_cndmask_b32 v251,v251,v102,vcc
v_mov_b32 v104,2147483392
v_cmp_gt_u32 vcc,30,v103
s_nop 1
v_cndmask_b32 v104,v104,v102,vcc
s_and_b32 s54,s59,15
s_mul_i32 s54,s54,768
s_lshr_b32 s100,s59,4
s_mul_i32 s100,s100,122880
s_add_u32 s100,s100,s54
s_mul_i32 s101,s59,7680
s_mul_i32 s54,s59,3840
buffer_load_dword a255,v104,s[4:7],s54 offen offset:0
buffer_load_dword a255,v247,s[28:31],s100 offen offset:0
v_mov_b32 v244,v0
v_and_b32 v101,63,v244
v_lshrrev_b32 v102,6,v244
v_lshrrev_b32 v103,4,v101
v_and_b32 v104,15,v101
v_lshrrev_b32 v105,2,v104
v_and_b32 v106,3,v104
v_lshrrev_b32 v107,1,v104
v_and_b32 v107,3,v107
v_lshlrev_b32 v107,1,v107
v_xor_b32 v107,v103,v107
v_lshlrev_b32 v107,4,v107
v_mul_u32_u24 v108,384,v104
v_add_u32 v216,v107,v108
v_xor_b32 v107,64,v107
v_add_u32 v217,v107,v108
v_lshrrev_b32 v107,1,v106
v_lshlrev_b32 v107,4,v107
v_and_b32 v108,1,v106
v_lshlrev_b32 v108,3,v108
v_add_u32 v111,v107,v108
v_lshlrev_b32 v112,2,v103
v_add_u32 v112,v112,v105
v_lshrrev_b32 v107,1,v112
v_and_b32 v107,3,v107
v_lshlrev_b32 v107,5,v107
v_mul_u32_u24 v108,384,v112
v_add_u32 v108,v108,v111
v_lshlrev_b32 v109,7,v112
v_add_u32 v109,v109,v111
v_xor_b32 v110,0,v107
v_add_u32 v218,v110,v108
v_add_u32 v226,v110,v109
v_xor_b32 v110,32,v107
v_add_u32 v219,v110,v108
v_add_u32 v227,v110,v109
v_xor_b32 v110,64,v107
v_add_u32 v220,v110,v108
v_add_u32 v228,v110,v109
v_xor_b32 v110,96,v107
v_add_u32 v221,v110,v108
v_add_u32 v229,v110,v109
v_lshrrev_b32 v107,1,v105
v_and_b32 v108,1,v103
v_lshlrev_b32 v108,1,v108
v_or_b32 v107,v107,v108
v_lshlrev_b32 v107,5,v107
v_lshlrev_b32 v108,3,v103
v_add_u32 v108,v108,v105
v_mul_u32_u24 v108,384,v108
v_add_u32 v108,v108,v111
v_xor_b32 v110,0,v107
v_add_u32 v222,v110,v108
v_xor_b32 v110,32,v107
v_add_u32 v223,v110,v108
v_xor_b32 v110,64,v107
v_add_u32 v224,v110,v108
v_xor_b32 v110,96,v107
v_add_u32 v225,v110,v108
v_add_u32 v107,0,v101
v_mul_u32_u24 v108,2731,v107
v_lshrrev_b32 v108,16,v108
v_and_b32 v109,6,v108
v_and_b32 v110,7,v101
v_xor_b32 v109,v109,v110
v_and_b32 v110,56,v101
v_add_u32 v109,v109,v110
v_lshlrev_b32 v109,4,v109
v_mul_u32_u24 v110,3072,v102
v_add_u32 v230,v109,v110
v_and_b32 v109,2,v108
v_and_b32 v110,1,v102
v_lshlrev_b32 v110,2,v110
v_or_b32 v109,v109,v110
v_and_b32 v110,7,v101
v_xor_b32 v109,v109,v110
v_lshlrev_b32 v109,4,v109
v_mul_u32_u24 v110,24,v108
v_sub_u32 v110,v107,v110
v_and_b32 v110,24,v110
v_lshlrev_b32 v110,4,v110
v_add_u32 v109,v109,v110
v_lshlrev_b32 v110,3,v102
v_add_u32 v110,v110,v108
v_mul_u32_u24 v110,12288,v110
v_add_u32 v109,v109,v110
v_mov_b32 v236,v109
v_lshrrev_b32 v108,3,v101
v_and_b32 v109,6,v108
v_and_b32 v110,7,v101
v_xor_b32 v109,v109,v110
v_lshlrev_b32 v109,4,v109
v_mul_u32_u24 v110,24,v102
v_add_u32 v110,v110,v108
v_add_u32 v110,0,v110
v_mul_u32_u24 v110,1280,v110
v_add_u32 v109,v109,v110
v_mov_b32 v239,v109
v_add_u32 v107,64,v101
v_mul_u32_u24 v108,2731,v107
v_lshrrev_b32 v108,16,v108
v_and_b32 v109,6,v108
v_and_b32 v110,7,v101
v_xor_b32 v109,v109,v110
v_and_b32 v110,56,v101
v_add_u32 v109,v109,v110
v_lshlrev_b32 v109,4,v109
v_mul_u32_u24 v110,3072,v102
v_add_u32 v231,v109,v110
v_and_b32 v109,2,v108
v_and_b32 v110,1,v102
v_lshlrev_b32 v110,2,v110
v_or_b32 v109,v109,v110
v_and_b32 v110,7,v101
v_xor_b32 v109,v109,v110
v_lshlrev_b32 v109,4,v109
v_mul_u32_u24 v110,24,v108
v_sub_u32 v110,v107,v110
v_and_b32 v110,24,v110
v_lshlrev_b32 v110,4,v110
v_add_u32 v109,v109,v110
v_lshlrev_b32 v110,3,v102
v_add_u32 v110,v110,v108
v_mul_u32_u24 v110,12288,v110
v_add_u32 v109,v109,v110
v_subrev_u32 v237,1024,v109
v_lshrrev_b32 v108,3,v101
v_and_b32 v109,6,v108
v_and_b32 v110,7,v101
v_xor_b32 v109,v109,v110
v_lshlrev_b32 v109,4,v109
v_mul_u32_u24 v110,24,v102
v_add_u32 v110,v110,v108
v_add_u32 v110,8,v110
v_mul_u32_u24 v110,1280,v110
v_add_u32 v109,v109,v110
v_subrev_u32 v240,1024,v109
v_add_u32 v107,128,v101
v_mul_u32_u24 v108,2731,v107
v_lshrrev_b32 v108,16,v108
v_and_b32 v109,6,v108
v_and_b32 v110,7,v101
v_xor_b32 v109,v109,v110
v_and_b32 v110,56,v101
v_add_u32 v109,v109,v110
v_lshlrev_b32 v109,4,v109
v_mul_u32_u24 v110,3072,v102
v_add_u32 v232,v109,v110
v_and_b32 v109,2,v108
v_and_b32 v110,1,v102
v_lshlrev_b32 v110,2,v110
v_or_b32 v109,v109,v110
v_and_b32 v110,7,v101
v_xor_b32 v109,v109,v110
v_lshlrev_b32 v109,4,v109
v_mul_u32_u24 v110,24,v108
v_sub_u32 v110,v107,v110
v_and_b32 v110,24,v110
v_lshlrev_b32 v110,4,v110
v_add_u32 v109,v109,v110
v_lshlrev_b32 v110,3,v102
v_add_u32 v110,v110,v108
v_mul_u32_u24 v110,12288,v110
v_add_u32 v109,v109,v110
v_subrev_u32 v238,2048,v109
v_lshrrev_b32 v108,3,v101
v_and_b32 v109,6,v108
v_and_b32 v110,7,v101
v_xor_b32 v109,v109,v110
v_lshlrev_b32 v109,4,v109
v_mul_u32_u24 v110,24,v102
v_add_u32 v110,v110,v108
v_add_u32 v110,16,v110
v_mul_u32_u24 v110,1280,v110
v_add_u32 v109,v109,v110
v_subrev_u32 v241,2048,v109
v_lshrrev_b32 v107,3,v101
v_and_b32 v108,6,v107
v_and_b32 v109,7,v101
v_xor_b32 v108,v108,v109
v_lshlrev_b32 v108,4,v108
v_mul_u32_u24 v109,48,v102
v_add_u32 v107,v107,v109
v_mul_u32_u24 v107,1280,v107
v_add_u32 v233,v107,v108
v_add_u32 v234,9216,v233
v_add_u32 v235,18432,v233
v_and_b32 v108,6,v104
v_xor_b32 v108,v108,v103
v_lshlrev_b32 v108,4,v108
v_lshlrev_b32 v107,7,v104
v_mul_u32_u24 v109,6144,v102
v_add_u32 v107,v107,v109
v_add_u32 v242,v107,v108
v_xor_b32 v108,64,v108
v_add_u32 v245,v107,v108
v_mov_b32 v250,2147483392
v_cmp_eq_u32 vcc,0,v244
s_nop 1
v_mov_b32 v108,0
v_cndmask_b32 v250,v250,v108,vcc
v_lshlrev_b32 v107,13,v102
v_lshlrev_b32 v108,7,v101
v_add_u32 v252,v107,v108
v_mul_u32_u24 v107,60,v102
v_add_u32 v251,v107,v101
v_mul_u32_u24 v107,6144,v102
v_lshlrev_b32 v108,4,v101
v_add_u32 v243,v107,v108
s_mov_b32 s8,s66
s_and_b32 s9,s67,65535
s_mov_b32 s10,100663296
s_mov_b32 s11,131072
s_mov_b32 s12,s68
s_and_b32 s13,s69,65535
s_mov_b32 s14,100663296
s_mov_b32 s15,131072
s_mov_b32 s20,s72
s_and_b32 s21,s73,65535
s_mov_b32 s22,7864320
s_mov_b32 s23,131072
s_mov_b32 s24,s78
s_and_b32 s25,s79,65535
s_mov_b32 s26,402653184
s_mov_b32 s27,131072
s_mov_b32 s18,s74
s_mov_b32 s19,s75
s_mov_b32 s3,s76
s_mov_b32 s47,s77
s_lshl_b32 s54,s51,5
s_add_u32 s54,s54,s50
s_mul_i32 s33,s54,196608
s_add_u32 s42,s33,196608
s_lshr_b32 s40,s2,0
s_mul_i32 s40,s40,1
s_and_b32 s40,s40,15
s_mul_i32 s38,s50,245760
s_lshl_b32 s54,s51,4
s_add_u32 s54,s54,s52
s_mul_i32 s43,s54,245760
s_add_u32 s43,s43,32768
s_add_u32 s44,s43,4096
s_mov_b32 s46,1233125376
s_mov_b32 s48,1037384597
s_mov_b32 s49,1037384597
s_lshl_b32 s54,s51,8
s_lshl_b32 s55,s52,2
s_add_u32 s54,s54,s55
s_add_u32 s54,s54,67108864
v_mov_b32 v108,0
buffer_store_dword v108,v250,s[24:27],s54 offen offset:0 sc1
v_and_b32 v103,63,v244
v_lshlrev_b32 v102,7,v103
v_mov_b32 v251,2147483392
v_cmp_gt_u32 vcc,60,v103
s_nop 1
v_cndmask_b32 v251,v251,v102,vcc
v_and_b32 v107,31,v244
v_lshlrev_b32 v107,7,v107
s_lshl_b32 s54,s53,12
v_add_u32 v252,s54,v107
v_and_b32 v107,63,v244
v_lshlrev_b32 v107,4,v107
v_add_u32 v246,s32,v107
s_lshr_b32 s56,s2,3
s_and_b32 s56,s56,7
s_cmp_eq_u32 s56,0
s_cbranch_scc0 L_pcs1
s_getpc_b64 s[56:57]
L_pc1:
s_add_u32 s56,s56,L_code+0-L_pc1
s_addc_u32 s57,s57,0
v_mov_b32 v249,s57
v_add_co_u32 v248,vcc,s56,v252
s_nop 1
v_addc_co_u32 v249,vcc,0,v249,vcc
global_load_dword a255,v[248:249],off
L_pcs1:
v_and_b32 v111,63,v244
v_lshrrev_b32 v112,6,v244
v_lshrrev_b32 v113,4,v111
v_lshrrev_b32 v114,2,v111
v_and_b32 v114,3,v114
v_and_b32 v115,3,v111
v_lshrrev_b32 v116,1,v113
v_mul_u32_u24 v116,3072,v116
v_and_b32 v117,1,v113
v_lshlrev_b32 v118,2,v117
v_add_u32 v118,v118,v114
v_mul_u32_u24 v118,320,v118
v_add_u32 v116,v116,v118
v_lshrrev_b32 v118,1,v115
v_lshlrev_b32 v118,4,v118
v_add_u32 v116,v116,v118
v_and_b32 v118,1,v115
v_lshlrev_b32 v118,3,v118
v_add_u32 v116,v116,v118
v_lshlrev_b32 v117,5,v117
v_add_u32 v226,v116,v117
v_add_u32 v228,v116,v117
v_xor_b32 v117,32,v117
v_add_u32 v227,v116,v117
v_add_u32 v229,v116,v117
v_add_u32 v116,0,v111
v_mul_u32_u24 v117,3277,v116
v_lshrrev_b32 v117,16,v117
v_mul_u32_u24 v118,20,v117
v_sub_u32 v118,v116,v118
v_lshrrev_b32 v119,2,v117
v_and_b32 v119,1,v119
v_lshlrev_b32 v119,1,v119
v_xor_b32 v118,v118,v119
v_lshlrev_b32 v118,4,v118
v_lshlrev_b32 v119,3,v112
v_add_u32 v119,v119,v117
v_mul_u32_u24 v119,1280,v119
v_add_u32 v118,v118,v119
v_mov_b32 v239,v118
v_add_u32 v116,64,v111
v_mul_u32_u24 v117,3277,v116
v_lshrrev_b32 v117,16,v117
v_mul_u32_u24 v118,20,v117
v_sub_u32 v118,v116,v118
v_lshrrev_b32 v119,2,v117
v_and_b32 v119,1,v119
v_lshlrev_b32 v119,1,v119
v_xor_b32 v118,v118,v119
v_lshlrev_b32 v118,4,v118
v_lshlrev_b32 v119,3,v112
v_add_u32 v119,v119,v117
v_mul_u32_u24 v119,1280,v119
v_add_u32 v118,v118,v119
v_subrev_u32 v118,1024,v118
v_mov_b32 v240,v118
v_add_u32 v116,128,v111
v_mul_u32_u24 v117,3277,v116
v_lshrrev_b32 v117,16,v117
v_mul_u32_u24 v118,20,v117
v_sub_u32 v118,v116,v118
v_lshrrev_b32 v119,2,v117
v_and_b32 v119,1,v119
v_lshlrev_b32 v119,1,v119
v_xor_b32 v118,v118,v119
v_lshlrev_b32 v118,4,v118
v_lshlrev_b32 v119,3,v112
v_add_u32 v119,v119,v117
v_mul_u32_u24 v119,1280,v119
v_add_u32 v118,v118,v119
v_subrev_u32 v118,2048,v118
v_mov_b32 v241,2147483392
v_cmp_gt_u32 vcc,32,v111
s_nop 1
v_cndmask_b32 v241,v241,v118,vcc
v_lshlrev_b32 v116,4,v111
v_mul_u32_u24 v117,18432,v112
v_add_u32 v246,v116,v117
v_mul_u32_u24 v117,15360,v112
v_add_u32 v243,v116,v117
s_waitcnt vmcnt(15)
s_barrier
RD v[144:147],v242,0
RD v[148:151],v242,2048
RD v[152:155],v242,4096
RD v[156:159],v245,0
RD v[160:163],v245,2048
RD v[164:167],v245,4096
v_add_u32 v222,49152,v222
TR a[216:217],v222,0
TR a[218:219],v222,1536
v_add_u32 v223,49152,v223
TR a[220:221],v223,0
TR a[222:223],v223,1536
v_add_u32 v224,49152,v224
TR a[224:225],v224,0
TR a[226:227],v224,1536
v_add_u32 v225,49152,v225
TR a[228:229],v225,0
TR a[230:231],v225,1536
s_waitcnt lgkmcnt(4)
L_code:
L_st0:
MF v[0:3],a[216:219],v[144:147],0
TR a[232:233],v222,128
MF v[4:7],a[216:219],v[148:151],0
TR a[234:235],v222,1664
MF v[8:11],a[216:219],v[152:155],0
TR a[236:237],v223,128
MF v[12:15],a[220:223],v[144:147],0
TR a[238:239],v223,1664
MF v[16:19],a[220:223],v[148:151],0
MF v[20:23],a[220:223],v[152:155],0
s_waitcnt lgkmcnt(4)
MF v[24:27],a[224:227],v[144:147],0
TR a[216:217],v224,128
MF v[28:31],a[224:227],v[148:151],0
TR a[218:219],v224,1664
MF v[32:35],a[224:227],v[152:155],0
TR a[220:221],v225,128
MF v[36:39],a[228:231],v[144:147],0
TR a[222:223],v225,1664
MF v[40:43],a[228:231],v[148:151],0
MF v[44:47],a[228:231],v[152:155],0
s_waitcnt lgkmcnt(4)
MF v[48:51],a[232:235],v[144:147],0
TR a[224:225],v222,256
MF v[52:55],a[232:235],v[148:151],0
TR a[226:227],v222,1792
MF v[56:59],a[232:235],v[152:155],0
TR a[228:229],v223,256
MF v[60:63],a[236:239],v[144:147],0
TR a[230:231],v223,1792
MF v[64:67],a[236:239],v[148:151],0
MF v[68:71],a[236:239],v[152:155],0
s_waitcnt lgkmcnt(4)
MF v[72:75],a[216:219],v[144:147],0
TR a[232:233],v224,256
MF v[76:79],a[216:219],v[148:151],0
TR a[234:235],v224,1792
MF v[80:83],a[216:219],v[152:155],0
TR a[236:237],v225,256
MF v[84:87],a[220:223],v[144:147],0
TR a[238:239],v225,1792
MF v[88:91],a[220:223],v[148:151],0
MF v[92:95],a[220:223],v[152:155],0
s_waitcnt vmcnt(12) lgkmcnt(4)
s_barrier
MF v[96:99],a[224:227],v[144:147],0
TR a[216:217],v222,12288
MF v[100:103],a[224:227],v[148:151],0
TR a[218:219],v222,13824
MF v[104:107],a[224:227],v[152:155],0
s_add_u32 m0,s32,86016
TR a[220:221],v223,12288
MF v[108:111],a[228:231],v[144:147],0
s_add_u32 s36,s34,1179648
TR a[222:223],v223,13824
MF v[112:115],a[228:231],v[148:151],0
buffer_load_dwordx4 v236,s[28:31],s36 offen offset:0 lds
MF v[116:119],a[228:231],v[152:155],0
s_waitcnt lgkmcnt(4)
buffer_load_dwordx4 v237,s[28:31],s36 offen offset:1024 lds
MF v[120:123],a[232:235],v[144:147],0
TR a[224:225],v224,12288
MF v[124:127],a[232:235],v[148:151],0
TR a[226:227],v224,13824
MF v[128:131],a[232:235],v[152:155],0
TR a[228:229],v225,12288
MF v[132:135],a[236:239],v[144:147],0
TR a[230:231],v225,13824
MF v[136:139],a[236:239],v[148:151],0
buffer_load_dwordx4 v238,s[28:31],s36 offen offset:2048 lds
MF v[140:143],a[236:239],v[152:155],0
s_waitcnt lgkmcnt(4)
L_st1:
MF v[0:3],a[216:219],v[156:159],v[0:3]
s_add_u32 m0,s41,0
TR a[232:233],v222,12416
MF v[4:7],a[216:219],v[160:163],v[4:7]
s_add_u32 s35,s37,256
TR a[234:235],v222,13952
MF v[8:11],a[216:219],v[164:167],v[8:11]
TR a[236:237],v223,12416
buffer_load_dwordx4 v233,s[4:7],s35 offen offset:0 lds
MF v[12:15],a[220:223],v[156:159],v[12:15]
TR a[238:239],v223,13952
MF v[16:19],a[220:223],v[160:163],v[16:19]
buffer_load_dwordx4 v234,s[4:7],s35 offen offset:1024 lds
MF v[20:23],a[220:223],v[164:167],v[20:23]
s_waitcnt lgkmcnt(4)
buffer_load_dwordx4 v235,s[4:7],s35 offen offset:2048 lds
MF v[24:27],a[224:227],v[156:159],v[24:27]
s_add_u32 m0,s41,3072
TR a[216:217],v224,12416
MF v[28:31],a[224:227],v[160:163],v[28:31]
s_add_u32 s36,s37,30976
TR a[218:219],v224,13952
MF v[32:35],a[224:227],v[164:167],v[32:35]
TR a[220:221],v225,12416
buffer_load_dwordx4 v233,s[4:7],s36 offen offset:0 lds
MF v[36:39],a[228:231],v[156:159],v[36:39]
TR a[222:223],v225,13952
MF v[40:43],a[228:231],v[160:163],v[40:43]
buffer_load_dwordx4 v234,s[4:7],s36 offen offset:1024 lds
MF v[44:47],a[228:231],v[164:167],v[44:47]
s_waitcnt lgkmcnt(4)
buffer_load_dwordx4 v235,s[4:7],s36 offen offset:2048 lds
MF v[48:51],a[232:235],v[156:159],v[48:51]
s_add_u32 m0,s32,98304
TR a[224:225],v222,12544
MF v[52:55],a[232:235],v[160:163],v[52:55]
s_add_u32 s35,s34,1572864
TR a[226:227],v222,14080
MF v[56:59],a[232:235],v[164:167],v[56:59]
TR a[228:229],v223,12544
buffer_load_dwordx4 v236,s[28:31],s35 offen offset:0 lds
MF v[60:63],a[236:239],v[156:159],v[60:63]
TR a[230:231],v223,14080
MF v[64:67],a[236:239],v[160:163],v[64:67]
buffer_load_dwordx4 v237,s[28:31],s35 offen offset:1024 lds
MF v[68:71],a[236:239],v[164:167],v[68:71]
s_waitcnt lgkmcnt(4)
buffer_load_dwordx4 v238,s[28:31],s35 offen offset:2048 lds
MF v[72:75],a[216:219],v[156:159],v[72:75]
TR a[232:233],v224,12544
MF v[76:79],a[216:219],v[160:163],v[76:79]
TR a[234:235],v224,14080
MF v[80:83],a[216:219],v[164:167],v[80:83]
TR a[236:237],v225,12544
MF v[84:87],a[220:223],v[156:159],v[84:87]
TR a[238:239],v225,14080
MF v[88:91],a[220:223],v[160:163],v[88:91]
MF v[92:95],a[220:223],v[164:167],v[92:95]
s_waitcnt vmcnt(15) lgkmcnt(4)
s_barrier
MF v[96:99],a[224:227],v[156:159],v[96:99]
TR a[216:217],v222,24576
RD v[168:171],v242,24576
MF v[100:103],a[224:227],v[160:163],v[100:103]
TR a[218:219],v222,26112
RD v[172:175],v242,26624
MF v[104:107],a[224:227],v[164:167],v[104:107]
s_add_u32 m0,s32,49152
TR a[220:221],v223,24576
RD v[176:179],v242,28672
MF v[108:111],a[228:231],v[156:159],v[108:111]
s_add_u32 s36,s34,1966080
TR a[222:223],v223,26112
RD v[180:183],v245,24576
MF v[112:115],a[228:231],v[160:163],v[112:115]
buffer_load_dwordx4 v236,s[28:31],s36 offen offset:0 lds
MF v[116:119],a[228:231],v[164:167],v[116:119]
s_waitcnt lgkmcnt(8)
buffer_load_dwordx4 v237,s[28:31],s36 offen offset:1024 lds
MF v[120:123],a[232:235],v[156:159],v[120:123]
TR a[224:225],v224,24576
RD v[184:187],v245,26624
MF v[124:127],a[232:235],v[160:163],v[124:127]
TR a[226:227],v224,26112
RD v[188:191],v245,28672
MF v[128:131],a[232:235],v[164:167],v[128:131]
TR a[228:229],v225,24576
MF v[132:135],a[236:239],v[156:159],v[132:135]
TR a[230:231],v225,26112
MF v[136:139],a[236:239],v[160:163],v[136:139]
buffer_load_dwordx4 v238,s[28:31],s36 offen offset:2048 lds
MF v[140:143],a[236:239],v[164:167],v[140:143]
s_waitcnt lgkmcnt(7)
L_st2:
MF v[0:3],a[216:219],v[168:171],v[0:3]
s_add_u32 m0,s32,110592
TR a[232:233],v222,24704
MF v[4:7],a[216:219],v[172:175],v[4:7]
s_add_u32 s35,s33,0
TR a[234:235],v222,26240
MF v[8:11],a[216:219],v[176:179],v[8:11]
TR a[236:237],v223,24704
buffer_load_dwordx4 v230,s[8:11],s35 offen offset:0 nt lds
MF v[12:15],a[220:223],v[168:171],v[12:15]
TR a[238:239],v223,26240
MF v[16:19],a[220:223],v[172:175],v[16:19]
buffer_load_dwordx4 v231,s[8:11],s35 offen offset:1024 nt lds
MF v[20:23],a[220:223],v[176:179],v[20:23]
s_waitcnt lgkmcnt(4)
buffer_load_dwordx4 v232,s[8:11],s35 offen offset:2048 nt lds
MF v[24:27],a[224:227],v[168:171],v[24:27]
s_add_u32 m0,s32,122880
TR a[216:217],v224,24704
MF v[28:31],a[224:227],v[172:175],v[28:31]
s_add_u32 s36,s33,12288
TR a[218:219],v224,26240
MF v[32:35],a[224:227],v[176:179],v[32:35]
TR a[220:221],v225,24704
buffer_load_dwordx4 v230,s[8:11],s36 offen offset:0 nt lds
MF v[36:39],a[228:231],v[168:171],v[36:39]
TR a[222:223],v225,26240
MF v[40:43],a[228:231],v[172:175],v[40:43]
buffer_load_dwordx4 v231,s[8:11],s36 offen offset:1024 nt lds
MF v[44:47],a[228:231],v[176:179],v[44:47]
s_waitcnt lgkmcnt(4)
buffer_load_dwordx4 v232,s[8:11],s36 offen offset:2048 nt lds
MF v[48:51],a[232:235],v[168:171],v[48:51]
s_add_u32 m0,s32,135168
TR a[224:225],v222,24832
MF v[52:55],a[232:235],v[172:175],v[52:55]
s_add_u32 s35,s33,0
TR a[226:227],v222,26368
MF v[56:59],a[232:235],v[176:179],v[56:59]
TR a[228:229],v223,24832
buffer_load_dwordx4 v230,s[12:15],s35 offen offset:0 nt lds
MF v[60:63],a[236:239],v[168:171],v[60:63]
TR a[230:231],v223,26368
MF v[64:67],a[236:239],v[172:175],v[64:67]
buffer_load_dwordx4 v231,s[12:15],s35 offen offset:1024 nt lds
MF v[68:71],a[236:239],v[176:179],v[68:71]
s_waitcnt lgkmcnt(4)
buffer_load_dwordx4 v232,s[12:15],s35 offen offset:2048 nt lds
MF v[72:75],a[216:219],v[168:171],v[72:75]
TR a[232:233],v224,24832
MF v[76:79],a[216:219],v[172:175],v[76:79]
TR a[234:235],v224,26368
MF v[80:83],a[216:219],v[176:179],v[80:83]
TR a[236:237],v225,24832
MF v[84:87],a[220:223],v[168:171],v[84:87]
TR a[238:239],v225,26368
MF v[88:91],a[220:223],v[172:175],v[88:91]
MF v[92:95],a[220:223],v[176:179],v[92:95]
s_waitcnt vmcnt(21) lgkmcnt(4)
s_barrier
MF v[96:99],a[224:227],v[168:171],v[96:99]
TR a[216:217],v222,36864
MF v[100:103],a[224:227],v[172:175],v[100:103]
TR a[218:219],v222,38400
MF v[104:107],a[224:227],v[176:179],v[104:107]
s_add_u32 m0,s41,24576
TR a[220:221],v223,36864
MF v[108:111],a[228:231],v[168:171],v[108:111]
s_add_u32 s36,s37,384
TR a[222:223],v223,38400
MF v[112:115],a[228:231],v[172:175],v[112:115]
buffer_load_dwordx4 v233,s[4:7],s36 offen offset:0 lds
MF v[116:119],a[228:231],v[176:179],v[116:119]
s_waitcnt lgkmcnt(4)
buffer_load_dwordx4 v234,s[4:7],s36 offen offset:1024 lds
MF v[120:123],a[232:235],v[168:171],v[120:123]
TR a[224:225],v224,36864
MF v[124:127],a[232:235],v[172:175],v[124:127]
TR a[226:227],v224,38400
MF v[128:131],a[232:235],v[176:179],v[128:131]
TR a[228:229],v225,36864
MF v[132:135],a[236:239],v[168:171],v[132:135]
TR a[230:231],v225,38400
MF v[136:139],a[236:239],v[172:175],v[136:139]
buffer_load_dwordx4 v235,s[4:7],s36 offen offset:2048 lds
MF v[140:143],a[236:239],v[176:179],v[140:143]
s_waitcnt lgkmcnt(4)
L_st3:
MF v[0:3],a[216:219],v[180:183],v[0:3]
s_add_u32 m0,s41,27648
TR a[232:233],v222,36992
MF v[4:7],a[216:219],v[184:187],v[4:7]
s_add_u32 s35,s37,31104
TR a[234:235],v222,38528
MF v[8:11],a[216:219],v[188:191],v[8:11]
TR a[236:237],v223,36992
buffer_load_dwordx4 v233,s[4:7],s35 offen offset:0 lds
MF v[12:15],a[220:223],v[180:183],v[12:15]
TR a[238:239],v223,38528
MF v[16:19],a[220:223],v[184:187],v[16:19]
buffer_load_dwordx4 v234,s[4:7],s35 offen offset:1024 lds
MF v[20:23],a[220:223],v[188:191],v[20:23]
s_waitcnt lgkmcnt(4)
buffer_load_dwordx4 v235,s[4:7],s35 offen offset:2048 lds
MF v[24:27],a[224:227],v[180:183],v[24:27]
s_add_u32 m0,s32,61440
TR a[216:217],v224,36992
MF v[28:31],a[224:227],v[184:187],v[28:31]
s_add_u32 s36,s34,2359296
TR a[218:219],v224,38528
MF v[32:35],a[224:227],v[188:191],v[32:35]
TR a[220:221],v225,36992
buffer_load_dwordx4 v236,s[28:31],s36 offen offset:0 lds
MF v[36:39],a[228:231],v[180:183],v[36:39]
TR a[222:223],v225,38528
MF v[40:43],a[228:231],v[184:187],v[40:43]
buffer_load_dwordx4 v237,s[28:31],s36 offen offset:1024 lds
MF v[44:47],a[228:231],v[188:191],v[44:47]
s_waitcnt lgkmcnt(4)
buffer_load_dwordx4 v238,s[28:31],s36 offen offset:2048 lds
MF v[48:51],a[232:235],v[180:183],v[48:51]
s_add_u32 m0,s32,147456
TR a[224:225],v222,37120
MF v[52:55],a[232:235],v[184:187],v[52:55]
s_add_u32 s35,s34,2752512
TR a[226:227],v222,38656
MF v[56:59],a[232:235],v[188:191],v[56:59]
TR a[228:229],v223,37120
buffer_load_dwordx4 v236,s[28:31],s35 offen offset:0 lds
MF v[60:63],a[236:239],v[180:183],v[60:63]
TR a[230:231],v223,38656
MF v[64:67],a[236:239],v[184:187],v[64:67]
buffer_load_dwordx4 v237,s[28:31],s35 offen offset:1024 lds
MF v[68:71],a[236:239],v[188:191],v[68:71]
s_waitcnt lgkmcnt(4)
buffer_load_dwordx4 v238,s[28:31],s35 offen offset:2048 lds
MF v[72:75],a[216:219],v[180:183],v[72:75]
TR a[232:233],v224,37120
MF v[76:79],a[216:219],v[184:187],v[76:79]
TR a[234:235],v224,38656
MF v[80:83],a[216:219],v[188:191],v[80:83]
TR a[236:237],v225,37120
MF v[84:87],a[220:223],v[180:183],v[84:87]
TR a[238:239],v225,38656
MF v[88:91],a[220:223],v[184:187],v[88:91]
MF v[92:95],a[220:223],v[188:191],v[92:95]
s_waitcnt vmcnt(24) lgkmcnt(4)
s_barrier
MF v[96:99],a[224:227],v[180:183],v[96:99]
TR a[216:217],v222,49152
RD v[144:147],v242,0
MF v[100:103],a[224:227],v[184:187],v[100:103]
TR a[218:219],v222,50688
RD v[148:151],v242,2048
MF v[104:107],a[224:227],v[188:191],v[104:107]
s_add_u32 m0,s32,73728
TR a[220:221],v223,49152
RD v[152:155],v242,4096
MF v[108:111],a[228:231],v[180:183],v[108:111]
s_add_u32 s36,s34,3145728
TR a[222:223],v223,50688
RD v[156:159],v245,0
MF v[112:115],a[228:231],v[184:187],v[112:115]
buffer_load_dwordx4 v236,s[28:31],s36 offen offset:0 lds
MF v[116:119],a[228:231],v[188:191],v[116:119]
s_waitcnt lgkmcnt(8)
MF v[120:123],a[232:235],v[180:183],v[120:123]
TR a[224:225],v224,49152
RD v[160:163],v245,2048
MF v[124:127],a[232:235],v[184:187],v[124:127]
TR a[226:227],v224,50688
RD v[164:167],v245,4096
MF v[128:131],a[232:235],v[188:191],v[128:131]
TR a[228:229],v225,49152
MF v[132:135],a[236:239],v[180:183],v[132:135]
TR a[230:231],v225,50688
MF v[136:139],a[236:239],v[184:187],v[136:139]
MF v[140:143],a[236:239],v[188:191],v[140:143]
s_waitcnt lgkmcnt(7)
L_st4:
MF v[0:3],a[216:219],v[144:147],v[0:3]
TR a[232:233],v222,49280
MF v[4:7],a[216:219],v[148:151],v[4:7]
TR a[234:235],v222,50816
MF v[8:11],a[216:219],v[152:155],v[8:11]
TR a[236:237],v223,49280
MF v[12:15],a[220:223],v[144:147],v[12:15]
TR a[238:239],v223,50816
MF v[16:19],a[220:223],v[148:151],v[16:19]
buffer_load_dwordx4 v237,s[28:31],s36 offen offset:1024 lds
MF v[20:23],a[220:223],v[152:155],v[20:23]
s_waitcnt lgkmcnt(4)
MF v[24:27],a[224:227],v[144:147],v[24:27]
TR a[216:217],v224,49280
MF v[28:31],a[224:227],v[148:151],v[28:31]
TR a[218:219],v224,50816
MF v[32:35],a[224:227],v[152:155],v[32:35]
TR a[220:221],v225,49280
MF v[36:39],a[228:231],v[144:147],v[36:39]
TR a[222:223],v225,50816
MF v[40:43],a[228:231],v[148:151],v[40:43]
MF v[44:47],a[228:231],v[152:155],v[44:47]
s_waitcnt lgkmcnt(4)
MF v[48:51],a[232:235],v[144:147],v[48:51]
TR a[224:225],v222,49408
MF v[52:55],a[232:235],v[148:151],v[52:55]
TR a[226:227],v222,50944
MF v[56:59],a[232:235],v[152:155],v[56:59]
TR a[228:229],v223,49408
MF v[60:63],a[236:239],v[144:147],v[60:63]
TR a[230:231],v223,50944
MF v[64:67],a[236:239],v[148:151],v[64:67]
buffer_load_dwordx4 v238,s[28:31],s36 offen offset:2048 lds
MF v[68:71],a[236:239],v[152:155],v[68:71]
s_waitcnt lgkmcnt(4)
MF v[72:75],a[216:219],v[144:147],v[72:75]
TR a[232:233],v224,49408
MF v[76:79],a[216:219],v[148:151],v[76:79]
TR a[234:235],v224,50944
MF v[80:83],a[216:219],v[152:155],v[80:83]
TR a[236:237],v225,49408
MF v[84:87],a[220:223],v[144:147],v[84:87]
TR a[238:239],v225,50944
MF v[88:91],a[220:223],v[148:151],v[88:91]
MF v[92:95],a[220:223],v[152:155],v[92:95]
s_waitcnt vmcnt(24) lgkmcnt(4)
s_barrier
MF v[96:99],a[224:227],v[144:147],v[96:99]
TR a[216:217],v222,0
MF v[100:103],a[224:227],v[148:151],v[100:103]
TR a[218:219],v222,1536
MF v[104:107],a[224:227],v[152:155],v[104:107]
s_add_u32 m0,s41,0
TR a[220:221],v223,0
MF v[108:111],a[228:231],v[144:147],v[108:111]
s_add_u32 s35,s37,512
TR a[222:223],v223,1536
MF v[112:115],a[228:231],v[148:151],v[112:115]
buffer_load_dwordx4 v233,s[4:7],s35 offen offset:0 lds
MF v[116:119],a[228:231],v[152:155],v[116:119]
s_waitcnt lgkmcnt(4)
MF v[120:123],a[232:235],v[144:147],v[120:123]
TR a[224:225],v224,0
MF v[124:127],a[232:235],v[148:151],v[124:127]
TR a[226:227],v224,1536
MF v[128:131],a[232:235],v[152:155],v[128:131]
TR a[228:229],v225,0
MF v[132:135],a[236:239],v[144:147],v[132:135]
TR a[230:231],v225,1536
MF v[136:139],a[236:239],v[148:151],v[136:139]
buffer_load_dwordx4 v234,s[4:7],s35 offen offset:1024 lds
MF v[140:143],a[236:239],v[152:155],v[140:143]
s_waitcnt lgkmcnt(4)
L_st5:
s_mov_b32 s96,s3
s_and_b32 s97,s47,65535
s_mov_b32 s98,256
s_mov_b32 s99,131072
s_lshl_b32 s54,s51,4
v_mov_b32 v212,1
buffer_atomic_add v212,v250,s[96:99],s54 offen
MF v[0:3],a[216:219],v[156:159],v[0:3]
TR a[232:233],v222,128
MF v[4:7],a[216:219],v[160:163],v[4:7]
TR a[234:235],v222,1664
MF v[8:11],a[216:219],v[164:167],v[8:11]
TR a[236:237],v223,128
MF v[12:15],a[220:223],v[156:159],v[12:15]
TR a[238:239],v223,1664
MF v[16:19],a[220:223],v[160:163],v[16:19]
buffer_load_dwordx4 v235,s[4:7],s35 offen offset:2048 lds
MF v[20:23],a[220:223],v[164:167],v[20:23]
s_waitcnt lgkmcnt(4)
MF v[24:27],a[224:227],v[156:159],v[24:27]
TR a[216:217],v224,128
MF v[28:31],a[224:227],v[160:163],v[28:31]
TR a[218:219],v224,1664
MF v[32:35],a[224:227],v[164:167],v[32:35]
s_add_u32 m0,s41,3072
TR a[220:221],v225,128
MF v[36:39],a[228:231],v[156:159],v[36:39]
s_add_u32 s36,s37,31232
TR a[222:223],v225,1664
MF v[40:43],a[228:231],v[160:163],v[40:43]
buffer_load_dwordx4 v233,s[4:7],s36 offen offset:0 lds
MF v[44:47],a[228:231],v[164:167],v[44:47]
s_waitcnt lgkmcnt(4)
MF v[48:51],a[232:235],v[156:159],v[48:51]
TR a[224:225],v222,256
MF v[52:55],a[232:235],v[160:163],v[52:55]
TR a[226:227],v222,1792
MF v[56:59],a[232:235],v[164:167],v[56:59]
TR a[228:229],v223,256
MF v[60:63],a[236:239],v[156:159],v[60:63]
TR a[230:231],v223,1792
MF v[64:67],a[236:239],v[160:163],v[64:67]
buffer_load_dwordx4 v234,s[4:7],s36 offen offset:1024 lds
MF v[68:71],a[236:239],v[164:167],v[68:71]
s_waitcnt lgkmcnt(4)
MF v[72:75],a[216:219],v[156:159],v[72:75]
TR a[232:233],v224,256
MF v[76:79],a[216:219],v[160:163],v[76:79]
TR a[234:235],v224,1792
MF v[80:83],a[216:219],v[164:167],v[80:83]
TR a[236:237],v225,256
MF v[84:87],a[220:223],v[156:159],v[84:87]
TR a[238:239],v225,1792
MF v[88:91],a[220:223],v[160:163],v[88:91]
buffer_load_dwordx4 v235,s[4:7],s36 offen offset:2048 lds
MF v[92:95],a[220:223],v[164:167],v[92:95]
s_waitcnt vmcnt(13) lgkmcnt(4)
s_barrier
MF v[96:99],a[224:227],v[156:159],v[96:99]
TR a[216:217],v222,12288
RD v[168:171],v242,24576
MF v[100:103],a[224:227],v[160:163],v[100:103]
TR a[218:219],v222,13824
RD v[172:175],v242,26624
MF v[104:107],a[224:227],v[164:167],v[104:107]
s_add_u32 m0,s32,86016
TR a[220:221],v223,12288
RD v[176:179],v242,28672
MF v[108:111],a[228:231],v[156:159],v[108:111]
s_add_u32 s35,s34,3538944
TR a[222:223],v223,13824
RD v[180:183],v245,24576
MF v[112:115],a[228:231],v[160:163],v[112:115]
buffer_load_dwordx4 v236,s[28:31],s35 offen offset:0 lds
MF v[116:119],a[228:231],v[164:167],v[116:119]
s_waitcnt lgkmcnt(8)
MF v[120:123],a[232:235],v[156:159],v[120:123]
TR a[224:225],v224,12288
RD v[184:187],v245,26624
MF v[124:127],a[232:235],v[160:163],v[124:127]
TR a[226:227],v224,13824
RD v[188:191],v245,28672
MF v[128:131],a[232:235],v[164:167],v[128:131]
TR a[228:229],v225,12288
MF v[132:135],a[236:239],v[156:159],v[132:135]
TR a[230:231],v225,13824
MF v[136:139],a[236:239],v[160:163],v[136:139]
buffer_load_dwordx4 v237,s[28:31],s35 offen offset:1024 lds
MF v[140:143],a[236:239],v[164:167],v[140:143]
s_waitcnt lgkmcnt(7)
L_st6:
MF v[0:3],a[216:219],v[168:171],v[0:3]
TR a[232:233],v222,12416
MF v[4:7],a[216:219],v[172:175],v[4:7]
TR a[234:235],v222,13952
MF v[8:11],a[216:219],v[176:179],v[8:11]
TR a[236:237],v223,12416
MF v[12:15],a[220:223],v[168:171],v[12:15]
TR a[238:239],v223,13952
MF v[16:19],a[220:223],v[172:175],v[16:19]
buffer_load_dwordx4 v238,s[28:31],s35 offen offset:2048 lds
MF v[20:23],a[220:223],v[176:179],v[20:23]
s_waitcnt lgkmcnt(4)
MF v[24:27],a[224:227],v[168:171],v[24:27]
TR a[216:217],v224,12416
MF v[28:31],a[224:227],v[172:175],v[28:31]
TR a[218:219],v224,13952
MF v[32:35],a[224:227],v[176:179],v[32:35]
s_add_u32 m0,s32,98304
TR a[220:221],v225,12416
MF v[36:39],a[228:231],v[168:171],v[36:39]
s_add_u32 s36,s34,3932160
TR a[222:223],v225,13952
MF v[40:43],a[228:231],v[172:175],v[40:43]
buffer_load_dwordx4 v236,s[28:31],s36 offen offset:0 lds
MF v[44:47],a[228:231],v[176:179],v[44:47]
s_waitcnt lgkmcnt(4)
MF v[48:51],a[232:235],v[168:171],v[48:51]
TR a[224:225],v222,12544
MF v[52:55],a[232:235],v[172:175],v[52:55]
TR a[226:227],v222,14080
MF v[56:59],a[232:235],v[176:179],v[56:59]
TR a[228:229],v223,12544
MF v[60:63],a[236:239],v[168:171],v[60:63]
TR a[230:231],v223,14080
MF v[64:67],a[236:239],v[172:175],v[64:67]
buffer_load_dwordx4 v237,s[28:31],s36 offen offset:1024 lds
MF v[68:71],a[236:239],v[176:179],v[68:71]
s_waitcnt lgkmcnt(4)
MF v[72:75],a[216:219],v[168:171],v[72:75]
TR a[232:233],v224,12544
v_add_u32 v222,98304,v222
MF v[76:79],a[216:219],v[172:175],v[76:79]
TR a[234:235],v224,14080
v_add_u32 v223,98304,v223
MF v[80:83],a[216:219],v[176:179],v[80:83]
TR a[236:237],v225,12544
MF v[84:87],a[220:223],v[168:171],v[84:87]
TR a[238:239],v225,14080
MF v[88:91],a[220:223],v[172:175],v[88:91]
buffer_load_dwordx4 v238,s[28:31],s36 offen offset:2048 lds
MF v[92:95],a[220:223],v[176:179],v[92:95]
s_waitcnt vmcnt(16) lgkmcnt(4)
s_barrier
MF v[96:99],a[224:227],v[168:171],v[96:99]
TR a[216:217],v222,0
v_add_u32 v224,98304,v224
MF v[100:103],a[224:227],v[172:175],v[100:103]
TR a[218:219],v222,1536
v_add_u32 v225,98304,v225
MF v[104:107],a[224:227],v[176:179],v[104:107]
s_add_u32 m0,s41,24576
TR a[220:221],v223,0
MF v[108:111],a[228:231],v[168:171],v[108:111]
s_add_u32 s35,s37,640
TR a[222:223],v223,1536
MF v[112:115],a[228:231],v[172:175],v[112:115]
buffer_load_dwordx4 v233,s[4:7],s35 offen offset:0 lds
MF v[116:119],a[228:231],v[176:179],v[116:119]
s_waitcnt lgkmcnt(4)
MF v[120:123],a[232:235],v[168:171],v[120:123]
TR a[224:225],v224,0
MF v[124:127],a[232:235],v[172:175],v[124:127]
TR a[226:227],v224,1536
MF v[128:131],a[232:235],v[176:179],v[128:131]
TR a[228:229],v225,0
MF v[132:135],a[236:239],v[168:171],v[132:135]
TR a[230:231],v225,1536
MF v[136:139],a[236:239],v[172:175],v[136:139]
buffer_load_dwordx4 v234,s[4:7],s35 offen offset:1024 lds
MF v[140:143],a[236:239],v[176:179],v[140:143]
s_waitcnt lgkmcnt(4)
L_st7:
MF v[0:3],a[216:219],v[180:183],v[0:3]
TR a[232:233],v222,128
MF v[4:7],a[216:219],v[184:187],v[4:7]
TR a[234:235],v222,1664
MF v[8:11],a[216:219],v[188:191],v[8:11]
TR a[236:237],v223,128
MF v[12:15],a[220:223],v[180:183],v[12:15]
TR a[238:239],v223,1664
MF v[16:19],a[220:223],v[184:187],v[16:19]
buffer_load_dwordx4 v235,s[4:7],s35 offen offset:2048 lds
MF v[20:23],a[220:223],v[188:191],v[20:23]
s_waitcnt lgkmcnt(4)
MF v[24:27],a[224:227],v[180:183],v[24:27]
TR a[216:217],v224,128
MF v[28:31],a[224:227],v[184:187],v[28:31]
TR a[218:219],v224,1664
MF v[32:35],a[224:227],v[188:191],v[32:35]
s_add_u32 m0,s41,27648
TR a[220:221],v225,128
MF v[36:39],a[228:231],v[180:183],v[36:39]
s_add_u32 s36,s37,31360
TR a[222:223],v225,1664
MF v[40:43],a[228:231],v[184:187],v[40:43]
buffer_load_dwordx4 v233,s[4:7],s36 offen offset:0 lds
MF v[44:47],a[228:231],v[188:191],v[44:47]
s_waitcnt lgkmcnt(4)
MF v[48:51],a[232:235],v[180:183],v[48:51]
TR a[224:225],v222,256
MF v[52:55],a[232:235],v[184:187],v[52:55]
TR a[226:227],v222,1792
MF v[56:59],a[232:235],v[188:191],v[56:59]
TR a[228:229],v223,256
MF v[60:63],a[236:239],v[180:183],v[60:63]
TR a[230:231],v223,1792
MF v[64:67],a[236:239],v[184:187],v[64:67]
buffer_load_dwordx4 v234,s[4:7],s36 offen offset:1024 lds
MF v[68:71],a[236:239],v[188:191],v[68:71]
s_waitcnt lgkmcnt(4)
MF v[72:75],a[216:219],v[180:183],v[72:75]
TR a[232:233],v224,256
v_subrev_u32 v222,98304,v222
MF v[76:79],a[216:219],v[184:187],v[76:79]
TR a[234:235],v224,1792
v_subrev_u32 v223,98304,v223
MF v[80:83],a[216:219],v[188:191],v[80:83]
TR a[236:237],v225,256
MF v[84:87],a[220:223],v[180:183],v[84:87]
TR a[238:239],v225,1792
MF v[88:91],a[220:223],v[184:187],v[88:91]
buffer_load_dwordx4 v235,s[4:7],s36 offen offset:2048 lds
MF v[92:95],a[220:223],v[188:191],v[92:95]
s_waitcnt vmcnt(12) lgkmcnt(4)
s_barrier
MF v[96:99],a[224:227],v[180:183],v[96:99]
TR a[216:217],v222,24576
RD v[144:147],v242,0
MF v[100:103],a[224:227],v[184:187],v[100:103]
TR a[218:219],v222,26112
RD v[148:151],v242,2048
MF v[104:107],a[224:227],v[188:191],v[104:107]
s_add_u32 m0,s32,49152
TR a[220:221],v223,24576
RD v[152:155],v242,4096
MF v[108:111],a[228:231],v[180:183],v[108:111]
s_add_u32 s35,s34,4325376
TR a[222:223],v223,26112
RD v[156:159],v245,0
MF v[112:115],a[228:231],v[184:187],v[112:115]
buffer_load_dwordx4 v236,s[28:31],s35 offen offset:0 lds
MF v[116:119],a[228:231],v[188:191],v[116:119]
s_waitcnt lgkmcnt(8)
v_subrev_u32 v224,98304,v224
v_subrev_u32 v225,98304,v225
MF v[120:123],a[232:235],v[180:183],v[120:123]
TR a[224:225],v224,24576
RD v[160:163],v245,2048
MF v[124:127],a[232:235],v[184:187],v[124:127]
TR a[226:227],v224,26112
RD v[164:167],v245,4096
MF v[128:131],a[232:235],v[188:191],v[128:131]
TR a[228:229],v225,24576
MF v[132:135],a[236:239],v[180:183],v[132:135]
TR a[230:231],v225,26112
MF v[136:139],a[236:239],v[184:187],v[136:139]
buffer_load_dwordx4 v237,s[28:31],s35 offen offset:1024 lds
MF v[140:143],a[236:239],v[188:191],v[140:143]
s_waitcnt lgkmcnt(7)
L_st8:
s_lshr_b32 s56,s2,3
s_and_b32 s56,s56,7
s_cmp_eq_u32 s56,0
s_cbranch_scc0 L_pcs2
s_getpc_b64 s[56:57]
L_pc2:
s_add_u32 s56,s56,L_code+16384-L_pc2
s_addc_u32 s57,s57,0
v_mov_b32 v249,s57
v_add_co_u32 v248,vcc,s56,v252
s_nop 1
v_addc_co_u32 v249,vcc,0,v249,vcc
global_load_dword a255,v[248:249],off
L_pcs2:
MF v[0:3],a[216:219],v[144:147],v[0:3]
TR a[232:233],v222,24704
MF v[4:7],a[216:219],v[148:151],v[4:7]
TR a[234:235],v222,26240
MF v[8:11],a[216:219],v[152:155],v[8:11]
TR a[236:237],v223,24704
MF v[12:15],a[220:223],v[144:147],v[12:15]
TR a[238:239],v223,26240
MF v[16:19],a[220:223],v[148:151],v[16:19]
buffer_load_dwordx4 v238,s[28:31],s35 offen offset:2048 lds
MF v[20:23],a[220:223],v[152:155],v[20:23]
s_waitcnt lgkmcnt(4)
MF v[24:27],a[224:227],v[144:147],v[24:27]
TR a[216:217],v224,24704
MF v[28:31],a[224:227],v[148:151],v[28:31]
TR a[218:219],v224,26240
MF v[32:35],a[224:227],v[152:155],v[32:35]
s_add_u32 m0,s32,61440
TR a[220:221],v225,24704
MF v[36:39],a[228:231],v[144:147],v[36:39]
s_add_u32 s36,s34,4718592
s_add_u32 s54,s100,384
TR a[222:223],v225,26240
MF v[40:43],a[228:231],v[148:151],v[40:43]
buffer_load_dwordx4 v236,s[28:31],s36 offen offset:0 lds
MF v[44:47],a[228:231],v[152:155],v[44:47]
s_waitcnt lgkmcnt(4)
buffer_load_dword a255,v247,s[28:31],s54 offen offset:0
MF v[48:51],a[232:235],v[144:147],v[48:51]
TR a[224:225],v222,24832
MF v[52:55],a[232:235],v[148:151],v[52:55]
TR a[226:227],v222,26368
MF v[56:59],a[232:235],v[152:155],v[56:59]
TR a[228:229],v223,24832
MF v[60:63],a[236:239],v[144:147],v[60:63]
TR a[230:231],v223,26368
MF v[64:67],a[236:239],v[148:151],v[64:67]
buffer_load_dwordx4 v237,s[28:31],s36 offen offset:1024 lds
MF v[68:71],a[236:239],v[152:155],v[68:71]
s_waitcnt lgkmcnt(4)
MF v[72:75],a[216:219],v[144:147],v[72:75]
TR a[232:233],v224,24832
MF v[76:79],a[216:219],v[148:151],v[76:79]
TR a[234:235],v224,26368
MF v[80:83],a[216:219],v[152:155],v[80:83]
TR a[236:237],v225,24832
MF v[84:87],a[220:223],v[144:147],v[84:87]
TR a[238:239],v225,26368
MF v[88:91],a[220:223],v[148:151],v[88:91]
buffer_load_dwordx4 v238,s[28:31],s36 offen offset:2048 lds
MF v[92:95],a[220:223],v[152:155],v[92:95]
s_waitcnt vmcnt(16) lgkmcnt(4)
s_barrier
MF v[96:99],a[224:227],v[144:147],v[96:99]
TR a[216:217],v222,36864
MF v[100:103],a[224:227],v[148:151],v[100:103]
TR a[218:219],v222,38400
MF v[104:107],a[224:227],v[152:155],v[104:107]
s_add_u32 m0,s41,0
TR a[220:221],v223,36864
MF v[108:111],a[228:231],v[144:147],v[108:111]
s_add_u32 s35,s37,768
TR a[222:223],v223,38400
MF v[112:115],a[228:231],v[148:151],v[112:115]
buffer_load_dwordx4 v233,s[4:7],s35 offen offset:0 lds
MF v[116:119],a[228:231],v[152:155],v[116:119]
s_waitcnt lgkmcnt(4)
MF v[120:123],a[232:235],v[144:147],v[120:123]
TR a[224:225],v224,36864
MF v[124:127],a[232:235],v[148:151],v[124:127]
TR a[226:227],v224,38400
MF v[128:131],a[232:235],v[152:155],v[128:131]
TR a[228:229],v225,36864
MF v[132:135],a[236:239],v[144:147],v[132:135]
TR a[230:231],v225,38400
MF v[136:139],a[236:239],v[148:151],v[136:139]
buffer_load_dwordx4 v234,s[4:7],s35 offen offset:1024 lds
MF v[140:143],a[236:239],v[152:155],v[140:143]
s_waitcnt lgkmcnt(4)
L_st9:
MF v[0:3],a[216:219],v[156:159],v[0:3]
TR a[232:233],v222,36992
MF v[4:7],a[216:219],v[160:163],v[4:7]
TR a[234:235],v222,38528
MF v[8:11],a[216:219],v[164:167],v[8:11]
TR a[236:237],v223,36992
MF v[12:15],a[220:223],v[156:159],v[12:15]
TR a[238:239],v223,38528
MF v[16:19],a[220:223],v[160:163],v[16:19]
buffer_load_dwordx4 v235,s[4:7],s35 offen offset:2048 lds
MF v[20:23],a[220:223],v[164:167],v[20:23]
s_waitcnt lgkmcnt(4)
MF v[24:27],a[224:227],v[156:159],v[24:27]
TR a[216:217],v224,36992
MF v[28:31],a[224:227],v[160:163],v[28:31]
TR a[218:219],v224,38528
MF v[32:35],a[224:227],v[164:167],v[32:35]
s_add_u32 m0,s41,3072
TR a[220:221],v225,36992
MF v[36:39],a[228:231],v[156:159],v[36:39]
s_add_u32 s36,s37,31488
TR a[222:223],v225,38528
MF v[40:43],a[228:231],v[160:163],v[40:43]
buffer_load_dwordx4 v233,s[4:7],s36 offen offset:0 lds
MF v[44:47],a[228:231],v[164:167],v[44:47]
s_waitcnt lgkmcnt(4)
MF v[48:51],a[232:235],v[156:159],v[48:51]
TR a[224:225],v222,37120
MF v[52:55],a[232:235],v[160:163],v[52:55]
TR a[226:227],v222,38656
MF v[56:59],a[232:235],v[164:167],v[56:59]
TR a[228:229],v223,37120
MF v[60:63],a[236:239],v[156:159],v[60:63]
TR a[230:231],v223,38656
MF v[64:67],a[236:239],v[160:163],v[64:67]
buffer_load_dwordx4 v234,s[4:7],s36 offen offset:1024 lds
MF v[68:71],a[236:239],v[164:167],v[68:71]
s_waitcnt lgkmcnt(4)
MF v[72:75],a[216:219],v[156:159],v[72:75]
TR a[232:233],v224,37120
MF v[76:79],a[216:219],v[160:163],v[76:79]
TR a[234:235],v224,38656
MF v[80:83],a[216:219],v[164:167],v[80:83]
TR a[236:237],v225,37120
MF v[84:87],a[220:223],v[156:159],v[84:87]
TR a[238:239],v225,38656
MF v[88:91],a[220:223],v[160:163],v[88:91]
buffer_load_dwordx4 v235,s[4:7],s36 offen offset:2048 lds
MF v[92:95],a[220:223],v[164:167],v[92:95]
s_waitcnt vmcnt(13) lgkmcnt(4)
s_barrier
MF v[96:99],a[224:227],v[156:159],v[96:99]
TR a[216:217],v222,49152
RD v[168:171],v242,24576
MF v[100:103],a[224:227],v[160:163],v[100:103]
TR a[218:219],v222,50688
RD v[172:175],v242,26624
MF v[104:107],a[224:227],v[164:167],v[104:107]
s_add_u32 m0,s32,73728
TR a[220:221],v223,49152
RD v[176:179],v242,28672
MF v[108:111],a[228:231],v[156:159],v[108:111]
s_add_u32 s35,s34,5111808
TR a[222:223],v223,50688
RD v[180:183],v245,24576
MF v[112:115],a[228:231],v[160:163],v[112:115]
buffer_load_dwordx4 v236,s[28:31],s35 offen offset:0 lds
MF v[116:119],a[228:231],v[164:167],v[116:119]
s_waitcnt lgkmcnt(8)
MF v[120:123],a[232:235],v[156:159],v[120:123]
TR a[224:225],v224,49152
RD v[184:187],v245,26624
MF v[124:127],a[232:235],v[160:163],v[124:127]
TR a[226:227],v224,50688
RD v[188:191],v245,28672
MF v[128:131],a[232:235],v[164:167],v[128:131]
TR a[228:229],v225,49152
MF v[132:135],a[236:239],v[156:159],v[132:135]
TR a[230:231],v225,50688
MF v[136:139],a[236:239],v[160:163],v[136:139]
buffer_load_dwordx4 v237,s[28:31],s35 offen offset:1024 lds
MF v[140:143],a[236:239],v[164:167],v[140:143]
s_waitcnt lgkmcnt(7)
L_st10:
s_lshr_b32 s56,s52,2
s_and_b32 s57,s52,3
s_lshl_b32 s95,s56,2
s_lshl_b32 s95,15,s95
s_lshl_b32 s94,4369,s57
s_mov_b32 s54,s57
s_lshl_b32 s55,s56,2
s_add_u32 s54,s54,s55
s_mul_i32 s76,s54,491520
s_mul_i32 s55,s57,320
s_add_u32 s76,s76,s55
s_lshl_b32 s55,s51,4
s_add_u32 s54,s54,s55
s_mul_i32 s54,s54,147456
s_add_u32 s83,s54,75497472
s_cmp_le_u32 s57,0
s_cselect_b32 s54,1,0
s_lshl_b32 s55,s56,2
s_add_u32 s54,s54,s55
s_mul_i32 s77,s54,491520
s_mul_i32 s55,s57,320
s_add_u32 s77,s77,s55
s_lshl_b32 s55,s51,4
s_add_u32 s54,s54,s55
s_mul_i32 s54,s54,147456
s_add_u32 s80,s54,75497472
s_cmp_le_u32 s57,1
s_cselect_b32 s54,2,1
s_lshl_b32 s55,s56,2
s_add_u32 s54,s54,s55
s_mul_i32 s78,s54,491520
s_mul_i32 s55,s57,320
s_add_u32 s78,s78,s55
s_lshl_b32 s55,s51,4
s_add_u32 s54,s54,s55
s_mul_i32 s54,s54,147456
s_add_u32 s81,s54,75497472
s_cmp_le_u32 s57,2
s_cselect_b32 s54,3,2
s_lshl_b32 s55,s56,2
s_add_u32 s54,s54,s55
s_mul_i32 s79,s54,491520
s_mul_i32 s55,s57,320
s_add_u32 s79,s79,s55
s_lshl_b32 s55,s51,4
s_add_u32 s54,s54,s55
s_mul_i32 s54,s54,147456
s_add_u32 s82,s54,75497472
s_lshl_b32 s54,s51,2
s_add_u32 s54,s54,s57
s_lshl_b32 s54,s54,2
s_add_u32 s55,s54,s56
s_mul_i32 s84,s55,61440
s_add_u32 s84,s84,117440512
s_lshl_b32 s54,s54,2
s_add_u32 s54,s54,s56
s_mul_i32 s75,s54,15360
s_lshl_b32 s55,s53,10
s_add_u32 s75,s75,s55
s_add_u32 s75,s75,117440512
s_mul_i32 s61,s51,192
s_mul_i32 s55,s56,48
s_add_u32 s61,s61,s55
s_mul_i32 s61,s61,1280
s_mul_i32 s55,s57,320
s_add_u32 s61,s61,s55
s_lshl_b32 s54,s51,8
s_lshl_b32 s55,s52,2
s_add_u32 s54,s54,s55
s_add_u32 s59,s54,67108864
s_mov_b32 s85,s83
MF v[0:3],a[216:219],v[168:171],v[0:3]
TR a[232:233],v222,49280
MF v[4:7],a[216:219],v[172:175],v[4:7]
TR a[234:235],v222,50816
MF v[8:11],a[216:219],v[176:179],v[8:11]
TR a[236:237],v223,49280
MF v[12:15],a[220:223],v[168:171],v[12:15]
TR a[238:239],v223,50816
MF v[16:19],a[220:223],v[172:175],v[16:19]
buffer_load_dwordx4 v238,s[28:31],s35 offen offset:2048 lds
MF v[20:23],a[220:223],v[176:179],v[20:23]
s_waitcnt lgkmcnt(4)
MF v[24:27],a[224:227],v[168:171],v[24:27]
TR a[216:217],v224,49280
MF v[28:31],a[224:227],v[172:175],v[28:31]
TR a[218:219],v224,50816
MF v[32:35],a[224:227],v[176:179],v[32:35]
s_add_u32 m0,s32,147456
TR a[220:221],v225,49280
MF v[36:39],a[228:231],v[168:171],v[36:39]
s_add_u32 s36,s34,5505024
TR a[222:223],v225,50816
MF v[40:43],a[228:231],v[172:175],v[40:43]
buffer_load_dwordx4 v236,s[28:31],s36 offen offset:0 lds
MF v[44:47],a[228:231],v[176:179],v[44:47]
s_waitcnt lgkmcnt(4)
MF v[48:51],a[232:235],v[168:171],v[48:51]
TR a[224:225],v222,49408
MF v[52:55],a[232:235],v[172:175],v[52:55]
TR a[226:227],v222,50944
MF v[56:59],a[232:235],v[176:179],v[56:59]
TR a[228:229],v223,49408
MF v[60:63],a[236:239],v[168:171],v[60:63]
TR a[230:231],v223,50944
MF v[64:67],a[236:239],v[172:175],v[64:67]
buffer_load_dwordx4 v237,s[28:31],s36 offen offset:1024 lds
MF v[68:71],a[236:239],v[176:179],v[68:71]
s_waitcnt lgkmcnt(4)
MF v[72:75],a[216:219],v[168:171],v[72:75]
TR a[232:233],v224,49408
MF v[76:79],a[216:219],v[172:175],v[76:79]
TR a[234:235],v224,50944
MF v[80:83],a[216:219],v[176:179],v[80:83]
TR a[236:237],v225,49408
MF v[84:87],a[220:223],v[168:171],v[84:87]
TR a[238:239],v225,50944
MF v[88:91],a[220:223],v[172:175],v[88:91]
buffer_load_dwordx4 v238,s[28:31],s36 offen offset:2048 lds
MF v[92:95],a[220:223],v[176:179],v[92:95]
s_waitcnt vmcnt(16) lgkmcnt(4)
s_barrier
MF v[96:99],a[224:227],v[168:171],v[96:99]
TR a[216:217],v222,0
MF v[100:103],a[224:227],v[172:175],v[100:103]
TR a[218:219],v222,1536
MF v[104:107],a[224:227],v[176:179],v[104:107]
s_add_u32 m0,s41,24576
TR a[220:221],v223,0
MF v[108:111],a[228:231],v[168:171],v[108:111]
s_add_u32 s35,s37,896
TR a[222:223],v223,1536
MF v[112:115],a[228:231],v[172:175],v[112:115]
buffer_load_dwordx4 v233,s[4:7],s35 offen offset:0 lds
MF v[116:119],a[228:231],v[176:179],v[116:119]
s_waitcnt lgkmcnt(4)
MF v[120:123],a[232:235],v[168:171],v[120:123]
TR a[224:225],v224,0
MF v[124:127],a[232:235],v[172:175],v[124:127]
TR a[226:227],v224,1536
MF v[128:131],a[232:235],v[176:179],v[128:131]
TR a[228:229],v225,0
MF v[132:135],a[236:239],v[168:171],v[132:135]
TR a[230:231],v225,1536
MF v[136:139],a[236:239],v[172:175],v[136:139]
buffer_load_dwordx4 v234,s[4:7],s35 offen offset:1024 lds
MF v[140:143],a[236:239],v[176:179],v[140:143]
s_waitcnt lgkmcnt(4)
L_st11:
MF v[0:3],a[216:219],v[180:183],v[0:3]
TR a[232:233],v222,128
MF v[4:7],a[216:219],v[184:187],v[4:7]
TR a[234:235],v222,1664
MF v[8:11],a[216:219],v[188:191],v[8:11]
TR a[236:237],v223,128
MF v[12:15],a[220:223],v[180:183],v[12:15]
TR a[238:239],v223,1664
MF v[16:19],a[220:223],v[184:187],v[16:19]
buffer_load_dwordx4 v235,s[4:7],s35 offen offset:2048 lds
MF v[20:23],a[220:223],v[188:191],v[20:23]
s_waitcnt lgkmcnt(4)
MF v[24:27],a[224:227],v[180:183],v[24:27]
TR a[216:217],v224,128
MF v[28:31],a[224:227],v[184:187],v[28:31]
TR a[218:219],v224,1664
MF v[32:35],a[224:227],v[188:191],v[32:35]
s_add_u32 m0,s41,27648
TR a[220:221],v225,128
MF v[36:39],a[228:231],v[180:183],v[36:39]
s_add_u32 s36,s37,31616
TR a[222:223],v225,1664
MF v[40:43],a[228:231],v[184:187],v[40:43]
buffer_load_dwordx4 v233,s[4:7],s36 offen offset:0 lds
MF v[44:47],a[228:231],v[188:191],v[44:47]
s_waitcnt lgkmcnt(4)
MF v[48:51],a[232:235],v[180:183],v[48:51]
TR a[224:225],v222,256
MF v[52:55],a[232:235],v[184:187],v[52:55]
TR a[226:227],v222,1792
MF v[56:59],a[232:235],v[188:191],v[56:59]
TR a[228:229],v223,256
MF v[60:63],a[236:239],v[180:183],v[60:63]
TR a[230:231],v223,1792
MF v[64:67],a[236:239],v[184:187],v[64:67]
buffer_load_dwordx4 v234,s[4:7],s36 offen offset:1024 lds
MF v[68:71],a[236:239],v[188:191],v[68:71]
s_waitcnt lgkmcnt(4)
MF v[72:75],a[216:219],v[180:183],v[72:75]
TR a[232:233],v224,256
MF v[76:79],a[216:219],v[184:187],v[76:79]
TR a[234:235],v224,1792
MF v[80:83],a[216:219],v[188:191],v[80:83]
TR a[236:237],v225,256
MF v[84:87],a[220:223],v[180:183],v[84:87]
TR a[238:239],v225,1792
MF v[88:91],a[220:223],v[184:187],v[88:91]
buffer_load_dwordx4 v235,s[4:7],s36 offen offset:2048 lds
MF v[92:95],a[220:223],v[188:191],v[92:95]
s_waitcnt vmcnt(12) lgkmcnt(4)
s_barrier
MF v[96:99],a[224:227],v[180:183],v[96:99]
TR a[216:217],v222,12288
RD v[144:147],v242,0
MF v[100:103],a[224:227],v[184:187],v[100:103]
TR a[218:219],v222,13824
RD v[148:151],v242,2048
MF v[104:107],a[224:227],v[188:191],v[104:107]
s_add_u32 m0,s32,86016
TR a[220:221],v223,12288
RD v[152:155],v242,4096
MF v[108:111],a[228:231],v[180:183],v[108:111]
s_add_u32 s35,s34,5898240
TR a[222:223],v223,13824
RD v[156:159],v245,0
MF v[112:115],a[228:231],v[184:187],v[112:115]
buffer_load_dwordx4 v236,s[28:31],s35 offen offset:0 lds
MF v[116:119],a[228:231],v[188:191],v[116:119]
s_waitcnt lgkmcnt(8)
MF v[120:123],a[232:235],v[180:183],v[120:123]
TR a[224:225],v224,12288
RD v[160:163],v245,2048
MF v[124:127],a[232:235],v[184:187],v[124:127]
TR a[226:227],v224,13824
RD v[164:167],v245,4096
MF v[128:131],a[232:235],v[188:191],v[128:131]
TR a[228:229],v225,12288
MF v[132:135],a[236:239],v[180:183],v[132:135]
TR a[230:231],v225,13824
MF v[136:139],a[236:239],v[184:187],v[136:139]
buffer_load_dwordx4 v237,s[28:31],s35 offen offset:1024 lds
MF v[140:143],a[236:239],v[188:191],v[140:143]
s_waitcnt lgkmcnt(7)
L_st12:
MF v[0:3],a[216:219],v[144:147],v[0:3]
TR a[232:233],v222,12416
MF v[4:7],a[216:219],v[148:151],v[4:7]
TR a[234:235],v222,13952
MF v[8:11],a[216:219],v[152:155],v[8:11]
TR a[236:237],v223,12416
MF v[12:15],a[220:223],v[144:147],v[12:15]
TR a[238:239],v223,13952
MF v[16:19],a[220:223],v[148:151],v[16:19]
buffer_load_dwordx4 v238,s[28:31],s35 offen offset:2048 lds
MF v[20:23],a[220:223],v[152:155],v[20:23]
s_waitcnt lgkmcnt(4)
MF v[24:27],a[224:227],v[144:147],v[24:27]
TR a[216:217],v224,12416
MF v[28:31],a[224:227],v[148:151],v[28:31]
TR a[218:219],v224,13952
MF v[32:35],a[224:227],v[152:155],v[32:35]
s_add_u32 m0,s32,98304
TR a[220:221],v225,12416
MF v[36:39],a[228:231],v[144:147],v[36:39]
s_add_u32 s36,s34,6291456
TR a[222:223],v225,13952
MF v[40:43],a[228:231],v[148:151],v[40:43]
buffer_load_dwordx4 v236,s[28:31],s36 offen offset:0 lds
MF v[44:47],a[228:231],v[152:155],v[44:47]
s_waitcnt lgkmcnt(4)
MF v[48:51],a[232:235],v[144:147],v[48:51]
TR a[224:225],v222,12544
MF v[52:55],a[232:235],v[148:151],v[52:55]
TR a[226:227],v222,14080
MF v[56:59],a[232:235],v[152:155],v[56:59]
TR a[228:229],v223,12544
MF v[60:63],a[236:239],v[144:147],v[60:63]
TR a[230:231],v223,14080
MF v[64:67],a[236:239],v[148:151],v[64:67]
buffer_load_dwordx4 v237,s[28:31],s36 offen offset:1024 lds
MF v[68:71],a[236:239],v[152:155],v[68:71]
s_waitcnt lgkmcnt(4)
MF v[72:75],a[216:219],v[144:147],v[72:75]
TR a[232:233],v224,12544
MF v[76:79],a[216:219],v[148:151],v[76:79]
TR a[234:235],v224,14080
MF v[80:83],a[216:219],v[152:155],v[80:83]
TR a[236:237],v225,12544
MF v[84:87],a[220:223],v[144:147],v[84:87]
TR a[238:239],v225,14080
MF v[88:91],a[220:223],v[148:151],v[88:91]
buffer_load_dwordx4 v238,s[28:31],s36 offen offset:2048 lds
MF v[92:95],a[220:223],v[152:155],v[92:95]
s_waitcnt vmcnt(15) lgkmcnt(4)
s_barrier
MF v[96:99],a[224:227],v[144:147],v[96:99]
TR a[216:217],v222,24576
MF v[100:103],a[224:227],v[148:151],v[100:103]
TR a[218:219],v222,26112
MF v[104:107],a[224:227],v[152:155],v[104:107]
s_add_u32 m0,s41,0
TR a[220:221],v223,24576
MF v[108:111],a[228:231],v[144:147],v[108:111]
s_add_u32 s35,s37,1024
TR a[222:223],v223,26112
MF v[112:115],a[228:231],v[148:151],v[112:115]
buffer_load_dwordx4 v233,s[4:7],s35 offen offset:0 lds
MF v[116:119],a[228:231],v[152:155],v[116:119]
s_waitcnt lgkmcnt(4)
MF v[120:123],a[232:235],v[144:147],v[120:123]
TR a[224:225],v224,24576
MF v[124:127],a[232:235],v[148:151],v[124:127]
TR a[226:227],v224,26112
MF v[128:131],a[232:235],v[152:155],v[128:131]
TR a[228:229],v225,24576
MF v[132:135],a[236:239],v[144:147],v[132:135]
TR a[230:231],v225,26112
MF v[136:139],a[236:239],v[148:151],v[136:139]
buffer_load_dwordx4 v234,s[4:7],s35 offen offset:1024 lds
MF v[140:143],a[236:239],v[152:155],v[140:143]
s_waitcnt lgkmcnt(4)
L_st13:
MF v[0:3],a[216:219],v[156:159],v[0:3]
TR a[232:233],v222,24704
MF v[4:7],a[216:219],v[160:163],v[4:7]
TR a[234:235],v222,26240
MF v[8:11],a[216:219],v[164:167],v[8:11]
TR a[236:237],v223,24704
MF v[12:15],a[220:223],v[156:159],v[12:15]
TR a[238:239],v223,26240
MF v[16:19],a[220:223],v[160:163],v[16:19]
buffer_load_dwordx4 v235,s[4:7],s35 offen offset:2048 lds
MF v[20:23],a[220:223],v[164:167],v[20:23]
s_waitcnt lgkmcnt(4)
MF v[24:27],a[224:227],v[156:159],v[24:27]
TR a[216:217],v224,24704
MF v[28:31],a[224:227],v[160:163],v[28:31]
TR a[218:219],v224,26240
MF v[32:35],a[224:227],v[164:167],v[32:35]
s_add_u32 m0,s41,3072
TR a[220:221],v225,24704
MF v[36:39],a[228:231],v[156:159],v[36:39]
s_add_u32 s36,s37,31744
TR a[222:223],v225,26240
MF v[40:43],a[228:231],v[160:163],v[40:43]
buffer_load_dwordx4 v233,s[4:7],s36 offen offset:0 lds
MF v[44:47],a[228:231],v[164:167],v[44:47]
s_waitcnt lgkmcnt(4)
MF v[48:51],a[232:235],v[156:159],v[48:51]
TR a[224:225],v222,24832
MF v[52:55],a[232:235],v[160:163],v[52:55]
TR a[226:227],v222,26368
MF v[56:59],a[232:235],v[164:167],v[56:59]
TR a[228:229],v223,24832
MF v[60:63],a[236:239],v[156:159],v[60:63]
TR a[230:231],v223,26368
MF v[64:67],a[236:239],v[160:163],v[64:67]
buffer_load_dwordx4 v234,s[4:7],s36 offen offset:1024 lds
MF v[68:71],a[236:239],v[164:167],v[68:71]
s_waitcnt lgkmcnt(4)
MF v[72:75],a[216:219],v[156:159],v[72:75]
TR a[232:233],v224,24832
v_add_u32 v222,98304,v222
MF v[76:79],a[216:219],v[160:163],v[76:79]
TR a[234:235],v224,26368
v_add_u32 v223,98304,v223
MF v[80:83],a[216:219],v[164:167],v[80:83]
TR a[236:237],v225,24832
MF v[84:87],a[220:223],v[156:159],v[84:87]
TR a[238:239],v225,26368
MF v[88:91],a[220:223],v[160:163],v[88:91]
buffer_load_dwordx4 v235,s[4:7],s36 offen offset:2048 lds
MF v[92:95],a[220:223],v[164:167],v[92:95]
s_waitcnt vmcnt(12) lgkmcnt(4)
s_barrier
MF v[96:99],a[224:227],v[156:159],v[96:99]
TR a[216:217],v222,0
RD v[168:171],v242,24576
MF v[100:103],a[224:227],v[160:163],v[100:103]
TR a[218:219],v222,1536
RD v[172:175],v242,26624
MF v[104:107],a[224:227],v[164:167],v[104:107]
s_add_u32 m0,s32,49152
TR a[220:221],v223,0
RD v[176:179],v242,28672
MF v[108:111],a[228:231],v[156:159],v[108:111]
s_add_u32 s35,s34,6684672
TR a[222:223],v223,1536
RD v[180:183],v245,24576
MF v[112:115],a[228:231],v[160:163],v[112:115]
buffer_load_dwordx4 v236,s[28:31],s35 offen offset:0 lds
MF v[116:119],a[228:231],v[164:167],v[116:119]
s_waitcnt lgkmcnt(8)
v_add_u32 v224,98304,v224
v_add_u32 v225,98304,v225
MF v[120:123],a[232:235],v[156:159],v[120:123]
TR a[224:225],v224,0
RD v[184:187],v245,26624
MF v[124:127],a[232:235],v[160:163],v[124:127]
TR a[226:227],v224,1536
RD v[188:191],v245,28672
MF v[128:131],a[232:235],v[164:167],v[128:131]
TR a[228:229],v225,0
MF v[132:135],a[236:239],v[156:159],v[132:135]
TR a[230:231],v225,1536
MF v[136:139],a[236:239],v[160:163],v[136:139]
buffer_load_dwordx4 v237,s[28:31],s35 offen offset:1024 lds
MF v[140:143],a[236:239],v[164:167],v[140:143]
s_waitcnt lgkmcnt(7)
L_st14:
MF v[0:3],a[216:219],v[168:171],v[0:3]
TR a[232:233],v222,128
MF v[4:7],a[216:219],v[172:175],v[4:7]
TR a[234:235],v222,1664
MF v[8:11],a[216:219],v[176:179],v[8:11]
TR a[236:237],v223,128
MF v[12:15],a[220:223],v[168:171],v[12:15]
TR a[238:239],v223,1664
MF v[16:19],a[220:223],v[172:175],v[16:19]
buffer_load_dwordx4 v238,s[28:31],s35 offen offset:2048 lds
MF v[20:23],a[220:223],v[176:179],v[20:23]
s_waitcnt lgkmcnt(4)
MF v[24:27],a[224:227],v[168:171],v[24:27]
TR a[216:217],v224,128
MF v[28:31],a[224:227],v[172:175],v[28:31]
TR a[218:219],v224,1664
MF v[32:35],a[224:227],v[176:179],v[32:35]
s_add_u32 m0,s32,61440
TR a[220:221],v225,128
MF v[36:39],a[228:231],v[168:171],v[36:39]
s_add_u32 s36,s34,7077888
TR a[222:223],v225,1664
MF v[40:43],a[228:231],v[172:175],v[40:43]
buffer_load_dwordx4 v236,s[28:31],s36 offen offset:0 lds
MF v[44:47],a[228:231],v[176:179],v[44:47]
s_waitcnt lgkmcnt(4)
MF v[48:51],a[232:235],v[168:171],v[48:51]
TR a[224:225],v222,256
MF v[52:55],a[232:235],v[172:175],v[52:55]
TR a[226:227],v222,1792
MF v[56:59],a[232:235],v[176:179],v[56:59]
TR a[228:229],v223,256
MF v[60:63],a[236:239],v[168:171],v[60:63]
TR a[230:231],v223,1792
MF v[64:67],a[236:239],v[172:175],v[64:67]
buffer_load_dwordx4 v237,s[28:31],s36 offen offset:1024 lds
MF v[68:71],a[236:239],v[176:179],v[68:71]
s_waitcnt lgkmcnt(4)
MF v[72:75],a[216:219],v[168:171],v[72:75]
TR a[232:233],v224,256
v_subrev_u32 v222,98304,v222
MF v[76:79],a[216:219],v[172:175],v[76:79]
TR a[234:235],v224,1792
v_subrev_u32 v223,98304,v223
MF v[80:83],a[216:219],v[176:179],v[80:83]
TR a[236:237],v225,256
MF v[84:87],a[220:223],v[168:171],v[84:87]
TR a[238:239],v225,1792
MF v[88:91],a[220:223],v[172:175],v[88:91]
buffer_load_dwordx4 v238,s[28:31],s36 offen offset:2048 lds
MF v[92:95],a[220:223],v[176:179],v[92:95]
s_waitcnt vmcnt(15) lgkmcnt(4)
s_barrier
MF v[96:99],a[224:227],v[168:171],v[96:99]
TR a[216:217],v222,36864
v_subrev_u32 v224,98304,v224
MF v[100:103],a[224:227],v[172:175],v[100:103]
TR a[218:219],v222,38400
v_subrev_u32 v225,98304,v225
MF v[104:107],a[224:227],v[176:179],v[104:107]
s_add_u32 m0,s41,24576
TR a[220:221],v223,36864
MF v[108:111],a[228:231],v[168:171],v[108:111]
s_add_u32 s35,s37,1152
TR a[222:223],v223,38400
MF v[112:115],a[228:231],v[172:175],v[112:115]
buffer_load_dwordx4 v233,s[4:7],s35 offen offset:0 lds
MF v[116:119],a[228:231],v[176:179],v[116:119]
s_waitcnt lgkmcnt(4)
MF v[120:123],a[232:235],v[168:171],v[120:123]
TR a[224:225],v224,36864
MF v[124:127],a[232:235],v[172:175],v[124:127]
TR a[226:227],v224,38400
MF v[128:131],a[232:235],v[176:179],v[128:131]
TR a[228:229],v225,36864
MF v[132:135],a[236:239],v[168:171],v[132:135]
TR a[230:231],v225,38400
MF v[136:139],a[236:239],v[172:175],v[136:139]
buffer_load_dwordx4 v234,s[4:7],s35 offen offset:1024 lds
MF v[140:143],a[236:239],v[176:179],v[140:143]
s_waitcnt lgkmcnt(4)
L_st15:
MF v[0:3],a[216:219],v[180:183],v[0:3]
TR a[232:233],v222,36992
MF v[4:7],a[216:219],v[184:187],v[4:7]
TR a[234:235],v222,38528
MF v[8:11],a[216:219],v[188:191],v[8:11]
TR a[236:237],v223,36992
MF v[12:15],a[220:223],v[180:183],v[12:15]
TR a[238:239],v223,38528
MF v[16:19],a[220:223],v[184:187],v[16:19]
buffer_load_dwordx4 v235,s[4:7],s35 offen offset:2048 lds
MF v[20:23],a[220:223],v[188:191],v[20:23]
s_waitcnt lgkmcnt(4)
MF v[24:27],a[224:227],v[180:183],v[24:27]
TR a[216:217],v224,36992
MF v[28:31],a[224:227],v[184:187],v[28:31]
TR a[218:219],v224,38528
MF v[32:35],a[224:227],v[188:191],v[32:35]
s_add_u32 m0,s41,27648
TR a[220:221],v225,36992
MF v[36:39],a[228:231],v[180:183],v[36:39]
s_add_u32 s36,s37,31872
TR a[222:223],v225,38528
MF v[40:43],a[228:231],v[184:187],v[40:43]
buffer_load_dwordx4 v233,s[4:7],s36 offen offset:0 lds
MF v[44:47],a[228:231],v[188:191],v[44:47]
s_waitcnt lgkmcnt(4)
MF v[48:51],a[232:235],v[180:183],v[48:51]
TR a[224:225],v222,37120
MF v[52:55],a[232:235],v[184:187],v[52:55]
TR a[226:227],v222,38656
MF v[56:59],a[232:235],v[188:191],v[56:59]
TR a[228:229],v223,37120
MF v[60:63],a[236:239],v[180:183],v[60:63]
TR a[230:231],v223,38656
MF v[64:67],a[236:239],v[184:187],v[64:67]
buffer_load_dwordx4 v234,s[4:7],s36 offen offset:1024 lds
MF v[68:71],a[236:239],v[188:191],v[68:71]
s_waitcnt lgkmcnt(4)
MF v[72:75],a[216:219],v[180:183],v[72:75]
TR a[232:233],v224,37120
MF v[76:79],a[216:219],v[184:187],v[76:79]
TR a[234:235],v224,38656
MF v[80:83],a[216:219],v[188:191],v[80:83]
TR a[236:237],v225,37120
MF v[84:87],a[220:223],v[180:183],v[84:87]
TR a[238:239],v225,38656
MF v[88:91],a[220:223],v[184:187],v[88:91]
buffer_load_dwordx4 v235,s[4:7],s36 offen offset:2048 lds
MF v[92:95],a[220:223],v[188:191],v[92:95]
s_waitcnt vmcnt(12) lgkmcnt(4)
s_barrier
MF v[96:99],a[224:227],v[180:183],v[96:99]
TR a[216:217],v222,49152
RD v[144:147],v242,0
MF v[100:103],a[224:227],v[184:187],v[100:103]
TR a[218:219],v222,50688
RD v[148:151],v242,2048
MF v[104:107],a[224:227],v[188:191],v[104:107]
s_add_u32 m0,s32,73728
TR a[220:221],v223,49152
RD v[152:155],v242,4096
MF v[108:111],a[228:231],v[180:183],v[108:111]
s_add_u32 s35,s34,7471104
TR a[222:223],v223,50688
RD v[156:159],v245,0
MF v[112:115],a[228:231],v[184:187],v[112:115]
buffer_load_dwordx4 v236,s[28:31],s35 offen offset:0 lds
MF v[116:119],a[228:231],v[188:191],v[116:119]
s_waitcnt lgkmcnt(8)
MF v[120:123],a[232:235],v[180:183],v[120:123]
TR a[224:225],v224,49152
RD v[160:163],v245,2048
MF v[124:127],a[232:235],v[184:187],v[124:127]
TR a[226:227],v224,50688
RD v[164:167],v245,4096
MF v[128:131],a[232:235],v[188:191],v[128:131]
TR a[228:229],v225,49152
MF v[132:135],a[236:239],v[180:183],v[132:135]
TR a[230:231],v225,50688
MF v[136:139],a[236:239],v[184:187],v[136:139]
buffer_load_dwordx4 v237,s[28:31],s35 offen offset:1024 lds
MF v[140:143],a[236:239],v[188:191],v[140:143]
s_waitcnt lgkmcnt(7)
L_st16:
MF v[0:3],a[216:219],v[144:147],v[0:3]
TR a[232:233],v222,49280
MF v[4:7],a[216:219],v[148:151],v[4:7]
TR a[234:235],v222,50816
MF v[8:11],a[216:219],v[152:155],v[8:11]
TR a[236:237],v223,49280
MF v[12:15],a[220:223],v[144:147],v[12:15]
TR a[238:239],v223,50816
MF v[16:19],a[220:223],v[148:151],v[16:19]
buffer_load_dwordx4 v238,s[28:31],s35 offen offset:2048 lds
MF v[20:23],a[220:223],v[152:155],v[20:23]
s_waitcnt lgkmcnt(4)
MF v[24:27],a[224:227],v[144:147],v[24:27]
TR a[216:217],v224,49280
MF v[28:31],a[224:227],v[148:151],v[28:31]
TR a[218:219],v224,50816
MF v[32:35],a[224:227],v[152:155],v[32:35]
s_add_u32 m0,s32,147456
TR a[220:221],v225,49280
MF v[36:39],a[228:231],v[144:147],v[36:39]
s_add_u32 s36,s33,24576
TR a[222:223],v225,50816
MF v[40:43],a[228:231],v[148:151],v[40:43]
buffer_load_dwordx4 v230,s[8:11],s36 offen offset:0 nt lds
MF v[44:47],a[228:231],v[152:155],v[44:47]
s_waitcnt lgkmcnt(4)
MF v[48:51],a[232:235],v[144:147],v[48:51]
TR a[224:225],v222,49408
MF v[52:55],a[232:235],v[148:151],v[52:55]
TR a[226:227],v222,50944
MF v[56:59],a[232:235],v[152:155],v[56:59]
TR a[228:229],v223,49408
MF v[60:63],a[236:239],v[144:147],v[60:63]
TR a[230:231],v223,50944
MF v[64:67],a[236:239],v[148:151],v[64:67]
buffer_load_dwordx4 v231,s[8:11],s36 offen offset:1024 nt lds
MF v[68:71],a[236:239],v[152:155],v[68:71]
s_waitcnt lgkmcnt(4)
MF v[72:75],a[216:219],v[144:147],v[72:75]
TR a[232:233],v224,49408
MF v[76:79],a[216:219],v[148:151],v[76:79]
TR a[234:235],v224,50944
MF v[80:83],a[216:219],v[152:155],v[80:83]
TR a[236:237],v225,49408
MF v[84:87],a[220:223],v[144:147],v[84:87]
TR a[238:239],v225,50944
MF v[88:91],a[220:223],v[148:151],v[88:91]
buffer_load_dwordx4 v232,s[8:11],s36 offen offset:2048 nt lds
MF v[92:95],a[220:223],v[152:155],v[92:95]
s_waitcnt vmcnt(15) lgkmcnt(4)
s_barrier
MF v[96:99],a[224:227],v[144:147],v[96:99]
TR a[216:217],v222,0
MF v[100:103],a[224:227],v[148:151],v[100:103]
TR a[218:219],v222,1536
MF v[104:107],a[224:227],v[152:155],v[104:107]
s_add_u32 m0,s32,0
TR a[220:221],v223,0
MF v[108:111],a[228:231],v[144:147],v[108:111]
s_add_u32 s35,s33,12288
TR a[222:223],v223,1536
MF v[112:115],a[228:231],v[148:151],v[112:115]
buffer_load_dwordx4 v230,s[12:15],s35 offen offset:0 nt lds
MF v[116:119],a[228:231],v[152:155],v[116:119]
s_waitcnt lgkmcnt(4)
MF v[120:123],a[232:235],v[144:147],v[120:123]
TR a[224:225],v224,0
MF v[124:127],a[232:235],v[148:151],v[124:127]
TR a[226:227],v224,1536
MF v[128:131],a[232:235],v[152:155],v[128:131]
TR a[228:229],v225,0
MF v[132:135],a[236:239],v[144:147],v[132:135]
TR a[230:231],v225,1536
MF v[136:139],a[236:239],v[148:151],v[136:139]
buffer_load_dwordx4 v231,s[12:15],s35 offen offset:1024 nt lds
MF v[140:143],a[236:239],v[152:155],v[140:143]
s_waitcnt lgkmcnt(4)
L_st17:
MF v[0:3],a[216:219],v[156:159],v[0:3]
TR a[232:233],v222,128
MF v[4:7],a[216:219],v[160:163],v[4:7]
TR a[234:235],v222,1664
MF v[8:11],a[216:219],v[164:167],v[8:11]
TR a[236:237],v223,128
MF v[12:15],a[220:223],v[156:159],v[12:15]
TR a[238:239],v223,1664
MF v[16:19],a[220:223],v[160:163],v[16:19]
buffer_load_dwordx4 v232,s[12:15],s35 offen offset:2048 nt lds
MF v[20:23],a[220:223],v[164:167],v[20:23]
s_waitcnt lgkmcnt(4)
MF v[24:27],a[224:227],v[156:159],v[24:27]
TR a[216:217],v224,128
MF v[28:31],a[224:227],v[160:163],v[28:31]
TR a[218:219],v224,1664
MF v[32:35],a[224:227],v[164:167],v[32:35]
s_add_u32 m0,s32,12288
TR a[220:221],v225,128
MF v[36:39],a[228:231],v[156:159],v[36:39]
s_add_u32 s36,s33,36864
TR a[222:223],v225,1664
MF v[40:43],a[228:231],v[160:163],v[40:43]
buffer_load_dwordx4 v230,s[8:11],s36 offen offset:0 nt lds
MF v[44:47],a[228:231],v[164:167],v[44:47]
s_waitcnt lgkmcnt(4)
MF v[48:51],a[232:235],v[156:159],v[48:51]
TR a[224:225],v222,256
MF v[52:55],a[232:235],v[160:163],v[52:55]
TR a[226:227],v222,1792
MF v[56:59],a[232:235],v[164:167],v[56:59]
TR a[228:229],v223,256
MF v[60:63],a[236:239],v[156:159],v[60:63]
TR a[230:231],v223,1792
MF v[64:67],a[236:239],v[160:163],v[64:67]
buffer_load_dwordx4 v231,s[8:11],s36 offen offset:1024 nt lds
MF v[68:71],a[236:239],v[164:167],v[68:71]
s_waitcnt lgkmcnt(4)
MF v[72:75],a[216:219],v[156:159],v[72:75]
TR a[232:233],v224,256
MF v[76:79],a[216:219],v[160:163],v[76:79]
TR a[234:235],v224,1792
MF v[80:83],a[216:219],v[164:167],v[80:83]
TR a[236:237],v225,256
MF v[84:87],a[220:223],v[156:159],v[84:87]
TR a[238:239],v225,1792
MF v[88:91],a[220:223],v[160:163],v[88:91]
buffer_load_dwordx4 v232,s[8:11],s36 offen offset:2048 nt lds
MF v[92:95],a[220:223],v[164:167],v[92:95]
s_waitcnt vmcnt(12) lgkmcnt(4)
s_barrier
MF v[96:99],a[224:227],v[156:159],v[96:99]
TR a[216:217],v222,12288
RD v[168:171],v242,24576
MF v[100:103],a[224:227],v[160:163],v[100:103]
TR a[218:219],v222,13824
RD v[172:175],v242,26624
MF v[104:107],a[224:227],v[164:167],v[104:107]
s_add_u32 m0,s32,86016
TR a[220:221],v223,12288
RD v[176:179],v242,28672
MF v[108:111],a[228:231],v[156:159],v[108:111]
s_add_u32 s35,s33,24576
TR a[222:223],v223,13824
RD v[180:183],v245,24576
MF v[112:115],a[228:231],v[160:163],v[112:115]
buffer_load_dwordx4 v230,s[12:15],s35 offen offset:0 nt lds
MF v[116:119],a[228:231],v[164:167],v[116:119]
s_waitcnt lgkmcnt(8)
MF v[120:123],a[232:235],v[156:159],v[120:123]
TR a[224:225],v224,12288
RD v[184:187],v245,26624
MF v[124:127],a[232:235],v[160:163],v[124:127]
TR a[226:227],v224,13824
RD v[188:191],v245,28672
MF v[128:131],a[232:235],v[164:167],v[128:131]
TR a[228:229],v225,12288
MF v[132:135],a[236:239],v[156:159],v[132:135]
TR a[230:231],v225,13824
MF v[136:139],a[236:239],v[160:163],v[136:139]
buffer_load_dwordx4 v231,s[12:15],s35 offen offset:1024 nt lds
MF v[140:143],a[236:239],v[164:167],v[140:143]
s_waitcnt lgkmcnt(7)
L_st18:
MF v[0:3],a[216:219],v[168:171],v[0:3]
TR a[232:233],v222,12416
MF v[4:7],a[216:219],v[172:175],v[4:7]
TR a[234:235],v222,13952
MF v[8:11],a[216:219],v[176:179],v[8:11]
TR a[236:237],v223,12416
MF v[12:15],a[220:223],v[168:171],v[12:15]
TR a[238:239],v223,13952
MF v[16:19],a[220:223],v[172:175],v[16:19]
buffer_load_dwordx4 v232,s[12:15],s35 offen offset:2048 nt lds
MF v[20:23],a[220:223],v[176:179],v[20:23]
s_waitcnt lgkmcnt(4)
MF v[24:27],a[224:227],v[168:171],v[24:27]
TR a[216:217],v224,12416
MF v[28:31],a[224:227],v[172:175],v[28:31]
TR a[218:219],v224,13952
MF v[32:35],a[224:227],v[176:179],v[32:35]
s_add_u32 m0,s32,98304
TR a[220:221],v225,12416
MF v[36:39],a[228:231],v[168:171],v[36:39]
s_add_u32 s36,s33,49152
TR a[222:223],v225,13952
MF v[40:43],a[228:231],v[172:175],v[40:43]
buffer_load_dwordx4 v230,s[8:11],s36 offen offset:0 nt lds
MF v[44:47],a[228:231],v[176:179],v[44:47]
s_waitcnt lgkmcnt(4)
MF v[48:51],a[232:235],v[168:171],v[48:51]
TR a[224:225],v222,12544
MF v[52:55],a[232:235],v[172:175],v[52:55]
TR a[226:227],v222,14080
MF v[56:59],a[232:235],v[176:179],v[56:59]
TR a[228:229],v223,12544
MF v[60:63],a[236:239],v[168:171],v[60:63]
TR a[230:231],v223,14080
MF v[64:67],a[236:239],v[172:175],v[64:67]
buffer_load_dwordx4 v231,s[8:11],s36 offen offset:1024 nt lds
MF v[68:71],a[236:239],v[176:179],v[68:71]
s_waitcnt lgkmcnt(4)
MF v[72:75],a[216:219],v[168:171],v[72:75]
TR a[232:233],v224,12544
MF v[76:79],a[216:219],v[172:175],v[76:79]
TR a[234:235],v224,14080
MF v[80:83],a[216:219],v[176:179],v[80:83]
TR a[236:237],v225,12544
MF v[84:87],a[220:223],v[168:171],v[84:87]
TR a[238:239],v225,14080
MF v[88:91],a[220:223],v[172:175],v[88:91]
buffer_load_dwordx4 v232,s[8:11],s36 offen offset:2048 nt lds
MF v[92:95],a[220:223],v[176:179],v[92:95]
s_waitcnt vmcnt(15) lgkmcnt(4)
s_barrier
MF v[96:99],a[224:227],v[168:171],v[96:99]
TR a[216:217],v222,24576
MF v[100:103],a[224:227],v[172:175],v[100:103]
TR a[218:219],v222,26112
MF v[104:107],a[224:227],v[176:179],v[104:107]
s_add_u32 m0,s32,24576
TR a[220:221],v223,24576
MF v[108:111],a[228:231],v[168:171],v[108:111]
s_add_u32 s35,s33,36864
TR a[222:223],v223,26112
MF v[112:115],a[228:231],v[172:175],v[112:115]
buffer_load_dwordx4 v230,s[12:15],s35 offen offset:0 nt lds
MF v[116:119],a[228:231],v[176:179],v[116:119]
s_waitcnt lgkmcnt(4)
MF v[120:123],a[232:235],v[168:171],v[120:123]
TR a[224:225],v224,24576
MF v[124:127],a[232:235],v[172:175],v[124:127]
TR a[226:227],v224,26112
MF v[128:131],a[232:235],v[176:179],v[128:131]
TR a[228:229],v225,24576
MF v[132:135],a[236:239],v[168:171],v[132:135]
TR a[230:231],v225,26112
MF v[136:139],a[236:239],v[172:175],v[136:139]
buffer_load_dwordx4 v231,s[12:15],s35 offen offset:1024 nt lds
MF v[140:143],a[236:239],v[176:179],v[140:143]
s_waitcnt lgkmcnt(4)
L_st19:
MF v[0:3],a[216:219],v[180:183],v[0:3]
TR a[232:233],v222,24704
MF v[4:7],a[216:219],v[184:187],v[4:7]
TR a[234:235],v222,26240
MF v[8:11],a[216:219],v[188:191],v[8:11]
TR a[236:237],v223,24704
v_add_u32 v216,110592,v216
MF v[12:15],a[220:223],v[180:183],v[12:15]
TR a[238:239],v223,26240
v_add_u32 v217,110592,v217
MF v[16:19],a[220:223],v[184:187],v[16:19]
buffer_load_dwordx4 v232,s[12:15],s35 offen offset:2048 nt lds
MF v[20:23],a[220:223],v[188:191],v[20:23]
s_waitcnt lgkmcnt(4)
MF v[24:27],a[224:227],v[180:183],v[24:27]
TR a[216:217],v224,24704
MF v[28:31],a[224:227],v[184:187],v[28:31]
TR a[218:219],v224,26240
MF v[32:35],a[224:227],v[188:191],v[32:35]
s_add_u32 m0,s32,36864
TR a[220:221],v225,24704
MF v[36:39],a[228:231],v[180:183],v[36:39]
s_add_u32 s36,s33,61440
TR a[222:223],v225,26240
MF v[40:43],a[228:231],v[184:187],v[40:43]
buffer_load_dwordx4 v230,s[8:11],s36 offen offset:0 nt lds
MF v[44:47],a[228:231],v[188:191],v[44:47]
s_waitcnt lgkmcnt(4)
MF v[48:51],a[232:235],v[180:183],v[48:51]
TR a[224:225],v222,24832
MF v[52:55],a[232:235],v[184:187],v[52:55]
TR a[226:227],v222,26368
MF v[56:59],a[232:235],v[188:191],v[56:59]
TR a[228:229],v223,24832
MF v[60:63],a[236:239],v[180:183],v[60:63]
TR a[230:231],v223,26368
MF v[64:67],a[236:239],v[184:187],v[64:67]
buffer_load_dwordx4 v231,s[8:11],s36 offen offset:1024 nt lds
MF v[68:71],a[236:239],v[188:191],v[68:71]
s_waitcnt lgkmcnt(4)
MF v[72:75],a[216:219],v[180:183],v[72:75]
TR a[232:233],v224,24832
MF v[76:79],a[216:219],v[184:187],v[76:79]
TR a[234:235],v224,26368
MF v[80:83],a[216:219],v[188:191],v[80:83]
TR a[236:237],v225,24832
MF v[84:87],a[220:223],v[180:183],v[84:87]
TR a[238:239],v225,26368
MF v[88:91],a[220:223],v[184:187],v[88:91]
buffer_load_dwordx4 v232,s[8:11],s36 offen offset:2048 nt lds
MF v[92:95],a[220:223],v[188:191],v[92:95]
s_waitcnt lgkmcnt(4)
s_barrier
MF v[96:99],a[224:227],v[180:183],v[96:99]
RD a[216:219],v216,0
MF v[100:103],a[224:227],v[184:187],v[100:103]
RD a[220:223],v217,0
MF v[104:107],a[224:227],v[188:191],v[104:107]
s_add_u32 m0,s32,49152
MF v[108:111],a[228:231],v[180:183],v[108:111]
s_add_u32 s35,s33,49152
MF v[112:115],a[228:231],v[184:187],v[112:115]
buffer_load_dwordx4 v230,s[12:15],s35 offen offset:0 nt lds
MF v[116:119],a[228:231],v[188:191],v[116:119]
s_waitcnt lgkmcnt(2)
MF v[120:123],a[232:235],v[180:183],v[120:123]
RD a[224:227],v216,128
MF v[124:127],a[232:235],v[184:187],v[124:127]
RD a[228:231],v217,128
MF v[128:131],a[232:235],v[188:191],v[128:131]
MF v[132:135],a[236:239],v[180:183],v[132:135]
MF v[136:139],a[236:239],v[184:187],v[136:139]
buffer_load_dwordx4 v231,s[12:15],s35 offen offset:1024 nt lds
MF v[140:143],a[236:239],v[188:191],v[140:143]
s_waitcnt lgkmcnt(2)
v_pk_mul_f32 v[0:1],v[0:1],s[48:49]
v_pk_mul_f32 v[2:3],v[2:3],s[48:49]
v_pk_mul_f32 v[12:13],v[12:13],s[48:49]
v_pk_mul_f32 v[14:15],v[14:15],s[48:49]
v_pk_mul_f32 v[4:5],v[4:5],s[48:49]
v_pk_mul_f32 v[6:7],v[6:7],s[48:49]
v_pk_mul_f32 v[16:17],v[16:17],s[48:49]
v_pk_mul_f32 v[18:19],v[18:19],s[48:49]
v_pk_mul_f32 v[8:9],v[8:9],s[48:49]
v_pk_mul_f32 v[10:11],v[10:11],s[48:49]
v_pk_mul_f32 v[20:21],v[20:21],s[48:49]
v_pk_mul_f32 v[22:23],v[22:23],s[48:49]
v_cvt_pk_bf16_f32 v144,v0,v1
v_cvt_pk_bf16_f32 v145,v2,v3
v_cvt_pk_bf16_f32 v146,v12,v13
v_cvt_pk_bf16_f32 v147,v14,v15
v_cvt_pk_bf16_f32 v148,v4,v5
v_cvt_pk_bf16_f32 v149,v6,v7
v_cvt_pk_bf16_f32 v150,v16,v17
v_cvt_pk_bf16_f32 v151,v18,v19
v_cvt_pk_bf16_f32 v152,v8,v9
v_cvt_pk_bf16_f32 v153,v10,v11
v_cvt_pk_bf16_f32 v154,v20,v21
v_cvt_pk_bf16_f32 v155,v22,v23
v_permlane32_swap_b32 v144,v146
v_permlane32_swap_b32 v145,v147
v_permlane32_swap_b32 v148,v150
v_permlane32_swap_b32 v149,v151
v_permlane32_swap_b32 v152,v154
v_permlane32_swap_b32 v153,v155
v_permlane16_swap_b32 v144,v146
v_permlane16_swap_b32 v145,v147
v_permlane16_swap_b32 v148,v150
v_permlane16_swap_b32 v149,v151
v_permlane16_swap_b32 v152,v154
v_permlane16_swap_b32 v153,v155
v_pk_mul_f32 v[24:25],v[24:25],s[48:49]
v_pk_mul_f32 v[26:27],v[26:27],s[48:49]
v_pk_mul_f32 v[36:37],v[36:37],s[48:49]
v_pk_mul_f32 v[38:39],v[38:39],s[48:49]
v_pk_mul_f32 v[28:29],v[28:29],s[48:49]
v_pk_mul_f32 v[30:31],v[30:31],s[48:49]
v_pk_mul_f32 v[40:41],v[40:41],s[48:49]
v_pk_mul_f32 v[42:43],v[42:43],s[48:49]
v_pk_mul_f32 v[32:33],v[32:33],s[48:49]
v_pk_mul_f32 v[34:35],v[34:35],s[48:49]
v_pk_mul_f32 v[44:45],v[44:45],s[48:49]
v_pk_mul_f32 v[46:47],v[46:47],s[48:49]
v_cvt_pk_bf16_f32 v156,v24,v25
v_cvt_pk_bf16_f32 v157,v26,v27
v_cvt_pk_bf16_f32 v158,v36,v37
v_cvt_pk_bf16_f32 v159,v38,v39
v_cvt_pk_bf16_f32 v160,v28,v29
v_cvt_pk_bf16_f32 v161,v30,v31
v_cvt_pk_bf16_f32 v162,v40,v41
v_cvt_pk_bf16_f32 v163,v42,v43
v_cvt_pk_bf16_f32 v164,v32,v33
v_cvt_pk_bf16_f32 v165,v34,v35
v_cvt_pk_bf16_f32 v166,v44,v45
v_cvt_pk_bf16_f32 v167,v46,v47
v_permlane32_swap_b32 v156,v158
v_permlane32_swap_b32 v157,v159
v_permlane32_swap_b32 v160,v162
v_permlane32_swap_b32 v161,v163
v_permlane32_swap_b32 v164,v166
v_permlane32_swap_b32 v165,v167
v_permlane16_swap_b32 v156,v158
v_permlane16_swap_b32 v157,v159
v_permlane16_swap_b32 v160,v162
v_permlane16_swap_b32 v161,v163
v_permlane16_swap_b32 v164,v166
v_permlane16_swap_b32 v165,v167
v_pk_mul_f32 v[48:49],v[48:49],s[48:49]
v_pk_mul_f32 v[50:51],v[50:51],s[48:49]
v_pk_mul_f32 v[60:61],v[60:61],s[48:49]
v_pk_mul_f32 v[62:63],v[62:63],s[48:49]
v_pk_mul_f32 v[52:53],v[52:53],s[48:49]
v_pk_mul_f32 v[54:55],v[54:55],s[48:49]
v_pk_mul_f32 v[64:65],v[64:65],s[48:49]
v_pk_mul_f32 v[66:67],v[66:67],s[48:49]
v_pk_mul_f32 v[56:57],v[56:57],s[48:49]
v_pk_mul_f32 v[58:59],v[58:59],s[48:49]
v_pk_mul_f32 v[68:69],v[68:69],s[48:49]
v_pk_mul_f32 v[70:71],v[70:71],s[48:49]
v_cvt_pk_bf16_f32 v168,v48,v49
v_cvt_pk_bf16_f32 v169,v50,v51
v_cvt_pk_bf16_f32 v170,v60,v61
v_cvt_pk_bf16_f32 v171,v62,v63
v_cvt_pk_bf16_f32 v172,v52,v53
v_cvt_pk_bf16_f32 v173,v54,v55
v_cvt_pk_bf16_f32 v174,v64,v65
v_cvt_pk_bf16_f32 v175,v66,v67
v_cvt_pk_bf16_f32 v176,v56,v57
v_cvt_pk_bf16_f32 v177,v58,v59
v_cvt_pk_bf16_f32 v178,v68,v69
v_cvt_pk_bf16_f32 v179,v70,v71
v_permlane32_swap_b32 v168,v170
v_permlane32_swap_b32 v169,v171
v_permlane32_swap_b32 v172,v174
v_permlane32_swap_b32 v173,v175
v_permlane32_swap_b32 v176,v178
v_permlane32_swap_b32 v177,v179
v_permlane16_swap_b32 v168,v170
v_permlane16_swap_b32 v169,v171
v_permlane16_swap_b32 v172,v174
v_permlane16_swap_b32 v173,v175
v_permlane16_swap_b32 v176,v178
v_permlane16_swap_b32 v177,v179
v_pk_mul_f32 v[72:73],v[72:73],s[48:49]
v_pk_mul_f32 v[74:75],v[74:75],s[48:49]
v_pk_mul_f32 v[84:85],v[84:85],s[48:49]
v_pk_mul_f32 v[86:87],v[86:87],s[48:49]
v_pk_mul_f32 v[76:77],v[76:77],s[48:49]
v_pk_mul_f32 v[78:79],v[78:79],s[48:49]
v_pk_mul_f32 v[88:89],v[88:89],s[48:49]
v_pk_mul_f32 v[90:91],v[90:91],s[48:49]
v_pk_mul_f32 v[80:81],v[80:81],s[48:49]
v_pk_mul_f32 v[82:83],v[82:83],s[48:49]
v_pk_mul_f32 v[92:93],v[92:93],s[48:49]
v_pk_mul_f32 v[94:95],v[94:95],s[48:49]
v_cvt_pk_bf16_f32 v180,v72,v73
v_cvt_pk_bf16_f32 v181,v74,v75
v_cvt_pk_bf16_f32 v182,v84,v85
v_cvt_pk_bf16_f32 v183,v86,v87
v_cvt_pk_bf16_f32 v184,v76,v77
v_cvt_pk_bf16_f32 v185,v78,v79
v_cvt_pk_bf16_f32 v186,v88,v89
v_cvt_pk_bf16_f32 v187,v90,v91
v_cvt_pk_bf16_f32 v188,v80,v81
v_cvt_pk_bf16_f32 v189,v82,v83
v_cvt_pk_bf16_f32 v190,v92,v93
v_cvt_pk_bf16_f32 v191,v94,v95
v_permlane32_swap_b32 v180,v182
v_permlane32_swap_b32 v181,v183
v_permlane32_swap_b32 v184,v186
v_permlane32_swap_b32 v185,v187
v_permlane32_swap_b32 v188,v190
v_permlane32_swap_b32 v189,v191
v_permlane16_swap_b32 v180,v182
v_permlane16_swap_b32 v181,v183
v_permlane16_swap_b32 v184,v186
v_permlane16_swap_b32 v185,v187
v_permlane16_swap_b32 v188,v190
v_permlane16_swap_b32 v189,v191
v_pk_mul_f32 v[96:97],v[96:97],s[48:49]
v_pk_mul_f32 v[98:99],v[98:99],s[48:49]
v_pk_mul_f32 v[108:109],v[108:109],s[48:49]
v_pk_mul_f32 v[110:111],v[110:111],s[48:49]
v_pk_mul_f32 v[100:101],v[100:101],s[48:49]
v_pk_mul_f32 v[102:103],v[102:103],s[48:49]
v_pk_mul_f32 v[112:113],v[112:113],s[48:49]
v_pk_mul_f32 v[114:115],v[114:115],s[48:49]
v_pk_mul_f32 v[104:105],v[104:105],s[48:49]
v_pk_mul_f32 v[106:107],v[106:107],s[48:49]
v_pk_mul_f32 v[116:117],v[116:117],s[48:49]
v_pk_mul_f32 v[118:119],v[118:119],s[48:49]
v_cvt_pk_bf16_f32 v192,v96,v97
v_cvt_pk_bf16_f32 v193,v98,v99
v_cvt_pk_bf16_f32 v194,v108,v109
v_cvt_pk_bf16_f32 v195,v110,v111
v_cvt_pk_bf16_f32 v196,v100,v101
v_cvt_pk_bf16_f32 v197,v102,v103
v_cvt_pk_bf16_f32 v198,v112,v113
v_cvt_pk_bf16_f32 v199,v114,v115
v_cvt_pk_bf16_f32 v200,v104,v105
v_cvt_pk_bf16_f32 v201,v106,v107
v_cvt_pk_bf16_f32 v202,v116,v117
v_cvt_pk_bf16_f32 v203,v118,v119
v_permlane32_swap_b32 v192,v194
v_permlane32_swap_b32 v193,v195
v_permlane32_swap_b32 v196,v198
v_permlane32_swap_b32 v197,v199
v_permlane32_swap_b32 v200,v202
v_permlane32_swap_b32 v201,v203
v_permlane16_swap_b32 v192,v194
v_permlane16_swap_b32 v193,v195
v_permlane16_swap_b32 v196,v198
v_permlane16_swap_b32 v197,v199
v_permlane16_swap_b32 v200,v202
v_permlane16_swap_b32 v201,v203
v_pk_mul_f32 v[120:121],v[120:121],s[48:49]
v_pk_mul_f32 v[122:123],v[122:123],s[48:49]
v_pk_mul_f32 v[132:133],v[132:133],s[48:49]
v_pk_mul_f32 v[134:135],v[134:135],s[48:49]
v_pk_mul_f32 v[124:125],v[124:125],s[48:49]
v_pk_mul_f32 v[126:127],v[126:127],s[48:49]
v_pk_mul_f32 v[136:137],v[136:137],s[48:49]
v_pk_mul_f32 v[138:139],v[138:139],s[48:49]
v_pk_mul_f32 v[128:129],v[128:129],s[48:49]
v_pk_mul_f32 v[130:131],v[130:131],s[48:49]
v_pk_mul_f32 v[140:141],v[140:141],s[48:49]
v_pk_mul_f32 v[142:143],v[142:143],s[48:49]
v_cvt_pk_bf16_f32 v204,v120,v121
v_cvt_pk_bf16_f32 v205,v122,v123
v_cvt_pk_bf16_f32 v206,v132,v133
v_cvt_pk_bf16_f32 v207,v134,v135
v_cvt_pk_bf16_f32 v208,v124,v125
v_cvt_pk_bf16_f32 v209,v126,v127
v_cvt_pk_bf16_f32 v210,v136,v137
v_cvt_pk_bf16_f32 v211,v138,v139
v_cvt_pk_bf16_f32 v212,v128,v129
v_cvt_pk_bf16_f32 v213,v130,v131
v_cvt_pk_bf16_f32 v214,v140,v141
v_cvt_pk_bf16_f32 v215,v142,v143
v_permlane32_swap_b32 v204,v206
v_permlane32_swap_b32 v205,v207
v_permlane32_swap_b32 v208,v210
v_permlane32_swap_b32 v209,v211
v_permlane32_swap_b32 v212,v214
v_permlane32_swap_b32 v213,v215
v_permlane16_swap_b32 v204,v206
v_permlane16_swap_b32 v205,v207
v_permlane16_swap_b32 v208,v210
v_permlane16_swap_b32 v209,v211
v_permlane16_swap_b32 v212,v214
v_permlane16_swap_b32 v213,v215
L_st20:
MF v[0:3],a[216:219],v[144:147],0
RD a[232:235],v216,256
MF v[4:7],a[216:219],v[148:151],0
RD a[236:239],v217,256
MF v[8:11],a[216:219],v[152:155],0
MF v[0:3],a[220:223],v[156:159],v[0:3]
MF v[4:7],a[220:223],v[160:163],v[4:7]
buffer_load_dwordx4 v232,s[12:15],s35 offen offset:2048 nt lds
MF v[8:11],a[220:223],v[164:167],v[8:11]
s_waitcnt lgkmcnt(2)
MF v[0:3],a[224:227],v[168:171],v[0:3]
RD a[216:219],v216,6144
MF v[4:7],a[224:227],v[172:175],v[4:7]
RD a[220:223],v217,6144
MF v[8:11],a[224:227],v[176:179],v[8:11]
s_add_u32 m0,s32,61440
MF v[0:3],a[228:231],v[180:183],v[0:3]
s_add_u32 s36,s33,73728
MF v[4:7],a[228:231],v[184:187],v[4:7]
buffer_load_dwordx4 v230,s[8:11],s36 offen offset:0 nt lds
MF v[8:11],a[228:231],v[188:191],v[8:11]
s_waitcnt lgkmcnt(2)
MF v[0:3],a[232:235],v[192:195],v[0:3]
RD a[224:227],v216,6272
MF v[4:7],a[232:235],v[196:199],v[4:7]
RD a[228:231],v217,6272
MF v[8:11],a[232:235],v[200:203],v[8:11]
MF v[0:3],a[236:239],v[204:207],v[0:3]
MF v[4:7],a[236:239],v[208:211],v[4:7]
buffer_load_dwordx4 v231,s[8:11],s36 offen offset:1024 nt lds
MF v[8:11],a[236:239],v[212:215],v[8:11]
s_waitcnt lgkmcnt(2)
MF v[12:15],a[216:219],v[144:147],0
RD a[232:235],v216,6400
MF v[16:19],a[216:219],v[148:151],0
RD a[236:239],v217,6400
MF v[20:23],a[216:219],v[152:155],0
MF v[12:15],a[220:223],v[156:159],v[12:15]
MF v[16:19],a[220:223],v[160:163],v[16:19]
buffer_load_dwordx4 v232,s[8:11],s36 offen offset:2048 nt lds
MF v[20:23],a[220:223],v[164:167],v[20:23]
s_waitcnt lgkmcnt(2)
s_barrier
MF v[12:15],a[224:227],v[168:171],v[12:15]
RD a[216:219],v216,12288
MF v[16:19],a[224:227],v[172:175],v[16:19]
RD a[220:223],v217,12288
MF v[20:23],a[224:227],v[176:179],v[20:23]
s_add_u32 m0,s32,73728
MF v[12:15],a[228:231],v[180:183],v[12:15]
s_add_u32 s35,s33,61440
MF v[16:19],a[228:231],v[184:187],v[16:19]
buffer_load_dwordx4 v230,s[12:15],s35 offen offset:0 nt lds
MF v[20:23],a[228:231],v[188:191],v[20:23]
s_waitcnt lgkmcnt(2)
MF v[12:15],a[232:235],v[192:195],v[12:15]
RD a[224:227],v216,12416
MF v[16:19],a[232:235],v[196:199],v[16:19]
RD a[228:231],v217,12416
MF v[20:23],a[232:235],v[200:203],v[20:23]
MF v[12:15],a[236:239],v[204:207],v[12:15]
MF v[16:19],a[236:239],v[208:211],v[16:19]
MF v[20:23],a[236:239],v[212:215],v[20:23]
s_waitcnt lgkmcnt(2)
L_st21:
MF v[24:27],a[216:219],v[144:147],0
RD a[232:235],v216,12544
v_max3_f32 v98,v0,v1,v2
MF v[28:31],a[216:219],v[148:151],0
RD a[236:239],v217,12544
v_max3_f32 v98,v98,v3,v12
MF v[32:35],a[216:219],v[152:155],0
v_max3_f32 v98,v98,v13,v14
v_max_f32 v98,v98,v15
MF v[24:27],a[220:223],v[156:159],v[24:27]
v_max3_f32 v99,v4,v5,v6
v_max3_f32 v99,v99,v7,v16
MF v[28:31],a[220:223],v[160:163],v[28:31]
buffer_load_dwordx4 v231,s[12:15],s35 offen offset:1024 nt lds
MF v[32:35],a[220:223],v[164:167],v[32:35]
s_waitcnt lgkmcnt(2)
v_max3_f32 v99,v99,v17,v18
v_max_f32 v99,v99,v19
MF v[24:27],a[224:227],v[168:171],v[24:27]
RD a[216:219],v216,18432
v_add_u32 v218,135168,v218
MF v[28:31],a[224:227],v[172:175],v[28:31]
RD a[220:223],v217,18432
v_add_u32 v219,135168,v219
MF v[32:35],a[224:227],v[176:179],v[32:35]
v_max3_f32 v100,v8,v9,v10
v_max3_f32 v100,v100,v11,v20
MF v[24:27],a[228:231],v[180:183],v[24:27]
v_max3_f32 v100,v100,v21,v22
v_max_f32 v100,v100,v23
MF v[28:31],a[228:231],v[184:187],v[28:31]
v_mov_b32 v101,v98
v_mov_b32 v102,v99
MF v[32:35],a[228:231],v[188:191],v[32:35]
s_waitcnt lgkmcnt(2)
v_mov_b32 v103,v100
MF v[24:27],a[232:235],v[192:195],v[24:27]
RD a[224:227],v216,18560
v_add_u32 v220,135168,v220
MF v[28:31],a[232:235],v[196:199],v[28:31]
RD a[228:231],v217,18560
v_add_u32 v221,135168,v221
MF v[32:35],a[232:235],v[200:203],v[32:35]
v_permlane32_swap_b32 v98,v101
v_permlane32_swap_b32 v99,v102
MF v[24:27],a[236:239],v[204:207],v[24:27]
v_permlane32_swap_b32 v100,v103
v_max_f32 v98,v98,v101
MF v[28:31],a[236:239],v[208:211],v[28:31]
buffer_load_dwordx4 v232,s[12:15],s35 offen offset:2048 nt lds
MF v[32:35],a[236:239],v[212:215],v[32:35]
s_waitcnt lgkmcnt(2)
v_max_f32 v99,v99,v102
v_max_f32 v100,v100,v103
MF v[36:39],a[216:219],v[144:147],0
RD a[232:235],v216,18688
v_mov_b32 v101,v98
MF v[40:43],a[216:219],v[148:151],0
RD a[236:239],v217,18688
v_mov_b32 v102,v99
MF v[44:47],a[216:219],v[152:155],0
v_mov_b32 v103,v100
v_permlane16_swap_b32 v98,v101
MF v[36:39],a[220:223],v[156:159],v[36:39]
v_permlane16_swap_b32 v99,v102
v_max_f32 v98,v98,v101
MF v[40:43],a[220:223],v[160:163],v[40:43]
v_permlane16_swap_b32 v100,v103
v_max_f32 v99,v99,v102
MF v[44:47],a[220:223],v[164:167],v[44:47]
s_waitcnt lgkmcnt(2)
s_barrier
v_max_f32 v100,v100,v103
MF v[36:39],a[224:227],v[168:171],v[36:39]
TR a[216:217],v218,0
TR a[218:219],v218,6144
MF v[40:43],a[224:227],v[172:175],v[40:43]
TR a[220:221],v219,0
TR a[222:223],v219,6144
MF v[44:47],a[224:227],v[176:179],v[44:47]
s_add_u32 m0,s32,110592
v_xor_b32 v80,2147483648,v98
v_mov_b32 v81,v80
MF v[36:39],a[228:231],v[180:183],v[36:39]
s_add_u32 s36,s33,86016
v_mov_b32 v82,v80
v_mov_b32 v83,v80
MF v[40:43],a[228:231],v[184:187],v[40:43]
buffer_load_dwordx4 v230,s[8:11],s36 offen offset:0 nt lds
MF v[44:47],a[228:231],v[188:191],v[44:47]
s_waitcnt lgkmcnt(4)
v_xor_b32 v84,2147483648,v99
v_mov_b32 v85,v84
MF v[36:39],a[232:235],v[192:195],v[36:39]
TR a[224:225],v220,0
TR a[226:227],v220,6144
MF v[40:43],a[232:235],v[196:199],v[40:43]
TR a[228:229],v221,0
TR a[230:231],v221,6144
MF v[44:47],a[232:235],v[200:203],v[44:47]
v_mov_b32 v86,v84
v_mov_b32 v87,v84
MF v[36:39],a[236:239],v[204:207],v[36:39]
v_xor_b32 v88,2147483648,v100
v_mov_b32 v89,v88
MF v[40:43],a[236:239],v[208:211],v[40:43]
v_mov_b32 v90,v88
v_mov_b32 v91,v88
MF v[44:47],a[236:239],v[212:215],v[44:47]
s_waitcnt lgkmcnt(4)
v_add_f32 v0,v0,v80
v_add_f32 v1,v1,v80
v_add_f32 v2,v2,v80
v_add_f32 v3,v3,v80
v_exp_f32 v72,v0
v_exp_f32 v73,v1
s_nop 0
v_add_f32 v95,v72,v73
v_cvt_pk_bf16_f32 v48,v72,v73
v_exp_f32 v74,v2
v_exp_f32 v75,v3
v_add_f32 v95,v95,v74
v_add_f32 v95,v95,v75
v_cvt_pk_bf16_f32 v49,v74,v75
v_add_f32 v4,v4,v84
v_add_f32 v5,v5,v84
v_add_f32 v6,v6,v84
v_add_f32 v7,v7,v84
v_exp_f32 v76,v4
v_exp_f32 v77,v5
s_nop 0
v_add_f32 v96,v76,v77
v_cvt_pk_bf16_f32 v52,v76,v77
v_exp_f32 v78,v6
v_exp_f32 v79,v7
v_add_f32 v96,v96,v78
v_add_f32 v96,v96,v79
v_cvt_pk_bf16_f32 v53,v78,v79
v_add_f32 v8,v8,v88
v_add_f32 v9,v9,v88
v_add_f32 v10,v10,v88
v_add_f32 v11,v11,v88
v_exp_f32 v120,v8
v_exp_f32 v121,v9
s_nop 0
v_add_f32 v97,v120,v121
v_cvt_pk_bf16_f32 v56,v120,v121
v_exp_f32 v122,v10
v_exp_f32 v123,v11
v_add_f32 v97,v97,v122
v_add_f32 v97,v97,v123
v_cvt_pk_bf16_f32 v57,v122,v123
v_add_f32 v12,v12,v80
v_add_f32 v13,v13,v80
v_add_f32 v14,v14,v80
v_add_f32 v15,v15,v80
v_exp_f32 v124,v12
v_exp_f32 v125,v13
v_add_f32 v95,v95,v124
v_add_f32 v95,v95,v125
v_cvt_pk_bf16_f32 v50,v124,v125
v_exp_f32 v126,v14
v_exp_f32 v127,v15
v_add_f32 v95,v95,v126
v_add_f32 v95,v95,v127
v_cvt_pk_bf16_f32 v51,v126,v127
v_add_f32 v16,v16,v84
v_add_f32 v17,v17,v84
v_add_f32 v18,v18,v84
v_add_f32 v19,v19,v84
v_exp_f32 v72,v16
v_exp_f32 v73,v17
v_add_f32 v96,v96,v72
v_add_f32 v96,v96,v73
v_cvt_pk_bf16_f32 v54,v72,v73
v_exp_f32 v74,v18
v_exp_f32 v75,v19
v_add_f32 v96,v96,v74
v_add_f32 v96,v96,v75
v_cvt_pk_bf16_f32 v55,v74,v75
v_add_f32 v20,v20,v88
v_add_f32 v21,v21,v88
v_add_f32 v22,v22,v88
v_add_f32 v23,v23,v88
v_exp_f32 v76,v20
v_exp_f32 v77,v21
v_add_f32 v97,v97,v76
v_add_f32 v97,v97,v77
v_cvt_pk_bf16_f32 v58,v76,v77
v_exp_f32 v78,v22
v_exp_f32 v79,v23
v_add_f32 v97,v97,v78
v_add_f32 v97,v97,v79
v_cvt_pk_bf16_f32 v59,v78,v79
v_mov_b32 v92,v95
v_mov_b32 v93,v96
v_mov_b32 v94,v97
L_st22:
MF a[0:3],a[216:219],v[48:51],0
TR a[232:233],v218,128
TR a[234:235],v218,6272
MF a[4:7],a[216:219],v[52:55],0
TR a[236:237],v219,128
TR a[238:239],v219,6272
MF a[8:11],a[216:219],v[56:59],0
v_add_f32 v24,v24,v80
v_add_f32 v25,v25,v80
MF a[12:15],a[220:223],v[48:51],0
v_exp_f32 v72,v24
MF a[16:19],a[220:223],v[52:55],0
buffer_load_dwordx4 v231,s[8:11],s36 offen offset:1024 nt lds
MF a[20:23],a[220:223],v[56:59],0
s_waitcnt lgkmcnt(4)
v_exp_f32 v73,v25
MF a[24:27],a[224:227],v[48:51],0
TR a[216:217],v220,128
TR a[218:219],v220,6272
MF a[28:31],a[224:227],v[52:55],0
TR a[220:221],v221,128
TR a[222:223],v221,6272
MF a[32:35],a[224:227],v[56:59],0
v_add_f32 v26,v26,v80
v_add_f32 v27,v27,v80
MF a[36:39],a[228:231],v[48:51],0
v_exp_f32 v74,v26
MF a[40:43],a[228:231],v[52:55],0
v_exp_f32 v75,v27
MF a[44:47],a[228:231],v[56:59],0
s_waitcnt lgkmcnt(4)
v_add_f32 v95,v72,v73
v_cvt_pk_bf16_f32 v60,v72,v73
MF a[48:51],a[232:235],v[48:51],0
TR a[224:225],v218,256
TR a[226:227],v218,6400
MF a[52:55],a[232:235],v[52:55],0
TR a[228:229],v219,256
TR a[230:231],v219,6400
MF a[56:59],a[232:235],v[56:59],0
v_add_f32 v95,v95,v74
v_add_f32 v95,v95,v75
MF a[60:63],a[236:239],v[48:51],0
v_cvt_pk_bf16_f32 v61,v74,v75
v_add_f32 v28,v28,v84
MF a[64:67],a[236:239],v[52:55],0
buffer_load_dwordx4 v232,s[8:11],s36 offen offset:2048 nt lds
MF a[68:71],a[236:239],v[56:59],0
s_waitcnt lgkmcnt(4)
v_exp_f32 v76,v28
MF a[72:75],a[216:219],v[48:51],0
TR a[232:233],v220,256
TR a[234:235],v220,6400
MF a[76:79],a[216:219],v[52:55],0
TR a[236:237],v221,256
TR a[238:239],v221,6400
MF a[80:83],a[216:219],v[56:59],0
v_add_f32 v29,v29,v84
v_add_f32 v30,v30,v84
MF a[84:87],a[220:223],v[48:51],0
v_exp_f32 v77,v29
MF a[88:91],a[220:223],v[52:55],0
v_exp_f32 v78,v30
MF a[92:95],a[220:223],v[56:59],0
s_waitcnt vmcnt(30) lgkmcnt(4)
s_barrier
v_add_f32 v31,v31,v84
MF a[96:99],a[224:227],v[48:51],0
RD a[216:219],v216,36864
v_add_f32 v96,v76,v77
MF a[100:103],a[224:227],v[52:55],0
RD a[220:223],v217,36864
v_cvt_pk_bf16_f32 v64,v76,v77
MF a[104:107],a[224:227],v[56:59],0
s_add_u32 m0,s32,122880
v_exp_f32 v79,v31
MF a[108:111],a[228:231],v[48:51],0
s_add_u32 s35,s33,73728
v_add_f32 v96,v96,v78
v_add_f32 v96,v96,v79
MF a[112:115],a[228:231],v[52:55],0
buffer_load_dwordx4 v230,s[12:15],s35 offen offset:0 nt lds
MF a[116:119],a[228:231],v[56:59],0
s_waitcnt lgkmcnt(2)
v_cvt_pk_bf16_f32 v65,v78,v79
v_add_f32 v32,v32,v88
MF a[120:123],a[232:235],v[48:51],0
RD a[224:227],v216,36992
v_add_f32 v33,v33,v88
MF a[124:127],a[232:235],v[52:55],0
RD a[228:231],v217,36992
v_add_f32 v34,v34,v88
MF a[128:131],a[232:235],v[56:59],0
v_exp_f32 v120,v32
MF a[132:135],a[236:239],v[48:51],0
v_exp_f32 v121,v33
MF a[136:139],a[236:239],v[52:55],0
v_exp_f32 v122,v34
MF a[140:143],a[236:239],v[56:59],0
s_waitcnt lgkmcnt(2)
v_add_f32 v35,v35,v88
v_add_f32 v97,v120,v121
L_st23:
MF v[0:3],a[216:219],v[144:147],v[80:83]
RD a[232:235],v216,37120
v_cvt_pk_bf16_f32 v68,v120,v121
MF v[4:7],a[216:219],v[148:151],v[84:87]
RD a[236:239],v217,37120
v_add_f32 v97,v97,v122
MF v[8:11],a[216:219],v[152:155],v[88:91]
v_exp_f32 v123,v35
MF v[0:3],a[220:223],v[156:159],v[0:3]
v_add_f32 v97,v97,v123
v_cvt_pk_bf16_f32 v69,v122,v123
MF v[4:7],a[220:223],v[160:163],v[4:7]
buffer_load_dwordx4 v231,s[12:15],s35 offen offset:1024 nt lds
MF v[8:11],a[220:223],v[164:167],v[8:11]
s_waitcnt lgkmcnt(2)
v_add_f32 v36,v36,v80
v_add_f32 v37,v37,v80
MF v[0:3],a[224:227],v[168:171],v[0:3]
RD a[216:219],v216,43008
v_subrev_u32 v218,135168,v218
MF v[4:7],a[224:227],v[172:175],v[4:7]
RD a[220:223],v217,43008
v_subrev_u32 v219,135168,v219
MF v[8:11],a[224:227],v[176:179],v[8:11]
v_exp_f32 v124,v36
MF v[0:3],a[228:231],v[180:183],v[0:3]
v_exp_f32 v125,v37
MF v[4:7],a[228:231],v[184:187],v[4:7]
v_add_f32 v38,v38,v80
v_add_f32 v39,v39,v80
MF v[8:11],a[228:231],v[188:191],v[8:11]
s_waitcnt lgkmcnt(2)
v_exp_f32 v126,v38
MF v[0:3],a[232:235],v[192:195],v[0:3]
RD a[224:227],v216,43136
v_subrev_u32 v220,135168,v220
MF v[4:7],a[232:235],v[196:199],v[4:7]
RD a[228:231],v217,43136
v_subrev_u32 v221,135168,v221
MF v[8:11],a[232:235],v[200:203],v[8:11]
v_exp_f32 v127,v39
MF v[0:3],a[236:239],v[204:207],v[0:3]
v_add_f32 v95,v95,v124
v_add_f32 v95,v95,v125
MF v[4:7],a[236:239],v[208:211],v[4:7]
buffer_load_dwordx4 v232,s[12:15],s35 offen offset:2048 nt lds
MF v[8:11],a[236:239],v[212:215],v[8:11]
s_waitcnt lgkmcnt(2)
v_cvt_pk_bf16_f32 v62,v124,v125
v_add_f32 v95,v95,v126
MF v[12:15],a[216:219],v[144:147],v[80:83]
RD a[232:235],v216,43264
v_add_f32 v95,v95,v127
MF v[16:19],a[216:219],v[148:151],v[84:87]
RD a[236:239],v217,43264
v_cvt_pk_bf16_f32 v63,v126,v127
MF v[20:23],a[216:219],v[152:155],v[88:91]
v_add_f32 v40,v40,v84
v_add_f32 v41,v41,v84
MF v[12:15],a[220:223],v[156:159],v[12:15]
v_exp_f32 v72,v40
MF v[16:19],a[220:223],v[160:163],v[16:19]
v_exp_f32 v73,v41
MF v[20:23],a[220:223],v[164:167],v[20:23]
s_waitcnt vmcnt(30) lgkmcnt(2)
s_barrier
v_add_f32 v42,v42,v84
MF v[12:15],a[224:227],v[168:171],v[12:15]
TR a[216:217],v218,0
TR a[218:219],v218,6144
MF v[16:19],a[224:227],v[172:175],v[16:19]
TR a[220:221],v219,0
TR a[222:223],v219,6144
MF v[20:23],a[224:227],v[176:179],v[20:23]
s_add_u32 m0,s32,135168
v_exp_f32 v74,v42
MF v[12:15],a[228:231],v[180:183],v[12:15]
s_add_u32 s36,s33,98304
v_add_f32 v43,v43,v84
v_add_f32 v96,v96,v72
MF v[16:19],a[228:231],v[184:187],v[16:19]
buffer_load_dwordx4 v230,s[8:11],s36 offen offset:0 nt lds
MF v[20:23],a[228:231],v[188:191],v[20:23]
s_waitcnt lgkmcnt(4)
v_exp_f32 v75,v43
MF v[12:15],a[232:235],v[192:195],v[12:15]
TR a[224:225],v220,0
TR a[226:227],v220,6144
MF v[16:19],a[232:235],v[196:199],v[16:19]
TR a[228:229],v221,0
TR a[230:231],v221,6144
MF v[20:23],a[232:235],v[200:203],v[20:23]
v_add_f32 v96,v96,v73
v_cvt_pk_bf16_f32 v66,v72,v73
MF v[12:15],a[236:239],v[204:207],v[12:15]
v_add_f32 v96,v96,v74
v_add_f32 v96,v96,v75
MF v[16:19],a[236:239],v[208:211],v[16:19]
v_cvt_pk_bf16_f32 v67,v74,v75
v_add_f32 v44,v44,v88
MF v[20:23],a[236:239],v[212:215],v[20:23]
s_waitcnt lgkmcnt(4)
v_exp_f32 v76,v44
v_add_f32 v45,v45,v88
v_add_f32 v46,v46,v88
v_add_f32 v47,v47,v88
v_exp_f32 v77,v45
v_add_f32 v97,v97,v76
v_add_f32 v97,v97,v77
v_cvt_pk_bf16_f32 v70,v76,v77
v_exp_f32 v78,v46
v_exp_f32 v79,v47
v_add_f32 v97,v97,v78
v_add_f32 v97,v97,v79
v_cvt_pk_bf16_f32 v71,v78,v79
v_max3_f32 v104,v95,v96,v97
v_cmp_lt_f32 vcc,s46,v104
s_cbranch_vccnz L_rs0
L_rr0:
L_st24:
MF a[0:3],a[216:219],v[60:63],a[0:3]
TR a[232:233],v218,128
TR a[234:235],v218,6272
MF a[4:7],a[216:219],v[64:67],a[4:7]
TR a[236:237],v219,128
TR a[238:239],v219,6272
MF a[8:11],a[216:219],v[68:71],a[8:11]
v_subrev_u32 v216,98304,v216
v_subrev_u32 v217,98304,v217
MF a[12:15],a[220:223],v[60:63],a[12:15]
v_exp_f32 v72,v0
MF a[16:19],a[220:223],v[64:67],a[16:19]
buffer_load_dwordx4 v231,s[8:11],s36 offen offset:1024 nt lds
MF a[20:23],a[220:223],v[68:71],a[20:23]
s_waitcnt lgkmcnt(4)
v_exp_f32 v73,v1
MF a[24:27],a[224:227],v[60:63],a[24:27]
TR a[216:217],v220,128
TR a[218:219],v220,6272
MF a[28:31],a[224:227],v[64:67],a[28:31]
TR a[220:221],v221,128
TR a[222:223],v221,6272
MF a[32:35],a[224:227],v[68:71],a[32:35]
v_exp_f32 v74,v2
MF a[36:39],a[228:231],v[60:63],a[36:39]
v_exp_f32 v75,v3
MF a[40:43],a[228:231],v[64:67],a[40:43]
v_exp_f32 v76,v4
MF a[44:47],a[228:231],v[68:71],a[44:47]
s_waitcnt lgkmcnt(4)
v_exp_f32 v77,v5
MF a[48:51],a[232:235],v[60:63],a[48:51]
TR a[224:225],v218,256
TR a[226:227],v218,6400
MF a[52:55],a[232:235],v[64:67],a[52:55]
TR a[228:229],v219,256
TR a[230:231],v219,6400
MF a[56:59],a[232:235],v[68:71],a[56:59]
v_exp_f32 v78,v6
MF a[60:63],a[236:239],v[60:63],a[60:63]
v_exp_f32 v79,v7
MF a[64:67],a[236:239],v[64:67],a[64:67]
buffer_load_dwordx4 v232,s[8:11],s36 offen offset:2048 nt lds
MF a[68:71],a[236:239],v[68:71],a[68:71]
s_waitcnt lgkmcnt(4)
v_exp_f32 v120,v8
MF a[72:75],a[216:219],v[60:63],a[72:75]
TR a[232:233],v220,256
TR a[234:235],v220,6400
MF a[76:79],a[216:219],v[64:67],a[76:79]
TR a[236:237],v221,256
TR a[238:239],v221,6400
MF a[80:83],a[216:219],v[68:71],a[80:83]
v_exp_f32 v121,v9
MF a[84:87],a[220:223],v[60:63],a[84:87]
v_exp_f32 v122,v10
MF a[88:91],a[220:223],v[64:67],a[88:91]
v_exp_f32 v123,v11
MF a[92:95],a[220:223],v[68:71],a[92:95]
s_waitcnt vmcnt(30) lgkmcnt(4)
s_barrier
v_add_f32 v92,v92,v95
MF a[96:99],a[224:227],v[60:63],a[96:99]
RD a[216:219],v216,0
v_add_f32 v93,v93,v96
MF a[100:103],a[224:227],v[64:67],a[100:103]
RD a[220:223],v217,0
v_add_f32 v94,v94,v97
MF a[104:107],a[224:227],v[68:71],a[104:107]
s_add_u32 m0,s32,147456
v_exp_f32 v124,v12
MF a[108:111],a[228:231],v[60:63],a[108:111]
s_add_u32 s35,s33,86016
v_exp_f32 v125,v13
MF a[112:115],a[228:231],v[64:67],a[112:115]
buffer_load_dwordx4 v230,s[12:15],s35 offen offset:0 nt lds
MF a[116:119],a[228:231],v[68:71],a[116:119]
s_waitcnt lgkmcnt(2)
v_exp_f32 v126,v14
MF a[120:123],a[232:235],v[60:63],a[120:123]
RD a[224:227],v216,128
v_add_f32 v95,v72,v73
MF a[124:127],a[232:235],v[64:67],a[124:127]
RD a[228:231],v217,128
v_cvt_pk_bf16_f32 v48,v72,v73
MF a[128:131],a[232:235],v[68:71],a[128:131]
v_exp_f32 v127,v15
MF a[132:135],a[236:239],v[60:63],a[132:135]
v_exp_f32 v72,v16
MF a[136:139],a[236:239],v[64:67],a[136:139]
v_exp_f32 v73,v17
MF a[140:143],a[236:239],v[68:71],a[140:143]
s_waitcnt lgkmcnt(2)
v_add_f32 v95,v95,v74
v_add_f32 v95,v95,v75
L_st25:
MF v[24:27],a[216:219],v[144:147],v[80:83]
RD a[232:235],v216,256
v_cvt_pk_bf16_f32 v49,v74,v75
MF v[28:31],a[216:219],v[148:151],v[84:87]
RD a[236:239],v217,256
v_add_f32 v96,v76,v77
MF v[32:35],a[216:219],v[152:155],v[88:91]
v_exp_f32 v74,v18
MF v[24:27],a[220:223],v[156:159],v[24:27]
v_exp_f32 v75,v19
MF v[28:31],a[220:223],v[160:163],v[28:31]
buffer_load_dwordx4 v231,s[12:15],s35 offen offset:1024 nt lds
MF v[32:35],a[220:223],v[164:167],v[32:35]
s_waitcnt lgkmcnt(2)
v_cvt_pk_bf16_f32 v52,v76,v77
v_add_f32 v96,v96,v78
MF v[24:27],a[224:227],v[168:171],v[24:27]
RD a[216:219],v216,6144
v_add_u32 v218,86016,v218
MF v[28:31],a[224:227],v[172:175],v[28:31]
RD a[220:223],v217,6144
v_add_u32 v219,86016,v219
MF v[32:35],a[224:227],v[176:179],v[32:35]
v_exp_f32 v76,v20
MF v[24:27],a[228:231],v[180:183],v[24:27]
v_exp_f32 v77,v21
MF v[28:31],a[228:231],v[184:187],v[28:31]
v_add_f32 v96,v96,v79
v_cvt_pk_bf16_f32 v53,v78,v79
MF v[32:35],a[228:231],v[188:191],v[32:35]
s_waitcnt lgkmcnt(2)
v_exp_f32 v78,v22
MF v[24:27],a[232:235],v[192:195],v[24:27]
RD a[224:227],v216,6272
v_add_u32 v220,86016,v220
MF v[28:31],a[232:235],v[196:199],v[28:31]
RD a[228:231],v217,6272
v_add_u32 v221,86016,v221
MF v[32:35],a[232:235],v[200:203],v[32:35]
v_exp_f32 v79,v23
MF v[24:27],a[236:239],v[204:207],v[24:27]
v_add_f32 v97,v120,v121
v_cvt_pk_bf16_f32 v56,v120,v121
MF v[28:31],a[236:239],v[208:211],v[28:31]
buffer_load_dwordx4 v232,s[12:15],s35 offen offset:2048 nt lds
MF v[32:35],a[236:239],v[212:215],v[32:35]
s_waitcnt lgkmcnt(2)
v_add_f32 v97,v97,v122
v_add_f32 v97,v97,v123
MF v[36:39],a[216:219],v[144:147],v[80:83]
RD a[232:235],v216,6400
v_cvt_pk_bf16_f32 v57,v122,v123
MF v[40:43],a[216:219],v[148:151],v[84:87]
RD a[236:239],v217,6400
v_add_f32 v95,v95,v124
MF v[44:47],a[216:219],v[152:155],v[88:91]
v_add_f32 v95,v95,v125
v_cvt_pk_bf16_f32 v50,v124,v125
MF v[36:39],a[220:223],v[156:159],v[36:39]
v_add_f32 v95,v95,v126
v_add_f32 v95,v95,v127
MF v[40:43],a[220:223],v[160:163],v[40:43]
v_cvt_pk_bf16_f32 v51,v126,v127
v_add_f32 v96,v96,v72
MF v[44:47],a[220:223],v[164:167],v[44:47]
s_waitcnt vmcnt(30) lgkmcnt(2)
s_barrier
v_add_f32 v96,v96,v73
MF v[36:39],a[224:227],v[168:171],v[36:39]
TR a[216:217],v218,0
TR a[218:219],v218,6144
MF v[40:43],a[224:227],v[172:175],v[40:43]
TR a[220:221],v219,0
TR a[222:223],v219,6144
MF v[44:47],a[224:227],v[176:179],v[44:47]
s_add_u32 m0,s32,0
v_cvt_pk_bf16_f32 v54,v72,v73
v_add_f32 v96,v96,v74
MF v[36:39],a[228:231],v[180:183],v[36:39]
s_add_u32 s36,s33,110592
v_add_f32 v96,v96,v75
v_cvt_pk_bf16_f32 v55,v74,v75
MF v[40:43],a[228:231],v[184:187],v[40:43]
buffer_load_dwordx4 v230,s[8:11],s36 offen offset:0 nt lds
MF v[44:47],a[228:231],v[188:191],v[44:47]
s_waitcnt lgkmcnt(4)
v_add_f32 v97,v97,v76
v_add_f32 v97,v97,v77
MF v[36:39],a[232:235],v[192:195],v[36:39]
TR a[224:225],v220,0
TR a[226:227],v220,6144
MF v[40:43],a[232:235],v[196:199],v[40:43]
TR a[228:229],v221,0
TR a[230:231],v221,6144
MF v[44:47],a[232:235],v[200:203],v[44:47]
v_cvt_pk_bf16_f32 v58,v76,v77
v_add_f32 v97,v97,v78
MF v[36:39],a[236:239],v[204:207],v[36:39]
v_add_f32 v97,v97,v79
v_cvt_pk_bf16_f32 v59,v78,v79
MF v[40:43],a[236:239],v[208:211],v[40:43]
v_max3_f32 v104,v95,v96,v97
v_cmp_lt_f32 vcc,s46,v104
MF v[44:47],a[236:239],v[212:215],v[44:47]
s_waitcnt lgkmcnt(4)
s_cbranch_vccnz L_rs1
L_rr1:
L_st26:
MF a[0:3],a[216:219],v[48:51],a[0:3]
TR a[232:233],v218,128
TR a[234:235],v218,6272
MF a[4:7],a[216:219],v[52:55],a[4:7]
TR a[236:237],v219,128
TR a[238:239],v219,6272
MF a[8:11],a[216:219],v[56:59],a[8:11]
v_add_u32 v216,86016,v216
v_add_u32 v217,86016,v217
MF a[12:15],a[220:223],v[48:51],a[12:15]
v_exp_f32 v72,v24
MF a[16:19],a[220:223],v[52:55],a[16:19]
buffer_load_dwordx4 v231,s[8:11],s36 offen offset:1024 nt lds
MF a[20:23],a[220:223],v[56:59],a[20:23]
s_waitcnt lgkmcnt(4)
v_exp_f32 v73,v25
MF a[24:27],a[224:227],v[48:51],a[24:27]
TR a[216:217],v220,128
TR a[218:219],v220,6272
MF a[28:31],a[224:227],v[52:55],a[28:31]
TR a[220:221],v221,128
TR a[222:223],v221,6272
MF a[32:35],a[224:227],v[56:59],a[32:35]
v_exp_f32 v74,v26
MF a[36:39],a[228:231],v[48:51],a[36:39]
v_exp_f32 v75,v27
MF a[40:43],a[228:231],v[52:55],a[40:43]
v_exp_f32 v76,v28
MF a[44:47],a[228:231],v[56:59],a[44:47]
s_waitcnt lgkmcnt(4)
v_exp_f32 v77,v29
MF a[48:51],a[232:235],v[48:51],a[48:51]
TR a[224:225],v218,256
TR a[226:227],v218,6400
MF a[52:55],a[232:235],v[52:55],a[52:55]
TR a[228:229],v219,256
TR a[230:231],v219,6400
MF a[56:59],a[232:235],v[56:59],a[56:59]
v_exp_f32 v78,v30
MF a[60:63],a[236:239],v[48:51],a[60:63]
v_exp_f32 v79,v31
MF a[64:67],a[236:239],v[52:55],a[64:67]
buffer_load_dwordx4 v232,s[8:11],s36 offen offset:2048 nt lds
MF a[68:71],a[236:239],v[56:59],a[68:71]
s_waitcnt lgkmcnt(4)
v_exp_f32 v120,v32
MF a[72:75],a[216:219],v[48:51],a[72:75]
TR a[232:233],v220,256
TR a[234:235],v220,6400
MF a[76:79],a[216:219],v[52:55],a[76:79]
TR a[236:237],v221,256
TR a[238:239],v221,6400
MF a[80:83],a[216:219],v[56:59],a[80:83]
v_exp_f32 v121,v33
MF a[84:87],a[220:223],v[48:51],a[84:87]
v_exp_f32 v122,v34
MF a[88:91],a[220:223],v[52:55],a[88:91]
v_exp_f32 v123,v35
MF a[92:95],a[220:223],v[56:59],a[92:95]
s_waitcnt vmcnt(30) lgkmcnt(4)
s_barrier
v_add_f32 v92,v92,v95
MF a[96:99],a[224:227],v[48:51],a[96:99]
RD a[216:219],v216,0
v_add_f32 v93,v93,v96
MF a[100:103],a[224:227],v[52:55],a[100:103]
RD a[220:223],v217,0
v_add_f32 v94,v94,v97
MF a[104:107],a[224:227],v[56:59],a[104:107]
s_add_u32 m0,s32,12288
v_exp_f32 v124,v36
MF a[108:111],a[228:231],v[48:51],a[108:111]
s_add_u32 s35,s33,98304
v_exp_f32 v125,v37
MF a[112:115],a[228:231],v[52:55],a[112:115]
buffer_load_dwordx4 v230,s[12:15],s35 offen offset:0 nt lds
MF a[116:119],a[228:231],v[56:59],a[116:119]
s_waitcnt lgkmcnt(2)
v_exp_f32 v126,v38
MF a[120:123],a[232:235],v[48:51],a[120:123]
RD a[224:227],v216,128
v_add_f32 v95,v72,v73
MF a[124:127],a[232:235],v[52:55],a[124:127]
RD a[228:231],v217,128
v_cvt_pk_bf16_f32 v60,v72,v73
MF a[128:131],a[232:235],v[56:59],a[128:131]
v_exp_f32 v127,v39
MF a[132:135],a[236:239],v[48:51],a[132:135]
v_exp_f32 v72,v40
MF a[136:139],a[236:239],v[52:55],a[136:139]
v_exp_f32 v73,v41
MF a[140:143],a[236:239],v[56:59],a[140:143]
s_waitcnt lgkmcnt(2)
v_add_f32 v95,v95,v74
v_add_f32 v95,v95,v75
L_st27:
MF v[0:3],a[216:219],v[144:147],v[80:83]
RD a[232:235],v216,256
v_cvt_pk_bf16_f32 v61,v74,v75
MF v[4:7],a[216:219],v[148:151],v[84:87]
RD a[236:239],v217,256
v_add_f32 v96,v76,v77
MF v[8:11],a[216:219],v[152:155],v[88:91]
v_exp_f32 v74,v42
MF v[0:3],a[220:223],v[156:159],v[0:3]
v_exp_f32 v75,v43
MF v[4:7],a[220:223],v[160:163],v[4:7]
buffer_load_dwordx4 v231,s[12:15],s35 offen offset:1024 nt lds
MF v[8:11],a[220:223],v[164:167],v[8:11]
s_waitcnt lgkmcnt(2)
v_cvt_pk_bf16_f32 v64,v76,v77
v_add_f32 v96,v96,v78
MF v[0:3],a[224:227],v[168:171],v[0:3]
RD a[216:219],v216,6144
v_subrev_u32 v218,61440,v218
MF v[4:7],a[224:227],v[172:175],v[4:7]
RD a[220:223],v217,6144
v_subrev_u32 v219,61440,v219
MF v[8:11],a[224:227],v[176:179],v[8:11]
v_exp_f32 v76,v44
MF v[0:3],a[228:231],v[180:183],v[0:3]
v_exp_f32 v77,v45
MF v[4:7],a[228:231],v[184:187],v[4:7]
v_add_f32 v96,v96,v79
v_cvt_pk_bf16_f32 v65,v78,v79
MF v[8:11],a[228:231],v[188:191],v[8:11]
s_waitcnt lgkmcnt(2)
v_exp_f32 v78,v46
MF v[0:3],a[232:235],v[192:195],v[0:3]
RD a[224:227],v216,6272
v_subrev_u32 v220,61440,v220
MF v[4:7],a[232:235],v[196:199],v[4:7]
RD a[228:231],v217,6272
v_subrev_u32 v221,61440,v221
MF v[8:11],a[232:235],v[200:203],v[8:11]
v_exp_f32 v79,v47
MF v[0:3],a[236:239],v[204:207],v[0:3]
v_add_f32 v97,v120,v121
v_cvt_pk_bf16_f32 v68,v120,v121
MF v[4:7],a[236:239],v[208:211],v[4:7]
buffer_load_dwordx4 v232,s[12:15],s35 offen offset:2048 nt lds
MF v[8:11],a[236:239],v[212:215],v[8:11]
s_waitcnt lgkmcnt(2)
v_add_f32 v97,v97,v122
v_add_f32 v97,v97,v123
MF v[12:15],a[216:219],v[144:147],v[80:83]
RD a[232:235],v216,6400
v_cvt_pk_bf16_f32 v69,v122,v123
MF v[16:19],a[216:219],v[148:151],v[84:87]
RD a[236:239],v217,6400
v_add_f32 v95,v95,v124
MF v[20:23],a[216:219],v[152:155],v[88:91]
v_add_f32 v95,v95,v125
v_cvt_pk_bf16_f32 v62,v124,v125
MF v[12:15],a[220:223],v[156:159],v[12:15]
v_add_f32 v95,v95,v126
v_add_f32 v95,v95,v127
MF v[16:19],a[220:223],v[160:163],v[16:19]
v_cvt_pk_bf16_f32 v63,v126,v127
v_add_f32 v96,v96,v72
MF v[20:23],a[220:223],v[164:167],v[20:23]
s_waitcnt vmcnt(30) lgkmcnt(2)
s_barrier
v_add_f32 v96,v96,v73
MF v[12:15],a[224:227],v[168:171],v[12:15]
TR a[216:217],v218,0
TR a[218:219],v218,6144
MF v[16:19],a[224:227],v[172:175],v[16:19]
TR a[220:221],v219,0
TR a[222:223],v219,6144
MF v[20:23],a[224:227],v[176:179],v[20:23]
s_add_u32 m0,s32,86016
v_cvt_pk_bf16_f32 v66,v72,v73
v_add_f32 v96,v96,v74
MF v[12:15],a[228:231],v[180:183],v[12:15]
s_add_u32 s36,s33,122880
v_add_f32 v96,v96,v75
v_cvt_pk_bf16_f32 v67,v74,v75
MF v[16:19],a[228:231],v[184:187],v[16:19]
buffer_load_dwordx4 v230,s[8:11],s36 offen offset:0 nt lds
MF v[20:23],a[228:231],v[188:191],v[20:23]
s_waitcnt lgkmcnt(4)
v_add_f32 v97,v97,v76
v_add_f32 v97,v97,v77
MF v[12:15],a[232:235],v[192:195],v[12:15]
TR a[224:225],v220,0
TR a[226:227],v220,6144
MF v[16:19],a[232:235],v[196:199],v[16:19]
TR a[228:229],v221,0
TR a[230:231],v221,6144
MF v[20:23],a[232:235],v[200:203],v[20:23]
v_cvt_pk_bf16_f32 v70,v76,v77
v_add_f32 v97,v97,v78
MF v[12:15],a[236:239],v[204:207],v[12:15]
v_add_f32 v97,v97,v79
v_cvt_pk_bf16_f32 v71,v78,v79
MF v[16:19],a[236:239],v[208:211],v[16:19]
v_max3_f32 v104,v95,v96,v97
v_cmp_lt_f32 vcc,s46,v104
MF v[20:23],a[236:239],v[212:215],v[20:23]
s_waitcnt lgkmcnt(4)
s_cbranch_vccnz L_rs2
L_rr2:
L_st28:
MF a[0:3],a[216:219],v[60:63],a[0:3]
TR a[232:233],v218,128
TR a[234:235],v218,6272
MF a[4:7],a[216:219],v[64:67],a[4:7]
TR a[236:237],v219,128
TR a[238:239],v219,6272
MF a[8:11],a[216:219],v[68:71],a[8:11]
v_subrev_u32 v216,61440,v216
v_subrev_u32 v217,61440,v217
MF a[12:15],a[220:223],v[60:63],a[12:15]
v_exp_f32 v72,v0
MF a[16:19],a[220:223],v[64:67],a[16:19]
buffer_load_dwordx4 v231,s[8:11],s36 offen offset:1024 nt lds
MF a[20:23],a[220:223],v[68:71],a[20:23]
s_waitcnt lgkmcnt(4)
v_exp_f32 v73,v1
MF a[24:27],a[224:227],v[60:63],a[24:27]
TR a[216:217],v220,128
TR a[218:219],v220,6272
MF a[28:31],a[224:227],v[64:67],a[28:31]
TR a[220:221],v221,128
TR a[222:223],v221,6272
MF a[32:35],a[224:227],v[68:71],a[32:35]
v_exp_f32 v74,v2
MF a[36:39],a[228:231],v[60:63],a[36:39]
v_exp_f32 v75,v3
MF a[40:43],a[228:231],v[64:67],a[40:43]
v_exp_f32 v76,v4
MF a[44:47],a[228:231],v[68:71],a[44:47]
s_waitcnt lgkmcnt(4)
v_exp_f32 v77,v5
MF a[48:51],a[232:235],v[60:63],a[48:51]
TR a[224:225],v218,256
TR a[226:227],v218,6400
MF a[52:55],a[232:235],v[64:67],a[52:55]
TR a[228:229],v219,256
TR a[230:231],v219,6400
MF a[56:59],a[232:235],v[68:71],a[56:59]
v_exp_f32 v78,v6
MF a[60:63],a[236:239],v[60:63],a[60:63]
v_exp_f32 v79,v7
MF a[64:67],a[236:239],v[64:67],a[64:67]
buffer_load_dwordx4 v232,s[8:11],s36 offen offset:2048 nt lds
MF a[68:71],a[236:239],v[68:71],a[68:71]
s_waitcnt lgkmcnt(4)
v_exp_f32 v120,v8
MF a[72:75],a[216:219],v[60:63],a[72:75]
TR a[232:233],v220,256
TR a[234:235],v220,6400
MF a[76:79],a[216:219],v[64:67],a[76:79]
TR a[236:237],v221,256
TR a[238:239],v221,6400
MF a[80:83],a[216:219],v[68:71],a[80:83]
v_exp_f32 v121,v9
MF a[84:87],a[220:223],v[60:63],a[84:87]
v_exp_f32 v122,v10
MF a[88:91],a[220:223],v[64:67],a[88:91]
v_exp_f32 v123,v11
MF a[92:95],a[220:223],v[68:71],a[92:95]
s_waitcnt vmcnt(30) lgkmcnt(4)
s_barrier
v_add_f32 v92,v92,v95
MF a[96:99],a[224:227],v[60:63],a[96:99]
RD a[216:219],v216,0
v_add_f32 v93,v93,v96
MF a[100:103],a[224:227],v[64:67],a[100:103]
RD a[220:223],v217,0
v_add_f32 v94,v94,v97
MF a[104:107],a[224:227],v[68:71],a[104:107]
s_add_u32 m0,s32,98304
v_exp_f32 v124,v12
MF a[108:111],a[228:231],v[60:63],a[108:111]
s_add_u32 s35,s33,110592
v_exp_f32 v125,v13
MF a[112:115],a[228:231],v[64:67],a[112:115]
buffer_load_dwordx4 v230,s[12:15],s35 offen offset:0 nt lds
MF a[116:119],a[228:231],v[68:71],a[116:119]
s_waitcnt lgkmcnt(2)
v_exp_f32 v126,v14
MF a[120:123],a[232:235],v[60:63],a[120:123]
RD a[224:227],v216,128
v_add_f32 v95,v72,v73
MF a[124:127],a[232:235],v[64:67],a[124:127]
RD a[228:231],v217,128
v_cvt_pk_bf16_f32 v48,v72,v73
MF a[128:131],a[232:235],v[68:71],a[128:131]
v_exp_f32 v127,v15
MF a[132:135],a[236:239],v[60:63],a[132:135]
v_exp_f32 v72,v16
MF a[136:139],a[236:239],v[64:67],a[136:139]
v_exp_f32 v73,v17
MF a[140:143],a[236:239],v[68:71],a[140:143]
s_waitcnt lgkmcnt(2)
v_add_f32 v95,v95,v74
v_add_f32 v95,v95,v75
L_st29:
MF v[24:27],a[216:219],v[144:147],v[80:83]
RD a[232:235],v216,256
v_cvt_pk_bf16_f32 v49,v74,v75
MF v[28:31],a[216:219],v[148:151],v[84:87]
RD a[236:239],v217,256
v_add_f32 v96,v76,v77
MF v[32:35],a[216:219],v[152:155],v[88:91]
v_exp_f32 v74,v18
MF v[24:27],a[220:223],v[156:159],v[24:27]
v_exp_f32 v75,v19
MF v[28:31],a[220:223],v[160:163],v[28:31]
buffer_load_dwordx4 v231,s[12:15],s35 offen offset:1024 nt lds
MF v[32:35],a[220:223],v[164:167],v[32:35]
s_waitcnt lgkmcnt(2)
v_cvt_pk_bf16_f32 v52,v76,v77
v_add_f32 v96,v96,v78
MF v[24:27],a[224:227],v[168:171],v[24:27]
RD a[216:219],v216,6144
v_add_f32 v96,v96,v79
MF v[28:31],a[224:227],v[172:175],v[28:31]
RD a[220:223],v217,6144
v_cvt_pk_bf16_f32 v53,v78,v79
MF v[32:35],a[224:227],v[176:179],v[32:35]
v_exp_f32 v76,v20
MF v[24:27],a[228:231],v[180:183],v[24:27]
v_exp_f32 v77,v21
MF v[28:31],a[228:231],v[184:187],v[28:31]
v_exp_f32 v78,v22
MF v[32:35],a[228:231],v[188:191],v[32:35]
s_waitcnt lgkmcnt(2)
v_exp_f32 v79,v23
MF v[24:27],a[232:235],v[192:195],v[24:27]
RD a[224:227],v216,6272
v_add_f32 v97,v120,v121
MF v[28:31],a[232:235],v[196:199],v[28:31]
RD a[228:231],v217,6272
v_cvt_pk_bf16_f32 v56,v120,v121
MF v[32:35],a[232:235],v[200:203],v[32:35]
v_add_f32 v97,v97,v122
v_add_f32 v97,v97,v123
MF v[24:27],a[236:239],v[204:207],v[24:27]
v_cvt_pk_bf16_f32 v57,v122,v123
v_add_f32 v95,v95,v124
MF v[28:31],a[236:239],v[208:211],v[28:31]
buffer_load_dwordx4 v232,s[12:15],s35 offen offset:2048 nt lds
MF v[32:35],a[236:239],v[212:215],v[32:35]
s_waitcnt lgkmcnt(2)
v_add_f32 v95,v95,v125
v_cvt_pk_bf16_f32 v50,v124,v125
MF v[36:39],a[216:219],v[144:147],v[80:83]
RD a[232:235],v216,6400
v_add_f32 v95,v95,v126
MF v[40:43],a[216:219],v[148:151],v[84:87]
RD a[236:239],v217,6400
v_add_f32 v95,v95,v127
MF v[44:47],a[216:219],v[152:155],v[88:91]
v_cvt_pk_bf16_f32 v51,v126,v127
v_add_f32 v96,v96,v72
MF v[36:39],a[220:223],v[156:159],v[36:39]
v_add_f32 v96,v96,v73
v_cvt_pk_bf16_f32 v54,v72,v73
MF v[40:43],a[220:223],v[160:163],v[40:43]
v_add_f32 v96,v96,v74
v_add_f32 v96,v96,v75
MF v[44:47],a[220:223],v[164:167],v[44:47]
s_waitcnt vmcnt(30) lgkmcnt(2)
s_barrier
v_cvt_pk_bf16_f32 v55,v74,v75
MF v[36:39],a[224:227],v[168:171],v[36:39]
TR a[216:217],v218,24576
TR a[218:219],v218,30720
MF v[40:43],a[224:227],v[172:175],v[40:43]
TR a[220:221],v219,24576
TR a[222:223],v219,30720
MF v[44:47],a[224:227],v[176:179],v[44:47]
s_add_u32 m0,s32,24576
v_add_f32 v97,v97,v76
v_add_f32 v97,v97,v77
MF v[36:39],a[228:231],v[180:183],v[36:39]
s_add_u32 s36,s33,135168
v_cvt_pk_bf16_f32 v58,v76,v77
v_add_f32 v97,v97,v78
MF v[40:43],a[228:231],v[184:187],v[40:43]
buffer_load_dwordx4 v230,s[8:11],s36 offen offset:0 nt lds
MF v[44:47],a[228:231],v[188:191],v[44:47]
s_waitcnt lgkmcnt(4)
v_add_f32 v97,v97,v79
v_cvt_pk_bf16_f32 v59,v78,v79
MF v[36:39],a[232:235],v[192:195],v[36:39]
TR a[224:225],v220,24576
TR a[226:227],v220,30720
MF v[40:43],a[232:235],v[196:199],v[40:43]
TR a[228:229],v221,24576
TR a[230:231],v221,30720
MF v[44:47],a[232:235],v[200:203],v[44:47]
v_max3_f32 v104,v95,v96,v97
v_cmp_lt_f32 vcc,s46,v104
MF v[36:39],a[236:239],v[204:207],v[36:39]
MF v[40:43],a[236:239],v[208:211],v[40:43]
MF v[44:47],a[236:239],v[212:215],v[44:47]
s_waitcnt lgkmcnt(4)
s_cbranch_vccnz L_rs3
L_rr3:
L_st30:
MF a[0:3],a[216:219],v[48:51],a[0:3]
TR a[232:233],v218,24704
TR a[234:235],v218,30848
MF a[4:7],a[216:219],v[52:55],a[4:7]
TR a[236:237],v219,24704
TR a[238:239],v219,30848
MF a[8:11],a[216:219],v[56:59],a[8:11]
v_exp_f32 v72,v24
MF a[12:15],a[220:223],v[48:51],a[12:15]
v_exp_f32 v73,v25
MF a[16:19],a[220:223],v[52:55],a[16:19]
buffer_load_dwordx4 v231,s[8:11],s36 offen offset:1024 nt lds
MF a[20:23],a[220:223],v[56:59],a[20:23]
s_waitcnt lgkmcnt(4)
v_exp_f32 v74,v26
MF a[24:27],a[224:227],v[48:51],a[24:27]
TR a[216:217],v220,24704
TR a[218:219],v220,30848
MF a[28:31],a[224:227],v[52:55],a[28:31]
TR a[220:221],v221,24704
TR a[222:223],v221,30848
MF a[32:35],a[224:227],v[56:59],a[32:35]
v_exp_f32 v75,v27
MF a[36:39],a[228:231],v[48:51],a[36:39]
v_exp_f32 v76,v28
MF a[40:43],a[228:231],v[52:55],a[40:43]
v_exp_f32 v77,v29
MF a[44:47],a[228:231],v[56:59],a[44:47]
s_waitcnt lgkmcnt(4)
v_exp_f32 v78,v30
MF a[48:51],a[232:235],v[48:51],a[48:51]
TR a[224:225],v218,24832
TR a[226:227],v218,30976
MF a[52:55],a[232:235],v[52:55],a[52:55]
TR a[228:229],v219,24832
TR a[230:231],v219,30976
MF a[56:59],a[232:235],v[56:59],a[56:59]
v_exp_f32 v79,v31
MF a[60:63],a[236:239],v[48:51],a[60:63]
v_exp_f32 v120,v32
MF a[64:67],a[236:239],v[52:55],a[64:67]
buffer_load_dwordx4 v232,s[8:11],s36 offen offset:2048 nt lds
MF a[68:71],a[236:239],v[56:59],a[68:71]
s_waitcnt lgkmcnt(4)
v_exp_f32 v121,v33
MF a[72:75],a[216:219],v[48:51],a[72:75]
TR a[232:233],v220,24832
TR a[234:235],v220,30976
MF a[76:79],a[216:219],v[52:55],a[76:79]
TR a[236:237],v221,24832
TR a[238:239],v221,30976
MF a[80:83],a[216:219],v[56:59],a[80:83]
v_exp_f32 v122,v34
MF a[84:87],a[220:223],v[48:51],a[84:87]
v_exp_f32 v123,v35
MF a[88:91],a[220:223],v[52:55],a[88:91]
v_exp_f32 v124,v36
MF a[92:95],a[220:223],v[56:59],a[92:95]
s_waitcnt vmcnt(30) lgkmcnt(4)
s_barrier
v_add_f32 v92,v92,v95
MF a[96:99],a[224:227],v[48:51],a[96:99]
RD a[216:219],v216,24576
v_add_f32 v93,v93,v96
MF a[100:103],a[224:227],v[52:55],a[100:103]
RD a[220:223],v217,24576
v_add_f32 v94,v94,v97
MF a[104:107],a[224:227],v[56:59],a[104:107]
s_add_u32 m0,s32,36864
v_exp_f32 v125,v37
MF a[108:111],a[228:231],v[48:51],a[108:111]
s_add_u32 s35,s33,122880
v_exp_f32 v126,v38
MF a[112:115],a[228:231],v[52:55],a[112:115]
buffer_load_dwordx4 v230,s[12:15],s35 offen offset:0 nt lds
MF a[116:119],a[228:231],v[56:59],a[116:119]
s_waitcnt lgkmcnt(2)
v_exp_f32 v127,v39
MF a[120:123],a[232:235],v[48:51],a[120:123]
RD a[224:227],v216,24704
v_add_f32 v95,v72,v73
MF a[124:127],a[232:235],v[52:55],a[124:127]
RD a[228:231],v217,24704
v_cvt_pk_bf16_f32 v60,v72,v73
MF a[128:131],a[232:235],v[56:59],a[128:131]
v_exp_f32 v72,v40
MF a[132:135],a[236:239],v[48:51],a[132:135]
v_exp_f32 v73,v41
MF a[136:139],a[236:239],v[52:55],a[136:139]
v_add_f32 v95,v95,v74
v_add_f32 v95,v95,v75
MF a[140:143],a[236:239],v[56:59],a[140:143]
s_waitcnt lgkmcnt(2)
v_cvt_pk_bf16_f32 v61,v74,v75
v_add_f32 v96,v76,v77
L_st31:
MF v[0:3],a[216:219],v[144:147],v[80:83]
RD a[232:235],v216,24832
v_cvt_pk_bf16_f32 v64,v76,v77
MF v[4:7],a[216:219],v[148:151],v[84:87]
RD a[236:239],v217,24832
v_add_f32 v96,v96,v78
MF v[8:11],a[216:219],v[152:155],v[88:91]
v_exp_f32 v74,v42
MF v[0:3],a[220:223],v[156:159],v[0:3]
v_exp_f32 v75,v43
MF v[4:7],a[220:223],v[160:163],v[4:7]
buffer_load_dwordx4 v231,s[12:15],s35 offen offset:1024 nt lds
MF v[8:11],a[220:223],v[164:167],v[8:11]
s_waitcnt lgkmcnt(2)
v_exp_f32 v76,v44
MF v[0:3],a[224:227],v[168:171],v[0:3]
RD a[216:219],v216,30720
v_add_f32 v96,v96,v79
MF v[4:7],a[224:227],v[172:175],v[4:7]
RD a[220:223],v217,30720
v_cvt_pk_bf16_f32 v65,v78,v79
MF v[8:11],a[224:227],v[176:179],v[8:11]
v_exp_f32 v77,v45
MF v[0:3],a[228:231],v[180:183],v[0:3]
v_exp_f32 v78,v46
MF v[4:7],a[228:231],v[184:187],v[4:7]
v_exp_f32 v79,v47
MF v[8:11],a[228:231],v[188:191],v[8:11]
s_waitcnt lgkmcnt(2)
v_add_f32 v97,v120,v121
v_cvt_pk_bf16_f32 v68,v120,v121
MF v[0:3],a[232:235],v[192:195],v[0:3]
RD a[224:227],v216,30848
v_add_f32 v97,v97,v122
MF v[4:7],a[232:235],v[196:199],v[4:7]
RD a[228:231],v217,30848
v_add_f32 v97,v97,v123
MF v[8:11],a[232:235],v[200:203],v[8:11]
v_cvt_pk_bf16_f32 v69,v122,v123
v_add_f32 v95,v95,v124
MF v[0:3],a[236:239],v[204:207],v[0:3]
v_add_f32 v95,v95,v125
v_cvt_pk_bf16_f32 v62,v124,v125
MF v[4:7],a[236:239],v[208:211],v[4:7]
buffer_load_dwordx4 v232,s[12:15],s35 offen offset:2048 nt lds
MF v[8:11],a[236:239],v[212:215],v[8:11]
s_waitcnt lgkmcnt(2)
v_add_f32 v95,v95,v126
v_add_f32 v95,v95,v127
MF v[12:15],a[216:219],v[144:147],v[80:83]
RD a[232:235],v216,30976
v_cvt_pk_bf16_f32 v63,v126,v127
MF v[16:19],a[216:219],v[148:151],v[84:87]
RD a[236:239],v217,30976
v_add_f32 v96,v96,v72
MF v[20:23],a[216:219],v[152:155],v[88:91]
v_add_f32 v96,v96,v73
v_cvt_pk_bf16_f32 v66,v72,v73
MF v[12:15],a[220:223],v[156:159],v[12:15]
v_add_f32 v96,v96,v74
v_add_f32 v96,v96,v75
MF v[16:19],a[220:223],v[160:163],v[16:19]
v_cvt_pk_bf16_f32 v67,v74,v75
v_add_f32 v97,v97,v76
MF v[20:23],a[220:223],v[164:167],v[20:23]
s_waitcnt vmcnt(30) lgkmcnt(2)
s_barrier
v_add_f32 v97,v97,v77
MF v[12:15],a[224:227],v[168:171],v[12:15]
TR a[216:217],v218,49152
TR a[218:219],v218,55296
MF v[16:19],a[224:227],v[172:175],v[16:19]
TR a[220:221],v219,49152
TR a[222:223],v219,55296
MF v[20:23],a[224:227],v[176:179],v[20:23]
s_add_u32 m0,s32,49152
v_cvt_pk_bf16_f32 v70,v76,v77
v_add_f32 v97,v97,v78
MF v[12:15],a[228:231],v[180:183],v[12:15]
s_add_u32 s36,s33,147456
v_add_f32 v97,v97,v79
v_cvt_pk_bf16_f32 v71,v78,v79
MF v[16:19],a[228:231],v[184:187],v[16:19]
buffer_load_dwordx4 v230,s[8:11],s36 offen offset:0 nt lds
MF v[20:23],a[228:231],v[188:191],v[20:23]
s_waitcnt lgkmcnt(4)
v_max3_f32 v104,v95,v96,v97
v_cmp_lt_f32 vcc,s46,v104
MF v[12:15],a[232:235],v[192:195],v[12:15]
TR a[224:225],v220,49152
TR a[226:227],v220,55296
MF v[16:19],a[232:235],v[196:199],v[16:19]
TR a[228:229],v221,49152
TR a[230:231],v221,55296
MF v[20:23],a[232:235],v[200:203],v[20:23]
MF v[12:15],a[236:239],v[204:207],v[12:15]
MF v[16:19],a[236:239],v[208:211],v[16:19]
MF v[20:23],a[236:239],v[212:215],v[20:23]
s_waitcnt lgkmcnt(4)
s_cbranch_vccnz L_rs4
L_rr4:
L_st32:
s_lshr_b32 s56,s2,3
s_and_b32 s56,s56,7
s_cmp_eq_u32 s56,0
s_cbranch_scc0 L_pcs3
s_getpc_b64 s[56:57]
L_pc3:
s_add_u32 s56,s56,L_code+32768-L_pc3
s_addc_u32 s57,s57,0
v_mov_b32 v249,s57
v_add_co_u32 v248,vcc,s56,v252
s_nop 1
v_addc_co_u32 v249,vcc,0,v249,vcc
global_load_dword a255,v[248:249],off
L_pcs3:
MF a[0:3],a[216:219],v[60:63],a[0:3]
TR a[232:233],v218,49280
TR a[234:235],v218,55424
MF a[4:7],a[216:219],v[64:67],a[4:7]
TR a[236:237],v219,49280
TR a[238:239],v219,55424
MF a[8:11],a[216:219],v[68:71],a[8:11]
v_add_u32 v216,73728,v216
v_add_u32 v217,73728,v217
MF a[12:15],a[220:223],v[60:63],a[12:15]
v_exp_f32 v72,v0
MF a[16:19],a[220:223],v[64:67],a[16:19]
buffer_load_dwordx4 v231,s[8:11],s36 offen offset:1024 nt lds
MF a[20:23],a[220:223],v[68:71],a[20:23]
s_waitcnt lgkmcnt(4)
v_exp_f32 v73,v1
MF a[24:27],a[224:227],v[60:63],a[24:27]
TR a[216:217],v220,49280
TR a[218:219],v220,55424
MF a[28:31],a[224:227],v[64:67],a[28:31]
TR a[220:221],v221,49280
TR a[222:223],v221,55424
MF a[32:35],a[224:227],v[68:71],a[32:35]
v_exp_f32 v74,v2
MF a[36:39],a[228:231],v[60:63],a[36:39]
v_exp_f32 v75,v3
MF a[40:43],a[228:231],v[64:67],a[40:43]
v_exp_f32 v76,v4
MF a[44:47],a[228:231],v[68:71],a[44:47]
s_waitcnt lgkmcnt(4)
v_exp_f32 v77,v5
MF a[48:51],a[232:235],v[60:63],a[48:51]
TR a[224:225],v218,49408
TR a[226:227],v218,55552
MF a[52:55],a[232:235],v[64:67],a[52:55]
TR a[228:229],v219,49408
TR a[230:231],v219,55552
MF a[56:59],a[232:235],v[68:71],a[56:59]
v_exp_f32 v78,v6
MF a[60:63],a[236:239],v[60:63],a[60:63]
v_exp_f32 v79,v7
MF a[64:67],a[236:239],v[64:67],a[64:67]
buffer_load_dwordx4 v232,s[8:11],s36 offen offset:2048 nt lds
MF a[68:71],a[236:239],v[68:71],a[68:71]
s_waitcnt lgkmcnt(4)
v_exp_f32 v120,v8
MF a[72:75],a[216:219],v[60:63],a[72:75]
TR a[232:233],v220,49408
TR a[234:235],v220,55552
MF a[76:79],a[216:219],v[64:67],a[76:79]
TR a[236:237],v221,49408
TR a[238:239],v221,55552
MF a[80:83],a[216:219],v[68:71],a[80:83]
v_exp_f32 v121,v9
MF a[84:87],a[220:223],v[60:63],a[84:87]
v_exp_f32 v122,v10
MF a[88:91],a[220:223],v[64:67],a[88:91]
v_exp_f32 v123,v11
MF a[92:95],a[220:223],v[68:71],a[92:95]
s_waitcnt vmcnt(30) lgkmcnt(4)
s_barrier
v_add_f32 v92,v92,v95
MF a[96:99],a[224:227],v[60:63],a[96:99]
RD a[216:219],v216,0
v_add_f32 v93,v93,v96
MF a[100:103],a[224:227],v[64:67],a[100:103]
RD a[220:223],v217,0
v_add_f32 v94,v94,v97
MF a[104:107],a[224:227],v[68:71],a[104:107]
s_add_u32 m0,s32,61440
v_exp_f32 v124,v12
MF a[108:111],a[228:231],v[60:63],a[108:111]
s_add_u32 s35,s33,135168
v_exp_f32 v125,v13
MF a[112:115],a[228:231],v[64:67],a[112:115]
buffer_load_dwordx4 v230,s[12:15],s35 offen offset:0 nt lds
MF a[116:119],a[228:231],v[68:71],a[116:119]
s_waitcnt lgkmcnt(2)
v_exp_f32 v126,v14
MF a[120:123],a[232:235],v[60:63],a[120:123]
RD a[224:227],v216,128
v_add_f32 v95,v72,v73
MF a[124:127],a[232:235],v[64:67],a[124:127]
RD a[228:231],v217,128
v_cvt_pk_bf16_f32 v48,v72,v73
MF a[128:131],a[232:235],v[68:71],a[128:131]
v_exp_f32 v127,v15
MF a[132:135],a[236:239],v[60:63],a[132:135]
v_exp_f32 v72,v16
MF a[136:139],a[236:239],v[64:67],a[136:139]
v_exp_f32 v73,v17
MF a[140:143],a[236:239],v[68:71],a[140:143]
s_waitcnt lgkmcnt(2)
v_add_f32 v95,v95,v74
v_add_f32 v95,v95,v75
L_st33:
MF v[24:27],a[216:219],v[144:147],v[80:83]
RD a[232:235],v216,256
v_cvt_pk_bf16_f32 v49,v74,v75
MF v[28:31],a[216:219],v[148:151],v[84:87]
RD a[236:239],v217,256
v_add_f32 v96,v76,v77
MF v[32:35],a[216:219],v[152:155],v[88:91]
v_exp_f32 v74,v18
MF v[24:27],a[220:223],v[156:159],v[24:27]
v_exp_f32 v75,v19
MF v[28:31],a[220:223],v[160:163],v[28:31]
buffer_load_dwordx4 v231,s[12:15],s35 offen offset:1024 nt lds
MF v[32:35],a[220:223],v[164:167],v[32:35]
s_waitcnt lgkmcnt(2)
v_cvt_pk_bf16_f32 v52,v76,v77
v_add_f32 v96,v96,v78
MF v[24:27],a[224:227],v[168:171],v[24:27]
RD a[216:219],v216,6144
v_add_u32 v218,98304,v218
MF v[28:31],a[224:227],v[172:175],v[28:31]
RD a[220:223],v217,6144
v_add_u32 v219,98304,v219
MF v[32:35],a[224:227],v[176:179],v[32:35]
v_exp_f32 v76,v20
MF v[24:27],a[228:231],v[180:183],v[24:27]
v_exp_f32 v77,v21
MF v[28:31],a[228:231],v[184:187],v[28:31]
v_add_f32 v96,v96,v79
v_cvt_pk_bf16_f32 v53,v78,v79
MF v[32:35],a[228:231],v[188:191],v[32:35]
s_waitcnt lgkmcnt(2)
v_exp_f32 v78,v22
MF v[24:27],a[232:235],v[192:195],v[24:27]
RD a[224:227],v216,6272
v_add_u32 v220,98304,v220
MF v[28:31],a[232:235],v[196:199],v[28:31]
RD a[228:231],v217,6272
v_add_u32 v221,98304,v221
MF v[32:35],a[232:235],v[200:203],v[32:35]
v_exp_f32 v79,v23
MF v[24:27],a[236:239],v[204:207],v[24:27]
v_add_f32 v97,v120,v121
v_cvt_pk_bf16_f32 v56,v120,v121
MF v[28:31],a[236:239],v[208:211],v[28:31]
buffer_load_dwordx4 v232,s[12:15],s35 offen offset:2048 nt lds
MF v[32:35],a[236:239],v[212:215],v[32:35]
s_waitcnt lgkmcnt(2)
v_add_f32 v97,v97,v122
v_add_f32 v97,v97,v123
MF v[36:39],a[216:219],v[144:147],v[80:83]
RD a[232:235],v216,6400
v_cvt_pk_bf16_f32 v57,v122,v123
MF v[40:43],a[216:219],v[148:151],v[84:87]
RD a[236:239],v217,6400
v_add_f32 v95,v95,v124
MF v[44:47],a[216:219],v[152:155],v[88:91]
v_add_f32 v95,v95,v125
v_cvt_pk_bf16_f32 v50,v124,v125
MF v[36:39],a[220:223],v[156:159],v[36:39]
v_add_f32 v95,v95,v126
v_add_f32 v95,v95,v127
MF v[40:43],a[220:223],v[160:163],v[40:43]
v_cvt_pk_bf16_f32 v51,v126,v127
v_add_f32 v96,v96,v72
MF v[44:47],a[220:223],v[164:167],v[44:47]
s_waitcnt vmcnt(30) lgkmcnt(2)
s_barrier
v_add_f32 v96,v96,v73
MF v[36:39],a[224:227],v[168:171],v[36:39]
TR a[216:217],v218,0
TR a[218:219],v218,6144
MF v[40:43],a[224:227],v[172:175],v[40:43]
TR a[220:221],v219,0
TR a[222:223],v219,6144
MF v[44:47],a[224:227],v[176:179],v[44:47]
s_add_u32 m0,s32,73728
v_cvt_pk_bf16_f32 v54,v72,v73
v_add_f32 v96,v96,v74
MF v[36:39],a[228:231],v[180:183],v[36:39]
s_add_u32 s36,s33,159744
v_add_f32 v96,v96,v75
v_cvt_pk_bf16_f32 v55,v74,v75
MF v[40:43],a[228:231],v[184:187],v[40:43]
buffer_load_dwordx4 v230,s[8:11],s36 offen offset:0 nt lds
MF v[44:47],a[228:231],v[188:191],v[44:47]
s_waitcnt lgkmcnt(4)
v_add_f32 v97,v97,v76
v_add_f32 v97,v97,v77
MF v[36:39],a[232:235],v[192:195],v[36:39]
TR a[224:225],v220,0
TR a[226:227],v220,6144
MF v[40:43],a[232:235],v[196:199],v[40:43]
TR a[228:229],v221,0
TR a[230:231],v221,6144
MF v[44:47],a[232:235],v[200:203],v[44:47]
v_cvt_pk_bf16_f32 v58,v76,v77
v_add_f32 v97,v97,v78
MF v[36:39],a[236:239],v[204:207],v[36:39]
v_add_f32 v97,v97,v79
v_cvt_pk_bf16_f32 v59,v78,v79
MF v[40:43],a[236:239],v[208:211],v[40:43]
v_max3_f32 v104,v95,v96,v97
v_cmp_lt_f32 vcc,s46,v104
MF v[44:47],a[236:239],v[212:215],v[44:47]
s_waitcnt lgkmcnt(4)
s_cbranch_vccnz L_rs5
L_rr5:
L_st34:
MF a[0:3],a[216:219],v[48:51],a[0:3]
TR a[232:233],v218,128
TR a[234:235],v218,6272
MF a[4:7],a[216:219],v[52:55],a[4:7]
TR a[236:237],v219,128
TR a[238:239],v219,6272
MF a[8:11],a[216:219],v[56:59],a[8:11]
v_exp_f32 v72,v24
MF a[12:15],a[220:223],v[48:51],a[12:15]
v_exp_f32 v73,v25
MF a[16:19],a[220:223],v[52:55],a[16:19]
buffer_load_dwordx4 v231,s[8:11],s36 offen offset:1024 nt lds
MF a[20:23],a[220:223],v[56:59],a[20:23]
s_waitcnt lgkmcnt(4)
v_exp_f32 v74,v26
MF a[24:27],a[224:227],v[48:51],a[24:27]
TR a[216:217],v220,128
TR a[218:219],v220,6272
MF a[28:31],a[224:227],v[52:55],a[28:31]
TR a[220:221],v221,128
TR a[222:223],v221,6272
MF a[32:35],a[224:227],v[56:59],a[32:35]
v_exp_f32 v75,v27
MF a[36:39],a[228:231],v[48:51],a[36:39]
v_exp_f32 v76,v28
MF a[40:43],a[228:231],v[52:55],a[40:43]
v_exp_f32 v77,v29
MF a[44:47],a[228:231],v[56:59],a[44:47]
s_waitcnt lgkmcnt(4)
v_exp_f32 v78,v30
MF a[48:51],a[232:235],v[48:51],a[48:51]
TR a[224:225],v218,256
TR a[226:227],v218,6400
MF a[52:55],a[232:235],v[52:55],a[52:55]
TR a[228:229],v219,256
TR a[230:231],v219,6400
MF a[56:59],a[232:235],v[56:59],a[56:59]
v_exp_f32 v79,v31
MF a[60:63],a[236:239],v[48:51],a[60:63]
v_exp_f32 v120,v32
MF a[64:67],a[236:239],v[52:55],a[64:67]
buffer_load_dwordx4 v232,s[8:11],s36 offen offset:2048 nt lds
MF a[68:71],a[236:239],v[56:59],a[68:71]
s_waitcnt lgkmcnt(4)
v_exp_f32 v121,v33
MF a[72:75],a[216:219],v[48:51],a[72:75]
TR a[232:233],v220,256
TR a[234:235],v220,6400
MF a[76:79],a[216:219],v[52:55],a[76:79]
TR a[236:237],v221,256
TR a[238:239],v221,6400
MF a[80:83],a[216:219],v[56:59],a[80:83]
v_exp_f32 v122,v34
MF a[84:87],a[220:223],v[48:51],a[84:87]
v_exp_f32 v123,v35
MF a[88:91],a[220:223],v[52:55],a[88:91]
v_exp_f32 v124,v36
MF a[92:95],a[220:223],v[56:59],a[92:95]
s_waitcnt vmcnt(30) lgkmcnt(4)
s_barrier
v_add_f32 v92,v92,v95
MF a[96:99],a[224:227],v[48:51],a[96:99]
RD a[216:219],v216,24576
v_add_f32 v93,v93,v96
MF a[100:103],a[224:227],v[52:55],a[100:103]
RD a[220:223],v217,24576
v_add_f32 v94,v94,v97
MF a[104:107],a[224:227],v[56:59],a[104:107]
s_add_u32 m0,s32,110592
v_exp_f32 v125,v37
MF a[108:111],a[228:231],v[48:51],a[108:111]
s_add_u32 s35,s33,147456
v_exp_f32 v126,v38
MF a[112:115],a[228:231],v[52:55],a[112:115]
buffer_load_dwordx4 v230,s[12:15],s35 offen offset:0 nt lds
MF a[116:119],a[228:231],v[56:59],a[116:119]
s_waitcnt lgkmcnt(2)
v_exp_f32 v127,v39
MF a[120:123],a[232:235],v[48:51],a[120:123]
RD a[224:227],v216,24704
v_add_f32 v95,v72,v73
MF a[124:127],a[232:235],v[52:55],a[124:127]
RD a[228:231],v217,24704
v_cvt_pk_bf16_f32 v60,v72,v73
MF a[128:131],a[232:235],v[56:59],a[128:131]
v_exp_f32 v72,v40
MF a[132:135],a[236:239],v[48:51],a[132:135]
v_exp_f32 v73,v41
MF a[136:139],a[236:239],v[52:55],a[136:139]
v_add_f32 v95,v95,v74
v_add_f32 v95,v95,v75
MF a[140:143],a[236:239],v[56:59],a[140:143]
s_waitcnt lgkmcnt(2)
v_cvt_pk_bf16_f32 v61,v74,v75
v_add_f32 v96,v76,v77
L_st35:
MF v[0:3],a[216:219],v[144:147],v[80:83]
RD a[232:235],v216,24832
v_cvt_pk_bf16_f32 v64,v76,v77
MF v[4:7],a[216:219],v[148:151],v[84:87]
RD a[236:239],v217,24832
v_add_f32 v96,v96,v78
MF v[8:11],a[216:219],v[152:155],v[88:91]
v_exp_f32 v74,v42
MF v[0:3],a[220:223],v[156:159],v[0:3]
v_exp_f32 v75,v43
MF v[4:7],a[220:223],v[160:163],v[4:7]
buffer_load_dwordx4 v231,s[12:15],s35 offen offset:1024 nt lds
MF v[8:11],a[220:223],v[164:167],v[8:11]
s_waitcnt lgkmcnt(2)
v_exp_f32 v76,v44
MF v[0:3],a[224:227],v[168:171],v[0:3]
RD a[216:219],v216,30720
v_add_f32 v96,v96,v79
MF v[4:7],a[224:227],v[172:175],v[4:7]
RD a[220:223],v217,30720
v_cvt_pk_bf16_f32 v65,v78,v79
MF v[8:11],a[224:227],v[176:179],v[8:11]
v_exp_f32 v77,v45
MF v[0:3],a[228:231],v[180:183],v[0:3]
v_exp_f32 v78,v46
MF v[4:7],a[228:231],v[184:187],v[4:7]
v_exp_f32 v79,v47
MF v[8:11],a[228:231],v[188:191],v[8:11]
s_waitcnt lgkmcnt(2)
v_add_f32 v97,v120,v121
v_cvt_pk_bf16_f32 v68,v120,v121
MF v[0:3],a[232:235],v[192:195],v[0:3]
RD a[224:227],v216,30848
v_add_f32 v97,v97,v122
MF v[4:7],a[232:235],v[196:199],v[4:7]
RD a[228:231],v217,30848
v_add_f32 v97,v97,v123
MF v[8:11],a[232:235],v[200:203],v[8:11]
v_cvt_pk_bf16_f32 v69,v122,v123
v_add_f32 v95,v95,v124
MF v[0:3],a[236:239],v[204:207],v[0:3]
v_add_f32 v95,v95,v125
v_cvt_pk_bf16_f32 v62,v124,v125
MF v[4:7],a[236:239],v[208:211],v[4:7]
buffer_load_dwordx4 v232,s[12:15],s35 offen offset:2048 nt lds
MF v[8:11],a[236:239],v[212:215],v[8:11]
s_waitcnt lgkmcnt(2)
v_add_f32 v95,v95,v126
v_add_f32 v95,v95,v127
MF v[12:15],a[216:219],v[144:147],v[80:83]
RD a[232:235],v216,30976
v_cvt_pk_bf16_f32 v63,v126,v127
MF v[16:19],a[216:219],v[148:151],v[84:87]
RD a[236:239],v217,30976
v_add_f32 v96,v96,v72
MF v[20:23],a[216:219],v[152:155],v[88:91]
v_add_f32 v96,v96,v73
v_cvt_pk_bf16_f32 v66,v72,v73
MF v[12:15],a[220:223],v[156:159],v[12:15]
v_add_f32 v96,v96,v74
v_add_f32 v96,v96,v75
MF v[16:19],a[220:223],v[160:163],v[16:19]
v_cvt_pk_bf16_f32 v67,v74,v75
v_add_f32 v97,v97,v76
MF v[20:23],a[220:223],v[164:167],v[20:23]
s_waitcnt vmcnt(30) lgkmcnt(2)
s_barrier
v_add_f32 v97,v97,v77
MF v[12:15],a[224:227],v[168:171],v[12:15]
TR a[216:217],v218,24576
TR a[218:219],v218,30720
MF v[16:19],a[224:227],v[172:175],v[16:19]
TR a[220:221],v219,24576
TR a[222:223],v219,30720
MF v[20:23],a[224:227],v[176:179],v[20:23]
s_add_u32 m0,s32,122880
v_cvt_pk_bf16_f32 v70,v76,v77
v_add_f32 v97,v97,v78
MF v[12:15],a[228:231],v[180:183],v[12:15]
s_add_u32 s36,s33,172032
v_add_f32 v97,v97,v79
v_cvt_pk_bf16_f32 v71,v78,v79
MF v[16:19],a[228:231],v[184:187],v[16:19]
buffer_load_dwordx4 v230,s[8:11],s36 offen offset:0 nt lds
MF v[20:23],a[228:231],v[188:191],v[20:23]
s_waitcnt lgkmcnt(4)
v_max3_f32 v104,v95,v96,v97
v_cmp_lt_f32 vcc,s46,v104
MF v[12:15],a[232:235],v[192:195],v[12:15]
TR a[224:225],v220,24576
TR a[226:227],v220,30720
MF v[16:19],a[232:235],v[196:199],v[16:19]
TR a[228:229],v221,24576
TR a[230:231],v221,30720
MF v[20:23],a[232:235],v[200:203],v[20:23]
MF v[12:15],a[236:239],v[204:207],v[12:15]
MF v[16:19],a[236:239],v[208:211],v[16:19]
MF v[20:23],a[236:239],v[212:215],v[20:23]
s_waitcnt lgkmcnt(4)
s_cbranch_vccnz L_rs6
L_rr6:
L_st36:
MF a[0:3],a[216:219],v[60:63],a[0:3]
TR a[232:233],v218,24704
TR a[234:235],v218,30848
MF a[4:7],a[216:219],v[64:67],a[4:7]
TR a[236:237],v219,24704
TR a[238:239],v219,30848
MF a[8:11],a[216:219],v[68:71],a[8:11]
v_subrev_u32 v216,110592,v216
v_subrev_u32 v217,110592,v217
MF a[12:15],a[220:223],v[60:63],a[12:15]
v_exp_f32 v72,v0
MF a[16:19],a[220:223],v[64:67],a[16:19]
buffer_load_dwordx4 v231,s[8:11],s36 offen offset:1024 nt lds
MF a[20:23],a[220:223],v[68:71],a[20:23]
s_waitcnt lgkmcnt(4)
v_exp_f32 v73,v1
MF a[24:27],a[224:227],v[60:63],a[24:27]
TR a[216:217],v220,24704
TR a[218:219],v220,30848
MF a[28:31],a[224:227],v[64:67],a[28:31]
TR a[220:221],v221,24704
TR a[222:223],v221,30848
MF a[32:35],a[224:227],v[68:71],a[32:35]
v_exp_f32 v74,v2
MF a[36:39],a[228:231],v[60:63],a[36:39]
v_exp_f32 v75,v3
MF a[40:43],a[228:231],v[64:67],a[40:43]
v_exp_f32 v76,v4
MF a[44:47],a[228:231],v[68:71],a[44:47]
s_waitcnt lgkmcnt(4)
v_exp_f32 v77,v5
MF a[48:51],a[232:235],v[60:63],a[48:51]
TR a[224:225],v218,24832
TR a[226:227],v218,30976
MF a[52:55],a[232:235],v[64:67],a[52:55]
TR a[228:229],v219,24832
TR a[230:231],v219,30976
MF a[56:59],a[232:235],v[68:71],a[56:59]
v_exp_f32 v78,v6
MF a[60:63],a[236:239],v[60:63],a[60:63]
v_exp_f32 v79,v7
MF a[64:67],a[236:239],v[64:67],a[64:67]
buffer_load_dwordx4 v232,s[8:11],s36 offen offset:2048 nt lds
MF a[68:71],a[236:239],v[68:71],a[68:71]
s_waitcnt lgkmcnt(4)
v_exp_f32 v120,v8
MF a[72:75],a[216:219],v[60:63],a[72:75]
TR a[232:233],v220,24832
TR a[234:235],v220,30976
MF a[76:79],a[216:219],v[64:67],a[76:79]
TR a[236:237],v221,24832
TR a[238:239],v221,30976
MF a[80:83],a[216:219],v[68:71],a[80:83]
v_exp_f32 v121,v9
MF a[84:87],a[220:223],v[60:63],a[84:87]
v_exp_f32 v122,v10
MF a[88:91],a[220:223],v[64:67],a[88:91]
v_exp_f32 v123,v11
MF a[92:95],a[220:223],v[68:71],a[92:95]
s_waitcnt vmcnt(30) lgkmcnt(4)
s_barrier
v_add_f32 v92,v92,v95
MF a[96:99],a[224:227],v[60:63],a[96:99]
RD a[216:219],v216,0
v_add_f32 v93,v93,v96
MF a[100:103],a[224:227],v[64:67],a[100:103]
RD a[220:223],v217,0
v_add_f32 v94,v94,v97
MF a[104:107],a[224:227],v[68:71],a[104:107]
s_add_u32 m0,s32,135168
v_exp_f32 v124,v12
MF a[108:111],a[228:231],v[60:63],a[108:111]
s_add_u32 s35,s33,159744
v_exp_f32 v125,v13
MF a[112:115],a[228:231],v[64:67],a[112:115]
buffer_load_dwordx4 v230,s[12:15],s35 offen offset:0 nt lds
MF a[116:119],a[228:231],v[68:71],a[116:119]
s_waitcnt lgkmcnt(2)
v_exp_f32 v126,v14
MF a[120:123],a[232:235],v[60:63],a[120:123]
RD a[224:227],v216,128
v_add_f32 v95,v72,v73
MF a[124:127],a[232:235],v[64:67],a[124:127]
RD a[228:231],v217,128
v_cvt_pk_bf16_f32 v48,v72,v73
MF a[128:131],a[232:235],v[68:71],a[128:131]
v_exp_f32 v127,v15
MF a[132:135],a[236:239],v[60:63],a[132:135]
v_exp_f32 v72,v16
MF a[136:139],a[236:239],v[64:67],a[136:139]
v_exp_f32 v73,v17
MF a[140:143],a[236:239],v[68:71],a[140:143]
s_waitcnt lgkmcnt(2)
v_add_f32 v95,v95,v74
v_add_f32 v95,v95,v75
L_st37:
MF v[24:27],a[216:219],v[144:147],v[80:83]
RD a[232:235],v216,256
v_cvt_pk_bf16_f32 v49,v74,v75
MF v[28:31],a[216:219],v[148:151],v[84:87]
RD a[236:239],v217,256
v_add_f32 v96,v76,v77
MF v[32:35],a[216:219],v[152:155],v[88:91]
v_exp_f32 v74,v18
MF v[24:27],a[220:223],v[156:159],v[24:27]
v_exp_f32 v75,v19
MF v[28:31],a[220:223],v[160:163],v[28:31]
buffer_load_dwordx4 v231,s[12:15],s35 offen offset:1024 nt lds
MF v[32:35],a[220:223],v[164:167],v[32:35]
s_waitcnt lgkmcnt(2)
v_cvt_pk_bf16_f32 v52,v76,v77
v_add_f32 v96,v96,v78
MF v[24:27],a[224:227],v[168:171],v[24:27]
RD a[216:219],v216,6144
v_subrev_u32 v218,110592,v218
MF v[28:31],a[224:227],v[172:175],v[28:31]
RD a[220:223],v217,6144
v_subrev_u32 v219,110592,v219
MF v[32:35],a[224:227],v[176:179],v[32:35]
v_exp_f32 v76,v20
MF v[24:27],a[228:231],v[180:183],v[24:27]
v_exp_f32 v77,v21
MF v[28:31],a[228:231],v[184:187],v[28:31]
v_add_f32 v96,v96,v79
v_cvt_pk_bf16_f32 v53,v78,v79
MF v[32:35],a[228:231],v[188:191],v[32:35]
s_waitcnt lgkmcnt(2)
v_exp_f32 v78,v22
MF v[24:27],a[232:235],v[192:195],v[24:27]
RD a[224:227],v216,6272
v_subrev_u32 v220,110592,v220
MF v[28:31],a[232:235],v[196:199],v[28:31]
RD a[228:231],v217,6272
v_subrev_u32 v221,110592,v221
MF v[32:35],a[232:235],v[200:203],v[32:35]
v_exp_f32 v79,v23
MF v[24:27],a[236:239],v[204:207],v[24:27]
v_add_f32 v97,v120,v121
v_cvt_pk_bf16_f32 v56,v120,v121
MF v[28:31],a[236:239],v[208:211],v[28:31]
buffer_load_dwordx4 v232,s[12:15],s35 offen offset:2048 nt lds
MF v[32:35],a[236:239],v[212:215],v[32:35]
s_waitcnt lgkmcnt(2)
v_add_f32 v97,v97,v122
v_add_f32 v97,v97,v123
MF v[36:39],a[216:219],v[144:147],v[80:83]
RD a[232:235],v216,6400
v_cvt_pk_bf16_f32 v57,v122,v123
MF v[40:43],a[216:219],v[148:151],v[84:87]
RD a[236:239],v217,6400
v_add_f32 v95,v95,v124
MF v[44:47],a[216:219],v[152:155],v[88:91]
v_add_f32 v95,v95,v125
v_cvt_pk_bf16_f32 v50,v124,v125
MF v[36:39],a[220:223],v[156:159],v[36:39]
v_add_f32 v95,v95,v126
v_add_f32 v95,v95,v127
MF v[40:43],a[220:223],v[160:163],v[40:43]
v_cvt_pk_bf16_f32 v51,v126,v127
v_add_f32 v96,v96,v72
MF v[44:47],a[220:223],v[164:167],v[44:47]
s_waitcnt vmcnt(30) lgkmcnt(2)
s_barrier
v_add_f32 v96,v96,v73
MF v[36:39],a[224:227],v[168:171],v[36:39]
TR a[216:217],v218,0
TR a[218:219],v218,6144
MF v[40:43],a[224:227],v[172:175],v[40:43]
TR a[220:221],v219,0
TR a[222:223],v219,6144
MF v[44:47],a[224:227],v[176:179],v[44:47]
s_add_u32 m0,s32,147456
v_cvt_pk_bf16_f32 v54,v72,v73
v_add_f32 v96,v96,v74
MF v[36:39],a[228:231],v[180:183],v[36:39]
s_add_u32 s36,s33,184320
v_add_f32 v96,v96,v75
v_cvt_pk_bf16_f32 v55,v74,v75
MF v[40:43],a[228:231],v[184:187],v[40:43]
buffer_load_dwordx4 v230,s[8:11],s36 offen offset:0 nt lds
MF v[44:47],a[228:231],v[188:191],v[44:47]
s_waitcnt lgkmcnt(4)
v_add_f32 v97,v97,v76
v_add_f32 v97,v97,v77
MF v[36:39],a[232:235],v[192:195],v[36:39]
TR a[224:225],v220,0
TR a[226:227],v220,6144
MF v[40:43],a[232:235],v[196:199],v[40:43]
TR a[228:229],v221,0
TR a[230:231],v221,6144
MF v[44:47],a[232:235],v[200:203],v[44:47]
v_cvt_pk_bf16_f32 v58,v76,v77
v_add_f32 v97,v97,v78
MF v[36:39],a[236:239],v[204:207],v[36:39]
v_add_f32 v97,v97,v79
v_cvt_pk_bf16_f32 v59,v78,v79
MF v[40:43],a[236:239],v[208:211],v[40:43]
v_max3_f32 v104,v95,v96,v97
v_cmp_lt_f32 vcc,s46,v104
MF v[44:47],a[236:239],v[212:215],v[44:47]
s_waitcnt lgkmcnt(4)
s_cbranch_vccnz L_rs7
L_rr7:
L_st38:
MF a[0:3],a[216:219],v[48:51],a[0:3]
TR a[232:233],v218,128
TR a[234:235],v218,6272
MF a[4:7],a[216:219],v[52:55],a[4:7]
TR a[236:237],v219,128
TR a[238:239],v219,6272
MF a[8:11],a[216:219],v[56:59],a[8:11]
v_add_u32 v216,86016,v216
v_add_u32 v217,86016,v217
MF a[12:15],a[220:223],v[48:51],a[12:15]
v_exp_f32 v72,v24
MF a[16:19],a[220:223],v[52:55],a[16:19]
buffer_load_dwordx4 v231,s[8:11],s36 offen offset:1024 nt lds
MF a[20:23],a[220:223],v[56:59],a[20:23]
s_waitcnt lgkmcnt(4)
v_exp_f32 v73,v25
MF a[24:27],a[224:227],v[48:51],a[24:27]
TR a[216:217],v220,128
TR a[218:219],v220,6272
MF a[28:31],a[224:227],v[52:55],a[28:31]
TR a[220:221],v221,128
TR a[222:223],v221,6272
MF a[32:35],a[224:227],v[56:59],a[32:35]
v_exp_f32 v74,v26
MF a[36:39],a[228:231],v[48:51],a[36:39]
v_exp_f32 v75,v27
MF a[40:43],a[228:231],v[52:55],a[40:43]
v_exp_f32 v76,v28
MF a[44:47],a[228:231],v[56:59],a[44:47]
s_waitcnt lgkmcnt(4)
v_exp_f32 v77,v29
MF a[48:51],a[232:235],v[48:51],a[48:51]
TR a[224:225],v218,256
TR a[226:227],v218,6400
MF a[52:55],a[232:235],v[52:55],a[52:55]
TR a[228:229],v219,256
TR a[230:231],v219,6400
MF a[56:59],a[232:235],v[56:59],a[56:59]
v_exp_f32 v78,v30
MF a[60:63],a[236:239],v[48:51],a[60:63]
v_exp_f32 v79,v31
MF a[64:67],a[236:239],v[52:55],a[64:67]
buffer_load_dwordx4 v232,s[8:11],s36 offen offset:2048 nt lds
MF a[68:71],a[236:239],v[56:59],a[68:71]
s_waitcnt lgkmcnt(4)
v_exp_f32 v120,v32
MF a[72:75],a[216:219],v[48:51],a[72:75]
TR a[232:233],v220,256
TR a[234:235],v220,6400
MF a[76:79],a[216:219],v[52:55],a[76:79]
TR a[236:237],v221,256
TR a[238:239],v221,6400
MF a[80:83],a[216:219],v[56:59],a[80:83]
v_exp_f32 v121,v33
MF a[84:87],a[220:223],v[48:51],a[84:87]
v_exp_f32 v122,v34
MF a[88:91],a[220:223],v[52:55],a[88:91]
v_exp_f32 v123,v35
MF a[92:95],a[220:223],v[56:59],a[92:95]
s_waitcnt vmcnt(30) lgkmcnt(4)
s_barrier
v_add_f32 v92,v92,v95
MF a[96:99],a[224:227],v[48:51],a[96:99]
RD a[216:219],v216,0
v_add_f32 v93,v93,v96
MF a[100:103],a[224:227],v[52:55],a[100:103]
RD a[220:223],v217,0
v_add_f32 v94,v94,v97
MF a[104:107],a[224:227],v[56:59],a[104:107]
v_exp_f32 v124,v36
MF a[108:111],a[228:231],v[48:51],a[108:111]
v_exp_f32 v125,v37
MF a[112:115],a[228:231],v[52:55],a[112:115]
v_exp_f32 v126,v38
MF a[116:119],a[228:231],v[56:59],a[116:119]
s_waitcnt lgkmcnt(2)
v_exp_f32 v127,v39
MF a[120:123],a[232:235],v[48:51],a[120:123]
RD a[224:227],v216,128
v_add_f32 v95,v72,v73
MF a[124:127],a[232:235],v[52:55],a[124:127]
RD a[228:231],v217,128
v_cvt_pk_bf16_f32 v60,v72,v73
MF a[128:131],a[232:235],v[56:59],a[128:131]
v_exp_f32 v72,v40
MF a[132:135],a[236:239],v[48:51],a[132:135]
v_exp_f32 v73,v41
MF a[136:139],a[236:239],v[52:55],a[136:139]
v_add_f32 v95,v95,v74
v_add_f32 v95,v95,v75
MF a[140:143],a[236:239],v[56:59],a[140:143]
s_waitcnt lgkmcnt(2)
v_cvt_pk_bf16_f32 v61,v74,v75
v_add_f32 v96,v76,v77
L_st39:
MF v[0:3],a[216:219],v[144:147],v[80:83]
RD a[232:235],v216,256
v_cvt_pk_bf16_f32 v64,v76,v77
MF v[4:7],a[216:219],v[148:151],v[84:87]
RD a[236:239],v217,256
v_add_f32 v96,v96,v78
MF v[8:11],a[216:219],v[152:155],v[88:91]
v_exp_f32 v74,v42
MF v[0:3],a[220:223],v[156:159],v[0:3]
v_exp_f32 v75,v43
MF v[4:7],a[220:223],v[160:163],v[4:7]
v_exp_f32 v76,v44
MF v[8:11],a[220:223],v[164:167],v[8:11]
s_waitcnt lgkmcnt(2)
v_exp_f32 v77,v45
MF v[0:3],a[224:227],v[168:171],v[0:3]
RD a[216:219],v216,6144
v_add_u32 v218,86016,v218
MF v[4:7],a[224:227],v[172:175],v[4:7]
RD a[220:223],v217,6144
v_add_u32 v219,86016,v219
MF v[8:11],a[224:227],v[176:179],v[8:11]
v_add_f32 v96,v96,v79
v_cvt_pk_bf16_f32 v65,v78,v79
MF v[0:3],a[228:231],v[180:183],v[0:3]
v_exp_f32 v78,v46
MF v[4:7],a[228:231],v[184:187],v[4:7]
v_exp_f32 v79,v47
MF v[8:11],a[228:231],v[188:191],v[8:11]
s_waitcnt lgkmcnt(2)
v_add_f32 v97,v120,v121
v_cvt_pk_bf16_f32 v68,v120,v121
MF v[0:3],a[232:235],v[192:195],v[0:3]
RD a[224:227],v216,6272
v_add_u32 v220,86016,v220
MF v[4:7],a[232:235],v[196:199],v[4:7]
RD a[228:231],v217,6272
v_add_u32 v221,86016,v221
MF v[8:11],a[232:235],v[200:203],v[8:11]
v_add_f32 v97,v97,v122
v_add_f32 v97,v97,v123
MF v[0:3],a[236:239],v[204:207],v[0:3]
v_cvt_pk_bf16_f32 v69,v122,v123
v_add_f32 v95,v95,v124
MF v[4:7],a[236:239],v[208:211],v[4:7]
v_add_f32 v95,v95,v125
v_cvt_pk_bf16_f32 v62,v124,v125
MF v[8:11],a[236:239],v[212:215],v[8:11]
s_waitcnt lgkmcnt(2)
v_add_f32 v95,v95,v126
v_add_f32 v95,v95,v127
MF v[12:15],a[216:219],v[144:147],v[80:83]
RD a[232:235],v216,6400
v_cvt_pk_bf16_f32 v63,v126,v127
MF v[16:19],a[216:219],v[148:151],v[84:87]
RD a[236:239],v217,6400
v_add_f32 v96,v96,v72
MF v[20:23],a[216:219],v[152:155],v[88:91]
v_add_f32 v96,v96,v73
v_cvt_pk_bf16_f32 v66,v72,v73
MF v[12:15],a[220:223],v[156:159],v[12:15]
v_add_f32 v96,v96,v74
v_add_f32 v96,v96,v75
MF v[16:19],a[220:223],v[160:163],v[16:19]
v_cvt_pk_bf16_f32 v67,v74,v75
v_add_f32 v97,v97,v76
MF v[20:23],a[220:223],v[164:167],v[20:23]
s_waitcnt vmcnt(27) lgkmcnt(2)
s_barrier
v_add_f32 v97,v97,v77
MF v[12:15],a[224:227],v[168:171],v[12:15]
TR a[216:217],v218,0
TR a[218:219],v218,6144
MF v[16:19],a[224:227],v[172:175],v[16:19]
TR a[220:221],v219,0
TR a[222:223],v219,6144
MF v[20:23],a[224:227],v[176:179],v[20:23]
v_cvt_pk_bf16_f32 v70,v76,v77
v_add_f32 v97,v97,v78
MF v[12:15],a[228:231],v[180:183],v[12:15]
v_add_f32 v97,v97,v79
v_cvt_pk_bf16_f32 v71,v78,v79
MF v[16:19],a[228:231],v[184:187],v[16:19]
v_max3_f32 v104,v95,v96,v97
v_cmp_lt_f32 vcc,s46,v104
MF v[20:23],a[228:231],v[188:191],v[20:23]
s_waitcnt lgkmcnt(4)
MF v[12:15],a[232:235],v[192:195],v[12:15]
TR a[224:225],v220,0
TR a[226:227],v220,6144
MF v[16:19],a[232:235],v[196:199],v[16:19]
TR a[228:229],v221,0
TR a[230:231],v221,6144
MF v[20:23],a[232:235],v[200:203],v[20:23]
MF v[12:15],a[236:239],v[204:207],v[12:15]
MF v[16:19],a[236:239],v[208:211],v[16:19]
MF v[20:23],a[236:239],v[212:215],v[20:23]
s_waitcnt lgkmcnt(4)
s_cbranch_vccnz L_rs8
L_rr8:
L_st40:
MF a[0:3],a[216:219],v[60:63],a[0:3]
TR a[232:233],v218,128
TR a[234:235],v218,6272
MF a[4:7],a[216:219],v[64:67],a[4:7]
TR a[236:237],v219,128
TR a[238:239],v219,6272
MF a[8:11],a[216:219],v[68:71],a[8:11]
v_subrev_u32 v216,61440,v216
v_subrev_u32 v217,61440,v217
MF a[12:15],a[220:223],v[60:63],a[12:15]
v_exp_f32 v72,v0
MF a[16:19],a[220:223],v[64:67],a[16:19]
v_exp_f32 v73,v1
MF a[20:23],a[220:223],v[68:71],a[20:23]
s_waitcnt lgkmcnt(4)
v_exp_f32 v74,v2
MF a[24:27],a[224:227],v[60:63],a[24:27]
TR a[216:217],v220,128
TR a[218:219],v220,6272
MF a[28:31],a[224:227],v[64:67],a[28:31]
TR a[220:221],v221,128
TR a[222:223],v221,6272
MF a[32:35],a[224:227],v[68:71],a[32:35]
v_exp_f32 v75,v3
MF a[36:39],a[228:231],v[60:63],a[36:39]
v_exp_f32 v76,v4
MF a[40:43],a[228:231],v[64:67],a[40:43]
v_exp_f32 v77,v5
MF a[44:47],a[228:231],v[68:71],a[44:47]
s_waitcnt lgkmcnt(4)
v_exp_f32 v78,v6
MF a[48:51],a[232:235],v[60:63],a[48:51]
TR a[224:225],v218,256
TR a[226:227],v218,6400
MF a[52:55],a[232:235],v[64:67],a[52:55]
TR a[228:229],v219,256
TR a[230:231],v219,6400
MF a[56:59],a[232:235],v[68:71],a[56:59]
v_exp_f32 v79,v7
MF a[60:63],a[236:239],v[60:63],a[60:63]
v_exp_f32 v120,v8
MF a[64:67],a[236:239],v[64:67],a[64:67]
v_exp_f32 v121,v9
MF a[68:71],a[236:239],v[68:71],a[68:71]
s_waitcnt lgkmcnt(4)
v_exp_f32 v122,v10
MF a[72:75],a[216:219],v[60:63],a[72:75]
TR a[232:233],v220,256
TR a[234:235],v220,6400
MF a[76:79],a[216:219],v[64:67],a[76:79]
TR a[236:237],v221,256
TR a[238:239],v221,6400
MF a[80:83],a[216:219],v[68:71],a[80:83]
v_exp_f32 v123,v11
MF a[84:87],a[220:223],v[60:63],a[84:87]
v_exp_f32 v124,v12
MF a[88:91],a[220:223],v[64:67],a[88:91]
v_exp_f32 v125,v13
MF a[92:95],a[220:223],v[68:71],a[92:95]
s_waitcnt vmcnt(24) lgkmcnt(4)
s_barrier
v_add_f32 v92,v92,v95
MF a[96:99],a[224:227],v[60:63],a[96:99]
RD a[216:219],v216,0
v_add_f32 v93,v93,v96
MF a[100:103],a[224:227],v[64:67],a[100:103]
RD a[220:223],v217,0
v_add_f32 v94,v94,v97
MF a[104:107],a[224:227],v[68:71],a[104:107]
s_add_u32 m0,s32,86016
v_exp_f32 v126,v14
MF a[108:111],a[228:231],v[60:63],a[108:111]
s_add_u32 s35,s33,172032
v_exp_f32 v127,v15
MF a[112:115],a[228:231],v[64:67],a[112:115]
buffer_load_dwordx4 v230,s[12:15],s35 offen offset:0 nt lds
MF a[116:119],a[228:231],v[68:71],a[116:119]
s_waitcnt lgkmcnt(2)
v_add_f32 v95,v72,v73
v_cvt_pk_bf16_f32 v48,v72,v73
MF a[120:123],a[232:235],v[60:63],a[120:123]
RD a[224:227],v216,128
v_add_f32 v95,v95,v74
MF a[124:127],a[232:235],v[64:67],a[124:127]
RD a[228:231],v217,128
v_add_f32 v95,v95,v75
MF a[128:131],a[232:235],v[68:71],a[128:131]
v_exp_f32 v72,v16
MF a[132:135],a[236:239],v[60:63],a[132:135]
v_exp_f32 v73,v17
MF a[136:139],a[236:239],v[64:67],a[136:139]
v_cvt_pk_bf16_f32 v49,v74,v75
v_add_f32 v96,v76,v77
MF a[140:143],a[236:239],v[68:71],a[140:143]
s_waitcnt lgkmcnt(2)
v_exp_f32 v74,v18
L_st41:
MF v[24:27],a[216:219],v[144:147],v[80:83]
RD a[232:235],v216,256
v_cvt_pk_bf16_f32 v52,v76,v77
MF v[28:31],a[216:219],v[148:151],v[84:87]
RD a[236:239],v217,256
v_add_f32 v96,v96,v78
MF v[32:35],a[216:219],v[152:155],v[88:91]
v_exp_f32 v75,v19
MF v[24:27],a[220:223],v[156:159],v[24:27]
v_exp_f32 v76,v20
MF v[28:31],a[220:223],v[160:163],v[28:31]
buffer_load_dwordx4 v231,s[12:15],s35 offen offset:1024 nt lds
MF v[32:35],a[220:223],v[164:167],v[32:35]
s_waitcnt lgkmcnt(2)
v_exp_f32 v77,v21
MF v[24:27],a[224:227],v[168:171],v[24:27]
RD a[216:219],v216,6144
v_subrev_u32 v218,61440,v218
MF v[28:31],a[224:227],v[172:175],v[28:31]
RD a[220:223],v217,6144
v_subrev_u32 v219,61440,v219
MF v[32:35],a[224:227],v[176:179],v[32:35]
v_add_f32 v96,v96,v79
v_cvt_pk_bf16_f32 v53,v78,v79
MF v[24:27],a[228:231],v[180:183],v[24:27]
v_exp_f32 v78,v22
MF v[28:31],a[228:231],v[184:187],v[28:31]
v_exp_f32 v79,v23
MF v[32:35],a[228:231],v[188:191],v[32:35]
s_waitcnt lgkmcnt(2)
v_add_f32 v97,v120,v121
v_cvt_pk_bf16_f32 v56,v120,v121
MF v[24:27],a[232:235],v[192:195],v[24:27]
RD a[224:227],v216,6272
v_subrev_u32 v220,61440,v220
MF v[28:31],a[232:235],v[196:199],v[28:31]
RD a[228:231],v217,6272
v_subrev_u32 v221,61440,v221
MF v[32:35],a[232:235],v[200:203],v[32:35]
v_add_f32 v97,v97,v122
v_add_f32 v97,v97,v123
MF v[24:27],a[236:239],v[204:207],v[24:27]
v_cvt_pk_bf16_f32 v57,v122,v123
v_add_f32 v95,v95,v124
MF v[28:31],a[236:239],v[208:211],v[28:31]
buffer_load_dwordx4 v232,s[12:15],s35 offen offset:2048 nt lds
MF v[32:35],a[236:239],v[212:215],v[32:35]
s_waitcnt lgkmcnt(2)
v_add_f32 v95,v95,v125
v_cvt_pk_bf16_f32 v50,v124,v125
MF v[36:39],a[216:219],v[144:147],v[80:83]
RD a[232:235],v216,6400
v_add_f32 v95,v95,v126
MF v[40:43],a[216:219],v[148:151],v[84:87]
RD a[236:239],v217,6400
v_add_f32 v95,v95,v127
MF v[44:47],a[216:219],v[152:155],v[88:91]
v_cvt_pk_bf16_f32 v51,v126,v127
v_add_f32 v96,v96,v72
MF v[36:39],a[220:223],v[156:159],v[36:39]
v_add_f32 v96,v96,v73
v_cvt_pk_bf16_f32 v54,v72,v73
MF v[40:43],a[220:223],v[160:163],v[40:43]
v_add_f32 v96,v96,v74
v_add_f32 v96,v96,v75
MF v[44:47],a[220:223],v[164:167],v[44:47]
s_waitcnt vmcnt(24) lgkmcnt(2)
s_barrier
v_cvt_pk_bf16_f32 v55,v74,v75
MF v[36:39],a[224:227],v[168:171],v[36:39]
TR a[216:217],v218,0
TR a[218:219],v218,6144
MF v[40:43],a[224:227],v[172:175],v[40:43]
TR a[220:221],v219,0
TR a[222:223],v219,6144
MF v[44:47],a[224:227],v[176:179],v[44:47]
s_add_u32 m0,s32,98304
v_add_f32 v97,v97,v76
v_add_f32 v97,v97,v77
MF v[36:39],a[228:231],v[180:183],v[36:39]
s_add_u32 s36,s33,184320
v_cvt_pk_bf16_f32 v58,v76,v77
v_add_f32 v97,v97,v78
MF v[40:43],a[228:231],v[184:187],v[40:43]
buffer_load_dwordx4 v230,s[12:15],s36 offen offset:0 nt lds
MF v[44:47],a[228:231],v[188:191],v[44:47]
s_waitcnt lgkmcnt(4)
v_add_f32 v97,v97,v79
v_cvt_pk_bf16_f32 v59,v78,v79
MF v[36:39],a[232:235],v[192:195],v[36:39]
TR a[224:225],v220,0
TR a[226:227],v220,6144
MF v[40:43],a[232:235],v[196:199],v[40:43]
TR a[228:229],v221,0
TR a[230:231],v221,6144
MF v[44:47],a[232:235],v[200:203],v[44:47]
v_max3_f32 v104,v95,v96,v97
v_cmp_lt_f32 vcc,s46,v104
MF v[36:39],a[236:239],v[204:207],v[36:39]
MF v[40:43],a[236:239],v[208:211],v[40:43]
MF v[44:47],a[236:239],v[212:215],v[44:47]
s_waitcnt lgkmcnt(4)
s_cbranch_vccnz L_rs9
L_rr9:
L_st42:
MF a[0:3],a[216:219],v[48:51],a[0:3]
TR a[232:233],v218,128
TR a[234:235],v218,6272
MF a[4:7],a[216:219],v[52:55],a[4:7]
TR a[236:237],v219,128
TR a[238:239],v219,6272
MF a[8:11],a[216:219],v[56:59],a[8:11]
v_exp_f32 v72,v24
MF a[12:15],a[220:223],v[48:51],a[12:15]
v_exp_f32 v73,v25
MF a[16:19],a[220:223],v[52:55],a[16:19]
buffer_load_dwordx4 v231,s[12:15],s36 offen offset:1024 nt lds
MF a[20:23],a[220:223],v[56:59],a[20:23]
s_waitcnt lgkmcnt(4)
v_exp_f32 v74,v26
MF a[24:27],a[224:227],v[48:51],a[24:27]
TR a[216:217],v220,128
TR a[218:219],v220,6272
MF a[28:31],a[224:227],v[52:55],a[28:31]
TR a[220:221],v221,128
TR a[222:223],v221,6272
MF a[32:35],a[224:227],v[56:59],a[32:35]
v_exp_f32 v75,v27
MF a[36:39],a[228:231],v[48:51],a[36:39]
v_exp_f32 v76,v28
MF a[40:43],a[228:231],v[52:55],a[40:43]
v_exp_f32 v77,v29
MF a[44:47],a[228:231],v[56:59],a[44:47]
s_waitcnt lgkmcnt(4)
v_exp_f32 v78,v30
MF a[48:51],a[232:235],v[48:51],a[48:51]
TR a[224:225],v218,256
TR a[226:227],v218,6400
MF a[52:55],a[232:235],v[52:55],a[52:55]
TR a[228:229],v219,256
TR a[230:231],v219,6400
MF a[56:59],a[232:235],v[56:59],a[56:59]
v_exp_f32 v79,v31
MF a[60:63],a[236:239],v[48:51],a[60:63]
v_exp_f32 v120,v32
MF a[64:67],a[236:239],v[52:55],a[64:67]
buffer_load_dwordx4 v232,s[12:15],s36 offen offset:2048 nt lds
MF a[68:71],a[236:239],v[56:59],a[68:71]
s_waitcnt lgkmcnt(4)
v_exp_f32 v121,v33
MF a[72:75],a[216:219],v[48:51],a[72:75]
TR a[232:233],v220,256
TR a[234:235],v220,6400
MF a[76:79],a[216:219],v[52:55],a[76:79]
TR a[236:237],v221,256
TR a[238:239],v221,6400
MF a[80:83],a[216:219],v[56:59],a[80:83]
v_exp_f32 v122,v34
MF a[84:87],a[220:223],v[48:51],a[84:87]
v_exp_f32 v123,v35
MF a[88:91],a[220:223],v[52:55],a[88:91]
v_exp_f32 v124,v36
MF a[92:95],a[220:223],v[56:59],a[92:95]
s_waitcnt vmcnt(24) lgkmcnt(4)
s_barrier
v_add_f32 v92,v92,v95
MF a[96:99],a[224:227],v[48:51],a[96:99]
RD a[216:219],v216,24576
v_add_f32 v93,v93,v96
MF a[100:103],a[224:227],v[52:55],a[100:103]
RD a[220:223],v217,24576
v_add_f32 v94,v94,v97
MF a[104:107],a[224:227],v[56:59],a[104:107]
s_add_u32 m0,s41,0
v_exp_f32 v125,v37
MF a[108:111],a[228:231],v[48:51],a[108:111]
s_add_u32 s35,s37,0
v_exp_f32 v126,v38
MF a[112:115],a[228:231],v[52:55],a[112:115]
buffer_load_dwordx4 v233,s[4:7],s35 offen offset:0 lds
MF a[116:119],a[228:231],v[56:59],a[116:119]
s_waitcnt lgkmcnt(2)
v_exp_f32 v127,v39
MF a[120:123],a[232:235],v[48:51],a[120:123]
RD a[224:227],v216,24704
v_add_f32 v95,v72,v73
MF a[124:127],a[232:235],v[52:55],a[124:127]
RD a[228:231],v217,24704
v_cvt_pk_bf16_f32 v60,v72,v73
MF a[128:131],a[232:235],v[56:59],a[128:131]
v_exp_f32 v72,v40
MF a[132:135],a[236:239],v[48:51],a[132:135]
v_exp_f32 v73,v41
MF a[136:139],a[236:239],v[52:55],a[136:139]
buffer_load_dwordx4 v234,s[4:7],s35 offen offset:1024 lds
MF a[140:143],a[236:239],v[56:59],a[140:143]
s_waitcnt lgkmcnt(2)
v_add_f32 v95,v95,v74
v_add_f32 v95,v95,v75
L_st43:
MF v[0:3],a[216:219],v[144:147],v[80:83]
RD a[232:235],v216,24832
v_cvt_pk_bf16_f32 v61,v74,v75
MF v[4:7],a[216:219],v[148:151],v[84:87]
RD a[236:239],v217,24832
v_add_f32 v96,v76,v77
MF v[8:11],a[216:219],v[152:155],v[88:91]
v_exp_f32 v74,v42
MF v[0:3],a[220:223],v[156:159],v[0:3]
v_exp_f32 v75,v43
MF v[4:7],a[220:223],v[160:163],v[4:7]
buffer_load_dwordx4 v235,s[4:7],s35 offen offset:2048 lds
MF v[8:11],a[220:223],v[164:167],v[8:11]
s_waitcnt lgkmcnt(2)
v_cvt_pk_bf16_f32 v64,v76,v77
v_add_f32 v96,v96,v78
MF v[0:3],a[224:227],v[168:171],v[0:3]
RD a[216:219],v216,30720
v_add_f32 v96,v96,v79
MF v[4:7],a[224:227],v[172:175],v[4:7]
RD a[220:223],v217,30720
v_cvt_pk_bf16_f32 v65,v78,v79
MF v[8:11],a[224:227],v[176:179],v[8:11]
s_add_u32 m0,s41,3072
v_exp_f32 v76,v44
MF v[0:3],a[228:231],v[180:183],v[0:3]
s_add_u32 s36,s37,30720
v_exp_f32 v77,v45
MF v[4:7],a[228:231],v[184:187],v[4:7]
buffer_load_dwordx4 v233,s[4:7],s36 offen offset:0 lds
MF v[8:11],a[228:231],v[188:191],v[8:11]
s_waitcnt lgkmcnt(2)
v_exp_f32 v78,v46
MF v[0:3],a[232:235],v[192:195],v[0:3]
RD a[224:227],v216,30848
v_add_f32 v97,v120,v121
MF v[4:7],a[232:235],v[196:199],v[4:7]
RD a[228:231],v217,30848
v_cvt_pk_bf16_f32 v68,v120,v121
MF v[8:11],a[232:235],v[200:203],v[8:11]
v_exp_f32 v79,v47
MF v[0:3],a[236:239],v[204:207],v[0:3]
v_add_f32 v97,v97,v122
v_add_f32 v97,v97,v123
MF v[4:7],a[236:239],v[208:211],v[4:7]
buffer_load_dwordx4 v234,s[4:7],s36 offen offset:1024 lds
MF v[8:11],a[236:239],v[212:215],v[8:11]
s_waitcnt lgkmcnt(2)
v_cvt_pk_bf16_f32 v69,v122,v123
v_add_f32 v95,v95,v124
MF v[12:15],a[216:219],v[144:147],v[80:83]
RD a[232:235],v216,30976
v_add_f32 v95,v95,v125
MF v[16:19],a[216:219],v[148:151],v[84:87]
RD a[236:239],v217,30976
v_cvt_pk_bf16_f32 v62,v124,v125
MF v[20:23],a[216:219],v[152:155],v[88:91]
v_add_f32 v95,v95,v126
v_add_f32 v95,v95,v127
MF v[12:15],a[220:223],v[156:159],v[12:15]
v_cvt_pk_bf16_f32 v63,v126,v127
v_add_f32 v96,v96,v72
MF v[16:19],a[220:223],v[160:163],v[16:19]
buffer_load_dwordx4 v235,s[4:7],s36 offen offset:2048 lds
MF v[20:23],a[220:223],v[164:167],v[20:23]
s_waitcnt vmcnt(27) lgkmcnt(2)
s_barrier
v_add_f32 v96,v96,v73
MF v[12:15],a[224:227],v[168:171],v[12:15]
TR a[216:217],v218,24576
TR a[218:219],v218,30720
MF v[16:19],a[224:227],v[172:175],v[16:19]
TR a[220:221],v219,24576
TR a[222:223],v219,30720
MF v[20:23],a[224:227],v[176:179],v[20:23]
s_add_u32 m0,s41,24576
v_cvt_pk_bf16_f32 v66,v72,v73
v_add_f32 v96,v96,v74
MF v[12:15],a[228:231],v[180:183],v[12:15]
s_add_u32 s35,s37,128
v_add_f32 v96,v96,v75
v_cvt_pk_bf16_f32 v67,v74,v75
MF v[16:19],a[228:231],v[184:187],v[16:19]
buffer_load_dwordx4 v233,s[4:7],s35 offen offset:0 lds
MF v[20:23],a[228:231],v[188:191],v[20:23]
s_waitcnt lgkmcnt(4)
v_add_f32 v97,v97,v76
v_add_f32 v97,v97,v77
MF v[12:15],a[232:235],v[192:195],v[12:15]
TR a[224:225],v220,24576
TR a[226:227],v220,30720
MF v[16:19],a[232:235],v[196:199],v[16:19]
TR a[228:229],v221,24576
TR a[230:231],v221,30720
MF v[20:23],a[232:235],v[200:203],v[20:23]
v_cvt_pk_bf16_f32 v70,v76,v77
v_add_f32 v97,v97,v78
MF v[12:15],a[236:239],v[204:207],v[12:15]
v_add_f32 v97,v97,v79
v_cvt_pk_bf16_f32 v71,v78,v79
MF v[16:19],a[236:239],v[208:211],v[16:19]
buffer_load_dwordx4 v234,s[4:7],s35 offen offset:1024 lds
MF v[20:23],a[236:239],v[212:215],v[20:23]
s_waitcnt lgkmcnt(4)
v_max3_f32 v104,v95,v96,v97
v_cmp_lt_f32 vcc,s46,v104
s_cbranch_vccnz L_rs10
L_rr10:
L_st44:
MF a[0:3],a[216:219],v[60:63],a[0:3]
TR a[232:233],v218,24704
TR a[234:235],v218,30848
MF a[4:7],a[216:219],v[64:67],a[4:7]
TR a[236:237],v219,24704
TR a[238:239],v219,30848
MF a[8:11],a[216:219],v[68:71],a[8:11]
v_exp_f32 v72,v0
MF a[12:15],a[220:223],v[60:63],a[12:15]
v_exp_f32 v73,v1
MF a[16:19],a[220:223],v[64:67],a[16:19]
buffer_load_dwordx4 v235,s[4:7],s35 offen offset:2048 lds
MF a[20:23],a[220:223],v[68:71],a[20:23]
s_waitcnt lgkmcnt(4)
v_exp_f32 v74,v2
MF a[24:27],a[224:227],v[60:63],a[24:27]
TR a[216:217],v220,24704
TR a[218:219],v220,30848
MF a[28:31],a[224:227],v[64:67],a[28:31]
TR a[220:221],v221,24704
TR a[222:223],v221,30848
MF a[32:35],a[224:227],v[68:71],a[32:35]
s_add_u32 m0,s41,27648
v_exp_f32 v75,v3
MF a[36:39],a[228:231],v[60:63],a[36:39]
s_add_u32 s36,s37,30848
v_exp_f32 v76,v4
MF a[40:43],a[228:231],v[64:67],a[40:43]
buffer_load_dwordx4 v233,s[4:7],s36 offen offset:0 lds
MF a[44:47],a[228:231],v[68:71],a[44:47]
s_waitcnt lgkmcnt(4)
v_exp_f32 v77,v5
MF a[48:51],a[232:235],v[60:63],a[48:51]
TR a[224:225],v218,24832
TR a[226:227],v218,30976
MF a[52:55],a[232:235],v[64:67],a[52:55]
TR a[228:229],v219,24832
TR a[230:231],v219,30976
MF a[56:59],a[232:235],v[68:71],a[56:59]
v_exp_f32 v78,v6
MF a[60:63],a[236:239],v[60:63],a[60:63]
v_exp_f32 v79,v7
MF a[64:67],a[236:239],v[64:67],a[64:67]
buffer_load_dwordx4 v234,s[4:7],s36 offen offset:1024 lds
MF a[68:71],a[236:239],v[68:71],a[68:71]
s_waitcnt lgkmcnt(4)
v_exp_f32 v120,v8
MF a[72:75],a[216:219],v[60:63],a[72:75]
TR a[232:233],v220,24832
TR a[234:235],v220,30976
MF a[76:79],a[216:219],v[64:67],a[76:79]
TR a[236:237],v221,24832
TR a[238:239],v221,30976
MF a[80:83],a[216:219],v[68:71],a[80:83]
v_exp_f32 v121,v9
MF a[84:87],a[220:223],v[60:63],a[84:87]
v_exp_f32 v122,v10
MF a[88:91],a[220:223],v[64:67],a[88:91]
buffer_load_dwordx4 v235,s[4:7],s36 offen offset:2048 lds
MF a[92:95],a[220:223],v[68:71],a[92:95]
s_waitcnt vmcnt(30) lgkmcnt(4)
s_barrier
v_add_f32 v92,v92,v95
MF a[96:99],a[224:227],v[60:63],a[96:99]
RD a[216:219],v216,49152
v_add_f32 v93,v93,v96
MF a[100:103],a[224:227],v[64:67],a[100:103]
RD a[220:223],v217,49152
v_add_f32 v94,v94,v97
MF a[104:107],a[224:227],v[68:71],a[104:107]
s_add_u32 m0,s32,49152
v_exp_f32 v123,v11
MF a[108:111],a[228:231],v[60:63],a[108:111]
s_add_u32 s35,s34,384
v_exp_f32 v124,v12
MF a[112:115],a[228:231],v[64:67],a[112:115]
buffer_load_dwordx4 v236,s[28:31],s35 offen offset:0 lds
MF a[116:119],a[228:231],v[68:71],a[116:119]
s_waitcnt lgkmcnt(2)
v_exp_f32 v125,v13
MF a[120:123],a[232:235],v[60:63],a[120:123]
RD a[224:227],v216,49280
v_add_f32 v95,v72,v73
MF a[124:127],a[232:235],v[64:67],a[124:127]
RD a[228:231],v217,49280
v_cvt_pk_bf16_f32 v48,v72,v73
MF a[128:131],a[232:235],v[68:71],a[128:131]
v_exp_f32 v126,v14
MF a[132:135],a[236:239],v[60:63],a[132:135]
v_exp_f32 v127,v15
MF a[136:139],a[236:239],v[64:67],a[136:139]
v_exp_f32 v72,v16
MF a[140:143],a[236:239],v[68:71],a[140:143]
s_waitcnt lgkmcnt(2)
v_exp_f32 v73,v17
L_st45:
MF v[24:27],a[216:219],v[144:147],v[80:83]
RD a[232:235],v216,49408
v_add_f32 v95,v95,v74
MF v[28:31],a[216:219],v[148:151],v[84:87]
RD a[236:239],v217,49408
v_add_f32 v95,v95,v75
MF v[32:35],a[216:219],v[152:155],v[88:91]
v_cvt_pk_bf16_f32 v49,v74,v75
v_add_f32 v96,v76,v77
MF v[24:27],a[220:223],v[156:159],v[24:27]
v_exp_f32 v74,v18
MF v[28:31],a[220:223],v[160:163],v[28:31]
buffer_load_dwordx4 v237,s[28:31],s35 offen offset:1024 lds
MF v[32:35],a[220:223],v[164:167],v[32:35]
s_waitcnt lgkmcnt(2)
v_exp_f32 v75,v19
MF v[24:27],a[224:227],v[168:171],v[24:27]
RD a[216:219],v216,55296
v_add_u32 v218,49152,v218
MF v[28:31],a[224:227],v[172:175],v[28:31]
RD a[220:223],v217,55296
v_add_u32 v219,49152,v219
MF v[32:35],a[224:227],v[176:179],v[32:35]
v_cvt_pk_bf16_f32 v52,v76,v77
v_add_f32 v96,v96,v78
MF v[24:27],a[228:231],v[180:183],v[24:27]
v_exp_f32 v76,v20
MF v[28:31],a[228:231],v[184:187],v[28:31]
v_exp_f32 v77,v21
MF v[32:35],a[228:231],v[188:191],v[32:35]
s_waitcnt lgkmcnt(2)
v_add_f32 v96,v96,v79
v_cvt_pk_bf16_f32 v53,v78,v79
MF v[24:27],a[232:235],v[192:195],v[24:27]
RD a[224:227],v216,55424
v_add_u32 v220,49152,v220
MF v[28:31],a[232:235],v[196:199],v[28:31]
RD a[228:231],v217,55424
v_add_u32 v221,49152,v221
MF v[32:35],a[232:235],v[200:203],v[32:35]
v_exp_f32 v78,v22
MF v[24:27],a[236:239],v[204:207],v[24:27]
v_exp_f32 v79,v23
MF v[28:31],a[236:239],v[208:211],v[28:31]
buffer_load_dwordx4 v238,s[28:31],s35 offen offset:2048 lds
MF v[32:35],a[236:239],v[212:215],v[32:35]
s_waitcnt lgkmcnt(2)
v_add_f32 v97,v120,v121
v_cvt_pk_bf16_f32 v56,v120,v121
MF v[36:39],a[216:219],v[144:147],v[80:83]
RD a[232:235],v216,55552
v_add_f32 v97,v97,v122
MF v[40:43],a[216:219],v[148:151],v[84:87]
RD a[236:239],v217,55552
v_add_f32 v97,v97,v123
MF v[44:47],a[216:219],v[152:155],v[88:91]
v_cvt_pk_bf16_f32 v57,v122,v123
v_add_f32 v95,v95,v124
MF v[36:39],a[220:223],v[156:159],v[36:39]
v_add_f32 v95,v95,v125
v_cvt_pk_bf16_f32 v50,v124,v125
MF v[40:43],a[220:223],v[160:163],v[40:43]
v_add_f32 v95,v95,v126
v_add_f32 v95,v95,v127
MF v[44:47],a[220:223],v[164:167],v[44:47]
s_waitcnt vmcnt(30) lgkmcnt(2)
s_barrier
v_cvt_pk_bf16_f32 v51,v126,v127
MF v[36:39],a[224:227],v[168:171],v[36:39]
TR a[216:217],v218,24576
TR a[218:219],v218,30720
MF v[40:43],a[224:227],v[172:175],v[40:43]
TR a[220:221],v219,24576
TR a[222:223],v219,30720
MF v[44:47],a[224:227],v[176:179],v[44:47]
s_add_u32 m0,s32,61440
v_add_f32 v96,v96,v72
v_add_f32 v96,v96,v73
MF v[36:39],a[228:231],v[180:183],v[36:39]
s_add_u32 s36,s34,393600
v_cvt_pk_bf16_f32 v54,v72,v73
v_add_f32 v96,v96,v74
MF v[40:43],a[228:231],v[184:187],v[40:43]
buffer_load_dwordx4 v236,s[28:31],s36 offen offset:0 lds
MF v[44:47],a[228:231],v[188:191],v[44:47]
s_waitcnt lgkmcnt(4)
v_add_f32 v96,v96,v75
v_cvt_pk_bf16_f32 v55,v74,v75
MF v[36:39],a[232:235],v[192:195],v[36:39]
TR a[224:225],v220,24576
TR a[226:227],v220,30720
MF v[40:43],a[232:235],v[196:199],v[40:43]
TR a[228:229],v221,24576
TR a[230:231],v221,30720
MF v[44:47],a[232:235],v[200:203],v[44:47]
v_add_f32 v97,v97,v76
v_add_f32 v97,v97,v77
MF v[36:39],a[236:239],v[204:207],v[36:39]
v_cvt_pk_bf16_f32 v58,v76,v77
v_add_f32 v97,v97,v78
MF v[40:43],a[236:239],v[208:211],v[40:43]
v_add_f32 v97,v97,v79
v_cvt_pk_bf16_f32 v59,v78,v79
MF v[44:47],a[236:239],v[212:215],v[44:47]
s_waitcnt lgkmcnt(4)
v_max3_f32 v104,v95,v96,v97
v_cmp_lt_f32 vcc,s46,v104
s_cbranch_vccnz L_rs11
L_rr11:
L_st46:
MF a[0:3],a[216:219],v[48:51],a[0:3]
TR a[232:233],v218,24704
TR a[234:235],v218,30848
MF a[4:7],a[216:219],v[52:55],a[4:7]
TR a[236:237],v219,24704
TR a[238:239],v219,30848
MF a[8:11],a[216:219],v[56:59],a[8:11]
v_add_u32 v216,98304,v216
v_add_u32 v217,98304,v217
MF a[12:15],a[220:223],v[48:51],a[12:15]
v_exp_f32 v72,v24
MF a[16:19],a[220:223],v[52:55],a[16:19]
buffer_load_dwordx4 v237,s[28:31],s36 offen offset:1024 lds
MF a[20:23],a[220:223],v[56:59],a[20:23]
s_waitcnt lgkmcnt(4)
v_exp_f32 v73,v25
MF a[24:27],a[224:227],v[48:51],a[24:27]
TR a[216:217],v220,24704
TR a[218:219],v220,30848
MF a[28:31],a[224:227],v[52:55],a[28:31]
TR a[220:221],v221,24704
TR a[222:223],v221,30848
MF a[32:35],a[224:227],v[56:59],a[32:35]
v_exp_f32 v74,v26
MF a[36:39],a[228:231],v[48:51],a[36:39]
v_exp_f32 v75,v27
MF a[40:43],a[228:231],v[52:55],a[40:43]
v_exp_f32 v76,v28
MF a[44:47],a[228:231],v[56:59],a[44:47]
s_waitcnt lgkmcnt(4)
v_exp_f32 v77,v29
MF a[48:51],a[232:235],v[48:51],a[48:51]
TR a[224:225],v218,24832
TR a[226:227],v218,30976
MF a[52:55],a[232:235],v[52:55],a[52:55]
TR a[228:229],v219,24832
TR a[230:231],v219,30976
MF a[56:59],a[232:235],v[56:59],a[56:59]
v_exp_f32 v78,v30
MF a[60:63],a[236:239],v[48:51],a[60:63]
v_exp_f32 v79,v31
MF a[64:67],a[236:239],v[52:55],a[64:67]
buffer_load_dwordx4 v238,s[28:31],s36 offen offset:2048 lds
MF a[68:71],a[236:239],v[56:59],a[68:71]
s_waitcnt lgkmcnt(4)
v_exp_f32 v120,v32
MF a[72:75],a[216:219],v[48:51],a[72:75]
TR a[232:233],v220,24832
TR a[234:235],v220,30976
MF a[76:79],a[216:219],v[52:55],a[76:79]
TR a[236:237],v221,24832
TR a[238:239],v221,30976
MF a[80:83],a[216:219],v[56:59],a[80:83]
v_exp_f32 v121,v33
MF a[84:87],a[220:223],v[48:51],a[84:87]
v_exp_f32 v122,v34
MF a[88:91],a[220:223],v[52:55],a[88:91]
v_exp_f32 v123,v35
MF a[92:95],a[220:223],v[56:59],a[92:95]
s_waitcnt vmcnt(30) lgkmcnt(4)
s_barrier
v_add_f32 v92,v92,v95
MF a[96:99],a[224:227],v[48:51],a[96:99]
RD a[216:219],v216,0
v_add_f32 v93,v93,v96
MF a[100:103],a[224:227],v[52:55],a[100:103]
RD a[220:223],v217,0
v_add_f32 v94,v94,v97
MF a[104:107],a[224:227],v[56:59],a[104:107]
s_add_u32 m0,s32,73728
v_exp_f32 v124,v36
MF a[108:111],a[228:231],v[48:51],a[108:111]
s_add_u32 s35,s34,786816
v_exp_f32 v125,v37
MF a[112:115],a[228:231],v[52:55],a[112:115]
buffer_load_dwordx4 v236,s[28:31],s35 offen offset:0 lds
MF a[116:119],a[228:231],v[56:59],a[116:119]
s_waitcnt lgkmcnt(2)
v_exp_f32 v126,v38
MF a[120:123],a[232:235],v[48:51],a[120:123]
RD a[224:227],v216,128
v_add_f32 v95,v72,v73
MF a[124:127],a[232:235],v[52:55],a[124:127]
RD a[228:231],v217,128
v_cvt_pk_bf16_f32 v60,v72,v73
MF a[128:131],a[232:235],v[56:59],a[128:131]
v_exp_f32 v127,v39
MF a[132:135],a[236:239],v[48:51],a[132:135]
v_exp_f32 v72,v40
MF a[136:139],a[236:239],v[52:55],a[136:139]
v_exp_f32 v73,v41
MF a[140:143],a[236:239],v[56:59],a[140:143]
s_waitcnt lgkmcnt(2)
v_add_f32 v95,v95,v74
v_add_f32 v95,v95,v75
L_st47:
MF v[0:3],a[216:219],v[144:147],v[80:83]
RD a[232:235],v216,256
v_cvt_pk_bf16_f32 v61,v74,v75
MF v[4:7],a[216:219],v[148:151],v[84:87]
RD a[236:239],v217,256
v_add_f32 v96,v76,v77
MF v[8:11],a[216:219],v[152:155],v[88:91]
v_exp_f32 v74,v42
MF v[0:3],a[220:223],v[156:159],v[0:3]
v_exp_f32 v75,v43
MF v[4:7],a[220:223],v[160:163],v[4:7]
buffer_load_dwordx4 v237,s[28:31],s35 offen offset:1024 lds
MF v[8:11],a[220:223],v[164:167],v[8:11]
s_waitcnt lgkmcnt(2)
v_cvt_pk_bf16_f32 v64,v76,v77
v_add_f32 v96,v96,v78
MF v[0:3],a[224:227],v[168:171],v[0:3]
RD a[216:219],v216,6144
v_add_f32 v96,v96,v79
MF v[4:7],a[224:227],v[172:175],v[4:7]
RD a[220:223],v217,6144
v_cvt_pk_bf16_f32 v65,v78,v79
MF v[8:11],a[224:227],v[176:179],v[8:11]
v_exp_f32 v76,v44
MF v[0:3],a[228:231],v[180:183],v[0:3]
v_exp_f32 v77,v45
MF v[4:7],a[228:231],v[184:187],v[4:7]
v_exp_f32 v78,v46
MF v[8:11],a[228:231],v[188:191],v[8:11]
s_waitcnt lgkmcnt(2)
v_exp_f32 v79,v47
MF v[0:3],a[232:235],v[192:195],v[0:3]
RD a[224:227],v216,6272
v_add_f32 v97,v120,v121
MF v[4:7],a[232:235],v[196:199],v[4:7]
RD a[228:231],v217,6272
v_cvt_pk_bf16_f32 v68,v120,v121
MF v[8:11],a[232:235],v[200:203],v[8:11]
v_add_f32 v97,v97,v122
v_add_f32 v97,v97,v123
MF v[0:3],a[236:239],v[204:207],v[0:3]
v_cvt_pk_bf16_f32 v69,v122,v123
v_add_f32 v95,v95,v124
MF v[4:7],a[236:239],v[208:211],v[4:7]
buffer_load_dwordx4 v238,s[28:31],s35 offen offset:2048 lds
MF v[8:11],a[236:239],v[212:215],v[8:11]
s_waitcnt lgkmcnt(2)
v_add_f32 v95,v95,v125
v_cvt_pk_bf16_f32 v62,v124,v125
MF v[12:15],a[216:219],v[144:147],v[80:83]
RD a[232:235],v216,6400
v_add_f32 v95,v95,v126
MF v[16:19],a[216:219],v[148:151],v[84:87]
RD a[236:239],v217,6400
v_add_f32 v95,v95,v127
MF v[20:23],a[216:219],v[152:155],v[88:91]
v_cvt_pk_bf16_f32 v63,v126,v127
v_add_f32 v96,v96,v72
MF v[12:15],a[220:223],v[156:159],v[12:15]
v_add_f32 v96,v96,v73
v_cvt_pk_bf16_f32 v66,v72,v73
MF v[16:19],a[220:223],v[160:163],v[16:19]
v_add_f32 v96,v96,v74
v_add_f32 v96,v96,v75
MF v[20:23],a[220:223],v[164:167],v[20:23]
s_waitcnt vmcnt(30) lgkmcnt(2)
s_barrier
v_cvt_pk_bf16_f32 v67,v74,v75
MF v[12:15],a[224:227],v[168:171],v[12:15]
TR a[216:217],v218,49152
TR a[218:219],v218,55296
MF v[16:19],a[224:227],v[172:175],v[16:19]
TR a[220:221],v219,49152
TR a[222:223],v219,55296
MF v[20:23],a[224:227],v[176:179],v[20:23]
s_add_u32 m0,s32,110592
v_add_f32 v97,v97,v76
v_add_f32 v97,v97,v77
MF v[12:15],a[228:231],v[180:183],v[12:15]
s_add_u32 s36,s34,1180032
v_cvt_pk_bf16_f32 v70,v76,v77
v_add_f32 v97,v97,v78
MF v[16:19],a[228:231],v[184:187],v[16:19]
buffer_load_dwordx4 v236,s[28:31],s36 offen offset:0 lds
MF v[20:23],a[228:231],v[188:191],v[20:23]
s_waitcnt lgkmcnt(4)
v_add_f32 v97,v97,v79
v_cvt_pk_bf16_f32 v71,v78,v79
MF v[12:15],a[232:235],v[192:195],v[12:15]
TR a[224:225],v220,49152
TR a[226:227],v220,55296
MF v[16:19],a[232:235],v[196:199],v[16:19]
TR a[228:229],v221,49152
TR a[230:231],v221,55296
MF v[20:23],a[232:235],v[200:203],v[20:23]
v_max3_f32 v104,v95,v96,v97
v_cmp_lt_f32 vcc,s46,v104
MF v[12:15],a[236:239],v[204:207],v[12:15]
MF v[16:19],a[236:239],v[208:211],v[16:19]
MF v[20:23],a[236:239],v[212:215],v[20:23]
s_waitcnt lgkmcnt(4)
s_cbranch_vccnz L_rs12
L_rr12:
L_st48:
MF a[0:3],a[216:219],v[60:63],a[0:3]
TR a[232:233],v218,49280
TR a[234:235],v218,55424
MF a[4:7],a[216:219],v[64:67],a[4:7]
TR a[236:237],v219,49280
TR a[238:239],v219,55424
MF a[8:11],a[216:219],v[68:71],a[8:11]
v_exp_f32 v72,v0
MF a[12:15],a[220:223],v[60:63],a[12:15]
v_exp_f32 v73,v1
MF a[16:19],a[220:223],v[64:67],a[16:19]
buffer_load_dwordx4 v237,s[28:31],s36 offen offset:1024 lds
MF a[20:23],a[220:223],v[68:71],a[20:23]
s_waitcnt lgkmcnt(4)
v_exp_f32 v74,v2
MF a[24:27],a[224:227],v[60:63],a[24:27]
TR a[216:217],v220,49280
TR a[218:219],v220,55424
MF a[28:31],a[224:227],v[64:67],a[28:31]
TR a[220:221],v221,49280
TR a[222:223],v221,55424
MF a[32:35],a[224:227],v[68:71],a[32:35]
v_exp_f32 v75,v3
MF a[36:39],a[228:231],v[60:63],a[36:39]
v_exp_f32 v76,v4
MF a[40:43],a[228:231],v[64:67],a[40:43]
v_exp_f32 v77,v5
MF a[44:47],a[228:231],v[68:71],a[44:47]
s_waitcnt lgkmcnt(4)
v_exp_f32 v78,v6
MF a[48:51],a[232:235],v[60:63],a[48:51]
TR a[224:225],v218,49408
TR a[226:227],v218,55552
MF a[52:55],a[232:235],v[64:67],a[52:55]
TR a[228:229],v219,49408
TR a[230:231],v219,55552
MF a[56:59],a[232:235],v[68:71],a[56:59]
v_exp_f32 v79,v7
MF a[60:63],a[236:239],v[60:63],a[60:63]
v_exp_f32 v120,v8
MF a[64:67],a[236:239],v[64:67],a[64:67]
buffer_load_dwordx4 v238,s[28:31],s36 offen offset:2048 lds
MF a[68:71],a[236:239],v[68:71],a[68:71]
s_waitcnt lgkmcnt(4)
v_exp_f32 v121,v9
MF a[72:75],a[216:219],v[60:63],a[72:75]
TR a[232:233],v220,49408
TR a[234:235],v220,55552
MF a[76:79],a[216:219],v[64:67],a[76:79]
TR a[236:237],v221,49408
TR a[238:239],v221,55552
MF a[80:83],a[216:219],v[68:71],a[80:83]
v_exp_f32 v122,v10
MF a[84:87],a[220:223],v[60:63],a[84:87]
v_exp_f32 v123,v11
MF a[88:91],a[220:223],v[64:67],a[88:91]
v_exp_f32 v124,v12
MF a[92:95],a[220:223],v[68:71],a[92:95]
s_waitcnt vmcnt(30) lgkmcnt(4)
s_barrier
v_add_f32 v92,v92,v95
MF a[96:99],a[224:227],v[60:63],a[96:99]
RD a[216:219],v216,24576
v_add_f32 v93,v93,v96
MF a[100:103],a[224:227],v[64:67],a[100:103]
RD a[220:223],v217,24576
v_add_f32 v94,v94,v97
MF a[104:107],a[224:227],v[68:71],a[104:107]
s_add_u32 m0,s32,122880
v_exp_f32 v125,v13
MF a[108:111],a[228:231],v[60:63],a[108:111]
s_add_u32 s35,s34,1573248
v_exp_f32 v126,v14
MF a[112:115],a[228:231],v[64:67],a[112:115]
buffer_load_dwordx4 v236,s[28:31],s35 offen offset:0 lds
MF a[116:119],a[228:231],v[68:71],a[116:119]
s_waitcnt lgkmcnt(2)
v_exp_f32 v127,v15
MF a[120:123],a[232:235],v[60:63],a[120:123]
RD a[224:227],v216,24704
v_add_f32 v95,v72,v73
MF a[124:127],a[232:235],v[64:67],a[124:127]
RD a[228:231],v217,24704
v_cvt_pk_bf16_f32 v48,v72,v73
MF a[128:131],a[232:235],v[68:71],a[128:131]
v_exp_f32 v72,v16
MF a[132:135],a[236:239],v[60:63],a[132:135]
v_exp_f32 v73,v17
MF a[136:139],a[236:239],v[64:67],a[136:139]
v_add_f32 v95,v95,v74
v_add_f32 v95,v95,v75
MF a[140:143],a[236:239],v[68:71],a[140:143]
s_waitcnt lgkmcnt(2)
v_cvt_pk_bf16_f32 v49,v74,v75
v_add_f32 v96,v76,v77
L_st49:
MF v[24:27],a[216:219],v[144:147],v[80:83]
RD a[232:235],v216,24832
v_cvt_pk_bf16_f32 v52,v76,v77
MF v[28:31],a[216:219],v[148:151],v[84:87]
RD a[236:239],v217,24832
v_add_f32 v96,v96,v78
MF v[32:35],a[216:219],v[152:155],v[88:91]
v_exp_f32 v74,v18
MF v[24:27],a[220:223],v[156:159],v[24:27]
v_exp_f32 v75,v19
MF v[28:31],a[220:223],v[160:163],v[28:31]
buffer_load_dwordx4 v237,s[28:31],s35 offen offset:1024 lds
MF v[32:35],a[220:223],v[164:167],v[32:35]
s_waitcnt lgkmcnt(2)
v_exp_f32 v76,v20
MF v[24:27],a[224:227],v[168:171],v[24:27]
RD a[216:219],v216,30720
v_add_f32 v96,v96,v79
MF v[28:31],a[224:227],v[172:175],v[28:31]
RD a[220:223],v217,30720
v_cvt_pk_bf16_f32 v53,v78,v79
MF v[32:35],a[224:227],v[176:179],v[32:35]
v_exp_f32 v77,v21
MF v[24:27],a[228:231],v[180:183],v[24:27]
v_exp_f32 v78,v22
MF v[28:31],a[228:231],v[184:187],v[28:31]
v_exp_f32 v79,v23
MF v[32:35],a[228:231],v[188:191],v[32:35]
s_waitcnt lgkmcnt(2)
v_add_f32 v97,v120,v121
v_cvt_pk_bf16_f32 v56,v120,v121
MF v[24:27],a[232:235],v[192:195],v[24:27]
RD a[224:227],v216,30848
v_add_f32 v97,v97,v122
MF v[28:31],a[232:235],v[196:199],v[28:31]
RD a[228:231],v217,30848
v_add_f32 v97,v97,v123
MF v[32:35],a[232:235],v[200:203],v[32:35]
v_cvt_pk_bf16_f32 v57,v122,v123
v_add_f32 v95,v95,v124
MF v[24:27],a[236:239],v[204:207],v[24:27]
v_add_f32 v95,v95,v125
v_cvt_pk_bf16_f32 v50,v124,v125
MF v[28:31],a[236:239],v[208:211],v[28:31]
buffer_load_dwordx4 v238,s[28:31],s35 offen offset:2048 lds
MF v[32:35],a[236:239],v[212:215],v[32:35]
s_waitcnt lgkmcnt(2)
v_add_f32 v95,v95,v126
v_add_f32 v95,v95,v127
MF v[36:39],a[216:219],v[144:147],v[80:83]
RD a[232:235],v216,30976
v_cvt_pk_bf16_f32 v51,v126,v127
MF v[40:43],a[216:219],v[148:151],v[84:87]
RD a[236:239],v217,30976
v_add_f32 v96,v96,v72
MF v[44:47],a[216:219],v[152:155],v[88:91]
v_add_f32 v96,v96,v73
v_cvt_pk_bf16_f32 v54,v72,v73
MF v[36:39],a[220:223],v[156:159],v[36:39]
v_add_f32 v96,v96,v74
v_add_f32 v96,v96,v75
MF v[40:43],a[220:223],v[160:163],v[40:43]
v_cvt_pk_bf16_f32 v55,v74,v75
v_add_f32 v97,v97,v76
MF v[44:47],a[220:223],v[164:167],v[44:47]
s_waitcnt vmcnt(30) lgkmcnt(2)
s_barrier
v_add_f32 v97,v97,v77
MF v[36:39],a[224:227],v[168:171],v[36:39]
TR a[216:217],v218,0
TR a[218:219],v218,6144
MF v[40:43],a[224:227],v[172:175],v[40:43]
TR a[220:221],v219,0
TR a[222:223],v219,6144
MF v[44:47],a[224:227],v[176:179],v[44:47]
s_add_u32 m0,s32,135168
v_cvt_pk_bf16_f32 v58,v76,v77
v_add_f32 v97,v97,v78
MF v[36:39],a[228:231],v[180:183],v[36:39]
s_add_u32 s36,s34,1966464
v_add_f32 v97,v97,v79
v_cvt_pk_bf16_f32 v59,v78,v79
MF v[40:43],a[228:231],v[184:187],v[40:43]
buffer_load_dwordx4 v236,s[28:31],s36 offen offset:0 lds
MF v[44:47],a[228:231],v[188:191],v[44:47]
s_waitcnt lgkmcnt(4)
v_max3_f32 v104,v95,v96,v97
v_cmp_lt_f32 vcc,s46,v104
MF v[36:39],a[232:235],v[192:195],v[36:39]
TR a[224:225],v220,0
TR a[226:227],v220,6144
MF v[40:43],a[232:235],v[196:199],v[40:43]
TR a[228:229],v221,0
TR a[230:231],v221,6144
MF v[44:47],a[232:235],v[200:203],v[44:47]
MF v[36:39],a[236:239],v[204:207],v[36:39]
MF v[40:43],a[236:239],v[208:211],v[40:43]
MF v[44:47],a[236:239],v[212:215],v[44:47]
s_waitcnt lgkmcnt(4)
s_cbranch_vccnz L_rs13
L_rr13:
L_st50:
MF a[0:3],a[216:219],v[48:51],a[0:3]
TR a[232:233],v218,128
TR a[234:235],v218,6272
MF a[4:7],a[216:219],v[52:55],a[4:7]
TR a[236:237],v219,128
TR a[238:239],v219,6272
MF a[8:11],a[216:219],v[56:59],a[8:11]
v_exp_f32 v72,v24
MF a[12:15],a[220:223],v[48:51],a[12:15]
v_exp_f32 v73,v25
MF a[16:19],a[220:223],v[52:55],a[16:19]
buffer_load_dwordx4 v237,s[28:31],s36 offen offset:1024 lds
MF a[20:23],a[220:223],v[56:59],a[20:23]
s_waitcnt lgkmcnt(4)
v_exp_f32 v74,v26
MF a[24:27],a[224:227],v[48:51],a[24:27]
TR a[216:217],v220,128
TR a[218:219],v220,6272
MF a[28:31],a[224:227],v[52:55],a[28:31]
TR a[220:221],v221,128
TR a[222:223],v221,6272
MF a[32:35],a[224:227],v[56:59],a[32:35]
v_exp_f32 v75,v27
MF a[36:39],a[228:231],v[48:51],a[36:39]
v_exp_f32 v76,v28
MF a[40:43],a[228:231],v[52:55],a[40:43]
v_exp_f32 v77,v29
MF a[44:47],a[228:231],v[56:59],a[44:47]
s_waitcnt lgkmcnt(4)
v_exp_f32 v78,v30
MF a[48:51],a[232:235],v[48:51],a[48:51]
TR a[224:225],v218,256
TR a[226:227],v218,6400
MF a[52:55],a[232:235],v[52:55],a[52:55]
TR a[228:229],v219,256
TR a[230:231],v219,6400
MF a[56:59],a[232:235],v[56:59],a[56:59]
v_exp_f32 v79,v31
MF a[60:63],a[236:239],v[48:51],a[60:63]
v_exp_f32 v120,v32
MF a[64:67],a[236:239],v[52:55],a[64:67]
buffer_load_dwordx4 v238,s[28:31],s36 offen offset:2048 lds
MF a[68:71],a[236:239],v[56:59],a[68:71]
s_waitcnt lgkmcnt(4)
v_exp_f32 v121,v33
MF a[72:75],a[216:219],v[48:51],a[72:75]
TR a[232:233],v220,256
TR a[234:235],v220,6400
MF a[76:79],a[216:219],v[52:55],a[76:79]
TR a[236:237],v221,256
TR a[238:239],v221,6400
MF a[80:83],a[216:219],v[56:59],a[80:83]
v_exp_f32 v122,v34
MF a[84:87],a[220:223],v[48:51],a[84:87]
v_exp_f32 v123,v35
MF a[88:91],a[220:223],v[52:55],a[88:91]
v_exp_f32 v124,v36
MF a[92:95],a[220:223],v[56:59],a[92:95]
s_waitcnt vmcnt(30) lgkmcnt(4)
s_barrier
v_add_f32 v92,v92,v95
MF a[96:99],a[224:227],v[48:51],a[96:99]
TR a[216:217],v218,12288
TR a[218:219],v218,18432
MF a[100:103],a[224:227],v[52:55],a[100:103]
TR a[220:221],v219,12288
TR a[222:223],v219,18432
MF a[104:107],a[224:227],v[56:59],a[104:107]
s_add_u32 m0,s32,147456
v_exp_f32 v125,v37
MF a[108:111],a[228:231],v[48:51],a[108:111]
s_add_u32 s35,s33,196608
v_exp_f32 v126,v38
MF a[112:115],a[228:231],v[52:55],a[112:115]
buffer_load_dwordx4 v230,s[8:11],s35 offen offset:0 nt lds
MF a[116:119],a[228:231],v[56:59],a[116:119]
s_waitcnt lgkmcnt(4)
v_exp_f32 v127,v39
MF a[120:123],a[232:235],v[48:51],a[120:123]
TR a[224:225],v220,12288
TR a[226:227],v220,18432
MF a[124:127],a[232:235],v[52:55],a[124:127]
TR a[228:229],v221,12288
TR a[230:231],v221,18432
MF a[128:131],a[232:235],v[56:59],a[128:131]
v_add_f32 v93,v93,v96
v_add_f32 v94,v94,v97
MF a[132:135],a[236:239],v[48:51],a[132:135]
v_add_f32 v95,v72,v73
v_cvt_pk_bf16_f32 v60,v72,v73
MF a[136:139],a[236:239],v[52:55],a[136:139]
v_exp_f32 v72,v40
MF a[140:143],a[236:239],v[56:59],a[140:143]
s_waitcnt lgkmcnt(4)
v_exp_f32 v73,v41
v_add_f32 v95,v95,v74
v_add_f32 v95,v95,v75
v_cvt_pk_bf16_f32 v61,v74,v75
v_add_f32 v96,v76,v77
v_cvt_pk_bf16_f32 v64,v76,v77
v_add_f32 v96,v96,v78
v_add_f32 v96,v96,v79
v_cvt_pk_bf16_f32 v65,v78,v79
v_add_f32 v97,v120,v121
v_cvt_pk_bf16_f32 v68,v120,v121
v_add_f32 v97,v97,v122
v_add_f32 v97,v97,v123
v_cvt_pk_bf16_f32 v69,v122,v123
v_add_f32 v95,v95,v124
v_add_f32 v95,v95,v125
v_cvt_pk_bf16_f32 v62,v124,v125
v_add_f32 v95,v95,v126
v_add_f32 v95,v95,v127
v_cvt_pk_bf16_f32 v63,v126,v127
v_add_f32 v96,v96,v72
v_add_f32 v96,v96,v73
v_cvt_pk_bf16_f32 v66,v72,v73
v_exp_f32 v74,v42
v_exp_f32 v75,v43
v_add_f32 v96,v96,v74
v_add_f32 v96,v96,v75
v_cvt_pk_bf16_f32 v67,v74,v75
v_exp_f32 v76,v44
v_exp_f32 v77,v45
v_add_f32 v97,v97,v76
v_add_f32 v97,v97,v77
v_cvt_pk_bf16_f32 v70,v76,v77
v_exp_f32 v78,v46
v_exp_f32 v79,v47
v_add_f32 v97,v97,v78
v_add_f32 v97,v97,v79
v_cvt_pk_bf16_f32 v71,v78,v79
v_max3_f32 v104,v95,v96,v97
v_cmp_lt_f32 vcc,s46,v104
s_cbranch_vccnz L_rs14
L_rr14:
v_add_f32 v92,v92,v95
v_add_f32 v93,v93,v96
v_add_f32 v94,v94,v97
L_st51:
MF a[0:3],a[216:219],v[60:63],a[0:3]
TR a[232:233],v218,12416
TR a[234:235],v218,18560
MF a[4:7],a[216:219],v[64:67],a[4:7]
TR a[236:237],v219,12416
TR a[238:239],v219,18560
MF a[8:11],a[216:219],v[68:71],a[8:11]
v_mov_b32 v101,v92
v_mov_b32 v102,v93
MF a[12:15],a[220:223],v[60:63],a[12:15]
v_mov_b32 v103,v94
MF a[16:19],a[220:223],v[64:67],a[16:19]
buffer_load_dwordx4 v231,s[8:11],s35 offen offset:1024 nt lds
MF a[20:23],a[220:223],v[68:71],a[20:23]
s_waitcnt lgkmcnt(4)
v_permlane32_swap_b32 v92,v101
v_permlane32_swap_b32 v93,v102
MF a[24:27],a[224:227],v[60:63],a[24:27]
TR a[216:217],v220,12416
TR a[218:219],v220,18560
MF a[28:31],a[224:227],v[64:67],a[28:31]
TR a[220:221],v221,12416
TR a[222:223],v221,18560
MF a[32:35],a[224:227],v[68:71],a[32:35]
v_permlane32_swap_b32 v94,v103
v_add_f32 v92,v92,v101
MF a[36:39],a[228:231],v[60:63],a[36:39]
v_add_f32 v93,v93,v102
v_add_f32 v94,v94,v103
MF a[40:43],a[228:231],v[64:67],a[40:43]
v_mov_b32 v101,v92
v_mov_b32 v102,v93
MF a[44:47],a[228:231],v[68:71],a[44:47]
s_waitcnt lgkmcnt(4)
v_mov_b32 v103,v94
MF a[48:51],a[232:235],v[60:63],a[48:51]
TR a[224:225],v218,12544
TR a[226:227],v218,18688
MF a[52:55],a[232:235],v[64:67],a[52:55]
TR a[228:229],v219,12544
TR a[230:231],v219,18688
MF a[56:59],a[232:235],v[68:71],a[56:59]
v_permlane16_swap_b32 v92,v101
v_permlane16_swap_b32 v93,v102
MF a[60:63],a[236:239],v[60:63],a[60:63]
v_permlane16_swap_b32 v94,v103
v_add_f32 v92,v92,v101
MF a[64:67],a[236:239],v[64:67],a[64:67]
buffer_load_dwordx4 v232,s[8:11],s35 offen offset:2048 nt lds
MF a[68:71],a[236:239],v[68:71],a[68:71]
s_waitcnt lgkmcnt(4)
v_rcp_f32 v192,v92
MF a[72:75],a[216:219],v[60:63],a[72:75]
TR a[232:233],v220,12544
TR a[234:235],v220,18688
MF a[76:79],a[216:219],v[64:67],a[76:79]
TR a[236:237],v221,12544
TR a[238:239],v221,18688
MF a[80:83],a[216:219],v[68:71],a[80:83]
v_add_f32 v93,v93,v102
v_add_f32 v94,v94,v103
MF a[84:87],a[220:223],v[60:63],a[84:87]
v_rcp_f32 v193,v93
MF a[88:91],a[220:223],v[64:67],a[88:91]
v_rcp_f32 v194,v94
MF a[92:95],a[220:223],v[68:71],a[92:95]
s_waitcnt vmcnt(18) lgkmcnt(4)
s_barrier
MF a[96:99],a[224:227],v[60:63],a[96:99]
TR a[216:217],v222,0
RD v[144:147],v242,0
MF a[100:103],a[224:227],v[64:67],a[100:103]
TR a[218:219],v222,1536
RD v[148:151],v242,2048
MF a[104:107],a[224:227],v[68:71],a[104:107]
s_add_u32 m0,s32,86016
TR a[220:221],v223,0
RD v[152:155],v242,4096
MF a[108:111],a[228:231],v[60:63],a[108:111]
s_add_u32 s36,s33,208896
TR a[222:223],v223,1536
RD v[156:159],v245,0
MF a[112:115],a[228:231],v[64:67],a[112:115]
buffer_load_dwordx4 v230,s[8:11],s36 offen offset:0 nt lds
MF a[116:119],a[228:231],v[68:71],a[116:119]
s_waitcnt lgkmcnt(8)
MF a[120:123],a[232:235],v[60:63],a[120:123]
TR a[224:225],v224,0
RD v[160:163],v245,2048
MF a[124:127],a[232:235],v[64:67],a[124:127]
TR a[226:227],v224,1536
RD v[164:167],v245,4096
MF a[128:131],a[232:235],v[68:71],a[128:131]
TR a[228:229],v225,0
MF a[132:135],a[236:239],v[60:63],a[132:135]
TR a[230:231],v225,1536
MF a[136:139],a[236:239],v[64:67],a[136:139]
MF a[140:143],a[236:239],v[68:71],a[140:143]
s_waitcnt lgkmcnt(7)
L_st52:
MF v[0:3],a[216:219],v[144:147],0
TR a[232:233],v222,128
v_accvgpr_read_b32 v198,a0
MF v[4:7],a[216:219],v[148:151],0
TR a[234:235],v222,1664
v_accvgpr_read_b32 v199,a1
MF v[8:11],a[216:219],v[152:155],0
TR a[236:237],v223,128
v_accvgpr_read_b32 v200,a2
MF v[12:15],a[220:223],v[144:147],0
TR a[238:239],v223,1664
v_accvgpr_read_b32 v201,a3
MF v[16:19],a[220:223],v[148:151],0
buffer_load_dwordx4 v231,s[8:11],s36 offen offset:1024 nt lds
MF v[20:23],a[220:223],v[152:155],0
s_waitcnt lgkmcnt(4)
v_accvgpr_read_b32 v202,a12
v_accvgpr_read_b32 v203,a13
MF v[24:27],a[224:227],v[144:147],0
TR a[216:217],v224,128
v_accvgpr_read_b32 v204,a14
MF v[28:31],a[224:227],v[148:151],0
TR a[218:219],v224,1664
v_accvgpr_read_b32 v205,a15
MF v[32:35],a[224:227],v[152:155],0
TR a[220:221],v225,128
v_mul_f32 v198,v198,v192
MF v[36:39],a[228:231],v[144:147],0
TR a[222:223],v225,1664
v_mul_f32 v199,v199,v192
MF v[40:43],a[228:231],v[148:151],0
v_mul_f32 v200,v200,v192
v_mul_f32 v201,v201,v192
MF v[44:47],a[228:231],v[152:155],0
s_waitcnt lgkmcnt(4)
v_mul_f32 v202,v202,v192
v_mul_f32 v203,v203,v192
MF v[48:51],a[232:235],v[144:147],0
TR a[224:225],v222,256
v_mul_f32 v204,v204,v192
MF v[52:55],a[232:235],v[148:151],0
TR a[226:227],v222,1792
v_mul_f32 v205,v205,v192
MF v[56:59],a[232:235],v[152:155],0
TR a[228:229],v223,256
v_cvt_pk_bf16_f32 v198,v198,v199
MF v[60:63],a[236:239],v[144:147],0
TR a[230:231],v223,1792
v_cvt_pk_bf16_f32 v199,v200,v201
MF v[64:67],a[236:239],v[148:151],0
buffer_load_dwordx4 v232,s[8:11],s36 offen offset:2048 nt lds
MF v[68:71],a[236:239],v[152:155],0
s_waitcnt lgkmcnt(4)
v_cvt_pk_bf16_f32 v200,v202,v203
v_cvt_pk_bf16_f32 v201,v204,v205
MF v[72:75],a[216:219],v[144:147],0
TR a[232:233],v224,256
v_accvgpr_write_b32 a144,v198
MF v[76:79],a[216:219],v[148:151],0
TR a[234:235],v224,1792
v_accvgpr_write_b32 a145,v199
MF v[80:83],a[216:219],v[152:155],0
TR a[236:237],v225,256
v_accvgpr_write_b32 a146,v200
MF v[84:87],a[220:223],v[144:147],0
TR a[238:239],v225,1792
v_accvgpr_write_b32 a147,v201
MF v[88:91],a[220:223],v[148:151],0
v_accvgpr_read_b32 v206,a4
v_accvgpr_read_b32 v207,a5
MF v[92:95],a[220:223],v[152:155],0
s_waitcnt vmcnt(18) lgkmcnt(4)
s_barrier
v_accvgpr_read_b32 v208,a6
MF v[96:99],a[224:227],v[144:147],0
TR a[216:217],v222,12288
v_accvgpr_read_b32 v209,a7
MF v[100:103],a[224:227],v[148:151],0
TR a[218:219],v222,13824
v_accvgpr_read_b32 v210,a16
MF v[104:107],a[224:227],v[152:155],0
s_add_u32 m0,s32,98304
TR a[220:221],v223,12288
v_accvgpr_read_b32 v211,a17
MF v[108:111],a[228:231],v[144:147],0
s_add_u32 s35,s33,196608
TR a[222:223],v223,13824
v_accvgpr_read_b32 v212,a18
MF v[112:115],a[228:231],v[148:151],0
buffer_load_dwordx4 v230,s[12:15],s35 offen offset:0 nt lds
MF v[116:119],a[228:231],v[152:155],0
s_waitcnt lgkmcnt(4)
v_accvgpr_read_b32 v213,a19
v_mul_f32 v206,v206,v193
MF v[120:123],a[232:235],v[144:147],0
TR a[224:225],v224,12288
v_mul_f32 v207,v207,v193
MF v[124:127],a[232:235],v[148:151],0
TR a[226:227],v224,13824
v_mul_f32 v208,v208,v193
MF v[128:131],a[232:235],v[152:155],0
TR a[228:229],v225,12288
v_mul_f32 v209,v209,v193
MF v[132:135],a[236:239],v[144:147],0
TR a[230:231],v225,13824
v_mul_f32 v210,v210,v193
MF v[136:139],a[236:239],v[148:151],0
v_mul_f32 v211,v211,v193
v_mul_f32 v212,v212,v193
MF v[140:143],a[236:239],v[152:155],0
s_waitcnt lgkmcnt(4)
v_mul_f32 v213,v213,v193
v_cvt_pk_bf16_f32 v206,v206,v207
L_st53:
v_and_b32 v215,63,v244
v_mov_b32 v214,2147483392
v_cmp_gt_u32 vcc,15,v215
s_nop 1
v_cndmask_b32 v214,v214,v251,vcc
s_add_u32 s54,s101,0
buffer_load_dword a255,v214,s[20:23],s54 offen offset:0
s_lshr_b32 s56,s2,3
s_and_b32 s56,s56,7
s_cmp_eq_u32 s56,0
s_cbranch_scc0 L_pcs4
s_getpc_b64 s[56:57]
L_pc4:
s_add_u32 s56,s56,L_code+49152-L_pc4
s_addc_u32 s57,s57,0
v_mov_b32 v249,s57
v_add_co_u32 v248,vcc,s56,v252
s_nop 1
v_addc_co_u32 v249,vcc,0,v249,vcc
global_load_dword a255,v[248:249],off
L_pcs4:
MF v[0:3],a[216:219],v[156:159],v[0:3]
TR a[232:233],v222,12416
v_cvt_pk_bf16_f32 v207,v208,v209
MF v[4:7],a[216:219],v[160:163],v[4:7]
TR a[234:235],v222,13952
v_cvt_pk_bf16_f32 v208,v210,v211
MF v[8:11],a[216:219],v[164:167],v[8:11]
TR a[236:237],v223,12416
v_cvt_pk_bf16_f32 v209,v212,v213
MF v[12:15],a[220:223],v[156:159],v[12:15]
TR a[238:239],v223,13952
v_accvgpr_write_b32 a148,v206
MF v[16:19],a[220:223],v[160:163],v[16:19]
buffer_load_dwordx4 v231,s[12:15],s35 offen offset:1024 nt lds
MF v[20:23],a[220:223],v[164:167],v[20:23]
s_waitcnt lgkmcnt(4)
v_accvgpr_write_b32 a149,v207
v_accvgpr_write_b32 a150,v208
MF v[24:27],a[224:227],v[156:159],v[24:27]
TR a[216:217],v224,12416
v_accvgpr_write_b32 a151,v209
MF v[28:31],a[224:227],v[160:163],v[28:31]
TR a[218:219],v224,13952
v_accvgpr_read_b32 v198,a8
MF v[32:35],a[224:227],v[164:167],v[32:35]
TR a[220:221],v225,12416
v_accvgpr_read_b32 v199,a9
MF v[36:39],a[228:231],v[156:159],v[36:39]
TR a[222:223],v225,13952
v_accvgpr_read_b32 v200,a10
MF v[40:43],a[228:231],v[160:163],v[40:43]
v_accvgpr_read_b32 v201,a11
v_accvgpr_read_b32 v202,a20
MF v[44:47],a[228:231],v[164:167],v[44:47]
s_waitcnt lgkmcnt(4)
v_accvgpr_read_b32 v203,a21
v_accvgpr_read_b32 v204,a22
MF v[48:51],a[232:235],v[156:159],v[48:51]
TR a[224:225],v222,12544
v_accvgpr_read_b32 v205,a23
MF v[52:55],a[232:235],v[160:163],v[52:55]
TR a[226:227],v222,14080
v_mul_f32 v198,v198,v194
MF v[56:59],a[232:235],v[164:167],v[56:59]
TR a[228:229],v223,12544
v_mul_f32 v199,v199,v194
MF v[60:63],a[236:239],v[156:159],v[60:63]
TR a[230:231],v223,14080
v_mul_f32 v200,v200,v194
MF v[64:67],a[236:239],v[160:163],v[64:67]
buffer_load_dwordx4 v232,s[12:15],s35 offen offset:2048 nt lds
MF v[68:71],a[236:239],v[164:167],v[68:71]
s_waitcnt lgkmcnt(4)
v_mul_f32 v201,v201,v194
v_mul_f32 v202,v202,v194
MF v[72:75],a[216:219],v[156:159],v[72:75]
TR a[232:233],v224,12544
v_mul_f32 v203,v203,v194
MF v[76:79],a[216:219],v[160:163],v[76:79]
TR a[234:235],v224,14080
v_mul_f32 v204,v204,v194
MF v[80:83],a[216:219],v[164:167],v[80:83]
TR a[236:237],v225,12544
v_mul_f32 v205,v205,v194
MF v[84:87],a[220:223],v[156:159],v[84:87]
TR a[238:239],v225,14080
v_cvt_pk_bf16_f32 v198,v198,v199
MF v[88:91],a[220:223],v[160:163],v[88:91]
v_cvt_pk_bf16_f32 v199,v200,v201
v_cvt_pk_bf16_f32 v200,v202,v203
MF v[92:95],a[220:223],v[164:167],v[92:95]
s_waitcnt vmcnt(19) lgkmcnt(4)
s_barrier
v_cvt_pk_bf16_f32 v201,v204,v205
MF v[96:99],a[224:227],v[156:159],v[96:99]
TR a[216:217],v222,24576
RD v[168:171],v242,24576
MF v[100:103],a[224:227],v[160:163],v[100:103]
TR a[218:219],v222,26112
RD v[172:175],v242,26624
MF v[104:107],a[224:227],v[164:167],v[104:107]
s_add_u32 m0,s41,0
TR a[220:221],v223,24576
RD v[176:179],v242,28672
MF v[108:111],a[228:231],v[156:159],v[108:111]
s_add_u32 s36,s37,256
TR a[222:223],v223,26112
RD v[180:183],v245,24576
MF v[112:115],a[228:231],v[160:163],v[112:115]
buffer_load_dwordx4 v233,s[4:7],s36 offen offset:0 lds
MF v[116:119],a[228:231],v[164:167],v[116:119]
s_waitcnt lgkmcnt(8)
v_accvgpr_write_b32 a152,v198
v_accvgpr_write_b32 a153,v199
MF v[120:123],a[232:235],v[156:159],v[120:123]
TR a[224:225],v224,24576
RD v[184:187],v245,26624
MF v[124:127],a[232:235],v[160:163],v[124:127]
TR a[226:227],v224,26112
RD v[188:191],v245,28672
MF v[128:131],a[232:235],v[164:167],v[128:131]
TR a[228:229],v225,24576
v_accvgpr_write_b32 a154,v200
MF v[132:135],a[236:239],v[156:159],v[132:135]
TR a[230:231],v225,26112
v_accvgpr_write_b32 a155,v201
MF v[136:139],a[236:239],v[160:163],v[136:139]
buffer_load_dwordx4 v234,s[4:7],s36 offen offset:1024 lds
MF v[140:143],a[236:239],v[164:167],v[140:143]
s_waitcnt lgkmcnt(7)
v_accvgpr_read_b32 v206,a24
v_accvgpr_read_b32 v207,a25
L_st54:
MF v[0:3],a[216:219],v[168:171],v[0:3]
TR a[232:233],v222,24704
v_accvgpr_read_b32 v208,a26
MF v[4:7],a[216:219],v[172:175],v[4:7]
TR a[234:235],v222,26240
v_accvgpr_read_b32 v209,a27
MF v[8:11],a[216:219],v[176:179],v[8:11]
TR a[236:237],v223,24704
v_accvgpr_read_b32 v210,a36
MF v[12:15],a[220:223],v[168:171],v[12:15]
TR a[238:239],v223,26240
v_accvgpr_read_b32 v211,a37
MF v[16:19],a[220:223],v[172:175],v[16:19]
buffer_load_dwordx4 v235,s[4:7],s36 offen offset:2048 lds
MF v[20:23],a[220:223],v[176:179],v[20:23]
s_waitcnt lgkmcnt(4)
v_accvgpr_read_b32 v212,a38
v_accvgpr_read_b32 v213,a39
MF v[24:27],a[224:227],v[168:171],v[24:27]
TR a[216:217],v224,24704
v_mul_f32 v206,v206,v192
MF v[28:31],a[224:227],v[172:175],v[28:31]
TR a[218:219],v224,26240
v_mul_f32 v207,v207,v192
MF v[32:35],a[224:227],v[176:179],v[32:35]
s_add_u32 m0,s41,3072
TR a[220:221],v225,24704
v_mul_f32 v208,v208,v192
MF v[36:39],a[228:231],v[168:171],v[36:39]
s_add_u32 s35,s37,30976
TR a[222:223],v225,26240
v_mul_f32 v209,v209,v192
MF v[40:43],a[228:231],v[172:175],v[40:43]
buffer_load_dwordx4 v233,s[4:7],s35 offen offset:0 lds
MF v[44:47],a[228:231],v[176:179],v[44:47]
s_waitcnt lgkmcnt(4)
v_mul_f32 v210,v210,v192
v_mul_f32 v211,v211,v192
MF v[48:51],a[232:235],v[168:171],v[48:51]
TR a[224:225],v222,24832
v_mul_f32 v212,v212,v192
MF v[52:55],a[232:235],v[172:175],v[52:55]
TR a[226:227],v222,26368
v_mul_f32 v213,v213,v192
MF v[56:59],a[232:235],v[176:179],v[56:59]
TR a[228:229],v223,24832
v_cvt_pk_bf16_f32 v206,v206,v207
MF v[60:63],a[236:239],v[168:171],v[60:63]
TR a[230:231],v223,26368
v_cvt_pk_bf16_f32 v207,v208,v209
MF v[64:67],a[236:239],v[172:175],v[64:67]
buffer_load_dwordx4 v234,s[4:7],s35 offen offset:1024 lds
MF v[68:71],a[236:239],v[176:179],v[68:71]
s_waitcnt lgkmcnt(4)
v_cvt_pk_bf16_f32 v208,v210,v211
v_cvt_pk_bf16_f32 v209,v212,v213
MF v[72:75],a[216:219],v[168:171],v[72:75]
TR a[232:233],v224,24832
v_add_u32 v222,61440,v222
MF v[76:79],a[216:219],v[172:175],v[76:79]
TR a[234:235],v224,26368
v_add_u32 v223,61440,v223
MF v[80:83],a[216:219],v[176:179],v[80:83]
TR a[236:237],v225,24832
v_accvgpr_write_b32 a156,v206
MF v[84:87],a[220:223],v[168:171],v[84:87]
TR a[238:239],v225,26368
v_accvgpr_write_b32 a157,v207
MF v[88:91],a[220:223],v[172:175],v[88:91]
buffer_load_dwordx4 v235,s[4:7],s35 offen offset:2048 lds
MF v[92:95],a[220:223],v[176:179],v[92:95]
s_waitcnt vmcnt(22) lgkmcnt(4)
s_barrier
v_accvgpr_write_b32 a158,v208
MF v[96:99],a[224:227],v[168:171],v[96:99]
TR a[216:217],v222,0
v_add_u32 v224,61440,v224
MF v[100:103],a[224:227],v[172:175],v[100:103]
TR a[218:219],v222,1536
v_add_u32 v225,61440,v225
MF v[104:107],a[224:227],v[176:179],v[104:107]
s_add_u32 m0,s41,24576
TR a[220:221],v223,0
v_accvgpr_write_b32 a159,v209
MF v[108:111],a[228:231],v[168:171],v[108:111]
s_add_u32 s36,s37,384
TR a[222:223],v223,1536
v_accvgpr_read_b32 v198,a28
MF v[112:115],a[228:231],v[172:175],v[112:115]
buffer_load_dwordx4 v233,s[4:7],s36 offen offset:0 lds
MF v[116:119],a[228:231],v[176:179],v[116:119]
s_waitcnt lgkmcnt(4)
v_accvgpr_read_b32 v199,a29
v_accvgpr_read_b32 v200,a30
MF v[120:123],a[232:235],v[168:171],v[120:123]
TR a[224:225],v224,0
v_accvgpr_read_b32 v201,a31
MF v[124:127],a[232:235],v[172:175],v[124:127]
TR a[226:227],v224,1536
v_accvgpr_read_b32 v202,a40
MF v[128:131],a[232:235],v[176:179],v[128:131]
TR a[228:229],v225,0
v_accvgpr_read_b32 v203,a41
MF v[132:135],a[236:239],v[168:171],v[132:135]
TR a[230:231],v225,1536
v_accvgpr_read_b32 v204,a42
MF v[136:139],a[236:239],v[172:175],v[136:139]
buffer_load_dwordx4 v234,s[4:7],s36 offen offset:1024 lds
MF v[140:143],a[236:239],v[176:179],v[140:143]
s_waitcnt lgkmcnt(4)
v_accvgpr_read_b32 v205,a43
v_mul_f32 v198,v198,v193
L_st55:
MF v[0:3],a[216:219],v[180:183],v[0:3]
TR a[232:233],v222,128
v_mul_f32 v199,v199,v193
MF v[4:7],a[216:219],v[184:187],v[4:7]
TR a[234:235],v222,1664
v_mul_f32 v200,v200,v193
MF v[8:11],a[216:219],v[188:191],v[8:11]
TR a[236:237],v223,128
v_mul_f32 v201,v201,v193
MF v[12:15],a[220:223],v[180:183],v[12:15]
TR a[238:239],v223,1664
v_mul_f32 v202,v202,v193
MF v[16:19],a[220:223],v[184:187],v[16:19]
buffer_load_dwordx4 v235,s[4:7],s36 offen offset:2048 lds
MF v[20:23],a[220:223],v[188:191],v[20:23]
s_waitcnt lgkmcnt(4)
v_mul_f32 v203,v203,v193
v_mul_f32 v204,v204,v193
MF v[24:27],a[224:227],v[180:183],v[24:27]
TR a[216:217],v224,128
v_mul_f32 v205,v205,v193
MF v[28:31],a[224:227],v[184:187],v[28:31]
TR a[218:219],v224,1664
v_cvt_pk_bf16_f32 v198,v198,v199
MF v[32:35],a[224:227],v[188:191],v[32:35]
s_add_u32 m0,s41,27648
TR a[220:221],v225,128
v_cvt_pk_bf16_f32 v199,v200,v201
MF v[36:39],a[228:231],v[180:183],v[36:39]
s_add_u32 s35,s37,31104
TR a[222:223],v225,1664
v_cvt_pk_bf16_f32 v200,v202,v203
MF v[40:43],a[228:231],v[184:187],v[40:43]
buffer_load_dwordx4 v233,s[4:7],s35 offen offset:0 lds
MF v[44:47],a[228:231],v[188:191],v[44:47]
s_waitcnt lgkmcnt(4)
v_cvt_pk_bf16_f32 v201,v204,v205
v_accvgpr_write_b32 a160,v198
MF v[48:51],a[232:235],v[180:183],v[48:51]
TR a[224:225],v222,256
v_accvgpr_write_b32 a161,v199
MF v[52:55],a[232:235],v[184:187],v[52:55]
TR a[226:227],v222,1792
v_accvgpr_write_b32 a162,v200
MF v[56:59],a[232:235],v[188:191],v[56:59]
TR a[228:229],v223,256
v_accvgpr_write_b32 a163,v201
MF v[60:63],a[236:239],v[180:183],v[60:63]
TR a[230:231],v223,1792
v_accvgpr_read_b32 v206,a32
MF v[64:67],a[236:239],v[184:187],v[64:67]
buffer_load_dwordx4 v234,s[4:7],s35 offen offset:1024 lds
MF v[68:71],a[236:239],v[188:191],v[68:71]
s_waitcnt lgkmcnt(4)
v_accvgpr_read_b32 v207,a33
v_accvgpr_read_b32 v208,a34
MF v[72:75],a[216:219],v[180:183],v[72:75]
TR a[232:233],v224,256
v_accvgpr_read_b32 v209,a35
MF v[76:79],a[216:219],v[184:187],v[76:79]
TR a[234:235],v224,1792
v_accvgpr_read_b32 v210,a44
MF v[80:83],a[216:219],v[188:191],v[80:83]
TR a[236:237],v225,256
v_accvgpr_read_b32 v211,a45
MF v[84:87],a[220:223],v[180:183],v[84:87]
TR a[238:239],v225,1792
v_accvgpr_read_b32 v212,a46
MF v[88:91],a[220:223],v[184:187],v[88:91]
buffer_load_dwordx4 v235,s[4:7],s35 offen offset:2048 lds
MF v[92:95],a[220:223],v[188:191],v[92:95]
s_waitcnt vmcnt(6) lgkmcnt(4)
s_barrier
v_accvgpr_read_b32 v213,a47
MF v[96:99],a[224:227],v[180:183],v[96:99]
TR a[216:217],v222,12288
RD v[144:147],v242,0
MF v[100:103],a[224:227],v[184:187],v[100:103]
TR a[218:219],v222,13824
RD v[148:151],v242,2048
MF v[104:107],a[224:227],v[188:191],v[104:107]
s_add_u32 m0,s32,49152
TR a[220:221],v223,12288
RD v[152:155],v242,4096
MF v[108:111],a[228:231],v[180:183],v[108:111]
s_add_u32 s36,s34,2359680
TR a[222:223],v223,13824
RD v[156:159],v245,0
MF v[112:115],a[228:231],v[184:187],v[112:115]
buffer_load_dwordx4 v236,s[28:31],s36 offen offset:0 lds
MF v[116:119],a[228:231],v[188:191],v[116:119]
s_waitcnt lgkmcnt(8)
v_mul_f32 v206,v206,v194
v_mul_f32 v207,v207,v194
MF v[120:123],a[232:235],v[180:183],v[120:123]
TR a[224:225],v224,12288
RD v[160:163],v245,2048
MF v[124:127],a[232:235],v[184:187],v[124:127]
TR a[226:227],v224,13824
RD v[164:167],v245,4096
MF v[128:131],a[232:235],v[188:191],v[128:131]
TR a[228:229],v225,12288
v_mul_f32 v208,v208,v194
MF v[132:135],a[236:239],v[180:183],v[132:135]
TR a[230:231],v225,13824
v_mul_f32 v209,v209,v194
MF v[136:139],a[236:239],v[184:187],v[136:139]
buffer_load_dwordx4 v237,s[28:31],s36 offen offset:1024 lds
MF v[140:143],a[236:239],v[188:191],v[140:143]
s_waitcnt lgkmcnt(7)
v_mul_f32 v210,v210,v194
v_mul_f32 v211,v211,v194
L_st56:
MF v[0:3],a[216:219],v[144:147],v[0:3]
TR a[232:233],v222,12416
v_mul_f32 v212,v212,v194
MF v[4:7],a[216:219],v[148:151],v[4:7]
TR a[234:235],v222,13952
v_mul_f32 v213,v213,v194
MF v[8:11],a[216:219],v[152:155],v[8:11]
TR a[236:237],v223,12416
v_cvt_pk_bf16_f32 v206,v206,v207
MF v[12:15],a[220:223],v[144:147],v[12:15]
TR a[238:239],v223,13952
v_cvt_pk_bf16_f32 v207,v208,v209
MF v[16:19],a[220:223],v[148:151],v[16:19]
buffer_load_dwordx4 v238,s[28:31],s36 offen offset:2048 lds
MF v[20:23],a[220:223],v[152:155],v[20:23]
s_waitcnt lgkmcnt(4)
v_cvt_pk_bf16_f32 v208,v210,v211
v_cvt_pk_bf16_f32 v209,v212,v213
MF v[24:27],a[224:227],v[144:147],v[24:27]
TR a[216:217],v224,12416
v_accvgpr_write_b32 a164,v206
MF v[28:31],a[224:227],v[148:151],v[28:31]
TR a[218:219],v224,13952
v_accvgpr_write_b32 a165,v207
MF v[32:35],a[224:227],v[152:155],v[32:35]
s_add_u32 m0,s32,61440
TR a[220:221],v225,12416
v_accvgpr_write_b32 a166,v208
MF v[36:39],a[228:231],v[144:147],v[36:39]
s_add_u32 s35,s34,2752896
TR a[222:223],v225,13952
v_accvgpr_write_b32 a167,v209
MF v[40:43],a[228:231],v[148:151],v[40:43]
buffer_load_dwordx4 v236,s[28:31],s35 offen offset:0 lds
MF v[44:47],a[228:231],v[152:155],v[44:47]
s_waitcnt lgkmcnt(4)
v_accvgpr_read_b32 v198,a48
v_accvgpr_read_b32 v199,a49
MF v[48:51],a[232:235],v[144:147],v[48:51]
TR a[224:225],v222,12544
v_accvgpr_read_b32 v200,a50
MF v[52:55],a[232:235],v[148:151],v[52:55]
TR a[226:227],v222,14080
v_accvgpr_read_b32 v201,a51
MF v[56:59],a[232:235],v[152:155],v[56:59]
TR a[228:229],v223,12544
v_accvgpr_read_b32 v202,a60
MF v[60:63],a[236:239],v[144:147],v[60:63]
TR a[230:231],v223,14080
v_accvgpr_read_b32 v203,a61
MF v[64:67],a[236:239],v[148:151],v[64:67]
buffer_load_dwordx4 v237,s[28:31],s35 offen offset:1024 lds
MF v[68:71],a[236:239],v[152:155],v[68:71]
s_waitcnt lgkmcnt(4)
v_accvgpr_read_b32 v204,a62
v_accvgpr_read_b32 v205,a63
MF v[72:75],a[216:219],v[144:147],v[72:75]
TR a[232:233],v224,12544
v_mul_f32 v198,v198,v192
MF v[76:79],a[216:219],v[148:151],v[76:79]
TR a[234:235],v224,14080
v_mul_f32 v199,v199,v192
MF v[80:83],a[216:219],v[152:155],v[80:83]
TR a[236:237],v225,12544
v_mul_f32 v200,v200,v192
MF v[84:87],a[220:223],v[144:147],v[84:87]
TR a[238:239],v225,14080
v_mul_f32 v201,v201,v192
MF v[88:91],a[220:223],v[148:151],v[88:91]
buffer_load_dwordx4 v238,s[28:31],s35 offen offset:2048 lds
MF v[92:95],a[220:223],v[152:155],v[92:95]
s_waitcnt lgkmcnt(4)
s_barrier
v_mul_f32 v202,v202,v192
MF v[96:99],a[224:227],v[144:147],v[96:99]
TR a[216:217],v222,24576
v_mul_f32 v203,v203,v192
MF v[100:103],a[224:227],v[148:151],v[100:103]
TR a[218:219],v222,26112
v_mul_f32 v204,v204,v192
MF v[104:107],a[224:227],v[152:155],v[104:107]
s_add_u32 m0,s41,0
TR a[220:221],v223,24576
v_mul_f32 v205,v205,v192
MF v[108:111],a[228:231],v[144:147],v[108:111]
s_add_u32 s36,s37,512
TR a[222:223],v223,26112
v_cvt_pk_bf16_f32 v198,v198,v199
MF v[112:115],a[228:231],v[148:151],v[112:115]
buffer_load_dwordx4 v233,s[4:7],s36 offen offset:0 lds
MF v[116:119],a[228:231],v[152:155],v[116:119]
s_waitcnt lgkmcnt(4)
v_cvt_pk_bf16_f32 v199,v200,v201
v_cvt_pk_bf16_f32 v200,v202,v203
MF v[120:123],a[232:235],v[144:147],v[120:123]
TR a[224:225],v224,24576
v_cvt_pk_bf16_f32 v201,v204,v205
MF v[124:127],a[232:235],v[148:151],v[124:127]
TR a[226:227],v224,26112
v_accvgpr_write_b32 a168,v198
MF v[128:131],a[232:235],v[152:155],v[128:131]
TR a[228:229],v225,24576
v_accvgpr_write_b32 a169,v199
MF v[132:135],a[236:239],v[144:147],v[132:135]
TR a[230:231],v225,26112
v_accvgpr_write_b32 a170,v200
MF v[136:139],a[236:239],v[148:151],v[136:139]
buffer_load_dwordx4 v234,s[4:7],s36 offen offset:1024 lds
MF v[140:143],a[236:239],v[152:155],v[140:143]
s_waitcnt lgkmcnt(4)
v_accvgpr_write_b32 a171,v201
v_accvgpr_read_b32 v206,a52
L_st57:
v_mov_b32 v214,2147483392
v_cmp_gt_u32 vcc,15,v215
s_nop 1
v_cndmask_b32 v214,v214,v251,vcc
s_add_u32 s54,s101,1920
buffer_load_dword a255,v214,s[20:23],s54 offen offset:0
MF v[0:3],a[216:219],v[156:159],v[0:3]
TR a[232:233],v222,24704
v_accvgpr_read_b32 v207,a53
MF v[4:7],a[216:219],v[160:163],v[4:7]
TR a[234:235],v222,26240
v_accvgpr_read_b32 v208,a54
MF v[8:11],a[216:219],v[164:167],v[8:11]
TR a[236:237],v223,24704
v_accvgpr_read_b32 v209,a55
MF v[12:15],a[220:223],v[156:159],v[12:15]
TR a[238:239],v223,26240
v_accvgpr_read_b32 v210,a64
MF v[16:19],a[220:223],v[160:163],v[16:19]
buffer_load_dwordx4 v235,s[4:7],s36 offen offset:2048 lds
MF v[20:23],a[220:223],v[164:167],v[20:23]
s_waitcnt lgkmcnt(4)
v_accvgpr_read_b32 v211,a65
v_accvgpr_read_b32 v212,a66
MF v[24:27],a[224:227],v[156:159],v[24:27]
TR a[216:217],v224,24704
v_accvgpr_read_b32 v213,a67
MF v[28:31],a[224:227],v[160:163],v[28:31]
TR a[218:219],v224,26240
v_mul_f32 v206,v206,v193
MF v[32:35],a[224:227],v[164:167],v[32:35]
s_add_u32 m0,s41,3072
TR a[220:221],v225,24704
v_mul_f32 v207,v207,v193
MF v[36:39],a[228:231],v[156:159],v[36:39]
s_add_u32 s35,s37,31232
TR a[222:223],v225,26240
v_mul_f32 v208,v208,v193
MF v[40:43],a[228:231],v[160:163],v[40:43]
buffer_load_dwordx4 v233,s[4:7],s35 offen offset:0 lds
MF v[44:47],a[228:231],v[164:167],v[44:47]
s_waitcnt lgkmcnt(4)
v_mul_f32 v209,v209,v193
v_mul_f32 v210,v210,v193
MF v[48:51],a[232:235],v[156:159],v[48:51]
TR a[224:225],v222,24832
v_mul_f32 v211,v211,v193
MF v[52:55],a[232:235],v[160:163],v[52:55]
TR a[226:227],v222,26368
v_mul_f32 v212,v212,v193
MF v[56:59],a[232:235],v[164:167],v[56:59]
TR a[228:229],v223,24832
v_mul_f32 v213,v213,v193
MF v[60:63],a[236:239],v[156:159],v[60:63]
TR a[230:231],v223,26368
v_cvt_pk_bf16_f32 v206,v206,v207
MF v[64:67],a[236:239],v[160:163],v[64:67]
buffer_load_dwordx4 v234,s[4:7],s35 offen offset:1024 lds
MF v[68:71],a[236:239],v[164:167],v[68:71]
s_waitcnt lgkmcnt(4)
v_cvt_pk_bf16_f32 v207,v208,v209
v_cvt_pk_bf16_f32 v208,v210,v211
MF v[72:75],a[216:219],v[156:159],v[72:75]
TR a[232:233],v224,24832
v_subrev_u32 v222,61440,v222
MF v[76:79],a[216:219],v[160:163],v[76:79]
TR a[234:235],v224,26368
v_subrev_u32 v223,61440,v223
MF v[80:83],a[216:219],v[164:167],v[80:83]
TR a[236:237],v225,24832
v_cvt_pk_bf16_f32 v209,v212,v213
MF v[84:87],a[220:223],v[156:159],v[84:87]
TR a[238:239],v225,26368
v_accvgpr_write_b32 a172,v206
MF v[88:91],a[220:223],v[160:163],v[88:91]
buffer_load_dwordx4 v235,s[4:7],s35 offen offset:2048 lds
MF v[92:95],a[220:223],v[164:167],v[92:95]
s_waitcnt vmcnt(10) lgkmcnt(4)
s_barrier
v_accvgpr_write_b32 a173,v207
MF v[96:99],a[224:227],v[156:159],v[96:99]
TR a[216:217],v222,0
RD v[168:171],v242,24576
MF v[100:103],a[224:227],v[160:163],v[100:103]
TR a[218:219],v222,1536
RD v[172:175],v242,26624
MF v[104:107],a[224:227],v[164:167],v[104:107]
s_add_u32 m0,s32,73728
TR a[220:221],v223,0
RD v[176:179],v242,28672
MF v[108:111],a[228:231],v[156:159],v[108:111]
s_add_u32 s36,s34,3146112
TR a[222:223],v223,1536
RD v[180:183],v245,24576
MF v[112:115],a[228:231],v[160:163],v[112:115]
buffer_load_dwordx4 v236,s[28:31],s36 offen offset:0 lds
MF v[116:119],a[228:231],v[164:167],v[116:119]
s_waitcnt lgkmcnt(8)
v_subrev_u32 v224,61440,v224
v_subrev_u32 v225,61440,v225
MF v[120:123],a[232:235],v[156:159],v[120:123]
TR a[224:225],v224,0
RD v[184:187],v245,26624
MF v[124:127],a[232:235],v[160:163],v[124:127]
TR a[226:227],v224,1536
RD v[188:191],v245,28672
MF v[128:131],a[232:235],v[164:167],v[128:131]
TR a[228:229],v225,0
v_accvgpr_write_b32 a174,v208
MF v[132:135],a[236:239],v[156:159],v[132:135]
TR a[230:231],v225,1536
v_accvgpr_write_b32 a175,v209
MF v[136:139],a[236:239],v[160:163],v[136:139]
buffer_load_dwordx4 v237,s[28:31],s36 offen offset:1024 lds
MF v[140:143],a[236:239],v[164:167],v[140:143]
s_waitcnt lgkmcnt(7)
v_accvgpr_read_b32 v198,a56
v_accvgpr_read_b32 v199,a57
L_st58:
MF v[0:3],a[216:219],v[168:171],v[0:3]
TR a[232:233],v222,128
v_accvgpr_read_b32 v200,a58
MF v[4:7],a[216:219],v[172:175],v[4:7]
TR a[234:235],v222,1664
v_accvgpr_read_b32 v201,a59
MF v[8:11],a[216:219],v[176:179],v[8:11]
TR a[236:237],v223,128
v_accvgpr_read_b32 v202,a68
MF v[12:15],a[220:223],v[168:171],v[12:15]
TR a[238:239],v223,1664
v_accvgpr_read_b32 v203,a69
MF v[16:19],a[220:223],v[172:175],v[16:19]
buffer_load_dwordx4 v238,s[28:31],s36 offen offset:2048 lds
MF v[20:23],a[220:223],v[176:179],v[20:23]
s_waitcnt lgkmcnt(4)
v_accvgpr_read_b32 v204,a70
v_accvgpr_read_b32 v205,a71
MF v[24:27],a[224:227],v[168:171],v[24:27]
TR a[216:217],v224,128
v_mul_f32 v198,v198,v194
MF v[28:31],a[224:227],v[172:175],v[28:31]
TR a[218:219],v224,1664
v_mul_f32 v199,v199,v194
MF v[32:35],a[224:227],v[176:179],v[32:35]
s_add_u32 m0,s32,110592
TR a[220:221],v225,128
v_mul_f32 v200,v200,v194
MF v[36:39],a[228:231],v[168:171],v[36:39]
s_add_u32 s35,s34,3539328
TR a[222:223],v225,1664
v_mul_f32 v201,v201,v194
MF v[40:43],a[228:231],v[172:175],v[40:43]
buffer_load_dwordx4 v236,s[28:31],s35 offen offset:0 lds
MF v[44:47],a[228:231],v[176:179],v[44:47]
s_waitcnt lgkmcnt(4)
v_mul_f32 v202,v202,v194
v_mul_f32 v203,v203,v194
MF v[48:51],a[232:235],v[168:171],v[48:51]
TR a[224:225],v222,256
v_mul_f32 v204,v204,v194
MF v[52:55],a[232:235],v[172:175],v[52:55]
TR a[226:227],v222,1792
v_mul_f32 v205,v205,v194
MF v[56:59],a[232:235],v[176:179],v[56:59]
TR a[228:229],v223,256
v_cvt_pk_bf16_f32 v198,v198,v199
MF v[60:63],a[236:239],v[168:171],v[60:63]
TR a[230:231],v223,1792
v_cvt_pk_bf16_f32 v199,v200,v201
MF v[64:67],a[236:239],v[172:175],v[64:67]
buffer_load_dwordx4 v237,s[28:31],s35 offen offset:1024 lds
MF v[68:71],a[236:239],v[176:179],v[68:71]
s_waitcnt lgkmcnt(4)
v_cvt_pk_bf16_f32 v200,v202,v203
v_cvt_pk_bf16_f32 v201,v204,v205
MF v[72:75],a[216:219],v[168:171],v[72:75]
TR a[232:233],v224,256
v_accvgpr_write_b32 a176,v198
MF v[76:79],a[216:219],v[172:175],v[76:79]
TR a[234:235],v224,1792
v_accvgpr_write_b32 a177,v199
MF v[80:83],a[216:219],v[176:179],v[80:83]
TR a[236:237],v225,256
v_accvgpr_write_b32 a178,v200
MF v[84:87],a[220:223],v[168:171],v[84:87]
TR a[238:239],v225,1792
v_accvgpr_write_b32 a179,v201
MF v[88:91],a[220:223],v[172:175],v[88:91]
buffer_load_dwordx4 v238,s[28:31],s35 offen offset:2048 lds
MF v[92:95],a[220:223],v[176:179],v[92:95]
s_waitcnt vmcnt(13) lgkmcnt(4)
s_barrier
v_accvgpr_read_b32 v206,a72
MF v[96:99],a[224:227],v[168:171],v[96:99]
TR a[216:217],v222,12288
v_accvgpr_read_b32 v207,a73
MF v[100:103],a[224:227],v[172:175],v[100:103]
TR a[218:219],v222,13824
v_accvgpr_read_b32 v208,a74
MF v[104:107],a[224:227],v[176:179],v[104:107]
s_add_u32 m0,s41,24576
TR a[220:221],v223,12288
v_accvgpr_read_b32 v209,a75
MF v[108:111],a[228:231],v[168:171],v[108:111]
s_add_u32 s36,s37,640
TR a[222:223],v223,13824
v_accvgpr_read_b32 v210,a84
MF v[112:115],a[228:231],v[172:175],v[112:115]
buffer_load_dwordx4 v233,s[4:7],s36 offen offset:0 lds
MF v[116:119],a[228:231],v[176:179],v[116:119]
s_waitcnt lgkmcnt(4)
v_accvgpr_read_b32 v211,a85
v_accvgpr_read_b32 v212,a86
MF v[120:123],a[232:235],v[168:171],v[120:123]
TR a[224:225],v224,12288
v_accvgpr_read_b32 v213,a87
MF v[124:127],a[232:235],v[172:175],v[124:127]
TR a[226:227],v224,13824
v_mul_f32 v206,v206,v192
MF v[128:131],a[232:235],v[176:179],v[128:131]
TR a[228:229],v225,12288
v_mul_f32 v207,v207,v192
MF v[132:135],a[236:239],v[168:171],v[132:135]
TR a[230:231],v225,13824
v_mul_f32 v208,v208,v192
MF v[136:139],a[236:239],v[172:175],v[136:139]
buffer_load_dwordx4 v234,s[4:7],s36 offen offset:1024 lds
MF v[140:143],a[236:239],v[176:179],v[140:143]
s_waitcnt lgkmcnt(4)
v_mul_f32 v209,v209,v192
v_mul_f32 v210,v210,v192
L_st59:
MF v[0:3],a[216:219],v[180:183],v[0:3]
TR a[232:233],v222,12416
v_mul_f32 v211,v211,v192
MF v[4:7],a[216:219],v[184:187],v[4:7]
TR a[234:235],v222,13952
v_mul_f32 v212,v212,v192
MF v[8:11],a[216:219],v[188:191],v[8:11]
TR a[236:237],v223,12416
v_mul_f32 v213,v213,v192
MF v[12:15],a[220:223],v[180:183],v[12:15]
TR a[238:239],v223,13952
v_cvt_pk_bf16_f32 v206,v206,v207
MF v[16:19],a[220:223],v[184:187],v[16:19]
buffer_load_dwordx4 v235,s[4:7],s36 offen offset:2048 lds
MF v[20:23],a[220:223],v[188:191],v[20:23]
s_waitcnt lgkmcnt(4)
v_cvt_pk_bf16_f32 v207,v208,v209
v_cvt_pk_bf16_f32 v208,v210,v211
MF v[24:27],a[224:227],v[180:183],v[24:27]
TR a[216:217],v224,12416
v_cvt_pk_bf16_f32 v209,v212,v213
MF v[28:31],a[224:227],v[184:187],v[28:31]
TR a[218:219],v224,13952
v_accvgpr_write_b32 a180,v206
MF v[32:35],a[224:227],v[188:191],v[32:35]
s_add_u32 m0,s41,27648
TR a[220:221],v225,12416
v_accvgpr_write_b32 a181,v207
MF v[36:39],a[228:231],v[180:183],v[36:39]
s_add_u32 s35,s37,31360
TR a[222:223],v225,13952
v_accvgpr_write_b32 a182,v208
MF v[40:43],a[228:231],v[184:187],v[40:43]
buffer_load_dwordx4 v233,s[4:7],s35 offen offset:0 lds
MF v[44:47],a[228:231],v[188:191],v[44:47]
s_waitcnt lgkmcnt(4)
v_accvgpr_write_b32 a183,v209
v_accvgpr_read_b32 v198,a76
MF v[48:51],a[232:235],v[180:183],v[48:51]
TR a[224:225],v222,12544
v_accvgpr_read_b32 v199,a77
MF v[52:55],a[232:235],v[184:187],v[52:55]
TR a[226:227],v222,14080
v_accvgpr_read_b32 v200,a78
MF v[56:59],a[232:235],v[188:191],v[56:59]
TR a[228:229],v223,12544
v_accvgpr_read_b32 v201,a79
MF v[60:63],a[236:239],v[180:183],v[60:63]
TR a[230:231],v223,14080
v_accvgpr_read_b32 v202,a88
MF v[64:67],a[236:239],v[184:187],v[64:67]
buffer_load_dwordx4 v234,s[4:7],s35 offen offset:1024 lds
MF v[68:71],a[236:239],v[188:191],v[68:71]
s_waitcnt lgkmcnt(4)
v_accvgpr_read_b32 v203,a89
v_accvgpr_read_b32 v204,a90
MF v[72:75],a[216:219],v[180:183],v[72:75]
TR a[232:233],v224,12544
v_accvgpr_read_b32 v205,a91
MF v[76:79],a[216:219],v[184:187],v[76:79]
TR a[234:235],v224,14080
v_mul_f32 v198,v198,v193
MF v[80:83],a[216:219],v[188:191],v[80:83]
TR a[236:237],v225,12544
v_mul_f32 v199,v199,v193
MF v[84:87],a[220:223],v[180:183],v[84:87]
TR a[238:239],v225,14080
v_mul_f32 v200,v200,v193
MF v[88:91],a[220:223],v[184:187],v[88:91]
buffer_load_dwordx4 v235,s[4:7],s35 offen offset:2048 lds
MF v[92:95],a[220:223],v[188:191],v[92:95]
s_waitcnt vmcnt(9) lgkmcnt(4)
s_barrier
v_mul_f32 v201,v201,v193
MF v[96:99],a[224:227],v[180:183],v[96:99]
TR a[216:217],v222,24576
RD v[144:147],v242,0
MF v[100:103],a[224:227],v[184:187],v[100:103]
TR a[218:219],v222,26112
RD v[148:151],v242,2048
MF v[104:107],a[224:227],v[188:191],v[104:107]
s_add_u32 m0,s32,49152
TR a[220:221],v223,24576
RD v[152:155],v242,4096
MF v[108:111],a[228:231],v[180:183],v[108:111]
s_add_u32 s36,s34,3932544
TR a[222:223],v223,26112
RD v[156:159],v245,0
MF v[112:115],a[228:231],v[184:187],v[112:115]
buffer_load_dwordx4 v236,s[28:31],s36 offen offset:0 lds
MF v[116:119],a[228:231],v[188:191],v[116:119]
s_waitcnt lgkmcnt(8)
v_mul_f32 v202,v202,v193
v_mul_f32 v203,v203,v193
MF v[120:123],a[232:235],v[180:183],v[120:123]
TR a[224:225],v224,24576
RD v[160:163],v245,2048
MF v[124:127],a[232:235],v[184:187],v[124:127]
TR a[226:227],v224,26112
RD v[164:167],v245,4096
MF v[128:131],a[232:235],v[188:191],v[128:131]
TR a[228:229],v225,24576
v_mul_f32 v204,v204,v193
MF v[132:135],a[236:239],v[180:183],v[132:135]
TR a[230:231],v225,26112
v_mul_f32 v205,v205,v193
MF v[136:139],a[236:239],v[184:187],v[136:139]
buffer_load_dwordx4 v237,s[28:31],s36 offen offset:1024 lds
MF v[140:143],a[236:239],v[188:191],v[140:143]
s_waitcnt lgkmcnt(7)
v_cvt_pk_bf16_f32 v198,v198,v199
v_cvt_pk_bf16_f32 v199,v200,v201
L_st60:
MF v[0:3],a[216:219],v[144:147],v[0:3]
TR a[232:233],v222,24704
v_cvt_pk_bf16_f32 v200,v202,v203
MF v[4:7],a[216:219],v[148:151],v[4:7]
TR a[234:235],v222,26240
v_cvt_pk_bf16_f32 v201,v204,v205
MF v[8:11],a[216:219],v[152:155],v[8:11]
TR a[236:237],v223,24704
v_accvgpr_write_b32 a184,v198
MF v[12:15],a[220:223],v[144:147],v[12:15]
TR a[238:239],v223,26240
v_accvgpr_write_b32 a185,v199
MF v[16:19],a[220:223],v[148:151],v[16:19]
buffer_load_dwordx4 v238,s[28:31],s36 offen offset:2048 lds
MF v[20:23],a[220:223],v[152:155],v[20:23]
s_waitcnt lgkmcnt(4)
v_accvgpr_write_b32 a186,v200
v_accvgpr_write_b32 a187,v201
MF v[24:27],a[224:227],v[144:147],v[24:27]
TR a[216:217],v224,24704
v_accvgpr_read_b32 v206,a80
MF v[28:31],a[224:227],v[148:151],v[28:31]
TR a[218:219],v224,26240
v_accvgpr_read_b32 v207,a81
MF v[32:35],a[224:227],v[152:155],v[32:35]
s_add_u32 m0,s32,122880
TR a[220:221],v225,24704
v_accvgpr_read_b32 v208,a82
MF v[36:39],a[228:231],v[144:147],v[36:39]
s_add_u32 s35,s34,4325760
TR a[222:223],v225,26240
v_accvgpr_read_b32 v209,a83
MF v[40:43],a[228:231],v[148:151],v[40:43]
buffer_load_dwordx4 v236,s[28:31],s35 offen offset:0 lds
MF v[44:47],a[228:231],v[152:155],v[44:47]
s_waitcnt lgkmcnt(4)
v_accvgpr_read_b32 v210,a92
v_accvgpr_read_b32 v211,a93
MF v[48:51],a[232:235],v[144:147],v[48:51]
TR a[224:225],v222,24832
v_accvgpr_read_b32 v212,a94
MF v[52:55],a[232:235],v[148:151],v[52:55]
TR a[226:227],v222,26368
v_accvgpr_read_b32 v213,a95
MF v[56:59],a[232:235],v[152:155],v[56:59]
TR a[228:229],v223,24832
v_mul_f32 v206,v206,v194
MF v[60:63],a[236:239],v[144:147],v[60:63]
TR a[230:231],v223,26368
v_mul_f32 v207,v207,v194
MF v[64:67],a[236:239],v[148:151],v[64:67]
buffer_load_dwordx4 v237,s[28:31],s35 offen offset:1024 lds
MF v[68:71],a[236:239],v[152:155],v[68:71]
s_waitcnt lgkmcnt(4)
v_mul_f32 v208,v208,v194
v_mul_f32 v209,v209,v194
MF v[72:75],a[216:219],v[144:147],v[72:75]
TR a[232:233],v224,24832
v_add_u32 v222,61440,v222
MF v[76:79],a[216:219],v[148:151],v[76:79]
TR a[234:235],v224,26368
v_add_u32 v223,61440,v223
MF v[80:83],a[216:219],v[152:155],v[80:83]
TR a[236:237],v225,24832
v_mul_f32 v210,v210,v194
MF v[84:87],a[220:223],v[144:147],v[84:87]
TR a[238:239],v225,26368
v_mul_f32 v211,v211,v194
MF v[88:91],a[220:223],v[148:151],v[88:91]
buffer_load_dwordx4 v238,s[28:31],s35 offen offset:2048 lds
MF v[92:95],a[220:223],v[152:155],v[92:95]
s_waitcnt vmcnt(12) lgkmcnt(4)
s_barrier
v_mul_f32 v212,v212,v194
MF v[96:99],a[224:227],v[144:147],v[96:99]
TR a[216:217],v222,0
v_add_u32 v224,61440,v224
MF v[100:103],a[224:227],v[148:151],v[100:103]
TR a[218:219],v222,1536
v_add_u32 v225,61440,v225
MF v[104:107],a[224:227],v[152:155],v[104:107]
s_add_u32 m0,s41,0
TR a[220:221],v223,0
v_mul_f32 v213,v213,v194
MF v[108:111],a[228:231],v[144:147],v[108:111]
s_add_u32 s36,s37,768
TR a[222:223],v223,1536
v_cvt_pk_bf16_f32 v206,v206,v207
MF v[112:115],a[228:231],v[148:151],v[112:115]
buffer_load_dwordx4 v233,s[4:7],s36 offen offset:0 lds
MF v[116:119],a[228:231],v[152:155],v[116:119]
s_waitcnt lgkmcnt(4)
v_cvt_pk_bf16_f32 v207,v208,v209
v_cvt_pk_bf16_f32 v208,v210,v211
MF v[120:123],a[232:235],v[144:147],v[120:123]
TR a[224:225],v224,0
v_cvt_pk_bf16_f32 v209,v212,v213
MF v[124:127],a[232:235],v[148:151],v[124:127]
TR a[226:227],v224,1536
v_accvgpr_write_b32 a188,v206
MF v[128:131],a[232:235],v[152:155],v[128:131]
TR a[228:229],v225,0
v_accvgpr_write_b32 a189,v207
MF v[132:135],a[236:239],v[144:147],v[132:135]
TR a[230:231],v225,1536
v_accvgpr_write_b32 a190,v208
MF v[136:139],a[236:239],v[148:151],v[136:139]
buffer_load_dwordx4 v234,s[4:7],s36 offen offset:1024 lds
MF v[140:143],a[236:239],v[152:155],v[140:143]
s_waitcnt lgkmcnt(4)
v_accvgpr_write_b32 a191,v209
v_accvgpr_read_b32 v198,a96
L_st61:
v_mov_b32 v214,2147483392
v_cmp_gt_u32 vcc,15,v215
s_nop 1
v_cndmask_b32 v214,v214,v251,vcc
s_add_u32 s54,s101,3840
buffer_load_dword a255,v214,s[20:23],s54 offen offset:0
MF v[0:3],a[216:219],v[156:159],v[0:3]
TR a[232:233],v222,128
v_accvgpr_read_b32 v199,a97
MF v[4:7],a[216:219],v[160:163],v[4:7]
TR a[234:235],v222,1664
v_accvgpr_read_b32 v200,a98
MF v[8:11],a[216:219],v[164:167],v[8:11]
TR a[236:237],v223,128
v_accvgpr_read_b32 v201,a99
MF v[12:15],a[220:223],v[156:159],v[12:15]
TR a[238:239],v223,1664
v_accvgpr_read_b32 v202,a108
MF v[16:19],a[220:223],v[160:163],v[16:19]
buffer_load_dwordx4 v235,s[4:7],s36 offen offset:2048 lds
MF v[20:23],a[220:223],v[164:167],v[20:23]
s_waitcnt lgkmcnt(4)
v_accvgpr_read_b32 v203,a109
v_accvgpr_read_b32 v204,a110
MF v[24:27],a[224:227],v[156:159],v[24:27]
TR a[216:217],v224,128
v_accvgpr_read_b32 v205,a111
MF v[28:31],a[224:227],v[160:163],v[28:31]
TR a[218:219],v224,1664
v_mul_f32 v198,v198,v192
MF v[32:35],a[224:227],v[164:167],v[32:35]
s_add_u32 m0,s41,3072
TR a[220:221],v225,128
v_mul_f32 v199,v199,v192
MF v[36:39],a[228:231],v[156:159],v[36:39]
s_add_u32 s35,s37,31488
TR a[222:223],v225,1664
v_mul_f32 v200,v200,v192
MF v[40:43],a[228:231],v[160:163],v[40:43]
buffer_load_dwordx4 v233,s[4:7],s35 offen offset:0 lds
MF v[44:47],a[228:231],v[164:167],v[44:47]
s_waitcnt lgkmcnt(4)
v_mul_f32 v201,v201,v192
v_mul_f32 v202,v202,v192
MF v[48:51],a[232:235],v[156:159],v[48:51]
TR a[224:225],v222,256
v_mul_f32 v203,v203,v192
MF v[52:55],a[232:235],v[160:163],v[52:55]
TR a[226:227],v222,1792
v_mul_f32 v204,v204,v192
MF v[56:59],a[232:235],v[164:167],v[56:59]
TR a[228:229],v223,256
v_mul_f32 v205,v205,v192
MF v[60:63],a[236:239],v[156:159],v[60:63]
TR a[230:231],v223,1792
v_cvt_pk_bf16_f32 v198,v198,v199
MF v[64:67],a[236:239],v[160:163],v[64:67]
buffer_load_dwordx4 v234,s[4:7],s35 offen offset:1024 lds
MF v[68:71],a[236:239],v[164:167],v[68:71]
s_waitcnt lgkmcnt(4)
v_cvt_pk_bf16_f32 v199,v200,v201
v_cvt_pk_bf16_f32 v200,v202,v203
MF v[72:75],a[216:219],v[156:159],v[72:75]
TR a[232:233],v224,256
v_subrev_u32 v222,61440,v222
MF v[76:79],a[216:219],v[160:163],v[76:79]
TR a[234:235],v224,1792
v_subrev_u32 v223,61440,v223
MF v[80:83],a[216:219],v[164:167],v[80:83]
TR a[236:237],v225,256
v_cvt_pk_bf16_f32 v201,v204,v205
MF v[84:87],a[220:223],v[156:159],v[84:87]
TR a[238:239],v225,1792
v_accvgpr_write_b32 a192,v198
MF v[88:91],a[220:223],v[160:163],v[88:91]
buffer_load_dwordx4 v235,s[4:7],s35 offen offset:2048 lds
MF v[92:95],a[220:223],v[164:167],v[92:95]
s_waitcnt vmcnt(10) lgkmcnt(4)
s_barrier
v_accvgpr_write_b32 a193,v199
MF v[96:99],a[224:227],v[156:159],v[96:99]
TR a[216:217],v222,0
RD v[168:171],v242,24576
MF v[100:103],a[224:227],v[160:163],v[100:103]
TR a[218:219],v222,1536
RD v[172:175],v242,26624
MF v[104:107],a[224:227],v[164:167],v[104:107]
s_add_u32 m0,s32,61440
TR a[220:221],v223,0
RD v[176:179],v242,28672
MF v[108:111],a[228:231],v[156:159],v[108:111]
s_add_u32 s36,s34,4718976
TR a[222:223],v223,1536
RD v[180:183],v245,24576
MF v[112:115],a[228:231],v[160:163],v[112:115]
buffer_load_dwordx4 v236,s[28:31],s36 offen offset:0 lds
MF v[116:119],a[228:231],v[164:167],v[116:119]
s_waitcnt lgkmcnt(8)
v_subrev_u32 v224,61440,v224
v_subrev_u32 v225,61440,v225
MF v[120:123],a[232:235],v[156:159],v[120:123]
TR a[224:225],v224,0
RD v[184:187],v245,26624
MF v[124:127],a[232:235],v[160:163],v[124:127]
TR a[226:227],v224,1536
RD v[188:191],v245,28672
MF v[128:131],a[232:235],v[164:167],v[128:131]
TR a[228:229],v225,0
v_accvgpr_write_b32 a194,v200
MF v[132:135],a[236:239],v[156:159],v[132:135]
TR a[230:231],v225,1536
v_accvgpr_write_b32 a195,v201
MF v[136:139],a[236:239],v[160:163],v[136:139]
buffer_load_dwordx4 v237,s[28:31],s36 offen offset:1024 lds
MF v[140:143],a[236:239],v[164:167],v[140:143]
s_waitcnt lgkmcnt(7)
v_accvgpr_read_b32 v206,a100
v_accvgpr_read_b32 v207,a101
L_st62:
MF v[0:3],a[216:219],v[168:171],v[0:3]
TR a[232:233],v222,128
v_accvgpr_read_b32 v208,a102
MF v[4:7],a[216:219],v[172:175],v[4:7]
TR a[234:235],v222,1664
v_accvgpr_read_b32 v209,a103
MF v[8:11],a[216:219],v[176:179],v[8:11]
TR a[236:237],v223,128
v_accvgpr_read_b32 v210,a112
MF v[12:15],a[220:223],v[168:171],v[12:15]
TR a[238:239],v223,1664
v_accvgpr_read_b32 v211,a113
MF v[16:19],a[220:223],v[172:175],v[16:19]
buffer_load_dwordx4 v238,s[28:31],s36 offen offset:2048 lds
MF v[20:23],a[220:223],v[176:179],v[20:23]
s_waitcnt lgkmcnt(4)
v_accvgpr_read_b32 v212,a114
v_accvgpr_read_b32 v213,a115
MF v[24:27],a[224:227],v[168:171],v[24:27]
TR a[216:217],v224,128
v_mul_f32 v206,v206,v193
MF v[28:31],a[224:227],v[172:175],v[28:31]
TR a[218:219],v224,1664
v_mul_f32 v207,v207,v193
MF v[32:35],a[224:227],v[176:179],v[32:35]
s_add_u32 m0,s32,73728
TR a[220:221],v225,128
v_mul_f32 v208,v208,v193
MF v[36:39],a[228:231],v[168:171],v[36:39]
s_add_u32 s35,s34,5112192
TR a[222:223],v225,1664
v_mul_f32 v209,v209,v193
MF v[40:43],a[228:231],v[172:175],v[40:43]
buffer_load_dwordx4 v236,s[28:31],s35 offen offset:0 lds
MF v[44:47],a[228:231],v[176:179],v[44:47]
s_waitcnt lgkmcnt(4)
v_mul_f32 v210,v210,v193
v_mul_f32 v211,v211,v193
MF v[48:51],a[232:235],v[168:171],v[48:51]
TR a[224:225],v222,256
v_mul_f32 v212,v212,v193
MF v[52:55],a[232:235],v[172:175],v[52:55]
TR a[226:227],v222,1792
v_mul_f32 v213,v213,v193
MF v[56:59],a[232:235],v[176:179],v[56:59]
TR a[228:229],v223,256
v_cvt_pk_bf16_f32 v206,v206,v207
MF v[60:63],a[236:239],v[168:171],v[60:63]
TR a[230:231],v223,1792
v_cvt_pk_bf16_f32 v207,v208,v209
MF v[64:67],a[236:239],v[172:175],v[64:67]
buffer_load_dwordx4 v237,s[28:31],s35 offen offset:1024 lds
MF v[68:71],a[236:239],v[176:179],v[68:71]
s_waitcnt lgkmcnt(4)
v_cvt_pk_bf16_f32 v208,v210,v211
v_cvt_pk_bf16_f32 v209,v212,v213
MF v[72:75],a[216:219],v[168:171],v[72:75]
TR a[232:233],v224,256
v_add_u32 v222,73728,v222
MF v[76:79],a[216:219],v[172:175],v[76:79]
TR a[234:235],v224,1792
v_add_u32 v223,73728,v223
MF v[80:83],a[216:219],v[176:179],v[80:83]
TR a[236:237],v225,256
v_accvgpr_write_b32 a196,v206
MF v[84:87],a[220:223],v[168:171],v[84:87]
TR a[238:239],v225,1792
v_accvgpr_write_b32 a197,v207
MF v[88:91],a[220:223],v[172:175],v[88:91]
buffer_load_dwordx4 v238,s[28:31],s35 offen offset:2048 lds
MF v[92:95],a[220:223],v[176:179],v[92:95]
s_waitcnt vmcnt(13) lgkmcnt(4)
s_barrier
v_accvgpr_write_b32 a198,v208
MF v[96:99],a[224:227],v[168:171],v[96:99]
TR a[216:217],v222,0
v_add_u32 v224,73728,v224
MF v[100:103],a[224:227],v[172:175],v[100:103]
TR a[218:219],v222,1536
v_add_u32 v225,73728,v225
MF v[104:107],a[224:227],v[176:179],v[104:107]
s_add_u32 m0,s41,24576
TR a[220:221],v223,0
v_accvgpr_write_b32 a199,v209
MF v[108:111],a[228:231],v[168:171],v[108:111]
s_add_u32 s36,s37,896
TR a[222:223],v223,1536
v_accvgpr_read_b32 v198,a104
MF v[112:115],a[228:231],v[172:175],v[112:115]
buffer_load_dwordx4 v233,s[4:7],s36 offen offset:0 lds
MF v[116:119],a[228:231],v[176:179],v[116:119]
s_waitcnt lgkmcnt(4)
v_accvgpr_read_b32 v199,a105
v_accvgpr_read_b32 v200,a106
MF v[120:123],a[232:235],v[168:171],v[120:123]
TR a[224:225],v224,0
v_accvgpr_read_b32 v201,a107
MF v[124:127],a[232:235],v[172:175],v[124:127]
TR a[226:227],v224,1536
v_accvgpr_read_b32 v202,a116
MF v[128:131],a[232:235],v[176:179],v[128:131]
TR a[228:229],v225,0
v_accvgpr_read_b32 v203,a117
MF v[132:135],a[236:239],v[168:171],v[132:135]
TR a[230:231],v225,1536
v_accvgpr_read_b32 v204,a118
MF v[136:139],a[236:239],v[172:175],v[136:139]
buffer_load_dwordx4 v234,s[4:7],s36 offen offset:1024 lds
MF v[140:143],a[236:239],v[176:179],v[140:143]
s_waitcnt lgkmcnt(4)
v_accvgpr_read_b32 v205,a119
v_mul_f32 v198,v198,v194
L_st63:
MF v[0:3],a[216:219],v[180:183],v[0:3]
TR a[232:233],v222,128
v_mul_f32 v199,v199,v194
MF v[4:7],a[216:219],v[184:187],v[4:7]
TR a[234:235],v222,1664
v_mul_f32 v200,v200,v194
MF v[8:11],a[216:219],v[188:191],v[8:11]
TR a[236:237],v223,128
v_mul_f32 v201,v201,v194
MF v[12:15],a[220:223],v[180:183],v[12:15]
TR a[238:239],v223,1664
v_mul_f32 v202,v202,v194
MF v[16:19],a[220:223],v[184:187],v[16:19]
buffer_load_dwordx4 v235,s[4:7],s36 offen offset:2048 lds
MF v[20:23],a[220:223],v[188:191],v[20:23]
s_waitcnt lgkmcnt(4)
v_mul_f32 v203,v203,v194
v_mul_f32 v204,v204,v194
MF v[24:27],a[224:227],v[180:183],v[24:27]
TR a[216:217],v224,128
v_mul_f32 v205,v205,v194
MF v[28:31],a[224:227],v[184:187],v[28:31]
TR a[218:219],v224,1664
v_cvt_pk_bf16_f32 v198,v198,v199
MF v[32:35],a[224:227],v[188:191],v[32:35]
s_add_u32 m0,s41,27648
TR a[220:221],v225,128
v_cvt_pk_bf16_f32 v199,v200,v201
MF v[36:39],a[228:231],v[180:183],v[36:39]
s_add_u32 s35,s37,31616
TR a[222:223],v225,1664
v_cvt_pk_bf16_f32 v200,v202,v203
MF v[40:43],a[228:231],v[184:187],v[40:43]
buffer_load_dwordx4 v233,s[4:7],s35 offen offset:0 lds
MF v[44:47],a[228:231],v[188:191],v[44:47]
s_waitcnt lgkmcnt(4)
v_cvt_pk_bf16_f32 v201,v204,v205
v_accvgpr_write_b32 a200,v198
MF v[48:51],a[232:235],v[180:183],v[48:51]
TR a[224:225],v222,256
v_accvgpr_write_b32 a201,v199
MF v[52:55],a[232:235],v[184:187],v[52:55]
TR a[226:227],v222,1792
v_accvgpr_write_b32 a202,v200
MF v[56:59],a[232:235],v[188:191],v[56:59]
TR a[228:229],v223,256
v_accvgpr_write_b32 a203,v201
MF v[60:63],a[236:239],v[180:183],v[60:63]
TR a[230:231],v223,1792
v_accvgpr_read_b32 v206,a120
MF v[64:67],a[236:239],v[184:187],v[64:67]
buffer_load_dwordx4 v234,s[4:7],s35 offen offset:1024 lds
MF v[68:71],a[236:239],v[188:191],v[68:71]
s_waitcnt lgkmcnt(4)
v_accvgpr_read_b32 v207,a121
v_accvgpr_read_b32 v208,a122
MF v[72:75],a[216:219],v[180:183],v[72:75]
TR a[232:233],v224,256
v_subrev_u32 v222,73728,v222
MF v[76:79],a[216:219],v[184:187],v[76:79]
TR a[234:235],v224,1792
v_subrev_u32 v223,73728,v223
MF v[80:83],a[216:219],v[188:191],v[80:83]
TR a[236:237],v225,256
v_accvgpr_read_b32 v209,a123
MF v[84:87],a[220:223],v[180:183],v[84:87]
TR a[238:239],v225,1792
v_accvgpr_read_b32 v210,a132
MF v[88:91],a[220:223],v[184:187],v[88:91]
buffer_load_dwordx4 v235,s[4:7],s35 offen offset:2048 lds
MF v[92:95],a[220:223],v[188:191],v[92:95]
s_waitcnt vmcnt(9) lgkmcnt(4)
s_barrier
v_accvgpr_read_b32 v211,a133
MF v[96:99],a[224:227],v[180:183],v[96:99]
TR a[216:217],v222,12288
RD v[144:147],v242,0
MF v[100:103],a[224:227],v[184:187],v[100:103]
TR a[218:219],v222,13824
RD v[148:151],v242,2048
MF v[104:107],a[224:227],v[188:191],v[104:107]
s_add_u32 m0,s32,49152
TR a[220:221],v223,12288
RD v[152:155],v242,4096
MF v[108:111],a[228:231],v[180:183],v[108:111]
s_add_u32 s36,s34,5505408
TR a[222:223],v223,13824
RD v[156:159],v245,0
MF v[112:115],a[228:231],v[184:187],v[112:115]
buffer_load_dwordx4 v236,s[28:31],s36 offen offset:0 lds
MF v[116:119],a[228:231],v[188:191],v[116:119]
s_waitcnt lgkmcnt(8)
v_subrev_u32 v224,73728,v224
v_subrev_u32 v225,73728,v225
MF v[120:123],a[232:235],v[180:183],v[120:123]
TR a[224:225],v224,12288
RD v[160:163],v245,2048
MF v[124:127],a[232:235],v[184:187],v[124:127]
TR a[226:227],v224,13824
RD v[164:167],v245,4096
MF v[128:131],a[232:235],v[188:191],v[128:131]
TR a[228:229],v225,12288
v_accvgpr_read_b32 v212,a134
MF v[132:135],a[236:239],v[180:183],v[132:135]
TR a[230:231],v225,13824
v_accvgpr_read_b32 v213,a135
MF v[136:139],a[236:239],v[184:187],v[136:139]
buffer_load_dwordx4 v237,s[28:31],s36 offen offset:1024 lds
MF v[140:143],a[236:239],v[188:191],v[140:143]
s_waitcnt lgkmcnt(7)
v_mul_f32 v206,v206,v192
v_mul_f32 v207,v207,v192
L_st64:
MF v[0:3],a[216:219],v[144:147],v[0:3]
TR a[232:233],v222,12416
v_mul_f32 v208,v208,v192
MF v[4:7],a[216:219],v[148:151],v[4:7]
TR a[234:235],v222,13952
v_mul_f32 v209,v209,v192
MF v[8:11],a[216:219],v[152:155],v[8:11]
TR a[236:237],v223,12416
v_mul_f32 v210,v210,v192
MF v[12:15],a[220:223],v[144:147],v[12:15]
TR a[238:239],v223,13952
v_mul_f32 v211,v211,v192
MF v[16:19],a[220:223],v[148:151],v[16:19]
buffer_load_dwordx4 v238,s[28:31],s36 offen offset:2048 lds
MF v[20:23],a[220:223],v[152:155],v[20:23]
s_waitcnt lgkmcnt(4)
v_mul_f32 v212,v212,v192
v_mul_f32 v213,v213,v192
MF v[24:27],a[224:227],v[144:147],v[24:27]
TR a[216:217],v224,12416
v_cvt_pk_bf16_f32 v206,v206,v207
MF v[28:31],a[224:227],v[148:151],v[28:31]
TR a[218:219],v224,13952
v_cvt_pk_bf16_f32 v207,v208,v209
MF v[32:35],a[224:227],v[152:155],v[32:35]
s_add_u32 m0,s32,110592
TR a[220:221],v225,12416
v_cvt_pk_bf16_f32 v208,v210,v211
MF v[36:39],a[228:231],v[144:147],v[36:39]
s_add_u32 s35,s34,5898624
TR a[222:223],v225,13952
v_cvt_pk_bf16_f32 v209,v212,v213
MF v[40:43],a[228:231],v[148:151],v[40:43]
buffer_load_dwordx4 v236,s[28:31],s35 offen offset:0 lds
MF v[44:47],a[228:231],v[152:155],v[44:47]
s_waitcnt lgkmcnt(4)
v_accvgpr_write_b32 a204,v206
v_accvgpr_write_b32 a205,v207
MF v[48:51],a[232:235],v[144:147],v[48:51]
TR a[224:225],v222,12544
v_accvgpr_write_b32 a206,v208
MF v[52:55],a[232:235],v[148:151],v[52:55]
TR a[226:227],v222,14080
v_accvgpr_write_b32 a207,v209
MF v[56:59],a[232:235],v[152:155],v[56:59]
TR a[228:229],v223,12544
v_accvgpr_read_b32 v198,a124
MF v[60:63],a[236:239],v[144:147],v[60:63]
TR a[230:231],v223,14080
v_accvgpr_read_b32 v199,a125
MF v[64:67],a[236:239],v[148:151],v[64:67]
buffer_load_dwordx4 v237,s[28:31],s35 offen offset:1024 lds
MF v[68:71],a[236:239],v[152:155],v[68:71]
s_waitcnt lgkmcnt(4)
v_accvgpr_read_b32 v200,a126
v_accvgpr_read_b32 v201,a127
MF v[72:75],a[216:219],v[144:147],v[72:75]
TR a[232:233],v224,12544
v_accvgpr_read_b32 v202,a136
MF v[76:79],a[216:219],v[148:151],v[76:79]
TR a[234:235],v224,14080
v_accvgpr_read_b32 v203,a137
MF v[80:83],a[216:219],v[152:155],v[80:83]
TR a[236:237],v225,12544
v_accvgpr_read_b32 v204,a138
MF v[84:87],a[220:223],v[144:147],v[84:87]
TR a[238:239],v225,14080
v_accvgpr_read_b32 v205,a139
MF v[88:91],a[220:223],v[148:151],v[88:91]
buffer_load_dwordx4 v238,s[28:31],s35 offen offset:2048 lds
MF v[92:95],a[220:223],v[152:155],v[92:95]
s_waitcnt vmcnt(12) lgkmcnt(4)
s_barrier
v_mul_f32 v198,v198,v193
MF v[96:99],a[224:227],v[144:147],v[96:99]
TR a[216:217],v222,24576
v_mul_f32 v199,v199,v193
MF v[100:103],a[224:227],v[148:151],v[100:103]
TR a[218:219],v222,26112
v_mul_f32 v200,v200,v193
MF v[104:107],a[224:227],v[152:155],v[104:107]
s_add_u32 m0,s41,0
TR a[220:221],v223,24576
v_mul_f32 v201,v201,v193
MF v[108:111],a[228:231],v[144:147],v[108:111]
s_add_u32 s36,s37,1024
TR a[222:223],v223,26112
v_mul_f32 v202,v202,v193
MF v[112:115],a[228:231],v[148:151],v[112:115]
buffer_load_dwordx4 v233,s[4:7],s36 offen offset:0 lds
MF v[116:119],a[228:231],v[152:155],v[116:119]
s_waitcnt lgkmcnt(4)
v_mul_f32 v203,v203,v193
v_mul_f32 v204,v204,v193
MF v[120:123],a[232:235],v[144:147],v[120:123]
TR a[224:225],v224,24576
v_mul_f32 v205,v205,v193
MF v[124:127],a[232:235],v[148:151],v[124:127]
TR a[226:227],v224,26112
v_cvt_pk_bf16_f32 v198,v198,v199
MF v[128:131],a[232:235],v[152:155],v[128:131]
TR a[228:229],v225,24576
v_cvt_pk_bf16_f32 v199,v200,v201
MF v[132:135],a[236:239],v[144:147],v[132:135]
TR a[230:231],v225,26112
v_cvt_pk_bf16_f32 v200,v202,v203
MF v[136:139],a[236:239],v[148:151],v[136:139]
buffer_load_dwordx4 v234,s[4:7],s36 offen offset:1024 lds
MF v[140:143],a[236:239],v[152:155],v[140:143]
s_waitcnt lgkmcnt(4)
v_cvt_pk_bf16_f32 v201,v204,v205
v_accvgpr_write_b32 a208,v198
L_st65:
v_mov_b32 v214,2147483392
v_cmp_gt_u32 vcc,15,v215
s_nop 1
v_cndmask_b32 v214,v214,v251,vcc
s_add_u32 s54,s101,5760
buffer_load_dword a255,v214,s[20:23],s54 offen offset:0
MF v[0:3],a[216:219],v[156:159],v[0:3]
TR a[232:233],v222,24704
v_accvgpr_write_b32 a209,v199
MF v[4:7],a[216:219],v[160:163],v[4:7]
TR a[234:235],v222,26240
v_accvgpr_write_b32 a210,v200
MF v[8:11],a[216:219],v[164:167],v[8:11]
TR a[236:237],v223,24704
v_accvgpr_write_b32 a211,v201
MF v[12:15],a[220:223],v[156:159],v[12:15]
TR a[238:239],v223,26240
v_accvgpr_read_b32 v206,a128
MF v[16:19],a[220:223],v[160:163],v[16:19]
buffer_load_dwordx4 v235,s[4:7],s36 offen offset:2048 lds
MF v[20:23],a[220:223],v[164:167],v[20:23]
s_waitcnt lgkmcnt(4)
v_accvgpr_read_b32 v207,a129
v_accvgpr_read_b32 v208,a130
MF v[24:27],a[224:227],v[156:159],v[24:27]
TR a[216:217],v224,24704
v_accvgpr_read_b32 v209,a131
MF v[28:31],a[224:227],v[160:163],v[28:31]
TR a[218:219],v224,26240
v_accvgpr_read_b32 v210,a140
MF v[32:35],a[224:227],v[164:167],v[32:35]
s_add_u32 m0,s41,3072
TR a[220:221],v225,24704
v_accvgpr_read_b32 v211,a141
MF v[36:39],a[228:231],v[156:159],v[36:39]
s_add_u32 s35,s37,31744
TR a[222:223],v225,26240
v_accvgpr_read_b32 v212,a142
MF v[40:43],a[228:231],v[160:163],v[40:43]
buffer_load_dwordx4 v233,s[4:7],s35 offen offset:0 lds
MF v[44:47],a[228:231],v[164:167],v[44:47]
s_waitcnt lgkmcnt(4)
v_accvgpr_read_b32 v213,a143
v_mul_f32 v206,v206,v194
MF v[48:51],a[232:235],v[156:159],v[48:51]
TR a[224:225],v222,24832
v_mul_f32 v207,v207,v194
MF v[52:55],a[232:235],v[160:163],v[52:55]
TR a[226:227],v222,26368
v_mul_f32 v208,v208,v194
MF v[56:59],a[232:235],v[164:167],v[56:59]
TR a[228:229],v223,24832
v_mul_f32 v209,v209,v194
MF v[60:63],a[236:239],v[156:159],v[60:63]
TR a[230:231],v223,26368
v_mul_f32 v210,v210,v194
MF v[64:67],a[236:239],v[160:163],v[64:67]
buffer_load_dwordx4 v234,s[4:7],s35 offen offset:1024 lds
MF v[68:71],a[236:239],v[164:167],v[68:71]
s_waitcnt lgkmcnt(4)
v_mul_f32 v211,v211,v194
v_mul_f32 v212,v212,v194
MF v[72:75],a[216:219],v[156:159],v[72:75]
TR a[232:233],v224,24832
v_mul_f32 v213,v213,v194
MF v[76:79],a[216:219],v[160:163],v[76:79]
TR a[234:235],v224,26368
v_cvt_pk_bf16_f32 v206,v206,v207
MF v[80:83],a[216:219],v[164:167],v[80:83]
TR a[236:237],v225,24832
v_cvt_pk_bf16_f32 v207,v208,v209
MF v[84:87],a[220:223],v[156:159],v[84:87]
TR a[238:239],v225,26368
v_cvt_pk_bf16_f32 v208,v210,v211
MF v[88:91],a[220:223],v[160:163],v[88:91]
buffer_load_dwordx4 v235,s[4:7],s35 offen offset:2048 lds
MF v[92:95],a[220:223],v[164:167],v[92:95]
s_waitcnt vmcnt(10) lgkmcnt(4)
s_barrier
v_cvt_pk_bf16_f32 v209,v212,v213
MF v[96:99],a[224:227],v[156:159],v[96:99]
TR a[216:217],v222,0
RD v[168:171],v242,24576
MF v[100:103],a[224:227],v[160:163],v[100:103]
TR a[218:219],v222,1536
RD v[172:175],v242,26624
MF v[104:107],a[224:227],v[164:167],v[104:107]
s_add_u32 m0,s32,61440
TR a[220:221],v223,0
RD v[176:179],v242,28672
MF v[108:111],a[228:231],v[156:159],v[108:111]
s_add_u32 s36,s34,6291840
TR a[222:223],v223,1536
RD v[180:183],v245,24576
MF v[112:115],a[228:231],v[160:163],v[112:115]
buffer_load_dwordx4 v236,s[28:31],s36 offen offset:0 lds
MF v[116:119],a[228:231],v[164:167],v[116:119]
s_waitcnt lgkmcnt(8)
v_accvgpr_write_b32 a212,v206
v_accvgpr_write_b32 a213,v207
MF v[120:123],a[232:235],v[156:159],v[120:123]
TR a[224:225],v224,0
RD v[184:187],v245,26624
MF v[124:127],a[232:235],v[160:163],v[124:127]
TR a[226:227],v224,1536
RD v[188:191],v245,28672
MF v[128:131],a[232:235],v[164:167],v[128:131]
TR a[228:229],v225,0
v_accvgpr_write_b32 a214,v208
MF v[132:135],a[236:239],v[156:159],v[132:135]
TR a[230:231],v225,1536
v_accvgpr_write_b32 a215,v209
MF v[136:139],a[236:239],v[160:163],v[136:139]
buffer_load_dwordx4 v237,s[28:31],s36 offen offset:1024 lds
MF v[140:143],a[236:239],v[164:167],v[140:143]
s_waitcnt lgkmcnt(7)
L_st66:
MF v[0:3],a[216:219],v[168:171],v[0:3]
TR a[232:233],v222,128
MF v[4:7],a[216:219],v[172:175],v[4:7]
TR a[234:235],v222,1664
MF v[8:11],a[216:219],v[176:179],v[8:11]
TR a[236:237],v223,128
MF v[12:15],a[220:223],v[168:171],v[12:15]
TR a[238:239],v223,1664
MF v[16:19],a[220:223],v[172:175],v[16:19]
buffer_load_dwordx4 v238,s[28:31],s36 offen offset:2048 lds
MF v[20:23],a[220:223],v[176:179],v[20:23]
s_waitcnt lgkmcnt(4)
MF v[24:27],a[224:227],v[168:171],v[24:27]
TR a[216:217],v224,128
MF v[28:31],a[224:227],v[172:175],v[28:31]
TR a[218:219],v224,1664
MF v[32:35],a[224:227],v[176:179],v[32:35]
s_add_u32 m0,s32,122880
TR a[220:221],v225,128
MF v[36:39],a[228:231],v[168:171],v[36:39]
s_add_u32 s35,s34,6685056
TR a[222:223],v225,1664
MF v[40:43],a[228:231],v[172:175],v[40:43]
buffer_load_dwordx4 v236,s[28:31],s35 offen offset:0 lds
MF v[44:47],a[228:231],v[176:179],v[44:47]
s_waitcnt lgkmcnt(4)
MF v[48:51],a[232:235],v[168:171],v[48:51]
TR a[224:225],v222,256
MF v[52:55],a[232:235],v[172:175],v[52:55]
TR a[226:227],v222,1792
MF v[56:59],a[232:235],v[176:179],v[56:59]
TR a[228:229],v223,256
MF v[60:63],a[236:239],v[168:171],v[60:63]
TR a[230:231],v223,1792
MF v[64:67],a[236:239],v[172:175],v[64:67]
buffer_load_dwordx4 v237,s[28:31],s35 offen offset:1024 lds
MF v[68:71],a[236:239],v[176:179],v[68:71]
s_waitcnt lgkmcnt(4)
MF v[72:75],a[216:219],v[168:171],v[72:75]
TR a[232:233],v224,256
v_add_u32 v222,12288,v222
MF v[76:79],a[216:219],v[172:175],v[76:79]
TR a[234:235],v224,1792
v_add_u32 v223,12288,v223
MF v[80:83],a[216:219],v[176:179],v[80:83]
TR a[236:237],v225,256
MF v[84:87],a[220:223],v[168:171],v[84:87]
TR a[238:239],v225,1792
MF v[88:91],a[220:223],v[172:175],v[88:91]
buffer_load_dwordx4 v238,s[28:31],s35 offen offset:2048 lds
MF v[92:95],a[220:223],v[176:179],v[92:95]
s_waitcnt vmcnt(13) lgkmcnt(4)
s_barrier
MF v[96:99],a[224:227],v[168:171],v[96:99]
TR a[216:217],v222,49152
v_add_u32 v224,12288,v224
MF v[100:103],a[224:227],v[172:175],v[100:103]
TR a[218:219],v222,50688
v_add_u32 v225,12288,v225
MF v[104:107],a[224:227],v[176:179],v[104:107]
s_add_u32 m0,s41,24576
TR a[220:221],v223,49152
MF v[108:111],a[228:231],v[168:171],v[108:111]
s_add_u32 s36,s37,1152
TR a[222:223],v223,50688
MF v[112:115],a[228:231],v[172:175],v[112:115]
buffer_load_dwordx4 v233,s[4:7],s36 offen offset:0 lds
MF v[116:119],a[228:231],v[176:179],v[116:119]
s_waitcnt lgkmcnt(4)
MF v[120:123],a[232:235],v[168:171],v[120:123]
TR a[224:225],v224,49152
MF v[124:127],a[232:235],v[172:175],v[124:127]
TR a[226:227],v224,50688
MF v[128:131],a[232:235],v[176:179],v[128:131]
TR a[228:229],v225,49152
MF v[132:135],a[236:239],v[168:171],v[132:135]
TR a[230:231],v225,50688
MF v[136:139],a[236:239],v[172:175],v[136:139]
buffer_load_dwordx4 v234,s[4:7],s36 offen offset:1024 lds
MF v[140:143],a[236:239],v[176:179],v[140:143]
s_waitcnt lgkmcnt(4)
L_st67:
MF v[0:3],a[216:219],v[180:183],v[0:3]
TR a[232:233],v222,49280
MF v[4:7],a[216:219],v[184:187],v[4:7]
TR a[234:235],v222,50816
MF v[8:11],a[216:219],v[188:191],v[8:11]
TR a[236:237],v223,49280
MF v[12:15],a[220:223],v[180:183],v[12:15]
TR a[238:239],v223,50816
MF v[16:19],a[220:223],v[184:187],v[16:19]
buffer_load_dwordx4 v235,s[4:7],s36 offen offset:2048 lds
MF v[20:23],a[220:223],v[188:191],v[20:23]
s_waitcnt lgkmcnt(4)
MF v[24:27],a[224:227],v[180:183],v[24:27]
TR a[216:217],v224,49280
MF v[28:31],a[224:227],v[184:187],v[28:31]
TR a[218:219],v224,50816
MF v[32:35],a[224:227],v[188:191],v[32:35]
s_add_u32 m0,s41,27648
TR a[220:221],v225,49280
MF v[36:39],a[228:231],v[180:183],v[36:39]
s_add_u32 s35,s37,31872
TR a[222:223],v225,50816
MF v[40:43],a[228:231],v[184:187],v[40:43]
buffer_load_dwordx4 v233,s[4:7],s35 offen offset:0 lds
MF v[44:47],a[228:231],v[188:191],v[44:47]
s_waitcnt lgkmcnt(4)
MF v[48:51],a[232:235],v[180:183],v[48:51]
TR a[224:225],v222,49408
MF v[52:55],a[232:235],v[184:187],v[52:55]
TR a[226:227],v222,50944
MF v[56:59],a[232:235],v[188:191],v[56:59]
TR a[228:229],v223,49408
MF v[60:63],a[236:239],v[180:183],v[60:63]
TR a[230:231],v223,50944
MF v[64:67],a[236:239],v[184:187],v[64:67]
buffer_load_dwordx4 v234,s[4:7],s35 offen offset:1024 lds
MF v[68:71],a[236:239],v[188:191],v[68:71]
s_waitcnt lgkmcnt(4)
MF v[72:75],a[216:219],v[180:183],v[72:75]
TR a[232:233],v224,49408
MF v[76:79],a[216:219],v[184:187],v[76:79]
TR a[234:235],v224,50944
MF v[80:83],a[216:219],v[188:191],v[80:83]
TR a[236:237],v225,49408
MF v[84:87],a[220:223],v[180:183],v[84:87]
TR a[238:239],v225,50944
MF v[88:91],a[220:223],v[184:187],v[88:91]
buffer_load_dwordx4 v235,s[4:7],s35 offen offset:2048 lds
MF v[92:95],a[220:223],v[188:191],v[92:95]
s_waitcnt vmcnt(9) lgkmcnt(4)
s_barrier
MF v[96:99],a[224:227],v[180:183],v[96:99]
TR a[216:217],v222,0
RD v[144:147],v242,0
MF v[100:103],a[224:227],v[184:187],v[100:103]
TR a[218:219],v222,1536
RD v[148:151],v242,2048
MF v[104:107],a[224:227],v[188:191],v[104:107]
s_add_u32 m0,s32,49152
TR a[220:221],v223,0
RD v[152:155],v242,4096
MF v[108:111],a[228:231],v[180:183],v[108:111]
s_add_u32 s36,s34,7078272
TR a[222:223],v223,1536
RD v[156:159],v245,0
MF v[112:115],a[228:231],v[184:187],v[112:115]
buffer_load_dwordx4 v236,s[28:31],s36 offen offset:0 lds
MF v[116:119],a[228:231],v[188:191],v[116:119]
s_waitcnt lgkmcnt(8)
MF v[120:123],a[232:235],v[180:183],v[120:123]
TR a[224:225],v224,0
RD v[160:163],v245,2048
MF v[124:127],a[232:235],v[184:187],v[124:127]
TR a[226:227],v224,1536
RD v[164:167],v245,4096
MF v[128:131],a[232:235],v[188:191],v[128:131]
TR a[228:229],v225,0
MF v[132:135],a[236:239],v[180:183],v[132:135]
TR a[230:231],v225,1536
MF v[136:139],a[236:239],v[184:187],v[136:139]
buffer_load_dwordx4 v237,s[28:31],s36 offen offset:1024 lds
MF v[140:143],a[236:239],v[188:191],v[140:143]
s_waitcnt lgkmcnt(7)
L_st68:
MF v[0:3],a[216:219],v[144:147],v[0:3]
TR a[232:233],v222,128
MF v[4:7],a[216:219],v[148:151],v[4:7]
TR a[234:235],v222,1664
MF v[8:11],a[216:219],v[152:155],v[8:11]
TR a[236:237],v223,128
MF v[12:15],a[220:223],v[144:147],v[12:15]
TR a[238:239],v223,1664
MF v[16:19],a[220:223],v[148:151],v[16:19]
buffer_load_dwordx4 v238,s[28:31],s36 offen offset:2048 lds
MF v[20:23],a[220:223],v[152:155],v[20:23]
s_waitcnt lgkmcnt(4)
MF v[24:27],a[224:227],v[144:147],v[24:27]
TR a[216:217],v224,128
MF v[28:31],a[224:227],v[148:151],v[28:31]
TR a[218:219],v224,1664
MF v[32:35],a[224:227],v[152:155],v[32:35]
s_add_u32 m0,s32,73728
TR a[220:221],v225,128
MF v[36:39],a[228:231],v[144:147],v[36:39]
s_add_u32 s35,s34,7471488
TR a[222:223],v225,1664
MF v[40:43],a[228:231],v[148:151],v[40:43]
buffer_load_dwordx4 v236,s[28:31],s35 offen offset:0 lds
MF v[44:47],a[228:231],v[152:155],v[44:47]
s_waitcnt lgkmcnt(4)
MF v[48:51],a[232:235],v[144:147],v[48:51]
TR a[224:225],v222,256
MF v[52:55],a[232:235],v[148:151],v[52:55]
TR a[226:227],v222,1792
MF v[56:59],a[232:235],v[152:155],v[56:59]
TR a[228:229],v223,256
MF v[60:63],a[236:239],v[144:147],v[60:63]
TR a[230:231],v223,1792
MF v[64:67],a[236:239],v[148:151],v[64:67]
buffer_load_dwordx4 v237,s[28:31],s35 offen offset:1024 lds
MF v[68:71],a[236:239],v[152:155],v[68:71]
s_waitcnt lgkmcnt(4)
MF v[72:75],a[216:219],v[144:147],v[72:75]
TR a[232:233],v224,256
v_add_u32 v222,61440,v222
MF v[76:79],a[216:219],v[148:151],v[76:79]
TR a[234:235],v224,1792
v_add_u32 v223,61440,v223
MF v[80:83],a[216:219],v[152:155],v[80:83]
TR a[236:237],v225,256
MF v[84:87],a[220:223],v[144:147],v[84:87]
TR a[238:239],v225,1792
MF v[88:91],a[220:223],v[148:151],v[88:91]
buffer_load_dwordx4 v238,s[28:31],s35 offen offset:2048 lds
MF v[92:95],a[220:223],v[152:155],v[92:95]
s_waitcnt vmcnt(12) lgkmcnt(4)
s_barrier
MF v[96:99],a[224:227],v[144:147],v[96:99]
TR a[216:217],v222,0
v_add_u32 v224,61440,v224
MF v[100:103],a[224:227],v[148:151],v[100:103]
TR a[218:219],v222,1536
v_add_u32 v225,61440,v225
MF v[104:107],a[224:227],v[152:155],v[104:107]
s_add_u32 m0,s32,0
TR a[220:221],v223,0
MF v[108:111],a[228:231],v[144:147],v[108:111]
s_add_u32 s36,s33,221184
TR a[222:223],v223,1536
MF v[112:115],a[228:231],v[148:151],v[112:115]
buffer_load_dwordx4 v230,s[8:11],s36 offen offset:0 nt lds
MF v[116:119],a[228:231],v[152:155],v[116:119]
s_waitcnt lgkmcnt(4)
MF v[120:123],a[232:235],v[144:147],v[120:123]
TR a[224:225],v224,0
MF v[124:127],a[232:235],v[148:151],v[124:127]
TR a[226:227],v224,1536
MF v[128:131],a[232:235],v[152:155],v[128:131]
TR a[228:229],v225,0
MF v[132:135],a[236:239],v[144:147],v[132:135]
TR a[230:231],v225,1536
MF v[136:139],a[236:239],v[148:151],v[136:139]
buffer_load_dwordx4 v231,s[8:11],s36 offen offset:1024 nt lds
MF v[140:143],a[236:239],v[152:155],v[140:143]
s_waitcnt lgkmcnt(4)
L_st69:
MF v[0:3],a[216:219],v[156:159],v[0:3]
TR a[232:233],v222,128
MF v[4:7],a[216:219],v[160:163],v[4:7]
TR a[234:235],v222,1664
MF v[8:11],a[216:219],v[164:167],v[8:11]
TR a[236:237],v223,128
MF v[12:15],a[220:223],v[156:159],v[12:15]
TR a[238:239],v223,1664
MF v[16:19],a[220:223],v[160:163],v[16:19]
buffer_load_dwordx4 v232,s[8:11],s36 offen offset:2048 nt lds
MF v[20:23],a[220:223],v[164:167],v[20:23]
s_waitcnt lgkmcnt(4)
MF v[24:27],a[224:227],v[156:159],v[24:27]
TR a[216:217],v224,128
MF v[28:31],a[224:227],v[160:163],v[28:31]
TR a[218:219],v224,1664
MF v[32:35],a[224:227],v[164:167],v[32:35]
s_add_u32 m0,s32,12288
TR a[220:221],v225,128
MF v[36:39],a[228:231],v[156:159],v[36:39]
s_add_u32 s35,s33,208896
TR a[222:223],v225,1664
MF v[40:43],a[228:231],v[160:163],v[40:43]
buffer_load_dwordx4 v230,s[12:15],s35 offen offset:0 nt lds
MF v[44:47],a[228:231],v[164:167],v[44:47]
s_waitcnt lgkmcnt(4)
MF v[48:51],a[232:235],v[156:159],v[48:51]
TR a[224:225],v222,256
MF v[52:55],a[232:235],v[160:163],v[52:55]
TR a[226:227],v222,1792
MF v[56:59],a[232:235],v[164:167],v[56:59]
TR a[228:229],v223,256
MF v[60:63],a[236:239],v[156:159],v[60:63]
TR a[230:231],v223,1792
MF v[64:67],a[236:239],v[160:163],v[64:67]
buffer_load_dwordx4 v231,s[12:15],s35 offen offset:1024 nt lds
MF v[68:71],a[236:239],v[164:167],v[68:71]
s_waitcnt lgkmcnt(4)
MF v[72:75],a[216:219],v[156:159],v[72:75]
TR a[232:233],v224,256
v_subrev_u32 v222,73728,v222
MF v[76:79],a[216:219],v[160:163],v[76:79]
TR a[234:235],v224,1792
v_subrev_u32 v223,73728,v223
MF v[80:83],a[216:219],v[164:167],v[80:83]
TR a[236:237],v225,256
MF v[84:87],a[220:223],v[156:159],v[84:87]
TR a[238:239],v225,1792
MF v[88:91],a[220:223],v[160:163],v[88:91]
buffer_load_dwordx4 v232,s[12:15],s35 offen offset:2048 nt lds
MF v[92:95],a[220:223],v[164:167],v[92:95]
s_waitcnt vmcnt(9) lgkmcnt(4)
s_barrier
MF v[96:99],a[224:227],v[156:159],v[96:99]
TR a[216:217],v222,0
RD v[168:171],v242,24576
MF v[100:103],a[224:227],v[160:163],v[100:103]
TR a[218:219],v222,1536
RD v[172:175],v242,26624
MF v[104:107],a[224:227],v[164:167],v[104:107]
s_add_u32 m0,s32,61440
TR a[220:221],v223,0
RD v[176:179],v242,28672
MF v[108:111],a[228:231],v[156:159],v[108:111]
s_add_u32 s36,s33,233472
TR a[222:223],v223,1536
RD v[180:183],v245,24576
MF v[112:115],a[228:231],v[160:163],v[112:115]
buffer_load_dwordx4 v230,s[8:11],s36 offen offset:0 nt lds
MF v[116:119],a[228:231],v[164:167],v[116:119]
s_waitcnt lgkmcnt(8)
v_subrev_u32 v224,73728,v224
v_subrev_u32 v225,73728,v225
MF v[120:123],a[232:235],v[156:159],v[120:123]
TR a[224:225],v224,0
RD v[184:187],v245,26624
MF v[124:127],a[232:235],v[160:163],v[124:127]
TR a[226:227],v224,1536
RD v[188:191],v245,28672
MF v[128:131],a[232:235],v[164:167],v[128:131]
TR a[228:229],v225,0
MF v[132:135],a[236:239],v[156:159],v[132:135]
TR a[230:231],v225,1536
MF v[136:139],a[236:239],v[160:163],v[136:139]
buffer_load_dwordx4 v231,s[8:11],s36 offen offset:1024 nt lds
MF v[140:143],a[236:239],v[164:167],v[140:143]
s_waitcnt lgkmcnt(7)
L_st70:
MF v[0:3],a[216:219],v[168:171],v[0:3]
TR a[232:233],v222,128
MF v[4:7],a[216:219],v[172:175],v[4:7]
TR a[234:235],v222,1664
MF v[8:11],a[216:219],v[176:179],v[8:11]
TR a[236:237],v223,128
MF v[12:15],a[220:223],v[168:171],v[12:15]
TR a[238:239],v223,1664
MF v[16:19],a[220:223],v[172:175],v[16:19]
buffer_load_dwordx4 v232,s[8:11],s36 offen offset:2048 nt lds
MF v[20:23],a[220:223],v[176:179],v[20:23]
s_waitcnt lgkmcnt(4)
MF v[24:27],a[224:227],v[168:171],v[24:27]
TR a[216:217],v224,128
MF v[28:31],a[224:227],v[172:175],v[28:31]
TR a[218:219],v224,1664
MF v[32:35],a[224:227],v[176:179],v[32:35]
s_add_u32 m0,s32,110592
TR a[220:221],v225,128
MF v[36:39],a[228:231],v[168:171],v[36:39]
s_add_u32 s35,s33,221184
TR a[222:223],v225,1664
MF v[40:43],a[228:231],v[172:175],v[40:43]
buffer_load_dwordx4 v230,s[12:15],s35 offen offset:0 nt lds
MF v[44:47],a[228:231],v[176:179],v[44:47]
s_waitcnt lgkmcnt(4)
MF v[48:51],a[232:235],v[168:171],v[48:51]
TR a[224:225],v222,256
MF v[52:55],a[232:235],v[172:175],v[52:55]
TR a[226:227],v222,1792
MF v[56:59],a[232:235],v[176:179],v[56:59]
TR a[228:229],v223,256
MF v[60:63],a[236:239],v[168:171],v[60:63]
TR a[230:231],v223,1792
MF v[64:67],a[236:239],v[172:175],v[64:67]
buffer_load_dwordx4 v231,s[12:15],s35 offen offset:1024 nt lds
MF v[68:71],a[236:239],v[176:179],v[68:71]
s_waitcnt lgkmcnt(4)
MF v[72:75],a[216:219],v[168:171],v[72:75]
TR a[232:233],v224,256
MF v[76:79],a[216:219],v[172:175],v[76:79]
TR a[234:235],v224,1792
MF v[80:83],a[216:219],v[176:179],v[80:83]
TR a[236:237],v225,256
MF v[84:87],a[220:223],v[168:171],v[84:87]
TR a[238:239],v225,1792
MF v[88:91],a[220:223],v[172:175],v[88:91]
buffer_load_dwordx4 v232,s[12:15],s35 offen offset:2048 nt lds
MF v[92:95],a[220:223],v[176:179],v[92:95]
s_waitcnt vmcnt(12) lgkmcnt(4)
s_barrier
MF v[96:99],a[224:227],v[168:171],v[96:99]
TR a[216:217],v222,24576
MF v[100:103],a[224:227],v[172:175],v[100:103]
TR a[218:219],v222,26112
MF v[104:107],a[224:227],v[176:179],v[104:107]
s_add_u32 m0,s32,24576
TR a[220:221],v223,24576
MF v[108:111],a[228:231],v[168:171],v[108:111]
s_add_u32 s36,s33,245760
TR a[222:223],v223,26112
MF v[112:115],a[228:231],v[172:175],v[112:115]
buffer_load_dwordx4 v230,s[8:11],s36 offen offset:0 nt lds
MF v[116:119],a[228:231],v[176:179],v[116:119]
s_waitcnt lgkmcnt(4)
MF v[120:123],a[232:235],v[168:171],v[120:123]
TR a[224:225],v224,24576
MF v[124:127],a[232:235],v[172:175],v[124:127]
TR a[226:227],v224,26112
MF v[128:131],a[232:235],v[176:179],v[128:131]
TR a[228:229],v225,24576
MF v[132:135],a[236:239],v[168:171],v[132:135]
TR a[230:231],v225,26112
MF v[136:139],a[236:239],v[172:175],v[136:139]
buffer_load_dwordx4 v231,s[8:11],s36 offen offset:1024 nt lds
MF v[140:143],a[236:239],v[176:179],v[140:143]
s_waitcnt lgkmcnt(4)
L_st71:
MF v[0:3],a[216:219],v[180:183],v[0:3]
TR a[232:233],v222,24704
MF v[4:7],a[216:219],v[184:187],v[4:7]
TR a[234:235],v222,26240
MF v[8:11],a[216:219],v[188:191],v[8:11]
TR a[236:237],v223,24704
MF v[12:15],a[220:223],v[180:183],v[12:15]
TR a[238:239],v223,26240
MF v[16:19],a[220:223],v[184:187],v[16:19]
buffer_load_dwordx4 v232,s[8:11],s36 offen offset:2048 nt lds
MF v[20:23],a[220:223],v[188:191],v[20:23]
s_waitcnt lgkmcnt(4)
MF v[24:27],a[224:227],v[180:183],v[24:27]
TR a[216:217],v224,24704
MF v[28:31],a[224:227],v[184:187],v[28:31]
TR a[218:219],v224,26240
MF v[32:35],a[224:227],v[188:191],v[32:35]
s_add_u32 m0,s32,36864
TR a[220:221],v225,24704
MF v[36:39],a[228:231],v[180:183],v[36:39]
s_add_u32 s35,s33,233472
TR a[222:223],v225,26240
MF v[40:43],a[228:231],v[184:187],v[40:43]
buffer_load_dwordx4 v230,s[12:15],s35 offen offset:0 nt lds
MF v[44:47],a[228:231],v[188:191],v[44:47]
s_waitcnt lgkmcnt(4)
MF v[48:51],a[232:235],v[180:183],v[48:51]
TR a[224:225],v222,24832
MF v[52:55],a[232:235],v[184:187],v[52:55]
TR a[226:227],v222,26368
MF v[56:59],a[232:235],v[188:191],v[56:59]
TR a[228:229],v223,24832
MF v[60:63],a[236:239],v[180:183],v[60:63]
TR a[230:231],v223,26368
MF v[64:67],a[236:239],v[184:187],v[64:67]
buffer_load_dwordx4 v231,s[12:15],s35 offen offset:1024 nt lds
MF v[68:71],a[236:239],v[188:191],v[68:71]
s_waitcnt lgkmcnt(4)
MF v[72:75],a[216:219],v[180:183],v[72:75]
TR a[232:233],v224,24832
MF v[76:79],a[216:219],v[184:187],v[76:79]
TR a[234:235],v224,26368
MF v[80:83],a[216:219],v[188:191],v[80:83]
TR a[236:237],v225,24832
MF v[84:87],a[220:223],v[180:183],v[84:87]
TR a[238:239],v225,26368
MF v[88:91],a[220:223],v[184:187],v[88:91]
buffer_load_dwordx4 v232,s[12:15],s35 offen offset:2048 nt lds
MF v[92:95],a[220:223],v[188:191],v[92:95]
s_waitcnt lgkmcnt(4)
s_barrier
MF v[96:99],a[224:227],v[180:183],v[96:99]
RD a[216:219],v216,24576
MF v[100:103],a[224:227],v[184:187],v[100:103]
RD a[220:223],v217,24576
MF v[104:107],a[224:227],v[188:191],v[104:107]
s_add_u32 m0,s32,49152
MF v[108:111],a[228:231],v[180:183],v[108:111]
s_add_u32 s36,s33,258048
MF v[112:115],a[228:231],v[184:187],v[112:115]
buffer_load_dwordx4 v230,s[8:11],s36 offen offset:0 nt lds
MF v[116:119],a[228:231],v[188:191],v[116:119]
s_waitcnt lgkmcnt(2)
MF v[120:123],a[232:235],v[180:183],v[120:123]
RD a[224:227],v216,24704
MF v[124:127],a[232:235],v[184:187],v[124:127]
RD a[228:231],v217,24704
MF v[128:131],a[232:235],v[188:191],v[128:131]
MF v[132:135],a[236:239],v[180:183],v[132:135]
MF v[136:139],a[236:239],v[184:187],v[136:139]
buffer_load_dwordx4 v231,s[8:11],s36 offen offset:1024 nt lds
MF v[140:143],a[236:239],v[188:191],v[140:143]
s_waitcnt lgkmcnt(2)
v_pk_mul_f32 v[0:1],v[0:1],s[48:49]
v_pk_mul_f32 v[2:3],v[2:3],s[48:49]
v_pk_mul_f32 v[12:13],v[12:13],s[48:49]
v_pk_mul_f32 v[14:15],v[14:15],s[48:49]
v_pk_mul_f32 v[4:5],v[4:5],s[48:49]
v_pk_mul_f32 v[6:7],v[6:7],s[48:49]
v_pk_mul_f32 v[16:17],v[16:17],s[48:49]
v_pk_mul_f32 v[18:19],v[18:19],s[48:49]
v_pk_mul_f32 v[8:9],v[8:9],s[48:49]
v_pk_mul_f32 v[10:11],v[10:11],s[48:49]
v_pk_mul_f32 v[20:21],v[20:21],s[48:49]
v_pk_mul_f32 v[22:23],v[22:23],s[48:49]
v_cvt_pk_bf16_f32 v144,v0,v1
v_cvt_pk_bf16_f32 v145,v2,v3
v_cvt_pk_bf16_f32 v146,v12,v13
v_cvt_pk_bf16_f32 v147,v14,v15
v_cvt_pk_bf16_f32 v148,v4,v5
v_cvt_pk_bf16_f32 v149,v6,v7
v_cvt_pk_bf16_f32 v150,v16,v17
v_cvt_pk_bf16_f32 v151,v18,v19
v_cvt_pk_bf16_f32 v152,v8,v9
v_cvt_pk_bf16_f32 v153,v10,v11
v_cvt_pk_bf16_f32 v154,v20,v21
v_cvt_pk_bf16_f32 v155,v22,v23
v_permlane32_swap_b32 v144,v146
v_permlane32_swap_b32 v145,v147
v_permlane32_swap_b32 v148,v150
v_permlane32_swap_b32 v149,v151
v_permlane32_swap_b32 v152,v154
v_permlane32_swap_b32 v153,v155
v_permlane16_swap_b32 v144,v146
v_permlane16_swap_b32 v145,v147
v_permlane16_swap_b32 v148,v150
v_permlane16_swap_b32 v149,v151
v_permlane16_swap_b32 v152,v154
v_permlane16_swap_b32 v153,v155
v_pk_mul_f32 v[24:25],v[24:25],s[48:49]
v_pk_mul_f32 v[26:27],v[26:27],s[48:49]
v_pk_mul_f32 v[36:37],v[36:37],s[48:49]
v_pk_mul_f32 v[38:39],v[38:39],s[48:49]
v_pk_mul_f32 v[28:29],v[28:29],s[48:49]
v_pk_mul_f32 v[30:31],v[30:31],s[48:49]
v_pk_mul_f32 v[40:41],v[40:41],s[48:49]
v_pk_mul_f32 v[42:43],v[42:43],s[48:49]
v_pk_mul_f32 v[32:33],v[32:33],s[48:49]
v_pk_mul_f32 v[34:35],v[34:35],s[48:49]
v_pk_mul_f32 v[44:45],v[44:45],s[48:49]
v_pk_mul_f32 v[46:47],v[46:47],s[48:49]
v_cvt_pk_bf16_f32 v156,v24,v25
v_cvt_pk_bf16_f32 v157,v26,v27
v_cvt_pk_bf16_f32 v158,v36,v37
v_cvt_pk_bf16_f32 v159,v38,v39
v_cvt_pk_bf16_f32 v160,v28,v29
v_cvt_pk_bf16_f32 v161,v30,v31
v_cvt_pk_bf16_f32 v162,v40,v41
v_cvt_pk_bf16_f32 v163,v42,v43
v_cvt_pk_bf16_f32 v164,v32,v33
v_cvt_pk_bf16_f32 v165,v34,v35
v_cvt_pk_bf16_f32 v166,v44,v45
v_cvt_pk_bf16_f32 v167,v46,v47
v_permlane32_swap_b32 v156,v158
v_permlane32_swap_b32 v157,v159
v_permlane32_swap_b32 v160,v162
v_permlane32_swap_b32 v161,v163
v_permlane32_swap_b32 v164,v166
v_permlane32_swap_b32 v165,v167
v_permlane16_swap_b32 v156,v158
v_permlane16_swap_b32 v157,v159
v_permlane16_swap_b32 v160,v162
v_permlane16_swap_b32 v161,v163
v_permlane16_swap_b32 v164,v166
v_permlane16_swap_b32 v165,v167
v_pk_mul_f32 v[48:49],v[48:49],s[48:49]
v_pk_mul_f32 v[50:51],v[50:51],s[48:49]
v_pk_mul_f32 v[60:61],v[60:61],s[48:49]
v_pk_mul_f32 v[62:63],v[62:63],s[48:49]
v_pk_mul_f32 v[52:53],v[52:53],s[48:49]
v_pk_mul_f32 v[54:55],v[54:55],s[48:49]
v_pk_mul_f32 v[64:65],v[64:65],s[48:49]
v_pk_mul_f32 v[66:67],v[66:67],s[48:49]
v_pk_mul_f32 v[56:57],v[56:57],s[48:49]
v_pk_mul_f32 v[58:59],v[58:59],s[48:49]
v_pk_mul_f32 v[68:69],v[68:69],s[48:49]
v_pk_mul_f32 v[70:71],v[70:71],s[48:49]
v_cvt_pk_bf16_f32 v168,v48,v49
v_cvt_pk_bf16_f32 v169,v50,v51
v_cvt_pk_bf16_f32 v170,v60,v61
v_cvt_pk_bf16_f32 v171,v62,v63
v_cvt_pk_bf16_f32 v172,v52,v53
v_cvt_pk_bf16_f32 v173,v54,v55
v_cvt_pk_bf16_f32 v174,v64,v65
v_cvt_pk_bf16_f32 v175,v66,v67
v_cvt_pk_bf16_f32 v176,v56,v57
v_cvt_pk_bf16_f32 v177,v58,v59
v_cvt_pk_bf16_f32 v178,v68,v69
v_cvt_pk_bf16_f32 v179,v70,v71
v_permlane32_swap_b32 v168,v170
v_permlane32_swap_b32 v169,v171
v_permlane32_swap_b32 v172,v174
v_permlane32_swap_b32 v173,v175
v_permlane32_swap_b32 v176,v178
v_permlane32_swap_b32 v177,v179
v_permlane16_swap_b32 v168,v170
v_permlane16_swap_b32 v169,v171
v_permlane16_swap_b32 v172,v174
v_permlane16_swap_b32 v173,v175
v_permlane16_swap_b32 v176,v178
v_permlane16_swap_b32 v177,v179
v_pk_mul_f32 v[72:73],v[72:73],s[48:49]
v_pk_mul_f32 v[74:75],v[74:75],s[48:49]
v_pk_mul_f32 v[84:85],v[84:85],s[48:49]
v_pk_mul_f32 v[86:87],v[86:87],s[48:49]
v_pk_mul_f32 v[76:77],v[76:77],s[48:49]
v_pk_mul_f32 v[78:79],v[78:79],s[48:49]
v_pk_mul_f32 v[88:89],v[88:89],s[48:49]
v_pk_mul_f32 v[90:91],v[90:91],s[48:49]
v_pk_mul_f32 v[80:81],v[80:81],s[48:49]
v_pk_mul_f32 v[82:83],v[82:83],s[48:49]
v_pk_mul_f32 v[92:93],v[92:93],s[48:49]
v_pk_mul_f32 v[94:95],v[94:95],s[48:49]
v_cvt_pk_bf16_f32 v180,v72,v73
v_cvt_pk_bf16_f32 v181,v74,v75
v_cvt_pk_bf16_f32 v182,v84,v85
v_cvt_pk_bf16_f32 v183,v86,v87
v_cvt_pk_bf16_f32 v184,v76,v77
v_cvt_pk_bf16_f32 v185,v78,v79
v_cvt_pk_bf16_f32 v186,v88,v89
v_cvt_pk_bf16_f32 v187,v90,v91
v_cvt_pk_bf16_f32 v188,v80,v81
v_cvt_pk_bf16_f32 v189,v82,v83
v_cvt_pk_bf16_f32 v190,v92,v93
v_cvt_pk_bf16_f32 v191,v94,v95
v_permlane32_swap_b32 v180,v182
v_permlane32_swap_b32 v181,v183
v_permlane32_swap_b32 v184,v186
v_permlane32_swap_b32 v185,v187
v_permlane32_swap_b32 v188,v190
v_permlane32_swap_b32 v189,v191
v_permlane16_swap_b32 v180,v182
v_permlane16_swap_b32 v181,v183
v_permlane16_swap_b32 v184,v186
v_permlane16_swap_b32 v185,v187
v_permlane16_swap_b32 v188,v190
v_permlane16_swap_b32 v189,v191
v_pk_mul_f32 v[96:97],v[96:97],s[48:49]
v_pk_mul_f32 v[98:99],v[98:99],s[48:49]
v_pk_mul_f32 v[108:109],v[108:109],s[48:49]
v_pk_mul_f32 v[110:111],v[110:111],s[48:49]
v_pk_mul_f32 v[100:101],v[100:101],s[48:49]
v_pk_mul_f32 v[102:103],v[102:103],s[48:49]
v_pk_mul_f32 v[112:113],v[112:113],s[48:49]
v_pk_mul_f32 v[114:115],v[114:115],s[48:49]
v_pk_mul_f32 v[104:105],v[104:105],s[48:49]
v_pk_mul_f32 v[106:107],v[106:107],s[48:49]
v_pk_mul_f32 v[116:117],v[116:117],s[48:49]
v_pk_mul_f32 v[118:119],v[118:119],s[48:49]
v_cvt_pk_bf16_f32 v192,v96,v97
v_cvt_pk_bf16_f32 v193,v98,v99
v_cvt_pk_bf16_f32 v194,v108,v109
v_cvt_pk_bf16_f32 v195,v110,v111
v_cvt_pk_bf16_f32 v196,v100,v101
v_cvt_pk_bf16_f32 v197,v102,v103
v_cvt_pk_bf16_f32 v198,v112,v113
v_cvt_pk_bf16_f32 v199,v114,v115
v_cvt_pk_bf16_f32 v200,v104,v105
v_cvt_pk_bf16_f32 v201,v106,v107
v_cvt_pk_bf16_f32 v202,v116,v117
v_cvt_pk_bf16_f32 v203,v118,v119
v_permlane32_swap_b32 v192,v194
v_permlane32_swap_b32 v193,v195
v_permlane32_swap_b32 v196,v198
v_permlane32_swap_b32 v197,v199
v_permlane32_swap_b32 v200,v202
v_permlane32_swap_b32 v201,v203
v_permlane16_swap_b32 v192,v194
v_permlane16_swap_b32 v193,v195
v_permlane16_swap_b32 v196,v198
v_permlane16_swap_b32 v197,v199
v_permlane16_swap_b32 v200,v202
v_permlane16_swap_b32 v201,v203
v_pk_mul_f32 v[120:121],v[120:121],s[48:49]
v_pk_mul_f32 v[122:123],v[122:123],s[48:49]
v_pk_mul_f32 v[132:133],v[132:133],s[48:49]
v_pk_mul_f32 v[134:135],v[134:135],s[48:49]
v_pk_mul_f32 v[124:125],v[124:125],s[48:49]
v_pk_mul_f32 v[126:127],v[126:127],s[48:49]
v_pk_mul_f32 v[136:137],v[136:137],s[48:49]
v_pk_mul_f32 v[138:139],v[138:139],s[48:49]
v_pk_mul_f32 v[128:129],v[128:129],s[48:49]
v_pk_mul_f32 v[130:131],v[130:131],s[48:49]
v_pk_mul_f32 v[140:141],v[140:141],s[48:49]
v_pk_mul_f32 v[142:143],v[142:143],s[48:49]
v_cvt_pk_bf16_f32 v204,v120,v121
v_cvt_pk_bf16_f32 v205,v122,v123
v_cvt_pk_bf16_f32 v206,v132,v133
v_cvt_pk_bf16_f32 v207,v134,v135
v_cvt_pk_bf16_f32 v208,v124,v125
v_cvt_pk_bf16_f32 v209,v126,v127
v_cvt_pk_bf16_f32 v210,v136,v137
v_cvt_pk_bf16_f32 v211,v138,v139
v_cvt_pk_bf16_f32 v212,v128,v129
v_cvt_pk_bf16_f32 v213,v130,v131
v_cvt_pk_bf16_f32 v214,v140,v141
v_cvt_pk_bf16_f32 v215,v142,v143
v_permlane32_swap_b32 v204,v206
v_permlane32_swap_b32 v205,v207
v_permlane32_swap_b32 v208,v210
v_permlane32_swap_b32 v209,v211
v_permlane32_swap_b32 v212,v214
v_permlane32_swap_b32 v213,v215
v_permlane16_swap_b32 v204,v206
v_permlane16_swap_b32 v205,v207
v_permlane16_swap_b32 v208,v210
v_permlane16_swap_b32 v209,v211
v_permlane16_swap_b32 v212,v214
v_permlane16_swap_b32 v213,v215
L_st72:
MF v[0:3],a[216:219],v[144:147],0
RD a[232:235],v216,24832
MF v[4:7],a[216:219],v[148:151],0
RD a[236:239],v217,24832
MF v[8:11],a[216:219],v[152:155],0
MF v[0:3],a[220:223],v[156:159],v[0:3]
MF v[4:7],a[220:223],v[160:163],v[4:7]
buffer_load_dwordx4 v232,s[8:11],s36 offen offset:2048 nt lds
MF v[8:11],a[220:223],v[164:167],v[8:11]
s_waitcnt lgkmcnt(2)
MF v[0:3],a[224:227],v[168:171],v[0:3]
RD a[216:219],v216,30720
MF v[4:7],a[224:227],v[172:175],v[4:7]
RD a[220:223],v217,30720
MF v[8:11],a[224:227],v[176:179],v[8:11]
s_add_u32 m0,s32,122880
MF v[0:3],a[228:231],v[180:183],v[0:3]
s_add_u32 s35,s33,245760
MF v[4:7],a[228:231],v[184:187],v[4:7]
buffer_load_dwordx4 v230,s[12:15],s35 offen offset:0 nt lds
MF v[8:11],a[228:231],v[188:191],v[8:11]
s_waitcnt lgkmcnt(2)
MF v[0:3],a[232:235],v[192:195],v[0:3]
RD a[224:227],v216,30848
MF v[4:7],a[232:235],v[196:199],v[4:7]
RD a[228:231],v217,30848
MF v[8:11],a[232:235],v[200:203],v[8:11]
MF v[0:3],a[236:239],v[204:207],v[0:3]
MF v[4:7],a[236:239],v[208:211],v[4:7]
buffer_load_dwordx4 v231,s[12:15],s35 offen offset:1024 nt lds
MF v[8:11],a[236:239],v[212:215],v[8:11]
s_waitcnt lgkmcnt(2)
MF v[12:15],a[216:219],v[144:147],0
RD a[232:235],v216,30976
MF v[16:19],a[216:219],v[148:151],0
RD a[236:239],v217,30976
MF v[20:23],a[216:219],v[152:155],0
v_subrev_u32 v216,36864,v216
v_subrev_u32 v217,36864,v217
MF v[12:15],a[220:223],v[156:159],v[12:15]
MF v[16:19],a[220:223],v[160:163],v[16:19]
buffer_load_dwordx4 v232,s[12:15],s35 offen offset:2048 nt lds
MF v[20:23],a[220:223],v[164:167],v[20:23]
s_waitcnt lgkmcnt(2)
s_barrier
MF v[12:15],a[224:227],v[168:171],v[12:15]
RD a[216:219],v216,0
MF v[16:19],a[224:227],v[172:175],v[16:19]
RD a[220:223],v217,0
MF v[20:23],a[224:227],v[176:179],v[20:23]
s_add_u32 m0,s32,73728
MF v[12:15],a[228:231],v[180:183],v[12:15]
s_add_u32 s36,s33,270336
MF v[16:19],a[228:231],v[184:187],v[16:19]
buffer_load_dwordx4 v230,s[8:11],s36 offen offset:0 nt lds
MF v[20:23],a[228:231],v[188:191],v[20:23]
s_waitcnt lgkmcnt(2)
MF v[12:15],a[232:235],v[192:195],v[12:15]
RD a[224:227],v216,128
MF v[16:19],a[232:235],v[196:199],v[16:19]
RD a[228:231],v217,128
MF v[20:23],a[232:235],v[200:203],v[20:23]
MF v[12:15],a[236:239],v[204:207],v[12:15]
MF v[16:19],a[236:239],v[208:211],v[16:19]
buffer_load_dwordx4 v231,s[8:11],s36 offen offset:1024 nt lds
MF v[20:23],a[236:239],v[212:215],v[20:23]
s_waitcnt lgkmcnt(2)
L_st73:
MF v[24:27],a[216:219],v[144:147],0
RD a[232:235],v216,256
v_max3_f32 v98,v0,v1,v2
MF v[28:31],a[216:219],v[148:151],0
RD a[236:239],v217,256
v_max3_f32 v98,v98,v3,v12
MF v[32:35],a[216:219],v[152:155],0
v_max3_f32 v98,v98,v13,v14
v_max_f32 v98,v98,v15
MF v[24:27],a[220:223],v[156:159],v[24:27]
v_max3_f32 v99,v4,v5,v6
v_max3_f32 v99,v99,v7,v16
MF v[28:31],a[220:223],v[160:163],v[28:31]
buffer_load_dwordx4 v232,s[8:11],s36 offen offset:2048 nt lds
MF v[32:35],a[220:223],v[164:167],v[32:35]
s_waitcnt lgkmcnt(2)
v_max3_f32 v99,v99,v17,v18
v_max_f32 v99,v99,v19
MF v[24:27],a[224:227],v[168:171],v[24:27]
RD a[216:219],v216,6144
v_max3_f32 v100,v8,v9,v10
MF v[28:31],a[224:227],v[172:175],v[28:31]
RD a[220:223],v217,6144
v_max3_f32 v100,v100,v11,v20
MF v[32:35],a[224:227],v[176:179],v[32:35]
s_add_u32 m0,s32,135168
v_max3_f32 v100,v100,v21,v22
v_max_f32 v100,v100,v23
MF v[24:27],a[228:231],v[180:183],v[24:27]
s_add_u32 s35,s33,258048
v_mov_b32 v101,v98
v_mov_b32 v102,v99
MF v[28:31],a[228:231],v[184:187],v[28:31]
buffer_load_dwordx4 v230,s[12:15],s35 offen offset:0 nt lds
MF v[32:35],a[228:231],v[188:191],v[32:35]
s_waitcnt lgkmcnt(2)
v_mov_b32 v103,v100
v_permlane32_swap_b32 v98,v101
MF v[24:27],a[232:235],v[192:195],v[24:27]
RD a[224:227],v216,6272
v_permlane32_swap_b32 v99,v102
MF v[28:31],a[232:235],v[196:199],v[28:31]
RD a[228:231],v217,6272
v_permlane32_swap_b32 v100,v103
MF v[32:35],a[232:235],v[200:203],v[32:35]
v_max_f32 v98,v98,v101
v_max_f32 v99,v99,v102
MF v[24:27],a[236:239],v[204:207],v[24:27]
v_max_f32 v100,v100,v103
v_mov_b32 v101,v98
MF v[28:31],a[236:239],v[208:211],v[28:31]
buffer_load_dwordx4 v231,s[12:15],s35 offen offset:1024 nt lds
MF v[32:35],a[236:239],v[212:215],v[32:35]
s_waitcnt lgkmcnt(2)
v_mov_b32 v102,v99
v_mov_b32 v103,v100
MF v[36:39],a[216:219],v[144:147],0
RD a[232:235],v216,6400
v_permlane16_swap_b32 v98,v101
MF v[40:43],a[216:219],v[148:151],0
RD a[236:239],v217,6400
v_permlane16_swap_b32 v99,v102
MF v[44:47],a[216:219],v[152:155],0
v_permlane16_swap_b32 v100,v103
v_max_f32 v98,v98,v101
MF v[36:39],a[220:223],v[156:159],v[36:39]
v_max_f32 v99,v99,v102
v_max_f32 v100,v100,v103
MF v[40:43],a[220:223],v[160:163],v[40:43]
buffer_load_dwordx4 v232,s[12:15],s35 offen offset:2048 nt lds
MF v[44:47],a[220:223],v[164:167],v[44:47]
s_waitcnt lgkmcnt(2)
s_barrier
v_xor_b32 v80,2147483648,v98
MF v[36:39],a[224:227],v[168:171],v[36:39]
TR a[216:217],v218,12288
TR a[218:219],v218,18432
MF v[40:43],a[224:227],v[172:175],v[40:43]
TR a[220:221],v219,12288
TR a[222:223],v219,18432
MF v[44:47],a[224:227],v[176:179],v[44:47]
s_add_u32 m0,s32,147456
v_mov_b32 v81,v80
v_mov_b32 v82,v80
MF v[36:39],a[228:231],v[180:183],v[36:39]
s_add_u32 s36,s33,282624
v_mov_b32 v83,v80
v_xor_b32 v84,2147483648,v99
MF v[40:43],a[228:231],v[184:187],v[40:43]
buffer_load_dwordx4 v230,s[8:11],s36 offen offset:0 nt lds
MF v[44:47],a[228:231],v[188:191],v[44:47]
s_waitcnt lgkmcnt(4)
v_mov_b32 v85,v84
v_mov_b32 v86,v84
MF v[36:39],a[232:235],v[192:195],v[36:39]
TR a[224:225],v220,12288
TR a[226:227],v220,18432
MF v[40:43],a[232:235],v[196:199],v[40:43]
TR a[228:229],v221,12288
TR a[230:231],v221,18432
MF v[44:47],a[232:235],v[200:203],v[44:47]
v_mov_b32 v87,v84
v_xor_b32 v88,2147483648,v100
MF v[36:39],a[236:239],v[204:207],v[36:39]
v_mov_b32 v89,v88
v_mov_b32 v90,v88
MF v[40:43],a[236:239],v[208:211],v[40:43]
v_mov_b32 v91,v88
v_add_f32 v0,v0,v80
MF v[44:47],a[236:239],v[212:215],v[44:47]
s_waitcnt lgkmcnt(4)
v_exp_f32 v72,v0
v_add_f32 v1,v1,v80
v_add_f32 v2,v2,v80
v_add_f32 v3,v3,v80
v_exp_f32 v73,v1
s_nop 0
v_add_f32 v95,v72,v73
v_cvt_pk_bf16_f32 v48,v72,v73
v_exp_f32 v74,v2
v_exp_f32 v75,v3
v_add_f32 v95,v95,v74
v_add_f32 v95,v95,v75
v_cvt_pk_bf16_f32 v49,v74,v75
v_add_f32 v4,v4,v84
v_add_f32 v5,v5,v84
v_add_f32 v6,v6,v84
v_add_f32 v7,v7,v84
v_exp_f32 v76,v4
v_exp_f32 v77,v5
s_nop 0
v_add_f32 v96,v76,v77
v_cvt_pk_bf16_f32 v52,v76,v77
v_exp_f32 v78,v6
v_exp_f32 v79,v7
v_add_f32 v96,v96,v78
v_add_f32 v96,v96,v79
v_cvt_pk_bf16_f32 v53,v78,v79
v_add_f32 v8,v8,v88
v_add_f32 v9,v9,v88
v_add_f32 v10,v10,v88
v_add_f32 v11,v11,v88
v_exp_f32 v120,v8
v_exp_f32 v121,v9
s_nop 0
v_add_f32 v97,v120,v121
v_cvt_pk_bf16_f32 v56,v120,v121
v_exp_f32 v122,v10
v_exp_f32 v123,v11
v_add_f32 v97,v97,v122
v_add_f32 v97,v97,v123
v_cvt_pk_bf16_f32 v57,v122,v123
v_add_f32 v12,v12,v80
v_add_f32 v13,v13,v80
v_add_f32 v14,v14,v80
v_add_f32 v15,v15,v80
v_exp_f32 v124,v12
v_exp_f32 v125,v13
v_add_f32 v95,v95,v124
v_add_f32 v95,v95,v125
v_cvt_pk_bf16_f32 v50,v124,v125
v_exp_f32 v126,v14
v_exp_f32 v127,v15
v_add_f32 v95,v95,v126
v_add_f32 v95,v95,v127
v_cvt_pk_bf16_f32 v51,v126,v127
v_add_f32 v16,v16,v84
v_add_f32 v17,v17,v84
v_add_f32 v18,v18,v84
v_add_f32 v19,v19,v84
v_exp_f32 v72,v16
v_exp_f32 v73,v17
v_add_f32 v96,v96,v72
v_add_f32 v96,v96,v73
v_cvt_pk_bf16_f32 v54,v72,v73
v_exp_f32 v74,v18
v_exp_f32 v75,v19
v_add_f32 v96,v96,v74
v_add_f32 v96,v96,v75
v_cvt_pk_bf16_f32 v55,v74,v75
v_add_f32 v20,v20,v88
v_add_f32 v21,v21,v88
v_add_f32 v22,v22,v88
v_add_f32 v23,v23,v88
v_exp_f32 v76,v20
v_exp_f32 v77,v21
v_add_f32 v97,v97,v76
v_add_f32 v97,v97,v77
v_cvt_pk_bf16_f32 v58,v76,v77
v_exp_f32 v78,v22
v_exp_f32 v79,v23
v_add_f32 v97,v97,v78
v_add_f32 v97,v97,v79
v_cvt_pk_bf16_f32 v59,v78,v79
v_mov_b32 v92,v95
v_mov_b32 v93,v96
v_mov_b32 v94,v97
L_st74:
MF a[0:3],a[216:219],v[48:51],0
TR a[232:233],v218,12416
TR a[234:235],v218,18560
MF a[4:7],a[216:219],v[52:55],0
TR a[236:237],v219,12416
TR a[238:239],v219,18560
MF a[8:11],a[216:219],v[56:59],0
v_subrev_u32 v216,86016,v216
v_subrev_u32 v217,86016,v217
MF a[12:15],a[220:223],v[48:51],0
v_add_f32 v24,v24,v80
v_add_f32 v25,v25,v80
MF a[16:19],a[220:223],v[52:55],0
buffer_load_dwordx4 v231,s[8:11],s36 offen offset:1024 nt lds
MF a[20:23],a[220:223],v[56:59],0
s_waitcnt lgkmcnt(4)
v_exp_f32 v72,v24
MF a[24:27],a[224:227],v[48:51],0
TR a[216:217],v220,12416
TR a[218:219],v220,18560
MF a[28:31],a[224:227],v[52:55],0
TR a[220:221],v221,12416
TR a[222:223],v221,18560
MF a[32:35],a[224:227],v[56:59],0
v_exp_f32 v73,v25
MF a[36:39],a[228:231],v[48:51],0
v_add_f32 v26,v26,v80
v_add_f32 v27,v27,v80
MF a[40:43],a[228:231],v[52:55],0
v_exp_f32 v74,v26
MF a[44:47],a[228:231],v[56:59],0
s_waitcnt lgkmcnt(4)
v_exp_f32 v75,v27
MF a[48:51],a[232:235],v[48:51],0
TR a[224:225],v218,12544
TR a[226:227],v218,18688
MF a[52:55],a[232:235],v[52:55],0
TR a[228:229],v219,12544
TR a[230:231],v219,18688
MF a[56:59],a[232:235],v[56:59],0
v_add_f32 v95,v72,v73
v_cvt_pk_bf16_f32 v60,v72,v73
MF a[60:63],a[236:239],v[48:51],0
v_add_f32 v95,v95,v74
v_add_f32 v95,v95,v75
MF a[64:67],a[236:239],v[52:55],0
buffer_load_dwordx4 v232,s[8:11],s36 offen offset:2048 nt lds
MF a[68:71],a[236:239],v[56:59],0
s_waitcnt lgkmcnt(4)
v_cvt_pk_bf16_f32 v61,v74,v75
v_add_f32 v28,v28,v84
MF a[72:75],a[216:219],v[48:51],0
TR a[232:233],v220,12544
TR a[234:235],v220,18688
MF a[76:79],a[216:219],v[52:55],0
TR a[236:237],v221,12544
TR a[238:239],v221,18688
MF a[80:83],a[216:219],v[56:59],0
v_exp_f32 v76,v28
MF a[84:87],a[220:223],v[48:51],0
v_add_f32 v29,v29,v84
v_add_f32 v30,v30,v84
MF a[88:91],a[220:223],v[52:55],0
v_exp_f32 v77,v29
MF a[92:95],a[220:223],v[56:59],0
s_waitcnt vmcnt(30) lgkmcnt(4)
s_barrier
v_add_f32 v31,v31,v84
MF a[96:99],a[224:227],v[48:51],0
RD a[216:219],v216,0
v_add_f32 v96,v76,v77
MF a[100:103],a[224:227],v[52:55],0
RD a[220:223],v217,0
v_cvt_pk_bf16_f32 v64,v76,v77
MF a[104:107],a[224:227],v[56:59],0
s_add_u32 m0,s32,86016
v_exp_f32 v78,v30
MF a[108:111],a[228:231],v[48:51],0
s_add_u32 s35,s33,270336
v_exp_f32 v79,v31
MF a[112:115],a[228:231],v[52:55],0
buffer_load_dwordx4 v230,s[12:15],s35 offen offset:0 nt lds
MF a[116:119],a[228:231],v[56:59],0
s_waitcnt lgkmcnt(2)
v_add_f32 v96,v96,v78
v_add_f32 v96,v96,v79
MF a[120:123],a[232:235],v[48:51],0
RD a[224:227],v216,128
v_cvt_pk_bf16_f32 v65,v78,v79
MF a[124:127],a[232:235],v[52:55],0
RD a[228:231],v217,128
v_add_f32 v32,v32,v88
MF a[128:131],a[232:235],v[56:59],0
v_exp_f32 v120,v32
MF a[132:135],a[236:239],v[48:51],0
v_add_f32 v33,v33,v88
v_add_f32 v34,v34,v88
MF a[136:139],a[236:239],v[52:55],0
v_exp_f32 v121,v33
MF a[140:143],a[236:239],v[56:59],0
s_waitcnt lgkmcnt(2)
v_exp_f32 v122,v34
L_st75:
s_lshr_b32 s56,s2,3
s_and_b32 s56,s56,7
s_cmp_eq_u32 s56,0
s_cbranch_scc0 L_pcs5
s_getpc_b64 s[56:57]
L_pc5:
s_add_u32 s56,s56,L_code+65536-L_pc5
s_addc_u32 s57,s57,0
v_mov_b32 v249,s57
v_add_co_u32 v248,vcc,s56,v252
s_nop 1
v_addc_co_u32 v249,vcc,0,v249,vcc
global_load_dword a255,v[248:249],off
L_pcs5:
MF v[0:3],a[216:219],v[144:147],v[80:83]
RD a[232:235],v216,256
v_add_f32 v35,v35,v88
MF v[4:7],a[216:219],v[148:151],v[84:87]
RD a[236:239],v217,256
v_add_f32 v97,v120,v121
MF v[8:11],a[216:219],v[152:155],v[88:91]
v_exp_f32 v123,v35
MF v[0:3],a[220:223],v[156:159],v[0:3]
v_cvt_pk_bf16_f32 v68,v120,v121
v_add_f32 v97,v97,v122
MF v[4:7],a[220:223],v[160:163],v[4:7]
buffer_load_dwordx4 v231,s[12:15],s35 offen offset:1024 nt lds
MF v[8:11],a[220:223],v[164:167],v[8:11]
s_waitcnt lgkmcnt(2)
v_add_f32 v97,v97,v123
v_cvt_pk_bf16_f32 v69,v122,v123
MF v[0:3],a[224:227],v[168:171],v[0:3]
RD a[216:219],v216,6144
v_subrev_u32 v218,73728,v218
MF v[4:7],a[224:227],v[172:175],v[4:7]
RD a[220:223],v217,6144
v_subrev_u32 v219,73728,v219
MF v[8:11],a[224:227],v[176:179],v[8:11]
v_add_f32 v36,v36,v80
v_add_f32 v37,v37,v80
MF v[0:3],a[228:231],v[180:183],v[0:3]
v_exp_f32 v124,v36
MF v[4:7],a[228:231],v[184:187],v[4:7]
v_exp_f32 v125,v37
MF v[8:11],a[228:231],v[188:191],v[8:11]
s_waitcnt lgkmcnt(2)
v_add_f32 v38,v38,v80
v_add_f32 v39,v39,v80
MF v[0:3],a[232:235],v[192:195],v[0:3]
RD a[224:227],v216,6272
v_subrev_u32 v220,73728,v220
MF v[4:7],a[232:235],v[196:199],v[4:7]
RD a[228:231],v217,6272
v_subrev_u32 v221,73728,v221
MF v[8:11],a[232:235],v[200:203],v[8:11]
v_exp_f32 v126,v38
MF v[0:3],a[236:239],v[204:207],v[0:3]
v_exp_f32 v127,v39
MF v[4:7],a[236:239],v[208:211],v[4:7]
buffer_load_dwordx4 v232,s[12:15],s35 offen offset:2048 nt lds
MF v[8:11],a[236:239],v[212:215],v[8:11]
s_waitcnt lgkmcnt(2)
v_add_f32 v95,v95,v124
v_add_f32 v95,v95,v125
MF v[12:15],a[216:219],v[144:147],v[80:83]
RD a[232:235],v216,6400
v_cvt_pk_bf16_f32 v62,v124,v125
MF v[16:19],a[216:219],v[148:151],v[84:87]
RD a[236:239],v217,6400
v_add_f32 v95,v95,v126
MF v[20:23],a[216:219],v[152:155],v[88:91]
v_add_f32 v95,v95,v127
v_cvt_pk_bf16_f32 v63,v126,v127
MF v[12:15],a[220:223],v[156:159],v[12:15]
v_add_f32 v40,v40,v84
v_add_f32 v41,v41,v84
MF v[16:19],a[220:223],v[160:163],v[16:19]
v_exp_f32 v72,v40
MF v[20:23],a[220:223],v[164:167],v[20:23]
s_waitcnt vmcnt(30) lgkmcnt(2)
s_barrier
v_add_f32 v42,v42,v84
MF v[12:15],a[224:227],v[168:171],v[12:15]
TR a[216:217],v218,0
TR a[218:219],v218,6144
MF v[16:19],a[224:227],v[172:175],v[16:19]
TR a[220:221],v219,0
TR a[222:223],v219,6144
MF v[20:23],a[224:227],v[176:179],v[20:23]
s_add_u32 m0,s32,98304
v_exp_f32 v73,v41
MF v[12:15],a[228:231],v[180:183],v[12:15]
s_add_u32 s36,s33,294912
v_exp_f32 v74,v42
MF v[16:19],a[228:231],v[184:187],v[16:19]
buffer_load_dwordx4 v230,s[8:11],s36 offen offset:0 nt lds
MF v[20:23],a[228:231],v[188:191],v[20:23]
s_waitcnt lgkmcnt(4)
v_add_f32 v43,v43,v84
v_add_f32 v96,v96,v72
MF v[12:15],a[232:235],v[192:195],v[12:15]
TR a[224:225],v220,0
TR a[226:227],v220,6144
MF v[16:19],a[232:235],v[196:199],v[16:19]
TR a[228:229],v221,0
TR a[230:231],v221,6144
MF v[20:23],a[232:235],v[200:203],v[20:23]
v_exp_f32 v75,v43
MF v[12:15],a[236:239],v[204:207],v[12:15]
v_add_f32 v96,v96,v73
v_cvt_pk_bf16_f32 v66,v72,v73
MF v[16:19],a[236:239],v[208:211],v[16:19]
v_add_f32 v96,v96,v74
v_add_f32 v96,v96,v75
MF v[20:23],a[236:239],v[212:215],v[20:23]
s_waitcnt lgkmcnt(4)
v_cvt_pk_bf16_f32 v67,v74,v75
v_add_f32 v44,v44,v88
v_add_f32 v45,v45,v88
v_add_f32 v46,v46,v88
v_add_f32 v47,v47,v88
v_exp_f32 v76,v44
v_exp_f32 v77,v45
v_add_f32 v97,v97,v76
v_add_f32 v97,v97,v77
v_cvt_pk_bf16_f32 v70,v76,v77
v_exp_f32 v78,v46
v_exp_f32 v79,v47
v_add_f32 v97,v97,v78
v_add_f32 v97,v97,v79
v_cvt_pk_bf16_f32 v71,v78,v79
v_max3_f32 v104,v95,v96,v97
v_cmp_lt_f32 vcc,s46,v104
s_cbranch_vccnz L_rs15
L_rr15:
L_st76:
MF a[0:3],a[216:219],v[60:63],a[0:3]
TR a[232:233],v218,128
TR a[234:235],v218,6272
MF a[4:7],a[216:219],v[64:67],a[4:7]
TR a[236:237],v219,128
TR a[238:239],v219,6272
MF a[8:11],a[216:219],v[68:71],a[8:11]
v_add_u32 v216,24576,v216
v_add_u32 v217,24576,v217
MF a[12:15],a[220:223],v[60:63],a[12:15]
v_exp_f32 v72,v0
MF a[16:19],a[220:223],v[64:67],a[16:19]
buffer_load_dwordx4 v231,s[8:11],s36 offen offset:1024 nt lds
MF a[20:23],a[220:223],v[68:71],a[20:23]
s_waitcnt lgkmcnt(4)
v_exp_f32 v73,v1
MF a[24:27],a[224:227],v[60:63],a[24:27]
TR a[216:217],v220,128
TR a[218:219],v220,6272
MF a[28:31],a[224:227],v[64:67],a[28:31]
TR a[220:221],v221,128
TR a[222:223],v221,6272
MF a[32:35],a[224:227],v[68:71],a[32:35]
v_exp_f32 v74,v2
MF a[36:39],a[228:231],v[60:63],a[36:39]
v_exp_f32 v75,v3
MF a[40:43],a[228:231],v[64:67],a[40:43]
v_exp_f32 v76,v4
MF a[44:47],a[228:231],v[68:71],a[44:47]
s_waitcnt lgkmcnt(4)
v_exp_f32 v77,v5
MF a[48:51],a[232:235],v[60:63],a[48:51]
TR a[224:225],v218,256
TR a[226:227],v218,6400
MF a[52:55],a[232:235],v[64:67],a[52:55]
TR a[228:229],v219,256
TR a[230:231],v219,6400
MF a[56:59],a[232:235],v[68:71],a[56:59]
v_exp_f32 v78,v6
MF a[60:63],a[236:239],v[60:63],a[60:63]
v_exp_f32 v79,v7
MF a[64:67],a[236:239],v[64:67],a[64:67]
buffer_load_dwordx4 v232,s[8:11],s36 offen offset:2048 nt lds
MF a[68:71],a[236:239],v[68:71],a[68:71]
s_waitcnt lgkmcnt(4)
v_exp_f32 v120,v8
MF a[72:75],a[216:219],v[60:63],a[72:75]
TR a[232:233],v220,256
TR a[234:235],v220,6400
MF a[76:79],a[216:219],v[64:67],a[76:79]
TR a[236:237],v221,256
TR a[238:239],v221,6400
MF a[80:83],a[216:219],v[68:71],a[80:83]
v_exp_f32 v121,v9
MF a[84:87],a[220:223],v[60:63],a[84:87]
v_exp_f32 v122,v10
MF a[88:91],a[220:223],v[64:67],a[88:91]
v_exp_f32 v123,v11
MF a[92:95],a[220:223],v[68:71],a[92:95]
s_waitcnt vmcnt(30) lgkmcnt(4)
s_barrier
v_add_f32 v92,v92,v95
MF a[96:99],a[224:227],v[60:63],a[96:99]
RD a[216:219],v216,36864
v_add_f32 v93,v93,v96
MF a[100:103],a[224:227],v[64:67],a[100:103]
RD a[220:223],v217,36864
v_add_f32 v94,v94,v97
MF a[104:107],a[224:227],v[68:71],a[104:107]
s_add_u32 m0,s32,0
v_exp_f32 v124,v12
MF a[108:111],a[228:231],v[60:63],a[108:111]
s_add_u32 s35,s33,282624
v_exp_f32 v125,v13
MF a[112:115],a[228:231],v[64:67],a[112:115]
buffer_load_dwordx4 v230,s[12:15],s35 offen offset:0 nt lds
MF a[116:119],a[228:231],v[68:71],a[116:119]
s_waitcnt lgkmcnt(2)
v_exp_f32 v126,v14
MF a[120:123],a[232:235],v[60:63],a[120:123]
RD a[224:227],v216,36992
v_add_f32 v95,v72,v73
MF a[124:127],a[232:235],v[64:67],a[124:127]
RD a[228:231],v217,36992
v_cvt_pk_bf16_f32 v48,v72,v73
MF a[128:131],a[232:235],v[68:71],a[128:131]
v_exp_f32 v127,v15
MF a[132:135],a[236:239],v[60:63],a[132:135]
v_exp_f32 v72,v16
MF a[136:139],a[236:239],v[64:67],a[136:139]
v_exp_f32 v73,v17
MF a[140:143],a[236:239],v[68:71],a[140:143]
s_waitcnt lgkmcnt(2)
v_add_f32 v95,v95,v74
v_add_f32 v95,v95,v75
L_st77:
MF v[24:27],a[216:219],v[144:147],v[80:83]
RD a[232:235],v216,37120
v_cvt_pk_bf16_f32 v49,v74,v75
MF v[28:31],a[216:219],v[148:151],v[84:87]
RD a[236:239],v217,37120
v_add_f32 v96,v76,v77
MF v[32:35],a[216:219],v[152:155],v[88:91]
v_exp_f32 v74,v18
MF v[24:27],a[220:223],v[156:159],v[24:27]
v_exp_f32 v75,v19
MF v[28:31],a[220:223],v[160:163],v[28:31]
buffer_load_dwordx4 v231,s[12:15],s35 offen offset:1024 nt lds
MF v[32:35],a[220:223],v[164:167],v[32:35]
s_waitcnt lgkmcnt(2)
v_cvt_pk_bf16_f32 v52,v76,v77
v_add_f32 v96,v96,v78
MF v[24:27],a[224:227],v[168:171],v[24:27]
RD a[216:219],v216,43008
v_add_u32 v218,98304,v218
MF v[28:31],a[224:227],v[172:175],v[28:31]
RD a[220:223],v217,43008
v_add_u32 v219,98304,v219
MF v[32:35],a[224:227],v[176:179],v[32:35]
v_exp_f32 v76,v20
MF v[24:27],a[228:231],v[180:183],v[24:27]
v_exp_f32 v77,v21
MF v[28:31],a[228:231],v[184:187],v[28:31]
v_add_f32 v96,v96,v79
v_cvt_pk_bf16_f32 v53,v78,v79
MF v[32:35],a[228:231],v[188:191],v[32:35]
s_waitcnt lgkmcnt(2)
v_exp_f32 v78,v22
MF v[24:27],a[232:235],v[192:195],v[24:27]
RD a[224:227],v216,43136
v_add_u32 v220,98304,v220
MF v[28:31],a[232:235],v[196:199],v[28:31]
RD a[228:231],v217,43136
v_add_u32 v221,98304,v221
MF v[32:35],a[232:235],v[200:203],v[32:35]
v_exp_f32 v79,v23
MF v[24:27],a[236:239],v[204:207],v[24:27]
v_add_f32 v97,v120,v121
v_cvt_pk_bf16_f32 v56,v120,v121
MF v[28:31],a[236:239],v[208:211],v[28:31]
buffer_load_dwordx4 v232,s[12:15],s35 offen offset:2048 nt lds
MF v[32:35],a[236:239],v[212:215],v[32:35]
s_waitcnt lgkmcnt(2)
v_add_f32 v97,v97,v122
v_add_f32 v97,v97,v123
MF v[36:39],a[216:219],v[144:147],v[80:83]
RD a[232:235],v216,43264
v_cvt_pk_bf16_f32 v57,v122,v123
MF v[40:43],a[216:219],v[148:151],v[84:87]
RD a[236:239],v217,43264
v_add_f32 v95,v95,v124
MF v[44:47],a[216:219],v[152:155],v[88:91]
v_add_f32 v95,v95,v125
v_cvt_pk_bf16_f32 v50,v124,v125
MF v[36:39],a[220:223],v[156:159],v[36:39]
v_add_f32 v95,v95,v126
v_add_f32 v95,v95,v127
MF v[40:43],a[220:223],v[160:163],v[40:43]
v_cvt_pk_bf16_f32 v51,v126,v127
v_add_f32 v96,v96,v72
MF v[44:47],a[220:223],v[164:167],v[44:47]
s_waitcnt vmcnt(30) lgkmcnt(2)
s_barrier
v_add_f32 v96,v96,v73
MF v[36:39],a[224:227],v[168:171],v[36:39]
TR a[216:217],v218,0
TR a[218:219],v218,6144
MF v[40:43],a[224:227],v[172:175],v[40:43]
TR a[220:221],v219,0
TR a[222:223],v219,6144
MF v[44:47],a[224:227],v[176:179],v[44:47]
s_add_u32 m0,s32,12288
v_cvt_pk_bf16_f32 v54,v72,v73
v_add_f32 v96,v96,v74
MF v[36:39],a[228:231],v[180:183],v[36:39]
s_add_u32 s36,s33,307200
v_add_f32 v96,v96,v75
v_cvt_pk_bf16_f32 v55,v74,v75
MF v[40:43],a[228:231],v[184:187],v[40:43]
buffer_load_dwordx4 v230,s[8:11],s36 offen offset:0 nt lds
MF v[44:47],a[228:231],v[188:191],v[44:47]
s_waitcnt lgkmcnt(4)
v_add_f32 v97,v97,v76
v_add_f32 v97,v97,v77
MF v[36:39],a[232:235],v[192:195],v[36:39]
TR a[224:225],v220,0
TR a[226:227],v220,6144
MF v[40:43],a[232:235],v[196:199],v[40:43]
TR a[228:229],v221,0
TR a[230:231],v221,6144
MF v[44:47],a[232:235],v[200:203],v[44:47]
v_cvt_pk_bf16_f32 v58,v76,v77
v_add_f32 v97,v97,v78
MF v[36:39],a[236:239],v[204:207],v[36:39]
v_add_f32 v97,v97,v79
v_cvt_pk_bf16_f32 v59,v78,v79
MF v[40:43],a[236:239],v[208:211],v[40:43]
v_max3_f32 v104,v95,v96,v97
v_cmp_lt_f32 vcc,s46,v104
MF v[44:47],a[236:239],v[212:215],v[44:47]
s_waitcnt lgkmcnt(4)
s_cbranch_vccnz L_rs16
L_rr16:
L_st78:
MF a[0:3],a[216:219],v[48:51],a[0:3]
TR a[232:233],v218,128
TR a[234:235],v218,6272
MF a[4:7],a[216:219],v[52:55],a[4:7]
TR a[236:237],v219,128
TR a[238:239],v219,6272
MF a[8:11],a[216:219],v[56:59],a[8:11]
v_exp_f32 v72,v24
MF a[12:15],a[220:223],v[48:51],a[12:15]
v_exp_f32 v73,v25
MF a[16:19],a[220:223],v[52:55],a[16:19]
buffer_load_dwordx4 v231,s[8:11],s36 offen offset:1024 nt lds
MF a[20:23],a[220:223],v[56:59],a[20:23]
s_waitcnt lgkmcnt(4)
v_exp_f32 v74,v26
MF a[24:27],a[224:227],v[48:51],a[24:27]
TR a[216:217],v220,128
TR a[218:219],v220,6272
MF a[28:31],a[224:227],v[52:55],a[28:31]
TR a[220:221],v221,128
TR a[222:223],v221,6272
MF a[32:35],a[224:227],v[56:59],a[32:35]
v_exp_f32 v75,v27
MF a[36:39],a[228:231],v[48:51],a[36:39]
v_exp_f32 v76,v28
MF a[40:43],a[228:231],v[52:55],a[40:43]
v_exp_f32 v77,v29
MF a[44:47],a[228:231],v[56:59],a[44:47]
s_waitcnt lgkmcnt(4)
v_exp_f32 v78,v30
MF a[48:51],a[232:235],v[48:51],a[48:51]
TR a[224:225],v218,256
TR a[226:227],v218,6400
MF a[52:55],a[232:235],v[52:55],a[52:55]
TR a[228:229],v219,256
TR a[230:231],v219,6400
MF a[56:59],a[232:235],v[56:59],a[56:59]
v_exp_f32 v79,v31
MF a[60:63],a[236:239],v[48:51],a[60:63]
v_exp_f32 v120,v32
MF a[64:67],a[236:239],v[52:55],a[64:67]
buffer_load_dwordx4 v232,s[8:11],s36 offen offset:2048 nt lds
MF a[68:71],a[236:239],v[56:59],a[68:71]
s_waitcnt lgkmcnt(4)
v_exp_f32 v121,v33
MF a[72:75],a[216:219],v[48:51],a[72:75]
TR a[232:233],v220,256
TR a[234:235],v220,6400
MF a[76:79],a[216:219],v[52:55],a[76:79]
TR a[236:237],v221,256
TR a[238:239],v221,6400
MF a[80:83],a[216:219],v[56:59],a[80:83]
v_exp_f32 v122,v34
MF a[84:87],a[220:223],v[48:51],a[84:87]
v_exp_f32 v123,v35
MF a[88:91],a[220:223],v[52:55],a[88:91]
v_exp_f32 v124,v36
MF a[92:95],a[220:223],v[56:59],a[92:95]
s_waitcnt vmcnt(30) lgkmcnt(4)
s_barrier
v_add_f32 v92,v92,v95
MF a[96:99],a[224:227],v[48:51],a[96:99]
RD a[216:219],v216,0
v_add_f32 v93,v93,v96
MF a[100:103],a[224:227],v[52:55],a[100:103]
RD a[220:223],v217,0
v_add_f32 v94,v94,v97
MF a[104:107],a[224:227],v[56:59],a[104:107]
s_add_u32 m0,s32,61440
v_exp_f32 v125,v37
MF a[108:111],a[228:231],v[48:51],a[108:111]
s_add_u32 s35,s33,294912
v_exp_f32 v126,v38
MF a[112:115],a[228:231],v[52:55],a[112:115]
buffer_load_dwordx4 v230,s[12:15],s35 offen offset:0 nt lds
MF a[116:119],a[228:231],v[56:59],a[116:119]
s_waitcnt lgkmcnt(2)
v_exp_f32 v127,v39
MF a[120:123],a[232:235],v[48:51],a[120:123]
RD a[224:227],v216,128
v_add_f32 v95,v72,v73
MF a[124:127],a[232:235],v[52:55],a[124:127]
RD a[228:231],v217,128
v_cvt_pk_bf16_f32 v60,v72,v73
MF a[128:131],a[232:235],v[56:59],a[128:131]
v_exp_f32 v72,v40
MF a[132:135],a[236:239],v[48:51],a[132:135]
v_exp_f32 v73,v41
MF a[136:139],a[236:239],v[52:55],a[136:139]
v_add_f32 v95,v95,v74
v_add_f32 v95,v95,v75
MF a[140:143],a[236:239],v[56:59],a[140:143]
s_waitcnt lgkmcnt(2)
v_cvt_pk_bf16_f32 v61,v74,v75
v_add_f32 v96,v76,v77
L_st79:
MF v[0:3],a[216:219],v[144:147],v[80:83]
RD a[232:235],v216,256
v_cvt_pk_bf16_f32 v64,v76,v77
MF v[4:7],a[216:219],v[148:151],v[84:87]
RD a[236:239],v217,256
v_add_f32 v96,v96,v78
MF v[8:11],a[216:219],v[152:155],v[88:91]
v_exp_f32 v74,v42
MF v[0:3],a[220:223],v[156:159],v[0:3]
v_exp_f32 v75,v43
MF v[4:7],a[220:223],v[160:163],v[4:7]
buffer_load_dwordx4 v231,s[12:15],s35 offen offset:1024 nt lds
MF v[8:11],a[220:223],v[164:167],v[8:11]
s_waitcnt lgkmcnt(2)
v_exp_f32 v76,v44
MF v[0:3],a[224:227],v[168:171],v[0:3]
RD a[216:219],v216,6144
v_subrev_u32 v218,73728,v218
MF v[4:7],a[224:227],v[172:175],v[4:7]
RD a[220:223],v217,6144
v_subrev_u32 v219,73728,v219
MF v[8:11],a[224:227],v[176:179],v[8:11]
v_exp_f32 v77,v45
MF v[0:3],a[228:231],v[180:183],v[0:3]
v_add_f32 v96,v96,v79
v_cvt_pk_bf16_f32 v65,v78,v79
MF v[4:7],a[228:231],v[184:187],v[4:7]
v_exp_f32 v78,v46
MF v[8:11],a[228:231],v[188:191],v[8:11]
s_waitcnt lgkmcnt(2)
v_exp_f32 v79,v47
MF v[0:3],a[232:235],v[192:195],v[0:3]
RD a[224:227],v216,6272
v_subrev_u32 v220,73728,v220
MF v[4:7],a[232:235],v[196:199],v[4:7]
RD a[228:231],v217,6272
v_subrev_u32 v221,73728,v221
MF v[8:11],a[232:235],v[200:203],v[8:11]
v_add_f32 v97,v120,v121
v_cvt_pk_bf16_f32 v68,v120,v121
MF v[0:3],a[236:239],v[204:207],v[0:3]
v_add_f32 v97,v97,v122
v_add_f32 v97,v97,v123
MF v[4:7],a[236:239],v[208:211],v[4:7]
buffer_load_dwordx4 v232,s[12:15],s35 offen offset:2048 nt lds
MF v[8:11],a[236:239],v[212:215],v[8:11]
s_waitcnt lgkmcnt(2)
v_cvt_pk_bf16_f32 v69,v122,v123
v_add_f32 v95,v95,v124
MF v[12:15],a[216:219],v[144:147],v[80:83]
RD a[232:235],v216,6400
v_add_f32 v95,v95,v125
MF v[16:19],a[216:219],v[148:151],v[84:87]
RD a[236:239],v217,6400
v_cvt_pk_bf16_f32 v62,v124,v125
MF v[20:23],a[216:219],v[152:155],v[88:91]
v_add_f32 v95,v95,v126
v_add_f32 v95,v95,v127
MF v[12:15],a[220:223],v[156:159],v[12:15]
v_cvt_pk_bf16_f32 v63,v126,v127
v_add_f32 v96,v96,v72
MF v[16:19],a[220:223],v[160:163],v[16:19]
v_add_f32 v96,v96,v73
v_cvt_pk_bf16_f32 v66,v72,v73
MF v[20:23],a[220:223],v[164:167],v[20:23]
s_waitcnt vmcnt(30) lgkmcnt(2)
s_barrier
v_add_f32 v96,v96,v74
MF v[12:15],a[224:227],v[168:171],v[12:15]
TR a[216:217],v218,0
TR a[218:219],v218,6144
MF v[16:19],a[224:227],v[172:175],v[16:19]
TR a[220:221],v219,0
TR a[222:223],v219,6144
MF v[20:23],a[224:227],v[176:179],v[20:23]
s_add_u32 m0,s32,110592
v_add_f32 v96,v96,v75
v_cvt_pk_bf16_f32 v67,v74,v75
MF v[12:15],a[228:231],v[180:183],v[12:15]
s_add_u32 s36,s33,319488
v_add_f32 v97,v97,v76
v_add_f32 v97,v97,v77
MF v[16:19],a[228:231],v[184:187],v[16:19]
buffer_load_dwordx4 v230,s[8:11],s36 offen offset:0 nt lds
MF v[20:23],a[228:231],v[188:191],v[20:23]
s_waitcnt lgkmcnt(4)
v_cvt_pk_bf16_f32 v70,v76,v77
v_add_f32 v97,v97,v78
MF v[12:15],a[232:235],v[192:195],v[12:15]
TR a[224:225],v220,0
TR a[226:227],v220,6144
MF v[16:19],a[232:235],v[196:199],v[16:19]
TR a[228:229],v221,0
TR a[230:231],v221,6144
MF v[20:23],a[232:235],v[200:203],v[20:23]
v_add_f32 v97,v97,v79
v_cvt_pk_bf16_f32 v71,v78,v79
MF v[12:15],a[236:239],v[204:207],v[12:15]
v_max3_f32 v104,v95,v96,v97
v_cmp_lt_f32 vcc,s46,v104
MF v[16:19],a[236:239],v[208:211],v[16:19]
MF v[20:23],a[236:239],v[212:215],v[20:23]
s_waitcnt lgkmcnt(4)
s_cbranch_vccnz L_rs17
L_rr17:
L_st80:
s_mov_b32 s4,s3
s_and_b32 s5,s47,65535
s_mov_b32 s6,256
s_mov_b32 s7,131072
s_lshl_b32 s60,s51,4
buffer_load_dword v143,v250,s[4:7],s60 offen sc1
MF a[0:3],a[216:219],v[60:63],a[0:3]
TR a[232:233],v218,128
TR a[234:235],v218,6272
MF a[4:7],a[216:219],v[64:67],a[4:7]
TR a[236:237],v219,128
TR a[238:239],v219,6272
MF a[8:11],a[216:219],v[68:71],a[8:11]
v_exp_f32 v72,v0
MF a[12:15],a[220:223],v[60:63],a[12:15]
v_exp_f32 v73,v1
MF a[16:19],a[220:223],v[64:67],a[16:19]
buffer_load_dwordx4 v231,s[8:11],s36 offen offset:1024 nt lds
MF a[20:23],a[220:223],v[68:71],a[20:23]
s_waitcnt lgkmcnt(4)
v_exp_f32 v74,v2
MF a[24:27],a[224:227],v[60:63],a[24:27]
TR a[216:217],v220,128
TR a[218:219],v220,6272
MF a[28:31],a[224:227],v[64:67],a[28:31]
TR a[220:221],v221,128
TR a[222:223],v221,6272
MF a[32:35],a[224:227],v[68:71],a[32:35]
v_exp_f32 v75,v3
MF a[36:39],a[228:231],v[60:63],a[36:39]
v_exp_f32 v76,v4
MF a[40:43],a[228:231],v[64:67],a[40:43]
v_exp_f32 v77,v5
MF a[44:47],a[228:231],v[68:71],a[44:47]
s_waitcnt lgkmcnt(4)
v_exp_f32 v78,v6
MF a[48:51],a[232:235],v[60:63],a[48:51]
TR a[224:225],v218,256
TR a[226:227],v218,6400
MF a[52:55],a[232:235],v[64:67],a[52:55]
TR a[228:229],v219,256
TR a[230:231],v219,6400
MF a[56:59],a[232:235],v[68:71],a[56:59]
v_exp_f32 v79,v7
MF a[60:63],a[236:239],v[60:63],a[60:63]
v_exp_f32 v120,v8
MF a[64:67],a[236:239],v[64:67],a[64:67]
buffer_load_dwordx4 v232,s[8:11],s36 offen offset:2048 nt lds
MF a[68:71],a[236:239],v[68:71],a[68:71]
s_waitcnt lgkmcnt(4)
v_exp_f32 v121,v9
MF a[72:75],a[216:219],v[60:63],a[72:75]
TR a[232:233],v220,256
TR a[234:235],v220,6400
MF a[76:79],a[216:219],v[64:67],a[76:79]
TR a[236:237],v221,256
TR a[238:239],v221,6400
MF a[80:83],a[216:219],v[68:71],a[80:83]
v_exp_f32 v122,v10
MF a[84:87],a[220:223],v[60:63],a[84:87]
v_exp_f32 v123,v11
MF a[88:91],a[220:223],v[64:67],a[88:91]
v_exp_f32 v124,v12
MF a[92:95],a[220:223],v[68:71],a[92:95]
s_waitcnt vmcnt(31) lgkmcnt(4)
s_barrier
v_add_f32 v92,v92,v95
MF a[96:99],a[224:227],v[60:63],a[96:99]
RD a[216:219],v216,24576
v_add_f32 v93,v93,v96
MF a[100:103],a[224:227],v[64:67],a[100:103]
RD a[220:223],v217,24576
v_add_f32 v94,v94,v97
MF a[104:107],a[224:227],v[68:71],a[104:107]
s_add_u32 m0,s32,24576
v_exp_f32 v125,v13
MF a[108:111],a[228:231],v[60:63],a[108:111]
s_add_u32 s35,s33,307200
v_exp_f32 v126,v14
MF a[112:115],a[228:231],v[64:67],a[112:115]
buffer_load_dwordx4 v230,s[12:15],s35 offen offset:0 nt lds
MF a[116:119],a[228:231],v[68:71],a[116:119]
s_waitcnt lgkmcnt(2)
v_exp_f32 v127,v15
MF a[120:123],a[232:235],v[60:63],a[120:123]
RD a[224:227],v216,24704
v_add_f32 v95,v72,v73
MF a[124:127],a[232:235],v[64:67],a[124:127]
RD a[228:231],v217,24704
v_cvt_pk_bf16_f32 v48,v72,v73
MF a[128:131],a[232:235],v[68:71],a[128:131]
v_exp_f32 v72,v16
MF a[132:135],a[236:239],v[60:63],a[132:135]
v_exp_f32 v73,v17
MF a[136:139],a[236:239],v[64:67],a[136:139]
v_add_f32 v95,v95,v74
v_add_f32 v95,v95,v75
MF a[140:143],a[236:239],v[68:71],a[140:143]
s_waitcnt lgkmcnt(2)
v_cvt_pk_bf16_f32 v49,v74,v75
v_add_f32 v96,v76,v77
L_st81:
MF v[24:27],a[216:219],v[144:147],v[80:83]
RD a[232:235],v216,24832
v_cvt_pk_bf16_f32 v52,v76,v77
MF v[28:31],a[216:219],v[148:151],v[84:87]
RD a[236:239],v217,24832
v_add_f32 v96,v96,v78
MF v[32:35],a[216:219],v[152:155],v[88:91]
v_exp_f32 v74,v18
MF v[24:27],a[220:223],v[156:159],v[24:27]
v_exp_f32 v75,v19
MF v[28:31],a[220:223],v[160:163],v[28:31]
buffer_load_dwordx4 v231,s[12:15],s35 offen offset:1024 nt lds
MF v[32:35],a[220:223],v[164:167],v[32:35]
s_waitcnt lgkmcnt(2)
v_exp_f32 v76,v20
MF v[24:27],a[224:227],v[168:171],v[24:27]
RD a[216:219],v216,30720
v_add_u32 v218,49152,v218
MF v[28:31],a[224:227],v[172:175],v[28:31]
RD a[220:223],v217,30720
v_add_u32 v219,49152,v219
MF v[32:35],a[224:227],v[176:179],v[32:35]
v_exp_f32 v77,v21
MF v[24:27],a[228:231],v[180:183],v[24:27]
v_add_f32 v96,v96,v79
v_cvt_pk_bf16_f32 v53,v78,v79
MF v[28:31],a[228:231],v[184:187],v[28:31]
v_exp_f32 v78,v22
MF v[32:35],a[228:231],v[188:191],v[32:35]
s_waitcnt lgkmcnt(2)
v_exp_f32 v79,v23
MF v[24:27],a[232:235],v[192:195],v[24:27]
RD a[224:227],v216,30848
v_add_u32 v220,49152,v220
MF v[28:31],a[232:235],v[196:199],v[28:31]
RD a[228:231],v217,30848
v_add_u32 v221,49152,v221
MF v[32:35],a[232:235],v[200:203],v[32:35]
v_add_f32 v97,v120,v121
v_cvt_pk_bf16_f32 v56,v120,v121
MF v[24:27],a[236:239],v[204:207],v[24:27]
v_add_f32 v97,v97,v122
v_add_f32 v97,v97,v123
MF v[28:31],a[236:239],v[208:211],v[28:31]
buffer_load_dwordx4 v232,s[12:15],s35 offen offset:2048 nt lds
MF v[32:35],a[236:239],v[212:215],v[32:35]
s_waitcnt lgkmcnt(2)
v_cvt_pk_bf16_f32 v57,v122,v123
v_add_f32 v95,v95,v124
MF v[36:39],a[216:219],v[144:147],v[80:83]
RD a[232:235],v216,30976
v_add_f32 v95,v95,v125
MF v[40:43],a[216:219],v[148:151],v[84:87]
RD a[236:239],v217,30976
v_cvt_pk_bf16_f32 v50,v124,v125
MF v[44:47],a[216:219],v[152:155],v[88:91]
v_add_f32 v95,v95,v126
v_add_f32 v95,v95,v127
MF v[36:39],a[220:223],v[156:159],v[36:39]
v_cvt_pk_bf16_f32 v51,v126,v127
v_add_f32 v96,v96,v72
MF v[40:43],a[220:223],v[160:163],v[40:43]
v_add_f32 v96,v96,v73
v_cvt_pk_bf16_f32 v54,v72,v73
MF v[44:47],a[220:223],v[164:167],v[44:47]
s_waitcnt vmcnt(31) lgkmcnt(2)
s_barrier
v_add_f32 v96,v96,v74
MF v[36:39],a[224:227],v[168:171],v[36:39]
TR a[216:217],v218,36864
TR a[218:219],v218,43008
MF v[40:43],a[224:227],v[172:175],v[40:43]
TR a[220:221],v219,36864
TR a[222:223],v219,43008
MF v[44:47],a[224:227],v[176:179],v[44:47]
s_add_u32 m0,s32,36864
v_add_f32 v96,v96,v75
v_cvt_pk_bf16_f32 v55,v74,v75
MF v[36:39],a[228:231],v[180:183],v[36:39]
s_add_u32 s36,s33,331776
v_add_f32 v97,v97,v76
v_add_f32 v97,v97,v77
MF v[40:43],a[228:231],v[184:187],v[40:43]
buffer_load_dwordx4 v230,s[8:11],s36 offen offset:0 nt lds
MF v[44:47],a[228:231],v[188:191],v[44:47]
s_waitcnt lgkmcnt(4)
v_cvt_pk_bf16_f32 v58,v76,v77
v_add_f32 v97,v97,v78
MF v[36:39],a[232:235],v[192:195],v[36:39]
TR a[224:225],v220,36864
TR a[226:227],v220,43008
MF v[40:43],a[232:235],v[196:199],v[40:43]
TR a[228:229],v221,36864
TR a[230:231],v221,43008
MF v[44:47],a[232:235],v[200:203],v[44:47]
v_add_f32 v97,v97,v79
v_cvt_pk_bf16_f32 v59,v78,v79
MF v[36:39],a[236:239],v[204:207],v[36:39]
v_max3_f32 v104,v95,v96,v97
v_cmp_lt_f32 vcc,s46,v104
MF v[40:43],a[236:239],v[208:211],v[40:43]
MF v[44:47],a[236:239],v[212:215],v[44:47]
s_waitcnt lgkmcnt(4)
s_cbranch_vccnz L_rs18
L_rr18:
L_st82:
MF a[0:3],a[216:219],v[48:51],a[0:3]
TR a[232:233],v218,36992
TR a[234:235],v218,43136
MF a[4:7],a[216:219],v[52:55],a[4:7]
TR a[236:237],v219,36992
TR a[238:239],v219,43136
MF a[8:11],a[216:219],v[56:59],a[8:11]
v_exp_f32 v72,v24
MF a[12:15],a[220:223],v[48:51],a[12:15]
v_exp_f32 v73,v25
MF a[16:19],a[220:223],v[52:55],a[16:19]
buffer_load_dwordx4 v231,s[8:11],s36 offen offset:1024 nt lds
MF a[20:23],a[220:223],v[56:59],a[20:23]
s_waitcnt lgkmcnt(4)
v_exp_f32 v74,v26
MF a[24:27],a[224:227],v[48:51],a[24:27]
TR a[216:217],v220,36992
TR a[218:219],v220,43136
MF a[28:31],a[224:227],v[52:55],a[28:31]
TR a[220:221],v221,36992
TR a[222:223],v221,43136
MF a[32:35],a[224:227],v[56:59],a[32:35]
v_exp_f32 v75,v27
MF a[36:39],a[228:231],v[48:51],a[36:39]
v_exp_f32 v76,v28
MF a[40:43],a[228:231],v[52:55],a[40:43]
v_exp_f32 v77,v29
MF a[44:47],a[228:231],v[56:59],a[44:47]
s_waitcnt lgkmcnt(4)
v_exp_f32 v78,v30
MF a[48:51],a[232:235],v[48:51],a[48:51]
TR a[224:225],v218,37120
TR a[226:227],v218,43264
MF a[52:55],a[232:235],v[52:55],a[52:55]
TR a[228:229],v219,37120
TR a[230:231],v219,43264
MF a[56:59],a[232:235],v[56:59],a[56:59]
v_exp_f32 v79,v31
MF a[60:63],a[236:239],v[48:51],a[60:63]
v_exp_f32 v120,v32
MF a[64:67],a[236:239],v[52:55],a[64:67]
buffer_load_dwordx4 v232,s[8:11],s36 offen offset:2048 nt lds
MF a[68:71],a[236:239],v[56:59],a[68:71]
s_waitcnt lgkmcnt(4)
v_exp_f32 v121,v33
MF a[72:75],a[216:219],v[48:51],a[72:75]
TR a[232:233],v220,37120
TR a[234:235],v220,43264
MF a[76:79],a[216:219],v[52:55],a[76:79]
TR a[236:237],v221,37120
TR a[238:239],v221,43264
MF a[80:83],a[216:219],v[56:59],a[80:83]
v_exp_f32 v122,v34
MF a[84:87],a[220:223],v[48:51],a[84:87]
v_exp_f32 v123,v35
MF a[88:91],a[220:223],v[52:55],a[88:91]
v_exp_f32 v124,v36
MF a[92:95],a[220:223],v[56:59],a[92:95]
s_waitcnt vmcnt(31) lgkmcnt(4)
s_barrier
v_add_f32 v92,v92,v95
MF a[96:99],a[224:227],v[48:51],a[96:99]
RD a[216:219],v216,49152
v_add_f32 v93,v93,v96
MF a[100:103],a[224:227],v[52:55],a[100:103]
RD a[220:223],v217,49152
v_add_f32 v94,v94,v97
MF a[104:107],a[224:227],v[56:59],a[104:107]
s_add_u32 m0,s32,49152
v_exp_f32 v125,v37
MF a[108:111],a[228:231],v[48:51],a[108:111]
s_add_u32 s35,s33,319488
v_exp_f32 v126,v38
MF a[112:115],a[228:231],v[52:55],a[112:115]
buffer_load_dwordx4 v230,s[12:15],s35 offen offset:0 nt lds
MF a[116:119],a[228:231],v[56:59],a[116:119]
s_waitcnt lgkmcnt(2)
v_exp_f32 v127,v39
MF a[120:123],a[232:235],v[48:51],a[120:123]
RD a[224:227],v216,49280
v_add_f32 v95,v72,v73
MF a[124:127],a[232:235],v[52:55],a[124:127]
RD a[228:231],v217,49280
v_cvt_pk_bf16_f32 v60,v72,v73
MF a[128:131],a[232:235],v[56:59],a[128:131]
v_exp_f32 v72,v40
MF a[132:135],a[236:239],v[48:51],a[132:135]
v_exp_f32 v73,v41
MF a[136:139],a[236:239],v[52:55],a[136:139]
v_add_f32 v95,v95,v74
v_add_f32 v95,v95,v75
MF a[140:143],a[236:239],v[56:59],a[140:143]
s_waitcnt lgkmcnt(2)
v_cvt_pk_bf16_f32 v61,v74,v75
v_add_f32 v96,v76,v77
L_st83:
MF v[0:3],a[216:219],v[144:147],v[80:83]
RD a[232:235],v216,49408
v_cvt_pk_bf16_f32 v64,v76,v77
MF v[4:7],a[216:219],v[148:151],v[84:87]
RD a[236:239],v217,49408
v_add_f32 v96,v96,v78
MF v[8:11],a[216:219],v[152:155],v[88:91]
v_exp_f32 v74,v42
MF v[0:3],a[220:223],v[156:159],v[0:3]
v_exp_f32 v75,v43
MF v[4:7],a[220:223],v[160:163],v[4:7]
buffer_load_dwordx4 v231,s[12:15],s35 offen offset:1024 nt lds
MF v[8:11],a[220:223],v[164:167],v[8:11]
s_waitcnt lgkmcnt(2)
v_exp_f32 v76,v44
MF v[0:3],a[224:227],v[168:171],v[0:3]
RD a[216:219],v216,55296
v_add_f32 v96,v96,v79
MF v[4:7],a[224:227],v[172:175],v[4:7]
RD a[220:223],v217,55296
v_cvt_pk_bf16_f32 v65,v78,v79
MF v[8:11],a[224:227],v[176:179],v[8:11]
v_exp_f32 v77,v45
MF v[0:3],a[228:231],v[180:183],v[0:3]
v_exp_f32 v78,v46
MF v[4:7],a[228:231],v[184:187],v[4:7]
v_exp_f32 v79,v47
MF v[8:11],a[228:231],v[188:191],v[8:11]
s_waitcnt lgkmcnt(2)
v_add_f32 v97,v120,v121
v_cvt_pk_bf16_f32 v68,v120,v121
MF v[0:3],a[232:235],v[192:195],v[0:3]
RD a[224:227],v216,55424
v_add_f32 v97,v97,v122
MF v[4:7],a[232:235],v[196:199],v[4:7]
RD a[228:231],v217,55424
v_add_f32 v97,v97,v123
MF v[8:11],a[232:235],v[200:203],v[8:11]
v_cvt_pk_bf16_f32 v69,v122,v123
v_add_f32 v95,v95,v124
MF v[0:3],a[236:239],v[204:207],v[0:3]
v_add_f32 v95,v95,v125
v_cvt_pk_bf16_f32 v62,v124,v125
MF v[4:7],a[236:239],v[208:211],v[4:7]
buffer_load_dwordx4 v232,s[12:15],s35 offen offset:2048 nt lds
MF v[8:11],a[236:239],v[212:215],v[8:11]
s_waitcnt lgkmcnt(2)
v_add_f32 v95,v95,v126
v_add_f32 v95,v95,v127
MF v[12:15],a[216:219],v[144:147],v[80:83]
RD a[232:235],v216,55552
v_cvt_pk_bf16_f32 v63,v126,v127
MF v[16:19],a[216:219],v[148:151],v[84:87]
RD a[236:239],v217,55552
v_add_f32 v96,v96,v72
MF v[20:23],a[216:219],v[152:155],v[88:91]
v_add_f32 v96,v96,v73
v_cvt_pk_bf16_f32 v66,v72,v73
MF v[12:15],a[220:223],v[156:159],v[12:15]
v_add_f32 v96,v96,v74
v_add_f32 v96,v96,v75
MF v[16:19],a[220:223],v[160:163],v[16:19]
v_cvt_pk_bf16_f32 v67,v74,v75
v_add_f32 v97,v97,v76
MF v[20:23],a[220:223],v[164:167],v[20:23]
s_waitcnt vmcnt(31) lgkmcnt(2)
s_barrier
v_add_f32 v97,v97,v77
MF v[12:15],a[224:227],v[168:171],v[12:15]
TR a[216:217],v218,49152
TR a[218:219],v218,55296
MF v[16:19],a[224:227],v[172:175],v[16:19]
TR a[220:221],v219,49152
TR a[222:223],v219,55296
MF v[20:23],a[224:227],v[176:179],v[20:23]
s_add_u32 m0,s32,122880
v_cvt_pk_bf16_f32 v70,v76,v77
v_add_f32 v97,v97,v78
MF v[12:15],a[228:231],v[180:183],v[12:15]
s_add_u32 s36,s33,344064
v_add_f32 v97,v97,v79
v_cvt_pk_bf16_f32 v71,v78,v79
MF v[16:19],a[228:231],v[184:187],v[16:19]
buffer_load_dwordx4 v230,s[8:11],s36 offen offset:0 nt lds
MF v[20:23],a[228:231],v[188:191],v[20:23]
s_waitcnt lgkmcnt(4)
v_max3_f32 v104,v95,v96,v97
v_cmp_lt_f32 vcc,s46,v104
MF v[12:15],a[232:235],v[192:195],v[12:15]
TR a[224:225],v220,49152
TR a[226:227],v220,55296
MF v[16:19],a[232:235],v[196:199],v[16:19]
TR a[228:229],v221,49152
TR a[230:231],v221,55296
MF v[20:23],a[232:235],v[200:203],v[20:23]
MF v[12:15],a[236:239],v[204:207],v[12:15]
MF v[16:19],a[236:239],v[208:211],v[16:19]
MF v[20:23],a[236:239],v[212:215],v[20:23]
s_waitcnt lgkmcnt(4)
s_cbranch_vccnz L_rs19
L_rr19:
L_st84:
MF a[0:3],a[216:219],v[60:63],a[0:3]
TR a[232:233],v218,49280
TR a[234:235],v218,55424
MF a[4:7],a[216:219],v[64:67],a[4:7]
TR a[236:237],v219,49280
TR a[238:239],v219,55424
MF a[8:11],a[216:219],v[68:71],a[8:11]
v_add_u32 v216,73728,v216
v_add_u32 v217,73728,v217
MF a[12:15],a[220:223],v[60:63],a[12:15]
v_exp_f32 v72,v0
MF a[16:19],a[220:223],v[64:67],a[16:19]
buffer_load_dwordx4 v231,s[8:11],s36 offen offset:1024 nt lds
MF a[20:23],a[220:223],v[68:71],a[20:23]
s_waitcnt lgkmcnt(4)
v_exp_f32 v73,v1
MF a[24:27],a[224:227],v[60:63],a[24:27]
TR a[216:217],v220,49280
TR a[218:219],v220,55424
MF a[28:31],a[224:227],v[64:67],a[28:31]
TR a[220:221],v221,49280
TR a[222:223],v221,55424
MF a[32:35],a[224:227],v[68:71],a[32:35]
v_exp_f32 v74,v2
MF a[36:39],a[228:231],v[60:63],a[36:39]
v_exp_f32 v75,v3
MF a[40:43],a[228:231],v[64:67],a[40:43]
v_exp_f32 v76,v4
MF a[44:47],a[228:231],v[68:71],a[44:47]
s_waitcnt lgkmcnt(4)
v_exp_f32 v77,v5
MF a[48:51],a[232:235],v[60:63],a[48:51]
TR a[224:225],v218,49408
TR a[226:227],v218,55552
MF a[52:55],a[232:235],v[64:67],a[52:55]
TR a[228:229],v219,49408
TR a[230:231],v219,55552
MF a[56:59],a[232:235],v[68:71],a[56:59]
v_exp_f32 v78,v6
MF a[60:63],a[236:239],v[60:63],a[60:63]
v_exp_f32 v79,v7
MF a[64:67],a[236:239],v[64:67],a[64:67]
buffer_load_dwordx4 v232,s[8:11],s36 offen offset:2048 nt lds
MF a[68:71],a[236:239],v[68:71],a[68:71]
s_waitcnt lgkmcnt(4)
v_exp_f32 v120,v8
MF a[72:75],a[216:219],v[60:63],a[72:75]
TR a[232:233],v220,49408
TR a[234:235],v220,55552
MF a[76:79],a[216:219],v[64:67],a[76:79]
TR a[236:237],v221,49408
TR a[238:239],v221,55552
MF a[80:83],a[216:219],v[68:71],a[80:83]
v_exp_f32 v121,v9
MF a[84:87],a[220:223],v[60:63],a[84:87]
v_exp_f32 v122,v10
MF a[88:91],a[220:223],v[64:67],a[88:91]
v_exp_f32 v123,v11
MF a[92:95],a[220:223],v[68:71],a[92:95]
s_waitcnt vmcnt(31) lgkmcnt(4)
s_barrier
v_add_f32 v92,v92,v95
MF a[96:99],a[224:227],v[60:63],a[96:99]
RD a[216:219],v216,49152
v_add_f32 v93,v93,v96
MF a[100:103],a[224:227],v[64:67],a[100:103]
RD a[220:223],v217,49152
v_add_f32 v94,v94,v97
MF a[104:107],a[224:227],v[68:71],a[104:107]
s_add_u32 m0,s32,73728
v_exp_f32 v124,v12
MF a[108:111],a[228:231],v[60:63],a[108:111]
s_add_u32 s35,s33,331776
v_exp_f32 v125,v13
MF a[112:115],a[228:231],v[64:67],a[112:115]
buffer_load_dwordx4 v230,s[12:15],s35 offen offset:0 nt lds
MF a[116:119],a[228:231],v[68:71],a[116:119]
s_waitcnt lgkmcnt(2)
v_exp_f32 v126,v14
MF a[120:123],a[232:235],v[60:63],a[120:123]
RD a[224:227],v216,49280
v_add_f32 v95,v72,v73
MF a[124:127],a[232:235],v[64:67],a[124:127]
RD a[228:231],v217,49280
v_cvt_pk_bf16_f32 v48,v72,v73
MF a[128:131],a[232:235],v[68:71],a[128:131]
v_exp_f32 v127,v15
MF a[132:135],a[236:239],v[60:63],a[132:135]
v_exp_f32 v72,v16
MF a[136:139],a[236:239],v[64:67],a[136:139]
v_exp_f32 v73,v17
MF a[140:143],a[236:239],v[68:71],a[140:143]
s_waitcnt lgkmcnt(2)
v_add_f32 v95,v95,v74
v_add_f32 v95,v95,v75
L_st85:
MF v[24:27],a[216:219],v[144:147],v[80:83]
RD a[232:235],v216,49408
v_cvt_pk_bf16_f32 v49,v74,v75
MF v[28:31],a[216:219],v[148:151],v[84:87]
RD a[236:239],v217,49408
v_add_f32 v96,v76,v77
MF v[32:35],a[216:219],v[152:155],v[88:91]
v_exp_f32 v74,v18
MF v[24:27],a[220:223],v[156:159],v[24:27]
v_exp_f32 v75,v19
MF v[28:31],a[220:223],v[160:163],v[28:31]
buffer_load_dwordx4 v231,s[12:15],s35 offen offset:1024 nt lds
MF v[32:35],a[220:223],v[164:167],v[32:35]
s_waitcnt lgkmcnt(2)
v_cvt_pk_bf16_f32 v52,v76,v77
v_add_f32 v96,v96,v78
MF v[24:27],a[224:227],v[168:171],v[24:27]
RD a[216:219],v216,55296
v_add_f32 v96,v96,v79
MF v[28:31],a[224:227],v[172:175],v[28:31]
RD a[220:223],v217,55296
v_cvt_pk_bf16_f32 v53,v78,v79
MF v[32:35],a[224:227],v[176:179],v[32:35]
v_exp_f32 v76,v20
MF v[24:27],a[228:231],v[180:183],v[24:27]
v_exp_f32 v77,v21
MF v[28:31],a[228:231],v[184:187],v[28:31]
v_exp_f32 v78,v22
MF v[32:35],a[228:231],v[188:191],v[32:35]
s_waitcnt lgkmcnt(2)
v_exp_f32 v79,v23
MF v[24:27],a[232:235],v[192:195],v[24:27]
RD a[224:227],v216,55424
v_add_f32 v97,v120,v121
MF v[28:31],a[232:235],v[196:199],v[28:31]
RD a[228:231],v217,55424
v_cvt_pk_bf16_f32 v56,v120,v121
MF v[32:35],a[232:235],v[200:203],v[32:35]
v_add_f32 v97,v97,v122
v_add_f32 v97,v97,v123
MF v[24:27],a[236:239],v[204:207],v[24:27]
v_cvt_pk_bf16_f32 v57,v122,v123
v_add_f32 v95,v95,v124
MF v[28:31],a[236:239],v[208:211],v[28:31]
buffer_load_dwordx4 v232,s[12:15],s35 offen offset:2048 nt lds
MF v[32:35],a[236:239],v[212:215],v[32:35]
s_waitcnt lgkmcnt(2)
v_add_f32 v95,v95,v125
v_cvt_pk_bf16_f32 v50,v124,v125
MF v[36:39],a[216:219],v[144:147],v[80:83]
RD a[232:235],v216,55552
v_add_f32 v95,v95,v126
MF v[40:43],a[216:219],v[148:151],v[84:87]
RD a[236:239],v217,55552
v_add_f32 v95,v95,v127
MF v[44:47],a[216:219],v[152:155],v[88:91]
v_cvt_pk_bf16_f32 v51,v126,v127
v_add_f32 v96,v96,v72
MF v[36:39],a[220:223],v[156:159],v[36:39]
v_add_f32 v96,v96,v73
v_cvt_pk_bf16_f32 v54,v72,v73
MF v[40:43],a[220:223],v[160:163],v[40:43]
v_add_f32 v96,v96,v74
v_add_f32 v96,v96,v75
MF v[44:47],a[220:223],v[164:167],v[44:47]
s_waitcnt vmcnt(31) lgkmcnt(2)
s_barrier
v_cvt_pk_bf16_f32 v55,v74,v75
MF v[36:39],a[224:227],v[168:171],v[36:39]
TR a[216:217],v218,0
TR a[218:219],v218,6144
MF v[40:43],a[224:227],v[172:175],v[40:43]
TR a[220:221],v219,0
TR a[222:223],v219,6144
MF v[44:47],a[224:227],v[176:179],v[44:47]
s_add_u32 m0,s32,135168
v_add_f32 v97,v97,v76
v_add_f32 v97,v97,v77
MF v[36:39],a[228:231],v[180:183],v[36:39]
s_add_u32 s36,s33,356352
v_cvt_pk_bf16_f32 v58,v76,v77
v_add_f32 v97,v97,v78
MF v[40:43],a[228:231],v[184:187],v[40:43]
buffer_load_dwordx4 v230,s[8:11],s36 offen offset:0 nt lds
MF v[44:47],a[228:231],v[188:191],v[44:47]
s_waitcnt lgkmcnt(4)
v_add_f32 v97,v97,v79
v_cvt_pk_bf16_f32 v59,v78,v79
MF v[36:39],a[232:235],v[192:195],v[36:39]
TR a[224:225],v220,0
TR a[226:227],v220,6144
MF v[40:43],a[232:235],v[196:199],v[40:43]
TR a[228:229],v221,0
TR a[230:231],v221,6144
MF v[44:47],a[232:235],v[200:203],v[44:47]
v_max3_f32 v104,v95,v96,v97
v_cmp_lt_f32 vcc,s46,v104
MF v[36:39],a[236:239],v[204:207],v[36:39]
MF v[40:43],a[236:239],v[208:211],v[40:43]
MF v[44:47],a[236:239],v[212:215],v[44:47]
s_waitcnt lgkmcnt(4)
s_cbranch_vccnz L_rs20
L_rr20:
L_st86:
MF a[0:3],a[216:219],v[48:51],a[0:3]
TR a[232:233],v218,128
TR a[234:235],v218,6272
MF a[4:7],a[216:219],v[52:55],a[4:7]
TR a[236:237],v219,128
TR a[238:239],v219,6272
MF a[8:11],a[216:219],v[56:59],a[8:11]
v_exp_f32 v72,v24
MF a[12:15],a[220:223],v[48:51],a[12:15]
v_exp_f32 v73,v25
MF a[16:19],a[220:223],v[52:55],a[16:19]
buffer_load_dwordx4 v231,s[8:11],s36 offen offset:1024 nt lds
MF a[20:23],a[220:223],v[56:59],a[20:23]
s_waitcnt lgkmcnt(4)
v_exp_f32 v74,v26
MF a[24:27],a[224:227],v[48:51],a[24:27]
TR a[216:217],v220,128
TR a[218:219],v220,6272
MF a[28:31],a[224:227],v[52:55],a[28:31]
TR a[220:221],v221,128
TR a[222:223],v221,6272
MF a[32:35],a[224:227],v[56:59],a[32:35]
v_exp_f32 v75,v27
MF a[36:39],a[228:231],v[48:51],a[36:39]
v_exp_f32 v76,v28
MF a[40:43],a[228:231],v[52:55],a[40:43]
v_exp_f32 v77,v29
MF a[44:47],a[228:231],v[56:59],a[44:47]
s_waitcnt lgkmcnt(4)
v_exp_f32 v78,v30
MF a[48:51],a[232:235],v[48:51],a[48:51]
TR a[224:225],v218,256
TR a[226:227],v218,6400
MF a[52:55],a[232:235],v[52:55],a[52:55]
TR a[228:229],v219,256
TR a[230:231],v219,6400
MF a[56:59],a[232:235],v[56:59],a[56:59]
v_exp_f32 v79,v31
MF a[60:63],a[236:239],v[48:51],a[60:63]
v_exp_f32 v120,v32
MF a[64:67],a[236:239],v[52:55],a[64:67]
buffer_load_dwordx4 v232,s[8:11],s36 offen offset:2048 nt lds
MF a[68:71],a[236:239],v[56:59],a[68:71]
s_waitcnt lgkmcnt(4)
v_exp_f32 v121,v33
MF a[72:75],a[216:219],v[48:51],a[72:75]
TR a[232:233],v220,256
TR a[234:235],v220,6400
MF a[76:79],a[216:219],v[52:55],a[76:79]
TR a[236:237],v221,256
TR a[238:239],v221,6400
MF a[80:83],a[216:219],v[56:59],a[80:83]
v_exp_f32 v122,v34
MF a[84:87],a[220:223],v[48:51],a[84:87]
v_exp_f32 v123,v35
MF a[88:91],a[220:223],v[52:55],a[88:91]
v_exp_f32 v124,v36
MF a[92:95],a[220:223],v[56:59],a[92:95]
s_waitcnt vmcnt(31) lgkmcnt(4)
s_barrier
v_add_f32 v92,v92,v95
MF a[96:99],a[224:227],v[48:51],a[96:99]
RD a[216:219],v216,0
v_add_f32 v93,v93,v96
MF a[100:103],a[224:227],v[52:55],a[100:103]
RD a[220:223],v217,0
v_add_f32 v94,v94,v97
MF a[104:107],a[224:227],v[56:59],a[104:107]
s_add_u32 m0,s32,147456
v_exp_f32 v125,v37
MF a[108:111],a[228:231],v[48:51],a[108:111]
s_add_u32 s35,s33,344064
v_exp_f32 v126,v38
MF a[112:115],a[228:231],v[52:55],a[112:115]
buffer_load_dwordx4 v230,s[12:15],s35 offen offset:0 nt lds
MF a[116:119],a[228:231],v[56:59],a[116:119]
s_waitcnt lgkmcnt(2)
v_exp_f32 v127,v39
MF a[120:123],a[232:235],v[48:51],a[120:123]
RD a[224:227],v216,128
v_add_f32 v95,v72,v73
MF a[124:127],a[232:235],v[52:55],a[124:127]
RD a[228:231],v217,128
v_cvt_pk_bf16_f32 v60,v72,v73
MF a[128:131],a[232:235],v[56:59],a[128:131]
v_exp_f32 v72,v40
MF a[132:135],a[236:239],v[48:51],a[132:135]
v_exp_f32 v73,v41
MF a[136:139],a[236:239],v[52:55],a[136:139]
v_add_f32 v95,v95,v74
v_add_f32 v95,v95,v75
MF a[140:143],a[236:239],v[56:59],a[140:143]
s_waitcnt lgkmcnt(2)
v_cvt_pk_bf16_f32 v61,v74,v75
v_add_f32 v96,v76,v77
L_st87:
MF v[0:3],a[216:219],v[144:147],v[80:83]
RD a[232:235],v216,256
v_cvt_pk_bf16_f32 v64,v76,v77
MF v[4:7],a[216:219],v[148:151],v[84:87]
RD a[236:239],v217,256
v_add_f32 v96,v96,v78
MF v[8:11],a[216:219],v[152:155],v[88:91]
v_exp_f32 v74,v42
MF v[0:3],a[220:223],v[156:159],v[0:3]
v_exp_f32 v75,v43
MF v[4:7],a[220:223],v[160:163],v[4:7]
buffer_load_dwordx4 v231,s[12:15],s35 offen offset:1024 nt lds
MF v[8:11],a[220:223],v[164:167],v[8:11]
s_waitcnt lgkmcnt(2)
v_exp_f32 v76,v44
MF v[0:3],a[224:227],v[168:171],v[0:3]
RD a[216:219],v216,6144
v_subrev_u32 v218,86016,v218
MF v[4:7],a[224:227],v[172:175],v[4:7]
RD a[220:223],v217,6144
v_subrev_u32 v219,86016,v219
MF v[8:11],a[224:227],v[176:179],v[8:11]
v_exp_f32 v77,v45
MF v[0:3],a[228:231],v[180:183],v[0:3]
v_add_f32 v96,v96,v79
v_cvt_pk_bf16_f32 v65,v78,v79
MF v[4:7],a[228:231],v[184:187],v[4:7]
v_exp_f32 v78,v46
MF v[8:11],a[228:231],v[188:191],v[8:11]
s_waitcnt lgkmcnt(2)
v_exp_f32 v79,v47
MF v[0:3],a[232:235],v[192:195],v[0:3]
RD a[224:227],v216,6272
v_subrev_u32 v220,86016,v220
MF v[4:7],a[232:235],v[196:199],v[4:7]
RD a[228:231],v217,6272
v_subrev_u32 v221,86016,v221
MF v[8:11],a[232:235],v[200:203],v[8:11]
v_add_f32 v97,v120,v121
v_cvt_pk_bf16_f32 v68,v120,v121
MF v[0:3],a[236:239],v[204:207],v[0:3]
v_add_f32 v97,v97,v122
v_add_f32 v97,v97,v123
MF v[4:7],a[236:239],v[208:211],v[4:7]
buffer_load_dwordx4 v232,s[12:15],s35 offen offset:2048 nt lds
MF v[8:11],a[236:239],v[212:215],v[8:11]
s_waitcnt lgkmcnt(2)
v_cvt_pk_bf16_f32 v69,v122,v123
v_add_f32 v95,v95,v124
MF v[12:15],a[216:219],v[144:147],v[80:83]
RD a[232:235],v216,6400
v_add_f32 v95,v95,v125
MF v[16:19],a[216:219],v[148:151],v[84:87]
RD a[236:239],v217,6400
v_cvt_pk_bf16_f32 v62,v124,v125
MF v[20:23],a[216:219],v[152:155],v[88:91]
v_add_f32 v95,v95,v126
v_add_f32 v95,v95,v127
MF v[12:15],a[220:223],v[156:159],v[12:15]
v_cvt_pk_bf16_f32 v63,v126,v127
v_add_f32 v96,v96,v72
MF v[16:19],a[220:223],v[160:163],v[16:19]
v_add_f32 v96,v96,v73
v_cvt_pk_bf16_f32 v66,v72,v73
MF v[20:23],a[220:223],v[164:167],v[20:23]
s_waitcnt vmcnt(31) lgkmcnt(2)
s_barrier
v_add_f32 v96,v96,v74
MF v[12:15],a[224:227],v[168:171],v[12:15]
TR a[216:217],v218,0
TR a[218:219],v218,6144
MF v[16:19],a[224:227],v[172:175],v[16:19]
TR a[220:221],v219,0
TR a[222:223],v219,6144
MF v[20:23],a[224:227],v[176:179],v[20:23]
s_add_u32 m0,s32,86016
v_add_f32 v96,v96,v75
v_cvt_pk_bf16_f32 v67,v74,v75
MF v[12:15],a[228:231],v[180:183],v[12:15]
s_add_u32 s36,s33,368640
v_add_f32 v97,v97,v76
v_add_f32 v97,v97,v77
MF v[16:19],a[228:231],v[184:187],v[16:19]
buffer_load_dwordx4 v230,s[8:11],s36 offen offset:0 nt lds
MF v[20:23],a[228:231],v[188:191],v[20:23]
s_waitcnt lgkmcnt(4)
v_cvt_pk_bf16_f32 v70,v76,v77
v_add_f32 v97,v97,v78
MF v[12:15],a[232:235],v[192:195],v[12:15]
TR a[224:225],v220,0
TR a[226:227],v220,6144
MF v[16:19],a[232:235],v[196:199],v[16:19]
TR a[228:229],v221,0
TR a[230:231],v221,6144
MF v[20:23],a[232:235],v[200:203],v[20:23]
v_add_f32 v97,v97,v79
v_cvt_pk_bf16_f32 v71,v78,v79
MF v[12:15],a[236:239],v[204:207],v[12:15]
v_max3_f32 v104,v95,v96,v97
v_cmp_lt_f32 vcc,s46,v104
MF v[16:19],a[236:239],v[208:211],v[16:19]
MF v[20:23],a[236:239],v[212:215],v[20:23]
s_waitcnt lgkmcnt(4)
s_cbranch_vccnz L_rs21
L_rr21:
L_st88:
MF a[0:3],a[216:219],v[60:63],a[0:3]
TR a[232:233],v218,128
TR a[234:235],v218,6272
MF a[4:7],a[216:219],v[64:67],a[4:7]
TR a[236:237],v219,128
TR a[238:239],v219,6272
MF a[8:11],a[216:219],v[68:71],a[8:11]
v_subrev_u32 v216,86016,v216
v_subrev_u32 v217,86016,v217
MF a[12:15],a[220:223],v[60:63],a[12:15]
v_exp_f32 v72,v0
MF a[16:19],a[220:223],v[64:67],a[16:19]
buffer_load_dwordx4 v231,s[8:11],s36 offen offset:1024 nt lds
MF a[20:23],a[220:223],v[68:71],a[20:23]
s_waitcnt lgkmcnt(4)
v_exp_f32 v73,v1
MF a[24:27],a[224:227],v[60:63],a[24:27]
TR a[216:217],v220,128
TR a[218:219],v220,6272
MF a[28:31],a[224:227],v[64:67],a[28:31]
TR a[220:221],v221,128
TR a[222:223],v221,6272
MF a[32:35],a[224:227],v[68:71],a[32:35]
v_exp_f32 v74,v2
MF a[36:39],a[228:231],v[60:63],a[36:39]
v_exp_f32 v75,v3
MF a[40:43],a[228:231],v[64:67],a[40:43]
v_exp_f32 v76,v4
MF a[44:47],a[228:231],v[68:71],a[44:47]
s_waitcnt lgkmcnt(4)
v_exp_f32 v77,v5
MF a[48:51],a[232:235],v[60:63],a[48:51]
TR a[224:225],v218,256
TR a[226:227],v218,6400
MF a[52:55],a[232:235],v[64:67],a[52:55]
TR a[228:229],v219,256
TR a[230:231],v219,6400
MF a[56:59],a[232:235],v[68:71],a[56:59]
v_exp_f32 v78,v6
MF a[60:63],a[236:239],v[60:63],a[60:63]
v_exp_f32 v79,v7
MF a[64:67],a[236:239],v[64:67],a[64:67]
buffer_load_dwordx4 v232,s[8:11],s36 offen offset:2048 nt lds
MF a[68:71],a[236:239],v[68:71],a[68:71]
s_waitcnt lgkmcnt(4)
v_exp_f32 v120,v8
MF a[72:75],a[216:219],v[60:63],a[72:75]
TR a[232:233],v220,256
TR a[234:235],v220,6400
MF a[76:79],a[216:219],v[64:67],a[76:79]
TR a[236:237],v221,256
TR a[238:239],v221,6400
MF a[80:83],a[216:219],v[68:71],a[80:83]
v_exp_f32 v121,v9
MF a[84:87],a[220:223],v[60:63],a[84:87]
v_exp_f32 v122,v10
MF a[88:91],a[220:223],v[64:67],a[88:91]
v_exp_f32 v123,v11
MF a[92:95],a[220:223],v[68:71],a[92:95]
s_waitcnt vmcnt(31) lgkmcnt(4)
s_barrier
v_add_f32 v92,v92,v95
MF a[96:99],a[224:227],v[60:63],a[96:99]
RD a[216:219],v216,0
v_add_f32 v93,v93,v96
MF a[100:103],a[224:227],v[64:67],a[100:103]
RD a[220:223],v217,0
v_add_f32 v94,v94,v97
MF a[104:107],a[224:227],v[68:71],a[104:107]
s_add_u32 m0,s32,98304
v_exp_f32 v124,v12
MF a[108:111],a[228:231],v[60:63],a[108:111]
s_add_u32 s35,s33,356352
v_exp_f32 v125,v13
MF a[112:115],a[228:231],v[64:67],a[112:115]
buffer_load_dwordx4 v230,s[12:15],s35 offen offset:0 nt lds
MF a[116:119],a[228:231],v[68:71],a[116:119]
s_waitcnt lgkmcnt(2)
v_exp_f32 v126,v14
MF a[120:123],a[232:235],v[60:63],a[120:123]
RD a[224:227],v216,128
v_add_f32 v95,v72,v73
MF a[124:127],a[232:235],v[64:67],a[124:127]
RD a[228:231],v217,128
v_cvt_pk_bf16_f32 v48,v72,v73
MF a[128:131],a[232:235],v[68:71],a[128:131]
v_exp_f32 v127,v15
MF a[132:135],a[236:239],v[60:63],a[132:135]
v_exp_f32 v72,v16
MF a[136:139],a[236:239],v[64:67],a[136:139]
v_exp_f32 v73,v17
MF a[140:143],a[236:239],v[68:71],a[140:143]
s_waitcnt lgkmcnt(2)
v_add_f32 v95,v95,v74
v_add_f32 v95,v95,v75
L_st89:
MF v[24:27],a[216:219],v[144:147],v[80:83]
RD a[232:235],v216,256
v_cvt_pk_bf16_f32 v49,v74,v75
MF v[28:31],a[216:219],v[148:151],v[84:87]
RD a[236:239],v217,256
v_add_f32 v96,v76,v77
MF v[32:35],a[216:219],v[152:155],v[88:91]
v_exp_f32 v74,v18
MF v[24:27],a[220:223],v[156:159],v[24:27]
v_exp_f32 v75,v19
MF v[28:31],a[220:223],v[160:163],v[28:31]
buffer_load_dwordx4 v231,s[12:15],s35 offen offset:1024 nt lds
MF v[32:35],a[220:223],v[164:167],v[32:35]
s_waitcnt lgkmcnt(2)
v_cvt_pk_bf16_f32 v52,v76,v77
v_add_f32 v96,v96,v78
MF v[24:27],a[224:227],v[168:171],v[24:27]
RD a[216:219],v216,6144
v_add_u32 v218,24576,v218
MF v[28:31],a[224:227],v[172:175],v[28:31]
RD a[220:223],v217,6144
v_add_u32 v219,24576,v219
MF v[32:35],a[224:227],v[176:179],v[32:35]
v_exp_f32 v76,v20
MF v[24:27],a[228:231],v[180:183],v[24:27]
v_exp_f32 v77,v21
MF v[28:31],a[228:231],v[184:187],v[28:31]
v_add_f32 v96,v96,v79
v_cvt_pk_bf16_f32 v53,v78,v79
MF v[32:35],a[228:231],v[188:191],v[32:35]
s_waitcnt lgkmcnt(2)
v_exp_f32 v78,v22
MF v[24:27],a[232:235],v[192:195],v[24:27]
RD a[224:227],v216,6272
v_add_u32 v220,24576,v220
MF v[28:31],a[232:235],v[196:199],v[28:31]
RD a[228:231],v217,6272
v_add_u32 v221,24576,v221
MF v[32:35],a[232:235],v[200:203],v[32:35]
v_exp_f32 v79,v23
MF v[24:27],a[236:239],v[204:207],v[24:27]
v_add_f32 v97,v120,v121
v_cvt_pk_bf16_f32 v56,v120,v121
MF v[28:31],a[236:239],v[208:211],v[28:31]
buffer_load_dwordx4 v232,s[12:15],s35 offen offset:2048 nt lds
MF v[32:35],a[236:239],v[212:215],v[32:35]
s_waitcnt lgkmcnt(2)
v_add_f32 v97,v97,v122
v_add_f32 v97,v97,v123
MF v[36:39],a[216:219],v[144:147],v[80:83]
RD a[232:235],v216,6400
v_cvt_pk_bf16_f32 v57,v122,v123
MF v[40:43],a[216:219],v[148:151],v[84:87]
RD a[236:239],v217,6400
v_add_f32 v95,v95,v124
MF v[44:47],a[216:219],v[152:155],v[88:91]
v_add_f32 v95,v95,v125
v_cvt_pk_bf16_f32 v50,v124,v125
MF v[36:39],a[220:223],v[156:159],v[36:39]
v_add_f32 v95,v95,v126
v_add_f32 v95,v95,v127
MF v[40:43],a[220:223],v[160:163],v[40:43]
v_cvt_pk_bf16_f32 v51,v126,v127
v_add_f32 v96,v96,v72
MF v[44:47],a[220:223],v[164:167],v[44:47]
s_waitcnt vmcnt(31) lgkmcnt(2)
s_barrier
v_add_f32 v96,v96,v73
MF v[36:39],a[224:227],v[168:171],v[36:39]
TR a[216:217],v218,36864
TR a[218:219],v218,43008
MF v[40:43],a[224:227],v[172:175],v[40:43]
TR a[220:221],v219,36864
TR a[222:223],v219,43008
MF v[44:47],a[224:227],v[176:179],v[44:47]
s_add_u32 m0,s32,0
v_cvt_pk_bf16_f32 v54,v72,v73
v_add_f32 v96,v96,v74
MF v[36:39],a[228:231],v[180:183],v[36:39]
s_add_u32 s36,s33,380928
v_add_f32 v96,v96,v75
v_cvt_pk_bf16_f32 v55,v74,v75
MF v[40:43],a[228:231],v[184:187],v[40:43]
buffer_load_dwordx4 v230,s[8:11],s36 offen offset:0 nt lds
MF v[44:47],a[228:231],v[188:191],v[44:47]
s_waitcnt lgkmcnt(4)
v_add_f32 v97,v97,v76
v_add_f32 v97,v97,v77
MF v[36:39],a[232:235],v[192:195],v[36:39]
TR a[224:225],v220,36864
TR a[226:227],v220,43008
MF v[40:43],a[232:235],v[196:199],v[40:43]
TR a[228:229],v221,36864
TR a[230:231],v221,43008
MF v[44:47],a[232:235],v[200:203],v[44:47]
v_cvt_pk_bf16_f32 v58,v76,v77
v_add_f32 v97,v97,v78
MF v[36:39],a[236:239],v[204:207],v[36:39]
v_add_f32 v97,v97,v79
v_cvt_pk_bf16_f32 v59,v78,v79
MF v[40:43],a[236:239],v[208:211],v[40:43]
v_max3_f32 v104,v95,v96,v97
v_cmp_lt_f32 vcc,s46,v104
MF v[44:47],a[236:239],v[212:215],v[44:47]
s_waitcnt lgkmcnt(4)
s_cbranch_vccnz L_rs22
L_rr22:
L_st90:
MF a[0:3],a[216:219],v[48:51],a[0:3]
TR a[232:233],v218,36992
TR a[234:235],v218,43136
MF a[4:7],a[216:219],v[52:55],a[4:7]
TR a[236:237],v219,36992
TR a[238:239],v219,43136
MF a[8:11],a[216:219],v[56:59],a[8:11]
v_add_u32 v216,98304,v216
v_add_u32 v217,98304,v217
MF a[12:15],a[220:223],v[48:51],a[12:15]
v_exp_f32 v72,v24
MF a[16:19],a[220:223],v[52:55],a[16:19]
buffer_load_dwordx4 v231,s[8:11],s36 offen offset:1024 nt lds
MF a[20:23],a[220:223],v[56:59],a[20:23]
s_waitcnt lgkmcnt(4)
v_exp_f32 v73,v25
MF a[24:27],a[224:227],v[48:51],a[24:27]
TR a[216:217],v220,36992
TR a[218:219],v220,43136
MF a[28:31],a[224:227],v[52:55],a[28:31]
TR a[220:221],v221,36992
TR a[222:223],v221,43136
MF a[32:35],a[224:227],v[56:59],a[32:35]
v_exp_f32 v74,v26
MF a[36:39],a[228:231],v[48:51],a[36:39]
v_exp_f32 v75,v27
MF a[40:43],a[228:231],v[52:55],a[40:43]
v_exp_f32 v76,v28
MF a[44:47],a[228:231],v[56:59],a[44:47]
s_waitcnt lgkmcnt(4)
v_exp_f32 v77,v29
MF a[48:51],a[232:235],v[48:51],a[48:51]
TR a[224:225],v218,37120
TR a[226:227],v218,43264
MF a[52:55],a[232:235],v[52:55],a[52:55]
TR a[228:229],v219,37120
TR a[230:231],v219,43264
MF a[56:59],a[232:235],v[56:59],a[56:59]
v_exp_f32 v78,v30
MF a[60:63],a[236:239],v[48:51],a[60:63]
v_exp_f32 v79,v31
MF a[64:67],a[236:239],v[52:55],a[64:67]
buffer_load_dwordx4 v232,s[8:11],s36 offen offset:2048 nt lds
MF a[68:71],a[236:239],v[56:59],a[68:71]
s_waitcnt lgkmcnt(4)
v_exp_f32 v120,v32
MF a[72:75],a[216:219],v[48:51],a[72:75]
TR a[232:233],v220,37120
TR a[234:235],v220,43264
MF a[76:79],a[216:219],v[52:55],a[76:79]
TR a[236:237],v221,37120
TR a[238:239],v221,43264
MF a[80:83],a[216:219],v[56:59],a[80:83]
v_exp_f32 v121,v33
MF a[84:87],a[220:223],v[48:51],a[84:87]
v_exp_f32 v122,v34
MF a[88:91],a[220:223],v[52:55],a[88:91]
v_exp_f32 v123,v35
MF a[92:95],a[220:223],v[56:59],a[92:95]
s_waitcnt vmcnt(30) lgkmcnt(4)
s_barrier
v_add_f32 v92,v92,v95
MF a[96:99],a[224:227],v[48:51],a[96:99]
RD a[216:219],v216,0
v_add_f32 v93,v93,v96
MF a[100:103],a[224:227],v[52:55],a[100:103]
RD a[220:223],v217,0
v_add_f32 v94,v94,v97
MF a[104:107],a[224:227],v[56:59],a[104:107]
s_add_u32 m0,s32,12288
v_exp_f32 v124,v36
MF a[108:111],a[228:231],v[48:51],a[108:111]
s_add_u32 s35,s33,368640
v_exp_f32 v125,v37
MF a[112:115],a[228:231],v[52:55],a[112:115]
buffer_load_dwordx4 v230,s[12:15],s35 offen offset:0 nt lds
MF a[116:119],a[228:231],v[56:59],a[116:119]
s_waitcnt lgkmcnt(2)
v_exp_f32 v126,v38
MF a[120:123],a[232:235],v[48:51],a[120:123]
RD a[224:227],v216,128
v_add_f32 v95,v72,v73
MF a[124:127],a[232:235],v[52:55],a[124:127]
RD a[228:231],v217,128
v_cvt_pk_bf16_f32 v60,v72,v73
MF a[128:131],a[232:235],v[56:59],a[128:131]
v_exp_f32 v127,v39
MF a[132:135],a[236:239],v[48:51],a[132:135]
v_exp_f32 v72,v40
MF a[136:139],a[236:239],v[52:55],a[136:139]
v_exp_f32 v73,v41
MF a[140:143],a[236:239],v[56:59],a[140:143]
s_waitcnt lgkmcnt(2)
v_add_f32 v95,v95,v74
v_add_f32 v95,v95,v75
s_cmp_eq_u32 s53,0
s_cbranch_scc0 L_chk_ok
v_readfirstlane_b32 s55,v143
s_nop 3
s_cmp_ge_u32 s55,16
s_cbranch_scc1 L_chk_ok
s_mov_b32 s54,262144
L_chk_loop:
s_sub_u32 s54,s54,1
s_cbranch_scc1 L_chk_ok
s_sleep 8
buffer_load_dword v143,v250,s[4:7],s60 offen sc1
s_waitcnt vmcnt(0)
v_readfirstlane_b32 s55,v143
s_nop 3
s_cmp_ge_u32 s55,16
s_cbranch_scc0 L_chk_loop
L_chk_ok:
s_lshl_b32 s60,s51,8
s_add_u32 s60,s60,67108864
v_subrev_u32 v138,64,v244
v_lshlrev_b32 v137,2,v138
v_mov_b32 v140,2147483392
v_cmp_gt_u32 vcc,16,v138
s_nop 1
v_cndmask_b32 v140,v140,v137,vcc
L_st91:
MF v[0:3],a[216:219],v[144:147],v[80:83]
RD a[232:235],v216,256
v_cvt_pk_bf16_f32 v61,v74,v75
MF v[4:7],a[216:219],v[148:151],v[84:87]
RD a[236:239],v217,256
v_add_f32 v96,v76,v77
MF v[8:11],a[216:219],v[152:155],v[88:91]
v_exp_f32 v74,v42
MF v[0:3],a[220:223],v[156:159],v[0:3]
v_exp_f32 v75,v43
MF v[4:7],a[220:223],v[160:163],v[4:7]
buffer_load_dwordx4 v231,s[12:15],s35 offen offset:1024 nt lds
MF v[8:11],a[220:223],v[164:167],v[8:11]
s_waitcnt lgkmcnt(2)
v_cvt_pk_bf16_f32 v64,v76,v77
v_add_f32 v96,v96,v78
MF v[0:3],a[224:227],v[168:171],v[0:3]
RD a[216:219],v216,6144
v_add_f32 v96,v96,v79
MF v[4:7],a[224:227],v[172:175],v[4:7]
RD a[220:223],v217,6144
v_cvt_pk_bf16_f32 v65,v78,v79
MF v[8:11],a[224:227],v[176:179],v[8:11]
v_exp_f32 v76,v44
MF v[0:3],a[228:231],v[180:183],v[0:3]
v_exp_f32 v77,v45
MF v[4:7],a[228:231],v[184:187],v[4:7]
v_exp_f32 v78,v46
MF v[8:11],a[228:231],v[188:191],v[8:11]
s_waitcnt lgkmcnt(2)
v_exp_f32 v79,v47
MF v[0:3],a[232:235],v[192:195],v[0:3]
RD a[224:227],v216,6272
v_add_f32 v97,v120,v121
MF v[4:7],a[232:235],v[196:199],v[4:7]
RD a[228:231],v217,6272
v_cvt_pk_bf16_f32 v68,v120,v121
MF v[8:11],a[232:235],v[200:203],v[8:11]
v_add_f32 v97,v97,v122
v_add_f32 v97,v97,v123
MF v[0:3],a[236:239],v[204:207],v[0:3]
v_cvt_pk_bf16_f32 v69,v122,v123
v_add_f32 v95,v95,v124
MF v[4:7],a[236:239],v[208:211],v[4:7]
buffer_load_dwordx4 v232,s[12:15],s35 offen offset:2048 nt lds
MF v[8:11],a[236:239],v[212:215],v[8:11]
s_waitcnt lgkmcnt(2)
v_add_f32 v95,v95,v125
v_cvt_pk_bf16_f32 v62,v124,v125
MF v[12:15],a[216:219],v[144:147],v[80:83]
RD a[232:235],v216,6400
v_add_f32 v95,v95,v126
MF v[16:19],a[216:219],v[148:151],v[84:87]
RD a[236:239],v217,6400
v_add_f32 v95,v95,v127
MF v[20:23],a[216:219],v[152:155],v[88:91]
v_cvt_pk_bf16_f32 v63,v126,v127
v_add_f32 v96,v96,v72
MF v[12:15],a[220:223],v[156:159],v[12:15]
v_add_f32 v96,v96,v73
v_cvt_pk_bf16_f32 v66,v72,v73
MF v[16:19],a[220:223],v[160:163],v[16:19]
v_add_f32 v96,v96,v74
v_add_f32 v96,v96,v75
MF v[20:23],a[220:223],v[164:167],v[20:23]
s_waitcnt vmcnt(30) lgkmcnt(2)
s_barrier
v_cvt_pk_bf16_f32 v67,v74,v75
MF v[12:15],a[224:227],v[168:171],v[12:15]
TR a[216:217],v218,0
TR a[218:219],v218,6144
MF v[16:19],a[224:227],v[172:175],v[16:19]
TR a[220:221],v219,0
TR a[222:223],v219,6144
MF v[20:23],a[224:227],v[176:179],v[20:23]
s_add_u32 m0,s32,61440
v_add_f32 v97,v97,v76
v_add_f32 v97,v97,v77
MF v[12:15],a[228:231],v[180:183],v[12:15]
s_add_u32 s36,s33,380928
v_cvt_pk_bf16_f32 v70,v76,v77
v_add_f32 v97,v97,v78
MF v[16:19],a[228:231],v[184:187],v[16:19]
buffer_load_dwordx4 v230,s[12:15],s36 offen offset:0 nt lds
MF v[20:23],a[228:231],v[188:191],v[20:23]
s_waitcnt lgkmcnt(4)
v_add_f32 v97,v97,v79
v_cvt_pk_bf16_f32 v71,v78,v79
MF v[12:15],a[232:235],v[192:195],v[12:15]
TR a[224:225],v220,0
TR a[226:227],v220,6144
MF v[16:19],a[232:235],v[196:199],v[16:19]
TR a[228:229],v221,0
TR a[230:231],v221,6144
MF v[20:23],a[232:235],v[200:203],v[20:23]
v_max3_f32 v104,v95,v96,v97
v_cmp_lt_f32 vcc,s46,v104
MF v[12:15],a[236:239],v[204:207],v[12:15]
MF v[16:19],a[236:239],v[208:211],v[16:19]
MF v[20:23],a[236:239],v[212:215],v[20:23]
s_waitcnt lgkmcnt(4)
s_cbranch_vccnz L_rs23
L_rr23:
L_st92:
MF a[0:3],a[216:219],v[60:63],a[0:3]
TR a[232:233],v218,128
TR a[234:235],v218,6272
MF a[4:7],a[216:219],v[64:67],a[4:7]
TR a[236:237],v219,128
TR a[238:239],v219,6272
MF a[8:11],a[216:219],v[68:71],a[8:11]
v_subrev_u32 v216,73728,v216
v_subrev_u32 v217,73728,v217
MF a[12:15],a[220:223],v[60:63],a[12:15]
v_exp_f32 v72,v0
MF a[16:19],a[220:223],v[64:67],a[16:19]
buffer_load_dwordx4 v231,s[12:15],s36 offen offset:1024 nt lds
MF a[20:23],a[220:223],v[68:71],a[20:23]
s_waitcnt lgkmcnt(4)
v_exp_f32 v73,v1
MF a[24:27],a[224:227],v[60:63],a[24:27]
TR a[216:217],v220,128
TR a[218:219],v220,6272
MF a[28:31],a[224:227],v[64:67],a[28:31]
TR a[220:221],v221,128
TR a[222:223],v221,6272
MF a[32:35],a[224:227],v[68:71],a[32:35]
v_exp_f32 v74,v2
MF a[36:39],a[228:231],v[60:63],a[36:39]
v_exp_f32 v75,v3
MF a[40:43],a[228:231],v[64:67],a[40:43]
v_exp_f32 v76,v4
MF a[44:47],a[228:231],v[68:71],a[44:47]
s_waitcnt lgkmcnt(4)
v_exp_f32 v77,v5
MF a[48:51],a[232:235],v[60:63],a[48:51]
TR a[224:225],v218,256
TR a[226:227],v218,6400
MF a[52:55],a[232:235],v[64:67],a[52:55]
TR a[228:229],v219,256
TR a[230:231],v219,6400
MF a[56:59],a[232:235],v[68:71],a[56:59]
v_exp_f32 v78,v6
MF a[60:63],a[236:239],v[60:63],a[60:63]
v_exp_f32 v79,v7
MF a[64:67],a[236:239],v[64:67],a[64:67]
buffer_load_dwordx4 v232,s[12:15],s36 offen offset:2048 nt lds
MF a[68:71],a[236:239],v[68:71],a[68:71]
s_waitcnt lgkmcnt(4)
v_exp_f32 v120,v8
MF a[72:75],a[216:219],v[60:63],a[72:75]
TR a[232:233],v220,256
TR a[234:235],v220,6400
MF a[76:79],a[216:219],v[64:67],a[76:79]
TR a[236:237],v221,256
TR a[238:239],v221,6400
MF a[80:83],a[216:219],v[68:71],a[80:83]
v_exp_f32 v121,v9
MF a[84:87],a[220:223],v[60:63],a[84:87]
v_exp_f32 v122,v10
MF a[88:91],a[220:223],v[64:67],a[88:91]
v_exp_f32 v123,v11
MF a[92:95],a[220:223],v[68:71],a[92:95]
s_waitcnt vmcnt(30) lgkmcnt(4)
s_barrier
v_add_f32 v92,v92,v95
MF a[96:99],a[224:227],v[60:63],a[96:99]
RD a[216:219],v216,0
v_add_f32 v93,v93,v96
MF a[100:103],a[224:227],v[64:67],a[100:103]
RD a[220:223],v217,0
v_add_f32 v94,v94,v97
MF a[104:107],a[224:227],v[68:71],a[104:107]
v_exp_f32 v124,v12
MF a[108:111],a[228:231],v[60:63],a[108:111]
v_exp_f32 v125,v13
MF a[112:115],a[228:231],v[64:67],a[112:115]
v_exp_f32 v126,v14
MF a[116:119],a[228:231],v[68:71],a[116:119]
s_waitcnt lgkmcnt(2)
v_exp_f32 v127,v15
MF a[120:123],a[232:235],v[60:63],a[120:123]
RD a[224:227],v216,128
v_add_f32 v95,v72,v73
MF a[124:127],a[232:235],v[64:67],a[124:127]
RD a[228:231],v217,128
v_cvt_pk_bf16_f32 v48,v72,v73
MF a[128:131],a[232:235],v[68:71],a[128:131]
v_exp_f32 v72,v16
MF a[132:135],a[236:239],v[60:63],a[132:135]
v_exp_f32 v73,v17
MF a[136:139],a[236:239],v[64:67],a[136:139]
v_add_f32 v95,v95,v74
v_add_f32 v95,v95,v75
MF a[140:143],a[236:239],v[68:71],a[140:143]
s_waitcnt lgkmcnt(2)
v_cvt_pk_bf16_f32 v49,v74,v75
v_add_f32 v96,v76,v77
L_st93:
MF v[24:27],a[216:219],v[144:147],v[80:83]
RD a[232:235],v216,256
v_cvt_pk_bf16_f32 v52,v76,v77
MF v[28:31],a[216:219],v[148:151],v[84:87]
RD a[236:239],v217,256
v_add_f32 v96,v96,v78
MF v[32:35],a[216:219],v[152:155],v[88:91]
v_exp_f32 v74,v18
MF v[24:27],a[220:223],v[156:159],v[24:27]
v_exp_f32 v75,v19
MF v[28:31],a[220:223],v[160:163],v[28:31]
v_exp_f32 v76,v20
MF v[32:35],a[220:223],v[164:167],v[32:35]
s_waitcnt lgkmcnt(2)
v_exp_f32 v77,v21
MF v[24:27],a[224:227],v[168:171],v[24:27]
RD a[216:219],v216,6144
v_add_f32 v96,v96,v79
MF v[28:31],a[224:227],v[172:175],v[28:31]
RD a[220:223],v217,6144
v_cvt_pk_bf16_f32 v53,v78,v79
MF v[32:35],a[224:227],v[176:179],v[32:35]
v_exp_f32 v78,v22
MF v[24:27],a[228:231],v[180:183],v[24:27]
v_exp_f32 v79,v23
MF v[28:31],a[228:231],v[184:187],v[28:31]
v_add_f32 v97,v120,v121
v_cvt_pk_bf16_f32 v56,v120,v121
MF v[32:35],a[228:231],v[188:191],v[32:35]
s_waitcnt lgkmcnt(2)
v_add_f32 v97,v97,v122
v_add_f32 v97,v97,v123
MF v[24:27],a[232:235],v[192:195],v[24:27]
RD a[224:227],v216,6272
v_cvt_pk_bf16_f32 v57,v122,v123
MF v[28:31],a[232:235],v[196:199],v[28:31]
RD a[228:231],v217,6272
v_add_f32 v95,v95,v124
MF v[32:35],a[232:235],v[200:203],v[32:35]
v_add_f32 v95,v95,v125
v_cvt_pk_bf16_f32 v50,v124,v125
MF v[24:27],a[236:239],v[204:207],v[24:27]
v_add_f32 v95,v95,v126
v_add_f32 v95,v95,v127
MF v[28:31],a[236:239],v[208:211],v[28:31]
v_cvt_pk_bf16_f32 v51,v126,v127
v_add_f32 v96,v96,v72
MF v[32:35],a[236:239],v[212:215],v[32:35]
s_waitcnt lgkmcnt(2)
v_add_f32 v96,v96,v73
v_cvt_pk_bf16_f32 v54,v72,v73
MF v[36:39],a[216:219],v[144:147],v[80:83]
RD a[232:235],v216,6400
v_add_f32 v96,v96,v74
MF v[40:43],a[216:219],v[148:151],v[84:87]
RD a[236:239],v217,6400
v_add_f32 v96,v96,v75
MF v[44:47],a[216:219],v[152:155],v[88:91]
v_cvt_pk_bf16_f32 v55,v74,v75
v_add_f32 v97,v97,v76
MF v[36:39],a[220:223],v[156:159],v[36:39]
v_add_f32 v97,v97,v77
v_cvt_pk_bf16_f32 v58,v76,v77
MF v[40:43],a[220:223],v[160:163],v[40:43]
v_add_f32 v97,v97,v78
v_add_f32 v97,v97,v79
MF v[44:47],a[220:223],v[164:167],v[44:47]
s_waitcnt vmcnt(27) lgkmcnt(2)
s_barrier
v_cvt_pk_bf16_f32 v59,v78,v79
MF v[36:39],a[224:227],v[168:171],v[36:39]
TR a[216:217],v218,24576
TR a[218:219],v218,30720
MF v[40:43],a[224:227],v[172:175],v[40:43]
TR a[220:221],v219,24576
TR a[222:223],v219,30720
MF v[44:47],a[224:227],v[176:179],v[44:47]
v_max3_f32 v104,v95,v96,v97
v_cmp_lt_f32 vcc,s46,v104
MF v[36:39],a[228:231],v[180:183],v[36:39]
MF v[40:43],a[228:231],v[184:187],v[40:43]
MF v[44:47],a[228:231],v[188:191],v[44:47]
s_waitcnt lgkmcnt(4)
MF v[36:39],a[232:235],v[192:195],v[36:39]
TR a[224:225],v220,24576
TR a[226:227],v220,30720
MF v[40:43],a[232:235],v[196:199],v[40:43]
TR a[228:229],v221,24576
TR a[230:231],v221,30720
MF v[44:47],a[232:235],v[200:203],v[44:47]
MF v[36:39],a[236:239],v[204:207],v[36:39]
MF v[40:43],a[236:239],v[208:211],v[40:43]
MF v[44:47],a[236:239],v[212:215],v[44:47]
s_waitcnt lgkmcnt(4)
s_cbranch_vccnz L_rs24
L_rr24:
L_st94:
MF a[0:3],a[216:219],v[48:51],a[0:3]
TR a[232:233],v218,24704
TR a[234:235],v218,30848
MF a[4:7],a[216:219],v[52:55],a[4:7]
TR a[236:237],v219,24704
TR a[238:239],v219,30848
MF a[8:11],a[216:219],v[56:59],a[8:11]
v_add_u32 v216,49152,v216
v_add_u32 v217,49152,v217
MF a[12:15],a[220:223],v[48:51],a[12:15]
s_add_u32 s85,s83,0
v_exp_f32 v72,v24
MF a[16:19],a[220:223],v[52:55],a[16:19]
v_exp_f32 v73,v25
MF a[20:23],a[220:223],v[56:59],a[20:23]
s_waitcnt lgkmcnt(4)
buffer_store_dwordx4 a[144:147],v246,s[24:27],s85 offen offset:0 sc1
MF a[24:27],a[224:227],v[48:51],a[24:27]
TR a[216:217],v220,24704
TR a[218:219],v220,30848
MF a[28:31],a[224:227],v[52:55],a[28:31]
TR a[220:221],v221,24704
TR a[222:223],v221,30848
MF a[32:35],a[224:227],v[56:59],a[32:35]
v_exp_f32 v74,v26
MF a[36:39],a[228:231],v[48:51],a[36:39]
v_exp_f32 v75,v27
MF a[40:43],a[228:231],v[52:55],a[40:43]
v_exp_f32 v76,v28
MF a[44:47],a[228:231],v[56:59],a[44:47]
s_waitcnt lgkmcnt(4)
buffer_store_dwordx4 a[148:151],v246,s[24:27],s85 offen offset:1024 sc1
MF a[48:51],a[232:235],v[48:51],a[48:51]
TR a[224:225],v218,24832
TR a[226:227],v218,30976
MF a[52:55],a[232:235],v[52:55],a[52:55]
TR a[228:229],v219,24832
TR a[230:231],v219,30976
MF a[56:59],a[232:235],v[56:59],a[56:59]
v_exp_f32 v77,v29
MF a[60:63],a[236:239],v[48:51],a[60:63]
v_exp_f32 v78,v30
MF a[64:67],a[236:239],v[52:55],a[64:67]
v_exp_f32 v79,v31
MF a[68:71],a[236:239],v[56:59],a[68:71]
s_waitcnt lgkmcnt(4)
v_exp_f32 v120,v32
MF a[72:75],a[216:219],v[48:51],a[72:75]
TR a[232:233],v220,24832
TR a[234:235],v220,30976
MF a[76:79],a[216:219],v[52:55],a[76:79]
TR a[236:237],v221,24832
TR a[238:239],v221,30976
MF a[80:83],a[216:219],v[56:59],a[80:83]
v_exp_f32 v121,v33
MF a[84:87],a[220:223],v[48:51],a[84:87]
v_exp_f32 v122,v34
MF a[88:91],a[220:223],v[52:55],a[88:91]
v_exp_f32 v123,v35
MF a[92:95],a[220:223],v[56:59],a[92:95]
s_waitcnt vmcnt(26) lgkmcnt(4)
s_barrier
v_add_f32 v92,v92,v95
MF a[96:99],a[224:227],v[48:51],a[96:99]
RD a[216:219],v216,36864
v_add_f32 v93,v93,v96
MF a[100:103],a[224:227],v[52:55],a[100:103]
RD a[220:223],v217,36864
v_add_f32 v94,v94,v97
MF a[104:107],a[224:227],v[56:59],a[104:107]
v_exp_f32 v124,v36
MF a[108:111],a[228:231],v[48:51],a[108:111]
v_exp_f32 v125,v37
MF a[112:115],a[228:231],v[52:55],a[112:115]
v_exp_f32 v126,v38
MF a[116:119],a[228:231],v[56:59],a[116:119]
s_waitcnt lgkmcnt(2)
v_exp_f32 v127,v39
MF a[120:123],a[232:235],v[48:51],a[120:123]
RD a[224:227],v216,36992
v_add_f32 v95,v72,v73
MF a[124:127],a[232:235],v[52:55],a[124:127]
RD a[228:231],v217,36992
v_cvt_pk_bf16_f32 v60,v72,v73
MF a[128:131],a[232:235],v[56:59],a[128:131]
v_exp_f32 v72,v40
MF a[132:135],a[236:239],v[48:51],a[132:135]
v_exp_f32 v73,v41
MF a[136:139],a[236:239],v[52:55],a[136:139]
v_add_f32 v95,v95,v74
v_add_f32 v95,v95,v75
MF a[140:143],a[236:239],v[56:59],a[140:143]
s_waitcnt lgkmcnt(2)
v_cvt_pk_bf16_f32 v61,v74,v75
v_add_f32 v96,v76,v77
L_st95:
MF v[0:3],a[216:219],v[144:147],v[80:83]
RD a[232:235],v216,37120
v_cvt_pk_bf16_f32 v64,v76,v77
MF v[4:7],a[216:219],v[148:151],v[84:87]
RD a[236:239],v217,37120
v_add_f32 v96,v96,v78
MF v[8:11],a[216:219],v[152:155],v[88:91]
v_exp_f32 v74,v42
MF v[0:3],a[220:223],v[156:159],v[0:3]
v_exp_f32 v75,v43
MF v[4:7],a[220:223],v[160:163],v[4:7]
v_exp_f32 v76,v44
MF v[8:11],a[220:223],v[164:167],v[8:11]
s_waitcnt lgkmcnt(2)
buffer_store_dwordx4 a[152:155],v246,s[24:27],s85 offen offset:2048 sc1
MF v[0:3],a[224:227],v[168:171],v[0:3]
RD a[216:219],v216,43008
v_add_f32 v96,v96,v79
MF v[4:7],a[224:227],v[172:175],v[4:7]
RD a[220:223],v217,43008
v_cvt_pk_bf16_f32 v65,v78,v79
MF v[8:11],a[224:227],v[176:179],v[8:11]
v_exp_f32 v77,v45
MF v[0:3],a[228:231],v[180:183],v[0:3]
s_add_u32 s85,s83,3072
v_exp_f32 v78,v46
MF v[4:7],a[228:231],v[184:187],v[4:7]
v_exp_f32 v79,v47
MF v[8:11],a[228:231],v[188:191],v[8:11]
s_waitcnt lgkmcnt(2)
buffer_store_dwordx4 a[156:159],v246,s[24:27],s85 offen offset:0 sc1
MF v[0:3],a[232:235],v[192:195],v[0:3]
RD a[224:227],v216,43136
v_add_f32 v97,v120,v121
MF v[4:7],a[232:235],v[196:199],v[4:7]
RD a[228:231],v217,43136
v_cvt_pk_bf16_f32 v68,v120,v121
MF v[8:11],a[232:235],v[200:203],v[8:11]
v_add_f32 v97,v97,v122
v_add_f32 v97,v97,v123
MF v[0:3],a[236:239],v[204:207],v[0:3]
v_cvt_pk_bf16_f32 v69,v122,v123
v_add_f32 v95,v95,v124
MF v[4:7],a[236:239],v[208:211],v[4:7]
v_add_f32 v95,v95,v125
v_cvt_pk_bf16_f32 v62,v124,v125
MF v[8:11],a[236:239],v[212:215],v[8:11]
s_waitcnt lgkmcnt(2)
v_add_f32 v95,v95,v126
v_add_f32 v95,v95,v127
MF v[12:15],a[216:219],v[144:147],v[80:83]
RD a[232:235],v216,43264
v_cvt_pk_bf16_f32 v63,v126,v127
MF v[16:19],a[216:219],v[148:151],v[84:87]
RD a[236:239],v217,43264
v_add_f32 v96,v96,v72
MF v[20:23],a[216:219],v[152:155],v[88:91]
v_add_f32 v96,v96,v73
v_cvt_pk_bf16_f32 v66,v72,v73
MF v[12:15],a[220:223],v[156:159],v[12:15]
v_add_f32 v96,v96,v74
v_add_f32 v96,v96,v75
MF v[16:19],a[220:223],v[160:163],v[16:19]
v_cvt_pk_bf16_f32 v67,v74,v75
v_add_f32 v97,v97,v76
MF v[20:23],a[220:223],v[164:167],v[20:23]
s_waitcnt vmcnt(25) lgkmcnt(2)
s_barrier
v_add_f32 v97,v97,v77
MF v[12:15],a[224:227],v[168:171],v[12:15]
TR a[216:217],v218,49152
TR a[218:219],v218,55296
MF v[16:19],a[224:227],v[172:175],v[16:19]
TR a[220:221],v219,49152
TR a[222:223],v219,55296
MF v[20:23],a[224:227],v[176:179],v[20:23]
v_cvt_pk_bf16_f32 v70,v76,v77
v_add_f32 v97,v97,v78
MF v[12:15],a[228:231],v[180:183],v[12:15]
v_add_f32 v97,v97,v79
v_cvt_pk_bf16_f32 v71,v78,v79
MF v[16:19],a[228:231],v[184:187],v[16:19]
v_max3_f32 v104,v95,v96,v97
v_cmp_lt_f32 vcc,s46,v104
MF v[20:23],a[228:231],v[188:191],v[20:23]
s_waitcnt lgkmcnt(4)
MF v[12:15],a[232:235],v[192:195],v[12:15]
TR a[224:225],v220,49152
TR a[226:227],v220,55296
MF v[16:19],a[232:235],v[196:199],v[16:19]
TR a[228:229],v221,49152
TR a[230:231],v221,55296
MF v[20:23],a[232:235],v[200:203],v[20:23]
MF v[12:15],a[236:239],v[204:207],v[12:15]
MF v[16:19],a[236:239],v[208:211],v[16:19]
MF v[20:23],a[236:239],v[212:215],v[20:23]
s_waitcnt lgkmcnt(4)
s_cbranch_vccnz L_rs25
L_rr25:
L_st96:
s_lshr_b32 s56,s2,3
s_and_b32 s56,s56,7
s_cmp_eq_u32 s56,0
s_cbranch_scc0 L_pcs6
s_getpc_b64 s[56:57]
L_pc6:
s_add_u32 s56,s56,L_code+81920-L_pc6
s_addc_u32 s57,s57,0
v_mov_b32 v249,s57
v_add_co_u32 v248,vcc,s56,v252
s_nop 1
v_addc_co_u32 v249,vcc,0,v249,vcc
global_load_dword a255,v[248:249],off
L_pcs6:
MF a[0:3],a[216:219],v[60:63],a[0:3]
TR a[232:233],v218,49280
TR a[234:235],v218,55424
MF a[4:7],a[216:219],v[64:67],a[4:7]
TR a[236:237],v219,49280
TR a[238:239],v219,55424
MF a[8:11],a[216:219],v[68:71],a[8:11]
v_exp_f32 v72,v0
MF a[12:15],a[220:223],v[60:63],a[12:15]
v_exp_f32 v73,v1
MF a[16:19],a[220:223],v[64:67],a[16:19]
v_exp_f32 v74,v2
MF a[20:23],a[220:223],v[68:71],a[20:23]
s_waitcnt lgkmcnt(4)
buffer_store_dwordx4 a[160:163],v246,s[24:27],s85 offen offset:1024 sc1
MF a[24:27],a[224:227],v[60:63],a[24:27]
TR a[216:217],v220,49280
TR a[218:219],v220,55424
MF a[28:31],a[224:227],v[64:67],a[28:31]
TR a[220:221],v221,49280
TR a[222:223],v221,55424
MF a[32:35],a[224:227],v[68:71],a[32:35]
v_exp_f32 v75,v3
MF a[36:39],a[228:231],v[60:63],a[36:39]
v_exp_f32 v76,v4
MF a[40:43],a[228:231],v[64:67],a[40:43]
v_exp_f32 v77,v5
MF a[44:47],a[228:231],v[68:71],a[44:47]
s_waitcnt lgkmcnt(4)
buffer_store_dwordx4 a[164:167],v246,s[24:27],s85 offen offset:2048 sc1
MF a[48:51],a[232:235],v[60:63],a[48:51]
TR a[224:225],v218,49408
TR a[226:227],v218,55552
MF a[52:55],a[232:235],v[64:67],a[52:55]
TR a[228:229],v219,49408
TR a[230:231],v219,55552
MF a[56:59],a[232:235],v[68:71],a[56:59]
v_exp_f32 v78,v6
MF a[60:63],a[236:239],v[60:63],a[60:63]
v_exp_f32 v79,v7
MF a[64:67],a[236:239],v[64:67],a[64:67]
v_exp_f32 v120,v8
MF a[68:71],a[236:239],v[68:71],a[68:71]
s_waitcnt lgkmcnt(4)
v_exp_f32 v121,v9
MF a[72:75],a[216:219],v[60:63],a[72:75]
TR a[232:233],v220,49408
TR a[234:235],v220,55552
MF a[76:79],a[216:219],v[64:67],a[76:79]
TR a[236:237],v221,49408
TR a[238:239],v221,55552
MF a[80:83],a[216:219],v[68:71],a[80:83]
v_exp_f32 v122,v10
MF a[84:87],a[220:223],v[60:63],a[84:87]
v_exp_f32 v123,v11
MF a[88:91],a[220:223],v[64:67],a[88:91]
v_exp_f32 v124,v12
MF a[92:95],a[220:223],v[68:71],a[92:95]
s_waitcnt vmcnt(24) lgkmcnt(4)
s_barrier
v_add_f32 v92,v92,v95
MF a[96:99],a[224:227],v[60:63],a[96:99]
RD a[216:219],v216,49152
v_add_f32 v93,v93,v96
MF a[100:103],a[224:227],v[64:67],a[100:103]
RD a[220:223],v217,49152
v_add_f32 v94,v94,v97
MF a[104:107],a[224:227],v[68:71],a[104:107]
s_add_u32 m0,s32,24576
v_exp_f32 v125,v13
MF a[108:111],a[228:231],v[60:63],a[108:111]
s_add_u32 s35,s76,0
v_exp_f32 v126,v14
MF a[112:115],a[228:231],v[64:67],a[112:115]
buffer_load_dwordx4 v239,s[20:23],s35 offen offset:0 lds
MF a[116:119],a[228:231],v[68:71],a[116:119]
s_waitcnt lgkmcnt(2)
v_exp_f32 v127,v15
MF a[120:123],a[232:235],v[60:63],a[120:123]
RD a[224:227],v216,49280
v_add_f32 v95,v72,v73
MF a[124:127],a[232:235],v[64:67],a[124:127]
RD a[228:231],v217,49280
v_cvt_pk_bf16_f32 v48,v72,v73
MF a[128:131],a[232:235],v[68:71],a[128:131]
v_exp_f32 v72,v16
MF a[132:135],a[236:239],v[60:63],a[132:135]
v_exp_f32 v73,v17
MF a[136:139],a[236:239],v[64:67],a[136:139]
v_add_f32 v95,v95,v74
v_add_f32 v95,v95,v75
MF a[140:143],a[236:239],v[68:71],a[140:143]
s_waitcnt lgkmcnt(2)
v_cvt_pk_bf16_f32 v49,v74,v75
v_add_f32 v96,v76,v77
L_st97:
MF v[24:27],a[216:219],v[144:147],v[80:83]
RD a[232:235],v216,49408
v_cvt_pk_bf16_f32 v52,v76,v77
MF v[28:31],a[216:219],v[148:151],v[84:87]
RD a[236:239],v217,49408
v_add_f32 v96,v96,v78
MF v[32:35],a[216:219],v[152:155],v[88:91]
v_exp_f32 v74,v18
MF v[24:27],a[220:223],v[156:159],v[24:27]
s_add_u32 s85,s83,6144
v_exp_f32 v75,v19
MF v[28:31],a[220:223],v[160:163],v[28:31]
buffer_load_dwordx4 v240,s[20:23],s35 offen offset:1024 lds
MF v[32:35],a[220:223],v[164:167],v[32:35]
s_waitcnt lgkmcnt(2)
buffer_store_dwordx4 a[168:171],v246,s[24:27],s85 offen offset:0 sc1
MF v[24:27],a[224:227],v[168:171],v[24:27]
RD a[216:219],v216,55296
v_add_u32 v218,73728,v218
MF v[28:31],a[224:227],v[172:175],v[28:31]
RD a[220:223],v217,55296
v_add_u32 v219,73728,v219
MF v[32:35],a[224:227],v[176:179],v[32:35]
v_exp_f32 v76,v20
MF v[24:27],a[228:231],v[180:183],v[24:27]
v_exp_f32 v77,v21
MF v[28:31],a[228:231],v[184:187],v[28:31]
v_add_f32 v96,v96,v79
v_cvt_pk_bf16_f32 v53,v78,v79
MF v[32:35],a[228:231],v[188:191],v[32:35]
s_waitcnt lgkmcnt(2)
buffer_store_dwordx4 a[172:175],v246,s[24:27],s85 offen offset:1024 sc1
MF v[24:27],a[232:235],v[192:195],v[24:27]
RD a[224:227],v216,55424
v_add_u32 v220,73728,v220
MF v[28:31],a[232:235],v[196:199],v[28:31]
RD a[228:231],v217,55424
v_add_u32 v221,73728,v221
MF v[32:35],a[232:235],v[200:203],v[32:35]
v_exp_f32 v78,v22
MF v[24:27],a[236:239],v[204:207],v[24:27]
v_exp_f32 v79,v23
MF v[28:31],a[236:239],v[208:211],v[28:31]
buffer_load_dwordx4 v241,s[20:23],s35 offen offset:2048 lds
MF v[32:35],a[236:239],v[212:215],v[32:35]
s_waitcnt lgkmcnt(2)
v_add_f32 v97,v120,v121
v_cvt_pk_bf16_f32 v56,v120,v121
MF v[36:39],a[216:219],v[144:147],v[80:83]
RD a[232:235],v216,55552
v_add_f32 v97,v97,v122
MF v[40:43],a[216:219],v[148:151],v[84:87]
RD a[236:239],v217,55552
v_add_f32 v97,v97,v123
MF v[44:47],a[216:219],v[152:155],v[88:91]
v_cvt_pk_bf16_f32 v57,v122,v123
v_add_f32 v95,v95,v124
MF v[36:39],a[220:223],v[156:159],v[36:39]
v_add_f32 v95,v95,v125
v_cvt_pk_bf16_f32 v50,v124,v125
MF v[40:43],a[220:223],v[160:163],v[40:43]
v_add_f32 v95,v95,v126
v_add_f32 v95,v95,v127
MF v[44:47],a[220:223],v[164:167],v[44:47]
s_waitcnt vmcnt(26) lgkmcnt(2)
s_barrier
v_cvt_pk_bf16_f32 v51,v126,v127
MF v[36:39],a[224:227],v[168:171],v[36:39]
TR a[216:217],v218,49152
TR a[218:219],v218,55296
MF v[40:43],a[224:227],v[172:175],v[40:43]
TR a[220:221],v219,49152
TR a[222:223],v219,55296
MF v[44:47],a[224:227],v[176:179],v[44:47]
s_add_u32 m0,s32,36864
v_add_f32 v96,v96,v72
v_add_f32 v96,v96,v73
MF v[36:39],a[228:231],v[180:183],v[36:39]
s_add_u32 s36,s76,40960
v_cvt_pk_bf16_f32 v54,v72,v73
v_add_f32 v96,v96,v74
MF v[40:43],a[228:231],v[184:187],v[40:43]
buffer_load_dwordx4 v239,s[20:23],s36 offen offset:0 lds
MF v[44:47],a[228:231],v[188:191],v[44:47]
s_waitcnt lgkmcnt(4)
v_add_f32 v96,v96,v75
v_cvt_pk_bf16_f32 v55,v74,v75
MF v[36:39],a[232:235],v[192:195],v[36:39]
TR a[224:225],v220,49152
TR a[226:227],v220,55296
MF v[40:43],a[232:235],v[196:199],v[40:43]
TR a[228:229],v221,49152
TR a[230:231],v221,55296
MF v[44:47],a[232:235],v[200:203],v[44:47]
v_add_f32 v97,v97,v76
v_add_f32 v97,v97,v77
MF v[36:39],a[236:239],v[204:207],v[36:39]
v_cvt_pk_bf16_f32 v58,v76,v77
v_add_f32 v97,v97,v78
MF v[40:43],a[236:239],v[208:211],v[40:43]
v_add_f32 v97,v97,v79
v_cvt_pk_bf16_f32 v59,v78,v79
MF v[44:47],a[236:239],v[212:215],v[44:47]
s_waitcnt lgkmcnt(4)
v_max3_f32 v104,v95,v96,v97
v_cmp_lt_f32 vcc,s46,v104
s_cbranch_vccnz L_rs26
L_rr26:
L_st98:
MF a[0:3],a[216:219],v[48:51],a[0:3]
TR a[232:233],v218,49280
TR a[234:235],v218,55424
MF a[4:7],a[216:219],v[52:55],a[4:7]
TR a[236:237],v219,49280
TR a[238:239],v219,55424
MF a[8:11],a[216:219],v[56:59],a[8:11]
v_exp_f32 v72,v24
MF a[12:15],a[220:223],v[48:51],a[12:15]
v_exp_f32 v73,v25
MF a[16:19],a[220:223],v[52:55],a[16:19]
buffer_load_dwordx4 v240,s[20:23],s36 offen offset:1024 lds
MF a[20:23],a[220:223],v[56:59],a[20:23]
s_waitcnt lgkmcnt(4)
buffer_store_dwordx4 a[176:179],v246,s[24:27],s85 offen offset:2048 sc1
MF a[24:27],a[224:227],v[48:51],a[24:27]
TR a[216:217],v220,49280
TR a[218:219],v220,55424
MF a[28:31],a[224:227],v[52:55],a[28:31]
TR a[220:221],v221,49280
TR a[222:223],v221,55424
MF a[32:35],a[224:227],v[56:59],a[32:35]
v_exp_f32 v74,v26
MF a[36:39],a[228:231],v[48:51],a[36:39]
s_add_u32 s85,s83,9216
v_exp_f32 v75,v27
MF a[40:43],a[228:231],v[52:55],a[40:43]
v_exp_f32 v76,v28
MF a[44:47],a[228:231],v[56:59],a[44:47]
s_waitcnt lgkmcnt(4)
buffer_store_dwordx4 a[180:183],v246,s[24:27],s85 offen offset:0 sc1
MF a[48:51],a[232:235],v[48:51],a[48:51]
TR a[224:225],v218,49408
TR a[226:227],v218,55552
MF a[52:55],a[232:235],v[52:55],a[52:55]
TR a[228:229],v219,49408
TR a[230:231],v219,55552
MF a[56:59],a[232:235],v[56:59],a[56:59]
v_exp_f32 v77,v29
MF a[60:63],a[236:239],v[48:51],a[60:63]
v_exp_f32 v78,v30
MF a[64:67],a[236:239],v[52:55],a[64:67]
buffer_load_dwordx4 v241,s[20:23],s36 offen offset:2048 lds
MF a[68:71],a[236:239],v[56:59],a[68:71]
s_waitcnt lgkmcnt(4)
v_exp_f32 v79,v31
MF a[72:75],a[216:219],v[48:51],a[72:75]
TR a[232:233],v220,49408
TR a[234:235],v220,55552
MF a[76:79],a[216:219],v[52:55],a[76:79]
TR a[236:237],v221,49408
TR a[238:239],v221,55552
MF a[80:83],a[216:219],v[56:59],a[80:83]
v_exp_f32 v120,v32
MF a[84:87],a[220:223],v[48:51],a[84:87]
v_exp_f32 v121,v33
MF a[88:91],a[220:223],v[52:55],a[88:91]
v_exp_f32 v122,v34
MF a[92:95],a[220:223],v[56:59],a[92:95]
s_waitcnt vmcnt(28) lgkmcnt(4)
s_barrier
v_add_f32 v92,v92,v95
MF a[96:99],a[224:227],v[48:51],a[96:99]
RD a[216:219],v216,0
v_add_f32 v93,v93,v96
MF a[100:103],a[224:227],v[52:55],a[100:103]
RD a[220:223],v217,0
v_add_f32 v94,v94,v97
MF a[104:107],a[224:227],v[56:59],a[104:107]
s_add_u32 m0,s32,49152
v_exp_f32 v123,v35
MF a[108:111],a[228:231],v[48:51],a[108:111]
s_add_u32 s35,s76,81920
v_exp_f32 v124,v36
MF a[112:115],a[228:231],v[52:55],a[112:115]
buffer_load_dwordx4 v239,s[20:23],s35 offen offset:0 lds
MF a[116:119],a[228:231],v[56:59],a[116:119]
s_waitcnt lgkmcnt(2)
v_exp_f32 v125,v37
MF a[120:123],a[232:235],v[48:51],a[120:123]
RD a[224:227],v216,128
v_add_f32 v95,v72,v73
MF a[124:127],a[232:235],v[52:55],a[124:127]
RD a[228:231],v217,128
v_cvt_pk_bf16_f32 v60,v72,v73
MF a[128:131],a[232:235],v[56:59],a[128:131]
v_exp_f32 v126,v38
MF a[132:135],a[236:239],v[48:51],a[132:135]
v_exp_f32 v127,v39
MF a[136:139],a[236:239],v[52:55],a[136:139]
v_exp_f32 v72,v40
MF a[140:143],a[236:239],v[56:59],a[140:143]
s_waitcnt lgkmcnt(2)
v_exp_f32 v73,v41
L_st99:
MF v[0:3],a[216:219],v[144:147],v[80:83]
RD a[232:235],v216,256
v_add_f32 v95,v95,v74
MF v[4:7],a[216:219],v[148:151],v[84:87]
RD a[236:239],v217,256
v_add_f32 v95,v95,v75
MF v[8:11],a[216:219],v[152:155],v[88:91]
v_cvt_pk_bf16_f32 v61,v74,v75
v_add_f32 v96,v76,v77
MF v[0:3],a[220:223],v[156:159],v[0:3]
v_exp_f32 v74,v42
MF v[4:7],a[220:223],v[160:163],v[4:7]
buffer_load_dwordx4 v240,s[20:23],s35 offen offset:1024 lds
MF v[8:11],a[220:223],v[164:167],v[8:11]
s_waitcnt lgkmcnt(2)
buffer_store_dwordx4 a[184:187],v246,s[24:27],s85 offen offset:1024 sc1
MF v[0:3],a[224:227],v[168:171],v[0:3]
RD a[216:219],v216,6144
v_cvt_pk_bf16_f32 v64,v76,v77
MF v[4:7],a[224:227],v[172:175],v[4:7]
RD a[220:223],v217,6144
v_add_f32 v96,v96,v78
MF v[8:11],a[224:227],v[176:179],v[8:11]
v_exp_f32 v75,v43
MF v[0:3],a[228:231],v[180:183],v[0:3]
v_exp_f32 v76,v44
MF v[4:7],a[228:231],v[184:187],v[4:7]
v_exp_f32 v77,v45
MF v[8:11],a[228:231],v[188:191],v[8:11]
s_waitcnt lgkmcnt(2)
buffer_store_dwordx4 a[188:191],v246,s[24:27],s85 offen offset:2048 sc1
MF v[0:3],a[232:235],v[192:195],v[0:3]
RD a[224:227],v216,6272
v_add_f32 v96,v96,v79
MF v[4:7],a[232:235],v[196:199],v[4:7]
RD a[228:231],v217,6272
v_cvt_pk_bf16_f32 v65,v78,v79
MF v[8:11],a[232:235],v[200:203],v[8:11]
v_exp_f32 v78,v46
MF v[0:3],a[236:239],v[204:207],v[0:3]
v_exp_f32 v79,v47
MF v[4:7],a[236:239],v[208:211],v[4:7]
buffer_load_dwordx4 v241,s[20:23],s35 offen offset:2048 lds
MF v[8:11],a[236:239],v[212:215],v[8:11]
s_waitcnt lgkmcnt(2)
v_add_f32 v97,v120,v121
v_cvt_pk_bf16_f32 v68,v120,v121
MF v[12:15],a[216:219],v[144:147],v[80:83]
RD a[232:235],v216,6400
v_add_f32 v97,v97,v122
MF v[16:19],a[216:219],v[148:151],v[84:87]
RD a[236:239],v217,6400
v_add_f32 v97,v97,v123
MF v[20:23],a[216:219],v[152:155],v[88:91]
v_cvt_pk_bf16_f32 v69,v122,v123
v_add_f32 v95,v95,v124
MF v[12:15],a[220:223],v[156:159],v[12:15]
v_add_f32 v95,v95,v125
v_cvt_pk_bf16_f32 v62,v124,v125
MF v[16:19],a[220:223],v[160:163],v[16:19]
v_add_f32 v95,v95,v126
v_add_f32 v95,v95,v127
MF v[20:23],a[220:223],v[164:167],v[20:23]
s_waitcnt vmcnt(30) lgkmcnt(2)
s_barrier
v_cvt_pk_bf16_f32 v63,v126,v127
MF v[12:15],a[224:227],v[168:171],v[12:15]
TR a[216:217],v218,0
TR a[218:219],v218,6144
MF v[16:19],a[224:227],v[172:175],v[16:19]
TR a[220:221],v219,0
TR a[222:223],v219,6144
MF v[20:23],a[224:227],v[176:179],v[20:23]
s_add_u32 m0,s32,73728
v_add_f32 v96,v96,v72
v_add_f32 v96,v96,v73
MF v[12:15],a[228:231],v[180:183],v[12:15]
s_add_u32 s36,s76,122880
v_cvt_pk_bf16_f32 v66,v72,v73
v_add_f32 v96,v96,v74
MF v[16:19],a[228:231],v[184:187],v[16:19]
buffer_load_dwordx4 v239,s[20:23],s36 offen offset:0 lds
MF v[20:23],a[228:231],v[188:191],v[20:23]
s_waitcnt lgkmcnt(4)
v_add_f32 v96,v96,v75
v_cvt_pk_bf16_f32 v67,v74,v75
MF v[12:15],a[232:235],v[192:195],v[12:15]
TR a[224:225],v220,0
TR a[226:227],v220,6144
MF v[16:19],a[232:235],v[196:199],v[16:19]
TR a[228:229],v221,0
TR a[230:231],v221,6144
MF v[20:23],a[232:235],v[200:203],v[20:23]
v_add_f32 v97,v97,v76
v_add_f32 v97,v97,v77
MF v[12:15],a[236:239],v[204:207],v[12:15]
v_cvt_pk_bf16_f32 v70,v76,v77
v_add_f32 v97,v97,v78
MF v[16:19],a[236:239],v[208:211],v[16:19]
v_add_f32 v97,v97,v79
v_cvt_pk_bf16_f32 v71,v78,v79
MF v[20:23],a[236:239],v[212:215],v[20:23]
s_waitcnt lgkmcnt(4)
v_max3_f32 v104,v95,v96,v97
v_cmp_lt_f32 vcc,s46,v104
s_cbranch_vccnz L_rs27
L_rr27:
L_st100:
MF a[0:3],a[216:219],v[60:63],a[0:3]
TR a[232:233],v218,128
TR a[234:235],v218,6272
MF a[4:7],a[216:219],v[64:67],a[4:7]
TR a[236:237],v219,128
TR a[238:239],v219,6272
MF a[8:11],a[216:219],v[68:71],a[8:11]
v_subrev_u32 v216,86016,v216
v_subrev_u32 v217,86016,v217
MF a[12:15],a[220:223],v[60:63],a[12:15]
s_add_u32 s85,s83,12288
v_exp_f32 v72,v0
MF a[16:19],a[220:223],v[64:67],a[16:19]
buffer_load_dwordx4 v240,s[20:23],s36 offen offset:1024 lds
MF a[20:23],a[220:223],v[68:71],a[20:23]
s_waitcnt lgkmcnt(4)
buffer_store_dwordx4 a[192:195],v246,s[24:27],s85 offen offset:0 sc1
MF a[24:27],a[224:227],v[60:63],a[24:27]
TR a[216:217],v220,128
TR a[218:219],v220,6272
MF a[28:31],a[224:227],v[64:67],a[28:31]
TR a[220:221],v221,128
TR a[222:223],v221,6272
MF a[32:35],a[224:227],v[68:71],a[32:35]
v_exp_f32 v73,v1
MF a[36:39],a[228:231],v[60:63],a[36:39]
v_exp_f32 v74,v2
MF a[40:43],a[228:231],v[64:67],a[40:43]
v_exp_f32 v75,v3
MF a[44:47],a[228:231],v[68:71],a[44:47]
s_waitcnt lgkmcnt(4)
buffer_store_dwordx4 a[196:199],v246,s[24:27],s85 offen offset:1024 sc1
MF a[48:51],a[232:235],v[60:63],a[48:51]
TR a[224:225],v218,256
TR a[226:227],v218,6400
MF a[52:55],a[232:235],v[64:67],a[52:55]
TR a[228:229],v219,256
TR a[230:231],v219,6400
MF a[56:59],a[232:235],v[68:71],a[56:59]
v_exp_f32 v76,v4
MF a[60:63],a[236:239],v[60:63],a[60:63]
v_exp_f32 v77,v5
MF a[64:67],a[236:239],v[64:67],a[64:67]
buffer_load_dwordx4 v241,s[20:23],s36 offen offset:2048 lds
MF a[68:71],a[236:239],v[68:71],a[68:71]
s_waitcnt lgkmcnt(4)
v_exp_f32 v78,v6
MF a[72:75],a[216:219],v[60:63],a[72:75]
TR a[232:233],v220,256
TR a[234:235],v220,6400
MF a[76:79],a[216:219],v[64:67],a[76:79]
TR a[236:237],v221,256
TR a[238:239],v221,6400
MF a[80:83],a[216:219],v[68:71],a[80:83]
v_exp_f32 v79,v7
MF a[84:87],a[220:223],v[60:63],a[84:87]
v_exp_f32 v120,v8
MF a[88:91],a[220:223],v[64:67],a[88:91]
v_exp_f32 v121,v9
MF a[92:95],a[220:223],v[68:71],a[92:95]
s_waitcnt vmcnt(32) lgkmcnt(4)
s_barrier
v_add_f32 v92,v92,v95
MF a[96:99],a[224:227],v[60:63],a[96:99]
RD a[216:219],v216,0
v_add_f32 v93,v93,v96
MF a[100:103],a[224:227],v[64:67],a[100:103]
RD a[220:223],v217,0
v_add_f32 v94,v94,v97
MF a[104:107],a[224:227],v[68:71],a[104:107]
s_add_u32 m0,s32,86016
v_exp_f32 v122,v10
MF a[108:111],a[228:231],v[60:63],a[108:111]
s_add_u32 s35,s76,163840
v_exp_f32 v123,v11
MF a[112:115],a[228:231],v[64:67],a[112:115]
buffer_load_dwordx4 v239,s[20:23],s35 offen offset:0 lds
MF a[116:119],a[228:231],v[68:71],a[116:119]
s_waitcnt lgkmcnt(2)
v_exp_f32 v124,v12
MF a[120:123],a[232:235],v[60:63],a[120:123]
RD a[224:227],v216,128
v_add_f32 v95,v72,v73
MF a[124:127],a[232:235],v[64:67],a[124:127]
RD a[228:231],v217,128
v_cvt_pk_bf16_f32 v48,v72,v73
MF a[128:131],a[232:235],v[68:71],a[128:131]
v_exp_f32 v125,v13
MF a[132:135],a[236:239],v[60:63],a[132:135]
v_exp_f32 v126,v14
MF a[136:139],a[236:239],v[64:67],a[136:139]
v_exp_f32 v127,v15
MF a[140:143],a[236:239],v[68:71],a[140:143]
s_waitcnt lgkmcnt(2)
v_exp_f32 v72,v16
L_st101:
MF v[24:27],a[216:219],v[144:147],v[80:83]
RD a[232:235],v216,256
v_add_f32 v95,v95,v74
MF v[28:31],a[216:219],v[148:151],v[84:87]
RD a[236:239],v217,256
v_add_f32 v95,v95,v75
MF v[32:35],a[216:219],v[152:155],v[88:91]
v_exp_f32 v73,v17
MF v[24:27],a[220:223],v[156:159],v[24:27]
v_cvt_pk_bf16_f32 v49,v74,v75
v_add_f32 v96,v76,v77
MF v[28:31],a[220:223],v[160:163],v[28:31]
buffer_load_dwordx4 v240,s[20:23],s35 offen offset:1024 lds
MF v[32:35],a[220:223],v[164:167],v[32:35]
s_waitcnt lgkmcnt(2)
buffer_store_dwordx4 a[200:203],v246,s[24:27],s85 offen offset:2048 sc1
MF v[24:27],a[224:227],v[168:171],v[24:27]
RD a[216:219],v216,6144
v_subrev_u32 v218,86016,v218
MF v[28:31],a[224:227],v[172:175],v[28:31]
RD a[220:223],v217,6144
v_subrev_u32 v219,86016,v219
MF v[32:35],a[224:227],v[176:179],v[32:35]
v_exp_f32 v74,v18
MF v[24:27],a[228:231],v[180:183],v[24:27]
s_add_u32 s85,s83,15360
v_exp_f32 v75,v19
MF v[28:31],a[228:231],v[184:187],v[28:31]
v_cvt_pk_bf16_f32 v52,v76,v77
v_add_f32 v96,v96,v78
MF v[32:35],a[228:231],v[188:191],v[32:35]
s_waitcnt lgkmcnt(2)
buffer_store_dwordx4 a[204:207],v246,s[24:27],s85 offen offset:0 sc1
MF v[24:27],a[232:235],v[192:195],v[24:27]
RD a[224:227],v216,6272
v_subrev_u32 v220,86016,v220
MF v[28:31],a[232:235],v[196:199],v[28:31]
RD a[228:231],v217,6272
v_subrev_u32 v221,86016,v221
MF v[32:35],a[232:235],v[200:203],v[32:35]
v_exp_f32 v76,v20
MF v[24:27],a[236:239],v[204:207],v[24:27]
v_exp_f32 v77,v21
MF v[28:31],a[236:239],v[208:211],v[28:31]
buffer_load_dwordx4 v241,s[20:23],s35 offen offset:2048 lds
MF v[32:35],a[236:239],v[212:215],v[32:35]
s_waitcnt lgkmcnt(2)
v_add_f32 v96,v96,v79
v_cvt_pk_bf16_f32 v53,v78,v79
MF v[36:39],a[216:219],v[144:147],v[80:83]
RD a[232:235],v216,6400
v_add_f32 v97,v120,v121
MF v[40:43],a[216:219],v[148:151],v[84:87]
RD a[236:239],v217,6400
v_cvt_pk_bf16_f32 v56,v120,v121
MF v[44:47],a[216:219],v[152:155],v[88:91]
v_exp_f32 v78,v22
MF v[36:39],a[220:223],v[156:159],v[36:39]
v_exp_f32 v79,v23
MF v[40:43],a[220:223],v[160:163],v[40:43]
v_add_f32 v97,v97,v122
v_add_f32 v97,v97,v123
MF v[44:47],a[220:223],v[164:167],v[44:47]
s_waitcnt vmcnt(34) lgkmcnt(2)
s_barrier
v_cvt_pk_bf16_f32 v57,v122,v123
MF v[36:39],a[224:227],v[168:171],v[36:39]
TR a[216:217],v218,0
TR a[218:219],v218,6144
MF v[40:43],a[224:227],v[172:175],v[40:43]
TR a[220:221],v219,0
TR a[222:223],v219,6144
MF v[44:47],a[224:227],v[176:179],v[44:47]
s_add_u32 m0,s32,98304
v_add_f32 v95,v95,v124
v_add_f32 v95,v95,v125
MF v[36:39],a[228:231],v[180:183],v[36:39]
s_add_u32 s36,s76,204800
v_cvt_pk_bf16_f32 v50,v124,v125
v_add_f32 v95,v95,v126
MF v[40:43],a[228:231],v[184:187],v[40:43]
buffer_load_dwordx4 v239,s[20:23],s36 offen offset:0 lds
MF v[44:47],a[228:231],v[188:191],v[44:47]
s_waitcnt lgkmcnt(4)
v_add_f32 v95,v95,v127
v_cvt_pk_bf16_f32 v51,v126,v127
MF v[36:39],a[232:235],v[192:195],v[36:39]
TR a[224:225],v220,0
TR a[226:227],v220,6144
MF v[40:43],a[232:235],v[196:199],v[40:43]
TR a[228:229],v221,0
TR a[230:231],v221,6144
MF v[44:47],a[232:235],v[200:203],v[44:47]
v_add_f32 v96,v96,v72
v_add_f32 v96,v96,v73
MF v[36:39],a[236:239],v[204:207],v[36:39]
v_cvt_pk_bf16_f32 v54,v72,v73
v_add_f32 v96,v96,v74
MF v[40:43],a[236:239],v[208:211],v[40:43]
v_add_f32 v96,v96,v75
v_cvt_pk_bf16_f32 v55,v74,v75
MF v[44:47],a[236:239],v[212:215],v[44:47]
s_waitcnt lgkmcnt(4)
v_add_f32 v97,v97,v76
v_add_f32 v97,v97,v77
v_cvt_pk_bf16_f32 v58,v76,v77
v_add_f32 v97,v97,v78
v_add_f32 v97,v97,v79
v_cvt_pk_bf16_f32 v59,v78,v79
v_max3_f32 v104,v95,v96,v97
v_cmp_lt_f32 vcc,s46,v104
s_cbranch_vccnz L_rs28
L_rr28:
L_st102:
MF a[0:3],a[216:219],v[48:51],a[0:3]
TR a[232:233],v218,128
TR a[234:235],v218,6272
MF a[4:7],a[216:219],v[52:55],a[4:7]
TR a[236:237],v219,128
TR a[238:239],v219,6272
MF a[8:11],a[216:219],v[56:59],a[8:11]
v_exp_f32 v72,v24
MF a[12:15],a[220:223],v[48:51],a[12:15]
v_exp_f32 v73,v25
MF a[16:19],a[220:223],v[52:55],a[16:19]
buffer_load_dwordx4 v240,s[20:23],s36 offen offset:1024 lds
MF a[20:23],a[220:223],v[56:59],a[20:23]
s_waitcnt lgkmcnt(4)
buffer_store_dwordx4 a[208:211],v246,s[24:27],s85 offen offset:1024 sc1
MF a[24:27],a[224:227],v[48:51],a[24:27]
TR a[216:217],v220,128
TR a[218:219],v220,6272
MF a[28:31],a[224:227],v[52:55],a[28:31]
TR a[220:221],v221,128
TR a[222:223],v221,6272
MF a[32:35],a[224:227],v[56:59],a[32:35]
v_exp_f32 v74,v26
MF a[36:39],a[228:231],v[48:51],a[36:39]
v_exp_f32 v75,v27
MF a[40:43],a[228:231],v[52:55],a[40:43]
v_exp_f32 v76,v28
MF a[44:47],a[228:231],v[56:59],a[44:47]
s_waitcnt lgkmcnt(4)
buffer_store_dwordx4 a[212:215],v246,s[24:27],s85 offen offset:2048 sc1
MF a[48:51],a[232:235],v[48:51],a[48:51]
TR a[224:225],v218,256
TR a[226:227],v218,6400
MF a[52:55],a[232:235],v[52:55],a[52:55]
TR a[228:229],v219,256
TR a[230:231],v219,6400
MF a[56:59],a[232:235],v[56:59],a[56:59]
v_exp_f32 v77,v29
MF a[60:63],a[236:239],v[48:51],a[60:63]
v_exp_f32 v78,v30
MF a[64:67],a[236:239],v[52:55],a[64:67]
buffer_load_dwordx4 v241,s[20:23],s36 offen offset:2048 lds
MF a[68:71],a[236:239],v[56:59],a[68:71]
s_waitcnt lgkmcnt(4)
v_exp_f32 v79,v31
MF a[72:75],a[216:219],v[48:51],a[72:75]
TR a[232:233],v220,256
TR a[234:235],v220,6400
MF a[76:79],a[216:219],v[52:55],a[76:79]
TR a[236:237],v221,256
TR a[238:239],v221,6400
MF a[80:83],a[216:219],v[56:59],a[80:83]
v_exp_f32 v120,v32
MF a[84:87],a[220:223],v[48:51],a[84:87]
v_exp_f32 v121,v33
MF a[88:91],a[220:223],v[52:55],a[88:91]
v_exp_f32 v122,v34
MF a[92:95],a[220:223],v[56:59],a[92:95]
s_waitcnt vmcnt(36) lgkmcnt(4)
s_barrier
v_add_f32 v92,v92,v95
MF a[96:99],a[224:227],v[48:51],a[96:99]
TR a[216:217],v218,49152
TR a[218:219],v218,55296
MF a[100:103],a[224:227],v[52:55],a[100:103]
TR a[220:221],v219,49152
TR a[222:223],v219,55296
MF a[104:107],a[224:227],v[56:59],a[104:107]
s_add_u32 m0,s32,0
v_exp_f32 v123,v35
MF a[108:111],a[228:231],v[48:51],a[108:111]
s_add_u32 s35,s76,245760
v_exp_f32 v124,v36
MF a[112:115],a[228:231],v[52:55],a[112:115]
buffer_load_dwordx4 v239,s[20:23],s35 offen offset:0 lds
MF a[116:119],a[228:231],v[56:59],a[116:119]
s_waitcnt lgkmcnt(4)
v_exp_f32 v125,v37
MF a[120:123],a[232:235],v[48:51],a[120:123]
TR a[224:225],v220,49152
TR a[226:227],v220,55296
MF a[124:127],a[232:235],v[52:55],a[124:127]
TR a[228:229],v221,49152
TR a[230:231],v221,55296
MF a[128:131],a[232:235],v[56:59],a[128:131]
v_exp_f32 v126,v38
MF a[132:135],a[236:239],v[48:51],a[132:135]
v_exp_f32 v127,v39
MF a[136:139],a[236:239],v[52:55],a[136:139]
v_add_f32 v93,v93,v96
v_add_f32 v94,v94,v97
MF a[140:143],a[236:239],v[56:59],a[140:143]
s_waitcnt lgkmcnt(4)
v_add_f32 v95,v72,v73
v_cvt_pk_bf16_f32 v60,v72,v73
v_add_f32 v95,v95,v74
v_add_f32 v95,v95,v75
v_cvt_pk_bf16_f32 v61,v74,v75
v_add_f32 v96,v76,v77
v_cvt_pk_bf16_f32 v64,v76,v77
v_add_f32 v96,v96,v78
v_add_f32 v96,v96,v79
v_cvt_pk_bf16_f32 v65,v78,v79
v_add_f32 v97,v120,v121
v_cvt_pk_bf16_f32 v68,v120,v121
v_add_f32 v97,v97,v122
v_add_f32 v97,v97,v123
v_cvt_pk_bf16_f32 v69,v122,v123
v_add_f32 v95,v95,v124
v_add_f32 v95,v95,v125
v_cvt_pk_bf16_f32 v62,v124,v125
v_add_f32 v95,v95,v126
v_add_f32 v95,v95,v127
v_cvt_pk_bf16_f32 v63,v126,v127
v_exp_f32 v72,v40
v_exp_f32 v73,v41
v_add_f32 v96,v96,v72
v_add_f32 v96,v96,v73
v_cvt_pk_bf16_f32 v66,v72,v73
v_exp_f32 v74,v42
v_exp_f32 v75,v43
v_add_f32 v96,v96,v74
v_add_f32 v96,v96,v75
v_cvt_pk_bf16_f32 v67,v74,v75
v_exp_f32 v76,v44
v_exp_f32 v77,v45
v_add_f32 v97,v97,v76
v_add_f32 v97,v97,v77
v_cvt_pk_bf16_f32 v70,v76,v77
v_exp_f32 v78,v46
v_exp_f32 v79,v47
v_add_f32 v97,v97,v78
v_add_f32 v97,v97,v79
v_cvt_pk_bf16_f32 v71,v78,v79
v_max3_f32 v104,v95,v96,v97
v_cmp_lt_f32 vcc,s46,v104
s_cbranch_vccnz L_rs29
L_rr29:
v_add_f32 v92,v92,v95
v_add_f32 v93,v93,v96
v_add_f32 v94,v94,v97
L_st103:
MF a[0:3],a[216:219],v[60:63],a[0:3]
TR a[232:233],v218,49280
TR a[234:235],v218,55424
MF a[4:7],a[216:219],v[64:67],a[4:7]
TR a[236:237],v219,49280
TR a[238:239],v219,55424
MF a[8:11],a[216:219],v[68:71],a[8:11]
v_add_u32 v226,24576,v226
v_add_u32 v227,24576,v227
MF a[12:15],a[220:223],v[60:63],a[12:15]
v_mov_b32 v101,v92
v_mov_b32 v102,v93
MF a[16:19],a[220:223],v[64:67],a[16:19]
buffer_load_dwordx4 v240,s[20:23],s35 offen offset:1024 lds
MF a[20:23],a[220:223],v[68:71],a[20:23]
s_waitcnt lgkmcnt(4)
v_mov_b32 v103,v94
v_permlane32_swap_b32 v92,v101
MF a[24:27],a[224:227],v[60:63],a[24:27]
TR a[216:217],v220,49280
TR a[218:219],v220,55424
MF a[28:31],a[224:227],v[64:67],a[28:31]
TR a[220:221],v221,49280
TR a[222:223],v221,55424
MF a[32:35],a[224:227],v[68:71],a[32:35]
v_permlane32_swap_b32 v93,v102
v_permlane32_swap_b32 v94,v103
MF a[36:39],a[228:231],v[60:63],a[36:39]
v_add_f32 v92,v92,v101
v_add_f32 v93,v93,v102
MF a[40:43],a[228:231],v[64:67],a[40:43]
v_add_f32 v94,v94,v103
v_mov_b32 v101,v92
MF a[44:47],a[228:231],v[68:71],a[44:47]
s_waitcnt lgkmcnt(4)
v_mov_b32 v102,v93
v_mov_b32 v103,v94
MF a[48:51],a[232:235],v[60:63],a[48:51]
TR a[224:225],v218,49408
TR a[226:227],v218,55552
MF a[52:55],a[232:235],v[64:67],a[52:55]
TR a[228:229],v219,49408
TR a[230:231],v219,55552
MF a[56:59],a[232:235],v[68:71],a[56:59]
v_permlane16_swap_b32 v92,v101
v_permlane16_swap_b32 v93,v102
MF a[60:63],a[236:239],v[60:63],a[60:63]
v_permlane16_swap_b32 v94,v103
v_add_f32 v92,v92,v101
MF a[64:67],a[236:239],v[64:67],a[64:67]
buffer_load_dwordx4 v241,s[20:23],s35 offen offset:2048 lds
MF a[68:71],a[236:239],v[68:71],a[68:71]
s_waitcnt lgkmcnt(4)
v_rcp_f32 v106,v92
MF a[72:75],a[216:219],v[60:63],a[72:75]
TR a[232:233],v220,49408
TR a[234:235],v220,55552
MF a[76:79],a[216:219],v[64:67],a[76:79]
TR a[236:237],v221,49408
TR a[238:239],v221,55552
MF a[80:83],a[216:219],v[68:71],a[80:83]
v_add_f32 v93,v93,v102
v_add_f32 v94,v94,v103
MF a[84:87],a[220:223],v[60:63],a[84:87]
v_rcp_f32 v107,v93
MF a[88:91],a[220:223],v[64:67],a[88:91]
v_rcp_f32 v108,v94
MF a[92:95],a[220:223],v[68:71],a[92:95]
s_waitcnt vmcnt(28) lgkmcnt(4)
s_barrier
MF a[96:99],a[224:227],v[60:63],a[96:99]
TR a[216:217],v226,0
MF a[100:103],a[224:227],v[64:67],a[100:103]
TR a[218:219],v226,6144
MF a[104:107],a[224:227],v[68:71],a[104:107]
s_add_u32 m0,s32,12288
TR a[220:221],v227,0
MF a[108:111],a[228:231],v[60:63],a[108:111]
s_add_u32 s36,s76,286720
TR a[222:223],v227,6144
MF a[112:115],a[228:231],v[64:67],a[112:115]
buffer_load_dwordx4 v239,s[20:23],s36 offen offset:0 lds
MF a[116:119],a[228:231],v[68:71],a[116:119]
s_waitcnt lgkmcnt(4)
MF a[120:123],a[232:235],v[60:63],a[120:123]
TR a[224:225],v226,64
MF a[124:127],a[232:235],v[64:67],a[124:127]
TR a[226:227],v226,6208
MF a[128:131],a[232:235],v[68:71],a[128:131]
TR a[228:229],v227,64
MF a[132:135],a[236:239],v[60:63],a[132:135]
TR a[230:231],v227,6208
MF a[136:139],a[236:239],v[64:67],a[136:139]
MF a[140:143],a[236:239],v[68:71],a[140:143]
s_waitcnt lgkmcnt(4)
v_mov_b32 v112,v106
v_mov_b32 v113,v106
v_mov_b32 v114,v107
v_mov_b32 v115,v107
v_mov_b32 v116,v108
v_mov_b32 v117,v108
s_mov_b32 s12,s18
s_and_b32 s13,s19,65535
s_mov_b32 s14,3932160
s_mov_b32 s15,131072
s_add_u32 s85,s83,73728
v_accvgpr_read_b32 v0,a0
v_accvgpr_read_b32 v1,a1
v_accvgpr_read_b32 v2,a2
v_accvgpr_read_b32 v3,a3
v_accvgpr_read_b32 v4,a12
v_accvgpr_read_b32 v5,a13
v_accvgpr_read_b32 v6,a14
v_accvgpr_read_b32 v7,a15
v_accvgpr_read_b32 v8,a4
v_accvgpr_read_b32 v9,a5
v_accvgpr_read_b32 v10,a6
v_accvgpr_read_b32 v11,a7
v_accvgpr_read_b32 v12,a16
v_accvgpr_read_b32 v13,a17
v_accvgpr_read_b32 v14,a18
v_accvgpr_read_b32 v15,a19
v_accvgpr_read_b32 v16,a8
v_accvgpr_read_b32 v17,a9
v_accvgpr_read_b32 v18,a10
v_accvgpr_read_b32 v19,a11
v_accvgpr_read_b32 v20,a20
v_accvgpr_read_b32 v21,a21
v_accvgpr_read_b32 v22,a22
v_accvgpr_read_b32 v23,a23
v_pk_mul_f32 v[0:1],v[0:1],v[112:113]
v_pk_mul_f32 v[2:3],v[2:3],v[112:113]
v_pk_mul_f32 v[4:5],v[4:5],v[112:113]
v_pk_mul_f32 v[6:7],v[6:7],v[112:113]
v_pk_mul_f32 v[8:9],v[8:9],v[114:115]
v_pk_mul_f32 v[10:11],v[10:11],v[114:115]
v_pk_mul_f32 v[12:13],v[12:13],v[114:115]
v_pk_mul_f32 v[14:15],v[14:15],v[114:115]
v_pk_mul_f32 v[16:17],v[16:17],v[116:117]
v_pk_mul_f32 v[18:19],v[18:19],v[116:117]
v_pk_mul_f32 v[20:21],v[20:21],v[116:117]
v_pk_mul_f32 v[22:23],v[22:23],v[116:117]
v_cvt_pk_bf16_f32 v144,v0,v1
v_cvt_pk_bf16_f32 v145,v2,v3
v_cvt_pk_bf16_f32 v146,v4,v5
v_cvt_pk_bf16_f32 v147,v6,v7
v_cvt_pk_bf16_f32 v148,v8,v9
v_cvt_pk_bf16_f32 v149,v10,v11
v_cvt_pk_bf16_f32 v150,v12,v13
v_cvt_pk_bf16_f32 v151,v14,v15
v_cvt_pk_bf16_f32 v152,v16,v17
v_cvt_pk_bf16_f32 v153,v18,v19
v_cvt_pk_bf16_f32 v154,v20,v21
v_cvt_pk_bf16_f32 v155,v22,v23
buffer_store_dwordx4 v[144:147],v246,s[24:27],s85 offen offset:0 sc1
buffer_store_dwordx4 v[148:151],v246,s[24:27],s85 offen offset:1024 sc1
buffer_store_dwordx4 v[152:155],v246,s[24:27],s85 offen offset:2048 sc1
s_add_u32 s85,s85,3072
v_accvgpr_read_b32 v0,a24
v_accvgpr_read_b32 v1,a25
v_accvgpr_read_b32 v2,a26
v_accvgpr_read_b32 v3,a27
v_accvgpr_read_b32 v4,a36
v_accvgpr_read_b32 v5,a37
v_accvgpr_read_b32 v6,a38
v_accvgpr_read_b32 v7,a39
v_accvgpr_read_b32 v8,a28
v_accvgpr_read_b32 v9,a29
v_accvgpr_read_b32 v10,a30
v_accvgpr_read_b32 v11,a31
v_accvgpr_read_b32 v12,a40
v_accvgpr_read_b32 v13,a41
v_accvgpr_read_b32 v14,a42
v_accvgpr_read_b32 v15,a43
v_accvgpr_read_b32 v16,a32
v_accvgpr_read_b32 v17,a33
v_accvgpr_read_b32 v18,a34
v_accvgpr_read_b32 v19,a35
v_accvgpr_read_b32 v20,a44
v_accvgpr_read_b32 v21,a45
v_accvgpr_read_b32 v22,a46
v_accvgpr_read_b32 v23,a47
v_pk_mul_f32 v[0:1],v[0:1],v[112:113]
v_pk_mul_f32 v[2:3],v[2:3],v[112:113]
v_pk_mul_f32 v[4:5],v[4:5],v[112:113]
v_pk_mul_f32 v[6:7],v[6:7],v[112:113]
v_pk_mul_f32 v[8:9],v[8:9],v[114:115]
v_pk_mul_f32 v[10:11],v[10:11],v[114:115]
v_pk_mul_f32 v[12:13],v[12:13],v[114:115]
v_pk_mul_f32 v[14:15],v[14:15],v[114:115]
v_pk_mul_f32 v[16:17],v[16:17],v[116:117]
v_pk_mul_f32 v[18:19],v[18:19],v[116:117]
v_pk_mul_f32 v[20:21],v[20:21],v[116:117]
v_pk_mul_f32 v[22:23],v[22:23],v[116:117]
v_cvt_pk_bf16_f32 v156,v0,v1
v_cvt_pk_bf16_f32 v157,v2,v3
v_cvt_pk_bf16_f32 v158,v4,v5
v_cvt_pk_bf16_f32 v159,v6,v7
v_cvt_pk_bf16_f32 v160,v8,v9
v_cvt_pk_bf16_f32 v161,v10,v11
v_cvt_pk_bf16_f32 v162,v12,v13
v_cvt_pk_bf16_f32 v163,v14,v15
v_cvt_pk_bf16_f32 v164,v16,v17
v_cvt_pk_bf16_f32 v165,v18,v19
v_cvt_pk_bf16_f32 v166,v20,v21
v_cvt_pk_bf16_f32 v167,v22,v23
buffer_store_dwordx4 v[156:159],v246,s[24:27],s85 offen offset:0 sc1
buffer_store_dwordx4 v[160:163],v246,s[24:27],s85 offen offset:1024 sc1
buffer_store_dwordx4 v[164:167],v246,s[24:27],s85 offen offset:2048 sc1
s_add_u32 s85,s85,3072
v_accvgpr_read_b32 v0,a48
v_accvgpr_read_b32 v1,a49
v_accvgpr_read_b32 v2,a50
v_accvgpr_read_b32 v3,a51
v_accvgpr_read_b32 v4,a60
v_accvgpr_read_b32 v5,a61
v_accvgpr_read_b32 v6,a62
v_accvgpr_read_b32 v7,a63
v_accvgpr_read_b32 v8,a52
v_accvgpr_read_b32 v9,a53
v_accvgpr_read_b32 v10,a54
v_accvgpr_read_b32 v11,a55
v_accvgpr_read_b32 v12,a64
v_accvgpr_read_b32 v13,a65
v_accvgpr_read_b32 v14,a66
v_accvgpr_read_b32 v15,a67
v_accvgpr_read_b32 v16,a56
v_accvgpr_read_b32 v17,a57
v_accvgpr_read_b32 v18,a58
v_accvgpr_read_b32 v19,a59
v_accvgpr_read_b32 v20,a68
v_accvgpr_read_b32 v21,a69
v_accvgpr_read_b32 v22,a70
v_accvgpr_read_b32 v23,a71
v_pk_mul_f32 v[0:1],v[0:1],v[112:113]
v_pk_mul_f32 v[2:3],v[2:3],v[112:113]
v_pk_mul_f32 v[4:5],v[4:5],v[112:113]
v_pk_mul_f32 v[6:7],v[6:7],v[112:113]
v_pk_mul_f32 v[8:9],v[8:9],v[114:115]
v_pk_mul_f32 v[10:11],v[10:11],v[114:115]
v_pk_mul_f32 v[12:13],v[12:13],v[114:115]
v_pk_mul_f32 v[14:15],v[14:15],v[114:115]
v_pk_mul_f32 v[16:17],v[16:17],v[116:117]
v_pk_mul_f32 v[18:19],v[18:19],v[116:117]
v_pk_mul_f32 v[20:21],v[20:21],v[116:117]
v_pk_mul_f32 v[22:23],v[22:23],v[116:117]
v_cvt_pk_bf16_f32 v168,v0,v1
v_cvt_pk_bf16_f32 v169,v2,v3
v_cvt_pk_bf16_f32 v170,v4,v5
v_cvt_pk_bf16_f32 v171,v6,v7
v_cvt_pk_bf16_f32 v172,v8,v9
v_cvt_pk_bf16_f32 v173,v10,v11
v_cvt_pk_bf16_f32 v174,v12,v13
v_cvt_pk_bf16_f32 v175,v14,v15
v_cvt_pk_bf16_f32 v176,v16,v17
v_cvt_pk_bf16_f32 v177,v18,v19
v_cvt_pk_bf16_f32 v178,v20,v21
v_cvt_pk_bf16_f32 v179,v22,v23
buffer_store_dwordx4 v[168:171],v246,s[24:27],s85 offen offset:0 sc1
buffer_store_dwordx4 v[172:175],v246,s[24:27],s85 offen offset:1024 sc1
buffer_store_dwordx4 v[176:179],v246,s[24:27],s85 offen offset:2048 sc1
s_add_u32 s85,s85,3072
v_accvgpr_read_b32 v0,a72
v_accvgpr_read_b32 v1,a73
v_accvgpr_read_b32 v2,a74
v_accvgpr_read_b32 v3,a75
v_accvgpr_read_b32 v4,a84
v_accvgpr_read_b32 v5,a85
v_accvgpr_read_b32 v6,a86
v_accvgpr_read_b32 v7,a87
v_accvgpr_read_b32 v8,a76
v_accvgpr_read_b32 v9,a77
v_accvgpr_read_b32 v10,a78
v_accvgpr_read_b32 v11,a79
v_accvgpr_read_b32 v12,a88
v_accvgpr_read_b32 v13,a89
v_accvgpr_read_b32 v14,a90
v_accvgpr_read_b32 v15,a91
v_accvgpr_read_b32 v16,a80
v_accvgpr_read_b32 v17,a81
v_accvgpr_read_b32 v18,a82
v_accvgpr_read_b32 v19,a83
v_accvgpr_read_b32 v20,a92
v_accvgpr_read_b32 v21,a93
v_accvgpr_read_b32 v22,a94
v_accvgpr_read_b32 v23,a95
v_pk_mul_f32 v[0:1],v[0:1],v[112:113]
v_pk_mul_f32 v[2:3],v[2:3],v[112:113]
v_pk_mul_f32 v[4:5],v[4:5],v[112:113]
v_pk_mul_f32 v[6:7],v[6:7],v[112:113]
v_pk_mul_f32 v[8:9],v[8:9],v[114:115]
v_pk_mul_f32 v[10:11],v[10:11],v[114:115]
v_pk_mul_f32 v[12:13],v[12:13],v[114:115]
v_pk_mul_f32 v[14:15],v[14:15],v[114:115]
v_pk_mul_f32 v[16:17],v[16:17],v[116:117]
v_pk_mul_f32 v[18:19],v[18:19],v[116:117]
v_pk_mul_f32 v[20:21],v[20:21],v[116:117]
v_pk_mul_f32 v[22:23],v[22:23],v[116:117]
v_cvt_pk_bf16_f32 v180,v0,v1
v_cvt_pk_bf16_f32 v181,v2,v3
v_cvt_pk_bf16_f32 v182,v4,v5
v_cvt_pk_bf16_f32 v183,v6,v7
v_cvt_pk_bf16_f32 v184,v8,v9
v_cvt_pk_bf16_f32 v185,v10,v11
v_cvt_pk_bf16_f32 v186,v12,v13
v_cvt_pk_bf16_f32 v187,v14,v15
v_cvt_pk_bf16_f32 v188,v16,v17
v_cvt_pk_bf16_f32 v189,v18,v19
v_cvt_pk_bf16_f32 v190,v20,v21
v_cvt_pk_bf16_f32 v191,v22,v23
buffer_store_dwordx4 v[180:183],v246,s[24:27],s85 offen offset:0 sc1
buffer_store_dwordx4 v[184:187],v246,s[24:27],s85 offen offset:1024 sc1
buffer_store_dwordx4 v[188:191],v246,s[24:27],s85 offen offset:2048 sc1
s_add_u32 s85,s85,3072
v_accvgpr_read_b32 v0,a96
v_accvgpr_read_b32 v1,a97
v_accvgpr_read_b32 v2,a98
v_accvgpr_read_b32 v3,a99
v_accvgpr_read_b32 v4,a108
v_accvgpr_read_b32 v5,a109
v_accvgpr_read_b32 v6,a110
v_accvgpr_read_b32 v7,a111
v_accvgpr_read_b32 v8,a100
v_accvgpr_read_b32 v9,a101
v_accvgpr_read_b32 v10,a102
v_accvgpr_read_b32 v11,a103
v_accvgpr_read_b32 v12,a112
v_accvgpr_read_b32 v13,a113
v_accvgpr_read_b32 v14,a114
v_accvgpr_read_b32 v15,a115
v_accvgpr_read_b32 v16,a104
v_accvgpr_read_b32 v17,a105
v_accvgpr_read_b32 v18,a106
v_accvgpr_read_b32 v19,a107
v_accvgpr_read_b32 v20,a116
v_accvgpr_read_b32 v21,a117
v_accvgpr_read_b32 v22,a118
v_accvgpr_read_b32 v23,a119
v_pk_mul_f32 v[0:1],v[0:1],v[112:113]
v_pk_mul_f32 v[2:3],v[2:3],v[112:113]
v_pk_mul_f32 v[4:5],v[4:5],v[112:113]
v_pk_mul_f32 v[6:7],v[6:7],v[112:113]
v_pk_mul_f32 v[8:9],v[8:9],v[114:115]
v_pk_mul_f32 v[10:11],v[10:11],v[114:115]
v_pk_mul_f32 v[12:13],v[12:13],v[114:115]
v_pk_mul_f32 v[14:15],v[14:15],v[114:115]
v_pk_mul_f32 v[16:17],v[16:17],v[116:117]
v_pk_mul_f32 v[18:19],v[18:19],v[116:117]
v_pk_mul_f32 v[20:21],v[20:21],v[116:117]
v_pk_mul_f32 v[22:23],v[22:23],v[116:117]
v_cvt_pk_bf16_f32 v192,v0,v1
v_cvt_pk_bf16_f32 v193,v2,v3
v_cvt_pk_bf16_f32 v194,v4,v5
v_cvt_pk_bf16_f32 v195,v6,v7
v_cvt_pk_bf16_f32 v196,v8,v9
v_cvt_pk_bf16_f32 v197,v10,v11
v_cvt_pk_bf16_f32 v198,v12,v13
v_cvt_pk_bf16_f32 v199,v14,v15
v_cvt_pk_bf16_f32 v200,v16,v17
v_cvt_pk_bf16_f32 v201,v18,v19
v_cvt_pk_bf16_f32 v202,v20,v21
v_cvt_pk_bf16_f32 v203,v22,v23
buffer_store_dwordx4 v[192:195],v246,s[24:27],s85 offen offset:0 sc1
buffer_store_dwordx4 v[196:199],v246,s[24:27],s85 offen offset:1024 sc1
buffer_store_dwordx4 v[200:203],v246,s[24:27],s85 offen offset:2048 sc1
s_add_u32 s85,s85,3072
v_accvgpr_read_b32 v0,a120
v_accvgpr_read_b32 v1,a121
v_accvgpr_read_b32 v2,a122
v_accvgpr_read_b32 v3,a123
v_accvgpr_read_b32 v4,a132
v_accvgpr_read_b32 v5,a133
v_accvgpr_read_b32 v6,a134
v_accvgpr_read_b32 v7,a135
v_accvgpr_read_b32 v8,a124
v_accvgpr_read_b32 v9,a125
v_accvgpr_read_b32 v10,a126
v_accvgpr_read_b32 v11,a127
v_accvgpr_read_b32 v12,a136
v_accvgpr_read_b32 v13,a137
v_accvgpr_read_b32 v14,a138
v_accvgpr_read_b32 v15,a139
v_accvgpr_read_b32 v16,a128
v_accvgpr_read_b32 v17,a129
v_accvgpr_read_b32 v18,a130
v_accvgpr_read_b32 v19,a131
v_accvgpr_read_b32 v20,a140
v_accvgpr_read_b32 v21,a141
v_accvgpr_read_b32 v22,a142
v_accvgpr_read_b32 v23,a143
v_pk_mul_f32 v[0:1],v[0:1],v[112:113]
v_pk_mul_f32 v[2:3],v[2:3],v[112:113]
v_pk_mul_f32 v[4:5],v[4:5],v[112:113]
v_pk_mul_f32 v[6:7],v[6:7],v[112:113]
v_pk_mul_f32 v[8:9],v[8:9],v[114:115]
v_pk_mul_f32 v[10:11],v[10:11],v[114:115]
v_pk_mul_f32 v[12:13],v[12:13],v[114:115]
v_pk_mul_f32 v[14:15],v[14:15],v[114:115]
v_pk_mul_f32 v[16:17],v[16:17],v[116:117]
v_pk_mul_f32 v[18:19],v[18:19],v[116:117]
v_pk_mul_f32 v[20:21],v[20:21],v[116:117]
v_pk_mul_f32 v[22:23],v[22:23],v[116:117]
v_cvt_pk_bf16_f32 v204,v0,v1
v_cvt_pk_bf16_f32 v205,v2,v3
v_cvt_pk_bf16_f32 v206,v4,v5
v_cvt_pk_bf16_f32 v207,v6,v7
v_cvt_pk_bf16_f32 v208,v8,v9
v_cvt_pk_bf16_f32 v209,v10,v11
v_cvt_pk_bf16_f32 v210,v12,v13
v_cvt_pk_bf16_f32 v211,v14,v15
v_cvt_pk_bf16_f32 v212,v16,v17
v_cvt_pk_bf16_f32 v213,v18,v19
v_cvt_pk_bf16_f32 v214,v20,v21
v_cvt_pk_bf16_f32 v215,v22,v23
buffer_store_dwordx4 v[204:207],v246,s[24:27],s85 offen offset:0 sc1
buffer_store_dwordx4 v[208:211],v246,s[24:27],s85 offen offset:1024 sc1
buffer_store_dwordx4 v[212:215],v246,s[24:27],s85 offen offset:2048 sc1
L_st104:
MF v[0:3],a[216:219],a[144:147],0
TR a[232:233],v226,128
MF v[4:7],a[216:219],a[148:151],0
TR a[234:235],v226,6272
MF v[8:11],a[216:219],a[152:155],0
TR a[236:237],v227,128
v_add_u32 v228,36864,v228
MF v[12:15],a[220:223],a[144:147],0
TR a[238:239],v227,6272
v_add_u32 v229,36864,v229
MF v[16:19],a[220:223],a[148:151],0
buffer_load_dwordx4 v240,s[20:23],s36 offen offset:1024 lds
MF v[20:23],a[220:223],a[152:155],0
s_waitcnt lgkmcnt(4)
MF v[24:27],a[224:227],a[144:147],0
TR a[216:217],v226,192
MF v[28:31],a[224:227],a[148:151],0
TR a[218:219],v226,6336
MF v[32:35],a[224:227],a[152:155],0
TR a[220:221],v227,192
MF v[36:39],a[228:231],a[144:147],0
TR a[222:223],v227,6336
MF v[40:43],a[228:231],a[148:151],0
buffer_load_dwordx4 v241,s[20:23],s36 offen offset:2048 lds
MF v[44:47],a[228:231],a[152:155],0
s_waitcnt lgkmcnt(4)
MF v[48:51],a[232:235],a[144:147],0
TR a[224:225],v226,256
MF v[52:55],a[232:235],a[148:151],0
TR a[226:227],v226,6400
MF v[56:59],a[232:235],a[152:155],0
TR a[228:229],v227,256
MF v[60:63],a[236:239],a[144:147],0
TR a[230:231],v227,6400
MF v[64:67],a[236:239],a[148:151],0
MF v[68:71],a[236:239],a[152:155],0
s_waitcnt vmcnt(44) lgkmcnt(4)
s_barrier
MF v[72:75],a[216:219],a[144:147],0
TR a[232:233],v228,0
MF v[76:79],a[216:219],a[148:151],0
TR a[234:235],v228,6144
MF v[80:83],a[216:219],a[152:155],0
s_add_u32 m0,s32,61440
TR a[236:237],v229,0
MF v[84:87],a[220:223],a[144:147],0
s_add_u32 s35,s76,327680
TR a[238:239],v229,6144
MF v[88:91],a[220:223],a[148:151],0
buffer_load_dwordx4 v239,s[20:23],s35 offen offset:0 lds
MF v[92:95],a[220:223],a[152:155],0
s_waitcnt lgkmcnt(4)
MF v[96:99],a[224:227],a[144:147],0
TR a[216:217],v228,64
MF v[100:103],a[224:227],a[148:151],0
TR a[218:219],v228,6208
MF v[104:107],a[224:227],a[152:155],0
TR a[220:221],v229,64
MF v[108:111],a[228:231],a[144:147],0
TR a[222:223],v229,6208
MF v[112:115],a[228:231],a[148:151],0
MF v[116:119],a[228:231],a[152:155],0
s_waitcnt lgkmcnt(4)
L_st105:
MF v[0:3],a[232:235],a[156:159],v[0:3]
TR a[224:225],v228,128
v_and_b32 v126,63,v244
MF v[4:7],a[232:235],a[160:163],v[4:7]
TR a[226:227],v228,6272
v_lshrrev_b32 v137,4,v126
MF v[8:11],a[232:235],a[164:167],v[8:11]
TR a[228:229],v229,128
v_and_b32 v138,15,v126
MF v[12:15],a[236:239],a[156:159],v[12:15]
TR a[230:231],v229,6272
v_mul_u32_u24 v139,1280,v138
MF v[16:19],a[236:239],a[160:163],v[16:19]
buffer_load_dwordx4 v240,s[20:23],s35 offen offset:1024 lds
MF v[20:23],a[236:239],a[164:167],v[20:23]
s_waitcnt lgkmcnt(4)
v_lshlrev_b32 v124,4,v137
v_add_u32 v142,v139,v124
MF v[24:27],a[216:219],a[156:159],v[24:27]
TR a[232:233],v228,192
v_lshlrev_b32 v143,4,v126
MF v[28:31],a[216:219],a[160:163],v[28:31]
TR a[234:235],v228,6336
v_lshrrev_b32 v139,2,v138
MF v[32:35],a[216:219],a[164:167],v[32:35]
TR a[236:237],v229,192
v_and_b32 v124,1,v139
MF v[36:39],a[220:223],a[156:159],v[36:39]
TR a[238:239],v229,6336
v_lshlrev_b32 v124,4,v124
MF v[40:43],a[220:223],a[160:163],v[40:43]
buffer_load_dwordx4 v241,s[20:23],s35 offen offset:2048 lds
MF v[44:47],a[220:223],a[164:167],v[44:47]
s_waitcnt lgkmcnt(4)
v_lshrrev_b32 v139,1,v139
v_lshlrev_b32 v139,2,v139
MF v[48:51],a[224:227],a[156:159],v[48:51]
TR a[216:217],v228,256
v_add_u32 v124,v124,v139
MF v[52:55],a[224:227],a[160:163],v[52:55]
TR a[218:219],v228,6400
v_and_b32 v139,3,v138
MF v[56:59],a[224:227],a[164:167],v[56:59]
TR a[220:221],v229,256
v_add_u32 v124,v124,v139
MF v[60:63],a[228:231],a[156:159],v[60:63]
TR a[222:223],v229,6400
v_lshlrev_b32 v139,3,v137
MF v[64:67],a[228:231],a[160:163],v[64:67]
v_sub_u32 v125,v124,v139
v_and_b32 v139,1,v125
MF v[68:71],a[228:231],a[164:167],v[68:71]
s_waitcnt vmcnt(42) lgkmcnt(4)
s_barrier
v_lshlrev_b32 v139,4,v139
MF v[72:75],a[232:235],a[156:159],v[72:75]
TR a[224:225],v226,24576
v_mov_b32 v124,16256
MF v[76:79],a[232:235],a[160:163],v[76:79]
TR a[226:227],v226,30720
v_lshlrev_b32 v124,v139,v124
MF v[80:83],a[232:235],a[164:167],v[80:83]
s_add_u32 m0,s32,24576
TR a[228:229],v227,24576
v_lshrrev_b32 v139,1,v125
MF v[84:87],a[236:239],a[156:159],v[84:87]
s_add_u32 s36,s76,368640
TR a[230:231],v227,30720
v_cmp_eq_u32 vcc,0,v139
MF v[88:91],a[236:239],a[160:163],v[88:91]
buffer_load_dwordx4 v239,s[20:23],s36 offen offset:0 lds
MF v[92:95],a[236:239],a[164:167],v[92:95]
s_waitcnt lgkmcnt(4)
v_cndmask_b32 v128,0,v124,vcc
v_cmp_eq_u32 vcc,1,v139
MF v[96:99],a[216:219],a[156:159],v[96:99]
TR a[232:233],v226,24640
MF v[100:103],a[216:219],a[160:163],v[100:103]
TR a[234:235],v226,30784
v_cndmask_b32 v129,0,v124,vcc
MF v[104:107],a[216:219],a[164:167],v[104:107]
TR a[236:237],v227,24640
v_cmp_eq_u32 vcc,2,v139
MF v[108:111],a[220:223],a[156:159],v[108:111]
TR a[238:239],v227,30784
MF v[112:115],a[220:223],a[160:163],v[112:115]
v_cndmask_b32 v130,0,v124,vcc
v_cmp_eq_u32 vcc,3,v139
MF v[116:119],a[220:223],a[164:167],v[116:119]
s_waitcnt lgkmcnt(4)
L_st106:
MF v[0:3],a[224:227],a[168:171],v[0:3]
TR a[216:217],v226,24704
v_cndmask_b32 v131,0,v124,vcc
MF v[4:7],a[224:227],a[172:175],v[4:7]
TR a[218:219],v226,30848
v_add_u32 v125,8,v125
MF v[8:11],a[224:227],a[176:179],v[8:11]
TR a[220:221],v227,24704
v_and_b32 v139,1,v125
MF v[12:15],a[228:231],a[168:171],v[12:15]
TR a[222:223],v227,30848
v_lshlrev_b32 v139,4,v139
MF v[16:19],a[228:231],a[172:175],v[16:19]
buffer_load_dwordx4 v240,s[20:23],s36 offen offset:1024 lds
MF v[20:23],a[228:231],a[176:179],v[20:23]
s_waitcnt lgkmcnt(4)
v_mov_b32 v124,16256
v_lshlrev_b32 v124,v139,v124
MF v[24:27],a[232:235],a[168:171],v[24:27]
TR a[224:225],v226,24768
v_lshrrev_b32 v139,1,v125
MF v[28:31],a[232:235],a[172:175],v[28:31]
TR a[226:227],v226,30912
v_cmp_eq_u32 vcc,0,v139
MF v[32:35],a[232:235],a[176:179],v[32:35]
TR a[228:229],v227,24768
MF v[36:39],a[236:239],a[168:171],v[36:39]
TR a[230:231],v227,30912
v_cndmask_b32 v132,0,v124,vcc
MF v[40:43],a[236:239],a[172:175],v[40:43]
buffer_load_dwordx4 v241,s[20:23],s36 offen offset:2048 lds
MF v[44:47],a[236:239],a[176:179],v[44:47]
s_waitcnt lgkmcnt(4)
v_cmp_eq_u32 vcc,1,v139
MF v[48:51],a[216:219],a[168:171],v[48:51]
TR a[232:233],v226,24832
MF v[52:55],a[216:219],a[172:175],v[52:55]
TR a[234:235],v226,30976
v_cndmask_b32 v133,0,v124,vcc
MF v[56:59],a[216:219],a[176:179],v[56:59]
TR a[236:237],v227,24832
v_cmp_eq_u32 vcc,2,v139
MF v[60:63],a[220:223],a[168:171],v[60:63]
TR a[238:239],v227,30976
MF v[64:67],a[220:223],a[172:175],v[64:67]
v_cndmask_b32 v134,0,v124,vcc
v_cmp_eq_u32 vcc,3,v139
MF v[68:71],a[220:223],a[176:179],v[68:71]
s_waitcnt vmcnt(40) lgkmcnt(4)
s_barrier
MF v[72:75],a[224:227],a[168:171],v[72:75]
TR a[216:217],v228,36864
v_cndmask_b32 v135,0,v124,vcc
MF v[76:79],a[224:227],a[172:175],v[76:79]
TR a[218:219],v228,43008
MF v[80:83],a[224:227],a[176:179],v[80:83]
s_add_u32 m0,s32,36864
TR a[220:221],v229,36864
MF v[84:87],a[228:231],a[168:171],v[84:87]
s_add_u32 s35,s76,409600
TR a[222:223],v229,43008
MF v[88:91],a[228:231],a[172:175],v[88:91]
buffer_load_dwordx4 v239,s[20:23],s35 offen offset:0 lds
MF v[92:95],a[228:231],a[176:179],v[92:95]
s_waitcnt lgkmcnt(4)
MF v[96:99],a[232:235],a[168:171],v[96:99]
TR a[224:225],v228,36928
MF v[100:103],a[232:235],a[172:175],v[100:103]
TR a[226:227],v228,43072
MF v[104:107],a[232:235],a[176:179],v[104:107]
TR a[228:229],v229,36928
MF v[108:111],a[236:239],a[168:171],v[108:111]
TR a[230:231],v229,43072
MF v[112:115],a[236:239],a[172:175],v[112:115]
MF v[116:119],a[236:239],a[176:179],v[116:119]
s_waitcnt lgkmcnt(4)
L_st107:
MF v[0:3],a[216:219],a[180:183],v[0:3]
TR a[232:233],v228,36992
MF v[4:7],a[216:219],a[184:187],v[4:7]
TR a[234:235],v228,43136
MF v[8:11],a[216:219],a[188:191],v[8:11]
TR a[236:237],v229,36992
v_add_u32 v226,61440,v226
MF v[12:15],a[220:223],a[180:183],v[12:15]
TR a[238:239],v229,43136
v_add_u32 v227,61440,v227
MF v[16:19],a[220:223],a[184:187],v[16:19]
buffer_load_dwordx4 v240,s[20:23],s35 offen offset:1024 lds
MF v[20:23],a[220:223],a[188:191],v[20:23]
s_waitcnt lgkmcnt(4)
MF v[24:27],a[224:227],a[180:183],v[24:27]
TR a[216:217],v228,37056
MF v[28:31],a[224:227],a[184:187],v[28:31]
TR a[218:219],v228,43200
MF v[32:35],a[224:227],a[188:191],v[32:35]
TR a[220:221],v229,37056
MF v[36:39],a[228:231],a[180:183],v[36:39]
TR a[222:223],v229,43200
MF v[40:43],a[228:231],a[184:187],v[40:43]
buffer_load_dwordx4 v241,s[20:23],s35 offen offset:2048 lds
MF v[44:47],a[228:231],a[188:191],v[44:47]
s_waitcnt lgkmcnt(4)
MF v[48:51],a[232:235],a[180:183],v[48:51]
TR a[224:225],v228,37120
MF v[52:55],a[232:235],a[184:187],v[52:55]
TR a[226:227],v228,43264
MF v[56:59],a[232:235],a[188:191],v[56:59]
TR a[228:229],v229,37120
MF v[60:63],a[236:239],a[180:183],v[60:63]
TR a[230:231],v229,43264
MF v[64:67],a[236:239],a[184:187],v[64:67]
MF v[68:71],a[236:239],a[188:191],v[68:71]
s_waitcnt vmcnt(11) lgkmcnt(4)
s_barrier
MF v[72:75],a[216:219],a[180:183],v[72:75]
TR a[232:233],v226,0
v_mov_b32 v141,2
MF v[76:79],a[216:219],a[184:187],v[76:79]
TR a[234:235],v226,6144
MF v[80:83],a[216:219],a[188:191],v[80:83]
s_add_u32 m0,s32,49152
TR a[236:237],v227,0
MF v[84:87],a[220:223],a[180:183],v[84:87]
s_add_u32 s36,s76,450560
TR a[238:239],v227,6144
MF v[88:91],a[220:223],a[184:187],v[88:91]
buffer_load_dwordx4 v239,s[20:23],s36 offen offset:0 lds
MF v[92:95],a[220:223],a[188:191],v[92:95]
s_waitcnt lgkmcnt(4)
buffer_store_dword v141,v250,s[24:27],s59 offen offset:0 sc1
MF v[96:99],a[224:227],a[180:183],v[96:99]
TR a[216:217],v226,64
MF v[100:103],a[224:227],a[184:187],v[100:103]
TR a[218:219],v226,6208
MF v[104:107],a[224:227],a[188:191],v[104:107]
TR a[220:221],v227,64
MF v[108:111],a[228:231],a[180:183],v[108:111]
TR a[222:223],v227,6208
MF v[112:115],a[228:231],a[184:187],v[112:115]
MF v[116:119],a[228:231],a[188:191],v[116:119]
s_waitcnt lgkmcnt(4)
L_st108:
MF v[0:3],a[232:235],a[192:195],v[0:3]
TR a[224:225],v226,128
MF v[4:7],a[232:235],a[196:199],v[4:7]
TR a[226:227],v226,6272
MF v[8:11],a[232:235],a[200:203],v[8:11]
TR a[228:229],v227,128
v_add_u32 v228,61440,v228
MF v[12:15],a[236:239],a[192:195],v[12:15]
TR a[230:231],v227,6272
v_add_u32 v229,61440,v229
MF v[16:19],a[236:239],a[196:199],v[16:19]
buffer_load_dwordx4 v240,s[20:23],s36 offen offset:1024 lds
MF v[20:23],a[236:239],a[200:203],v[20:23]
s_waitcnt lgkmcnt(4)
MF v[24:27],a[216:219],a[192:195],v[24:27]
TR a[232:233],v226,192
MF v[28:31],a[216:219],a[196:199],v[28:31]
TR a[234:235],v226,6336
MF v[32:35],a[216:219],a[200:203],v[32:35]
TR a[236:237],v227,192
MF v[36:39],a[220:223],a[192:195],v[36:39]
TR a[238:239],v227,6336
MF v[40:43],a[220:223],a[196:199],v[40:43]
buffer_load_dwordx4 v241,s[20:23],s36 offen offset:2048 lds
MF v[44:47],a[220:223],a[200:203],v[44:47]
s_waitcnt lgkmcnt(4)
MF v[48:51],a[224:227],a[192:195],v[48:51]
TR a[216:217],v226,256
MF v[52:55],a[224:227],a[196:199],v[52:55]
TR a[218:219],v226,6400
MF v[56:59],a[224:227],a[200:203],v[56:59]
TR a[220:221],v227,256
MF v[60:63],a[228:231],a[192:195],v[60:63]
TR a[222:223],v227,6400
MF v[64:67],a[228:231],a[196:199],v[64:67]
MF v[68:71],a[228:231],a[200:203],v[68:71]
s_waitcnt lgkmcnt(4)
s_barrier
MF v[72:75],a[232:235],a[192:195],v[72:75]
TR a[224:225],v228,0
MF v[76:79],a[232:235],a[196:199],v[76:79]
TR a[226:227],v228,6144
MF v[80:83],a[232:235],a[200:203],v[80:83]
s_add_u32 m0,s32,73728
TR a[228:229],v229,0
MF v[84:87],a[236:239],a[192:195],v[84:87]
s_add_u32 s35,s77,0
TR a[230:231],v229,6144
MF v[88:91],a[236:239],a[196:199],v[88:91]
buffer_load_dwordx4 v239,s[20:23],s35 offen offset:0 lds
MF v[92:95],a[236:239],a[200:203],v[92:95]
s_waitcnt lgkmcnt(4)
MF v[96:99],a[216:219],a[192:195],v[96:99]
TR a[232:233],v228,64
MF v[100:103],a[216:219],a[196:199],v[100:103]
TR a[234:235],v228,6208
MF v[104:107],a[216:219],a[200:203],v[104:107]
TR a[236:237],v229,64
MF v[108:111],a[220:223],a[192:195],v[108:111]
TR a[238:239],v229,6208
MF v[112:115],a[220:223],a[196:199],v[112:115]
MF v[116:119],a[220:223],a[200:203],v[116:119]
s_waitcnt lgkmcnt(4)
L_st109:
MF v[0:3],a[224:227],a[204:207],v[0:3]
TR a[216:217],v228,128
MF v[4:7],a[224:227],a[208:211],v[4:7]
TR a[218:219],v228,6272
MF v[8:11],a[224:227],a[212:215],v[8:11]
TR a[220:221],v229,128
v_subrev_u32 v226,86016,v226
MF v[12:15],a[228:231],a[204:207],v[12:15]
TR a[222:223],v229,6272
v_subrev_u32 v227,86016,v227
MF v[16:19],a[228:231],a[208:211],v[16:19]
buffer_load_dwordx4 v240,s[20:23],s35 offen offset:1024 lds
MF v[20:23],a[228:231],a[212:215],v[20:23]
s_waitcnt lgkmcnt(4)
MF v[24:27],a[232:235],a[204:207],v[24:27]
TR a[224:225],v228,192
MF v[28:31],a[232:235],a[208:211],v[28:31]
TR a[226:227],v228,6336
MF v[32:35],a[232:235],a[212:215],v[32:35]
TR a[228:229],v229,192
MF v[36:39],a[236:239],a[204:207],v[36:39]
TR a[230:231],v229,6336
MF v[40:43],a[236:239],a[208:211],v[40:43]
buffer_load_dwordx4 v241,s[20:23],s35 offen offset:2048 lds
MF v[44:47],a[236:239],a[212:215],v[44:47]
s_waitcnt lgkmcnt(4)
MF v[48:51],a[216:219],a[204:207],v[48:51]
TR a[232:233],v228,256
MF v[52:55],a[216:219],a[208:211],v[52:55]
TR a[234:235],v228,6400
MF v[56:59],a[216:219],a[212:215],v[56:59]
TR a[236:237],v229,256
MF v[60:63],a[220:223],a[204:207],v[60:63]
TR a[238:239],v229,6400
MF v[64:67],a[220:223],a[208:211],v[64:67]
MF v[68:71],a[220:223],a[212:215],v[68:71]
s_waitcnt lgkmcnt(4)
s_barrier
MF v[72:75],a[224:227],a[204:207],v[72:75]
TR a[216:217],v226,0
MF v[76:79],a[224:227],a[208:211],v[76:79]
TR a[218:219],v226,6144
MF v[80:83],a[224:227],a[212:215],v[80:83]
s_add_u32 m0,s32,86016
TR a[220:221],v227,0
MF v[84:87],a[228:231],a[204:207],v[84:87]
s_add_u32 s36,s77,40960
TR a[222:223],v227,6144
MF v[88:91],a[228:231],a[208:211],v[88:91]
buffer_load_dwordx4 v239,s[20:23],s36 offen offset:0 lds
MF v[92:95],a[228:231],a[212:215],v[92:95]
s_waitcnt lgkmcnt(4)
MF v[96:99],a[232:235],a[204:207],v[96:99]
TR a[224:225],v226,64
MF v[100:103],a[232:235],a[208:211],v[100:103]
TR a[226:227],v226,6208
MF v[104:107],a[232:235],a[212:215],v[104:107]
TR a[228:229],v227,64
MF v[108:111],a[236:239],a[204:207],v[108:111]
TR a[230:231],v227,6208
MF v[112:115],a[236:239],a[208:211],v[112:115]
MF v[116:119],a[236:239],a[212:215],v[116:119]
s_waitcnt lgkmcnt(4)
L_st110:
MF v[0:3],a[216:219],v[144:147],v[0:3]
TR a[232:233],v226,128
MF v[4:7],a[216:219],v[148:151],v[4:7]
TR a[234:235],v226,6272
MF v[8:11],a[216:219],v[152:155],v[8:11]
TR a[236:237],v227,128
v_subrev_u32 v228,86016,v228
MF v[12:15],a[220:223],v[144:147],v[12:15]
TR a[238:239],v227,6272
v_subrev_u32 v229,86016,v229
MF v[16:19],a[220:223],v[148:151],v[16:19]
buffer_load_dwordx4 v240,s[20:23],s36 offen offset:1024 lds
MF v[20:23],a[220:223],v[152:155],v[20:23]
s_waitcnt lgkmcnt(4)
MF v[24:27],a[224:227],v[144:147],v[24:27]
TR a[216:217],v226,192
MF v[28:31],a[224:227],v[148:151],v[28:31]
TR a[218:219],v226,6336
MF v[32:35],a[224:227],v[152:155],v[32:35]
TR a[220:221],v227,192
MF v[36:39],a[228:231],v[144:147],v[36:39]
TR a[222:223],v227,6336
MF v[40:43],a[228:231],v[148:151],v[40:43]
buffer_load_dwordx4 v241,s[20:23],s36 offen offset:2048 lds
MF v[44:47],a[228:231],v[152:155],v[44:47]
s_waitcnt lgkmcnt(4)
MF v[48:51],a[232:235],v[144:147],v[48:51]
TR a[224:225],v226,256
MF v[52:55],a[232:235],v[148:151],v[52:55]
TR a[226:227],v226,6400
MF v[56:59],a[232:235],v[152:155],v[56:59]
TR a[228:229],v227,256
MF v[60:63],a[236:239],v[144:147],v[60:63]
TR a[230:231],v227,6400
MF v[64:67],a[236:239],v[148:151],v[64:67]
MF v[68:71],a[236:239],v[152:155],v[68:71]
s_waitcnt vmcnt(19) lgkmcnt(4)
s_barrier
MF v[72:75],a[216:219],v[144:147],v[72:75]
TR a[232:233],v228,0
MF v[76:79],a[216:219],v[148:151],v[76:79]
TR a[234:235],v228,6144
MF v[80:83],a[216:219],v[152:155],v[80:83]
s_add_u32 m0,s32,98304
TR a[236:237],v229,0
MF v[84:87],a[220:223],v[144:147],v[84:87]
s_add_u32 s35,s77,81920
TR a[238:239],v229,6144
MF v[88:91],a[220:223],v[148:151],v[88:91]
buffer_load_dwordx4 v239,s[20:23],s35 offen offset:0 lds
MF v[92:95],a[220:223],v[152:155],v[92:95]
s_waitcnt lgkmcnt(4)
MF v[96:99],a[224:227],v[144:147],v[96:99]
TR a[216:217],v228,64
MF v[100:103],a[224:227],v[148:151],v[100:103]
TR a[218:219],v228,6208
MF v[104:107],a[224:227],v[152:155],v[104:107]
TR a[220:221],v229,64
MF v[108:111],a[228:231],v[144:147],v[108:111]
TR a[222:223],v229,6208
MF v[112:115],a[228:231],v[148:151],v[112:115]
MF v[116:119],a[228:231],v[152:155],v[116:119]
s_waitcnt lgkmcnt(4)
L_st111:
MF v[0:3],a[232:235],v[156:159],v[0:3]
TR a[224:225],v228,128
MF v[4:7],a[232:235],v[160:163],v[4:7]
TR a[226:227],v228,6272
MF v[8:11],a[232:235],v[164:167],v[8:11]
TR a[228:229],v229,128
v_add_u32 v226,36864,v226
MF v[12:15],a[236:239],v[156:159],v[12:15]
TR a[230:231],v229,6272
v_add_u32 v227,36864,v227
MF v[16:19],a[236:239],v[160:163],v[16:19]
buffer_load_dwordx4 v240,s[20:23],s35 offen offset:1024 lds
MF v[20:23],a[236:239],v[164:167],v[20:23]
s_waitcnt lgkmcnt(4)
MF v[24:27],a[216:219],v[156:159],v[24:27]
TR a[232:233],v228,192
MF v[28:31],a[216:219],v[160:163],v[28:31]
TR a[234:235],v228,6336
MF v[32:35],a[216:219],v[164:167],v[32:35]
TR a[236:237],v229,192
MF v[36:39],a[220:223],v[156:159],v[36:39]
TR a[238:239],v229,6336
MF v[40:43],a[220:223],v[160:163],v[40:43]
buffer_load_dwordx4 v241,s[20:23],s35 offen offset:2048 lds
MF v[44:47],a[220:223],v[164:167],v[44:47]
s_waitcnt lgkmcnt(4)
MF v[48:51],a[224:227],v[156:159],v[48:51]
TR a[216:217],v228,256
MF v[52:55],a[224:227],v[160:163],v[52:55]
TR a[218:219],v228,6400
MF v[56:59],a[224:227],v[164:167],v[56:59]
TR a[220:221],v229,256
MF v[60:63],a[228:231],v[156:159],v[60:63]
TR a[222:223],v229,6400
MF v[64:67],a[228:231],v[160:163],v[64:67]
MF v[68:71],a[228:231],v[164:167],v[68:71]
s_waitcnt vmcnt(19) lgkmcnt(4)
s_barrier
MF v[72:75],a[232:235],v[156:159],v[72:75]
TR a[224:225],v226,24576
MF v[76:79],a[232:235],v[160:163],v[76:79]
TR a[226:227],v226,30720
MF v[80:83],a[232:235],v[164:167],v[80:83]
s_add_u32 m0,s32,0
TR a[228:229],v227,24576
MF v[84:87],a[236:239],v[156:159],v[84:87]
s_add_u32 s36,s77,122880
TR a[230:231],v227,30720
MF v[88:91],a[236:239],v[160:163],v[88:91]
buffer_load_dwordx4 v239,s[20:23],s36 offen offset:0 lds
MF v[92:95],a[236:239],v[164:167],v[92:95]
s_waitcnt lgkmcnt(4)
MF v[96:99],a[216:219],v[156:159],v[96:99]
TR a[232:233],v226,24640
MF v[100:103],a[216:219],v[160:163],v[100:103]
TR a[234:235],v226,30784
MF v[104:107],a[216:219],v[164:167],v[104:107]
TR a[236:237],v227,24640
MF v[108:111],a[220:223],v[156:159],v[108:111]
TR a[238:239],v227,30784
MF v[112:115],a[220:223],v[160:163],v[112:115]
MF v[116:119],a[220:223],v[164:167],v[116:119]
s_waitcnt lgkmcnt(4)
buffer_load_dword v136,v140,s[24:27],s60 offen sc1
s_waitcnt vmcnt(0)
s_cmp_eq_u32 s53,1
s_cbranch_scc0 L_spb_ok
v_cmp_le_u32 vcc,2,v136
s_nop 0
s_and_b32 s55,vcc_lo,s95
s_cmp_eq_u32 s55,s95
s_cbranch_scc1 L_spb_ok
s_mov_b32 s54,262144
L_spb_loop:
s_sub_u32 s54,s54,1
s_cbranch_scc1 L_spb_ok
s_sleep 2
buffer_load_dword v136,v140,s[24:27],s60 offen sc1
s_waitcnt vmcnt(0)
v_cmp_le_u32 vcc,2,v136
s_nop 0
s_and_b32 s55,vcc_lo,s95
s_cmp_eq_u32 s55,s95
s_cbranch_scc0 L_spb_loop
L_spb_ok:
L_st112:
MF v[0:3],a[224:227],v[168:171],v[0:3]
TR a[216:217],v226,24704
MF v[4:7],a[224:227],v[172:175],v[4:7]
TR a[218:219],v226,30848
MF v[8:11],a[224:227],v[176:179],v[8:11]
TR a[220:221],v227,24704
MF v[12:15],a[228:231],v[168:171],v[12:15]
TR a[222:223],v227,30848
MF v[16:19],a[228:231],v[172:175],v[16:19]
buffer_load_dwordx4 v240,s[20:23],s36 offen offset:1024 lds
MF v[20:23],a[228:231],v[176:179],v[20:23]
s_waitcnt lgkmcnt(4)
MF v[24:27],a[232:235],v[168:171],v[24:27]
TR a[224:225],v226,24768
MF v[28:31],a[232:235],v[172:175],v[28:31]
TR a[226:227],v226,30912
MF v[32:35],a[232:235],v[176:179],v[32:35]
TR a[228:229],v227,24768
MF v[36:39],a[236:239],v[168:171],v[36:39]
TR a[230:231],v227,30912
MF v[40:43],a[236:239],v[172:175],v[40:43]
buffer_load_dwordx4 v241,s[20:23],s36 offen offset:2048 lds
MF v[44:47],a[236:239],v[176:179],v[44:47]
s_waitcnt lgkmcnt(4)
MF v[48:51],a[216:219],v[168:171],v[48:51]
TR a[232:233],v226,24832
MF v[52:55],a[216:219],v[172:175],v[52:55]
TR a[234:235],v226,30976
MF v[56:59],a[216:219],v[176:179],v[56:59]
TR a[236:237],v227,24832
MF v[60:63],a[220:223],v[168:171],v[60:63]
TR a[238:239],v227,30976
MF v[64:67],a[220:223],v[172:175],v[64:67]
MF v[68:71],a[220:223],v[176:179],v[68:71]
s_waitcnt lgkmcnt(4)
s_barrier
MF v[72:75],a[224:227],v[168:171],v[72:75]
TR a[216:217],v228,12288
MF v[76:79],a[224:227],v[172:175],v[76:79]
TR a[218:219],v228,18432
MF v[80:83],a[224:227],v[176:179],v[80:83]
s_add_u32 m0,s32,12288
TR a[220:221],v229,12288
MF v[84:87],a[228:231],v[168:171],v[84:87]
s_add_u32 s35,s77,163840
s_add_u32 s62,s80,0
TR a[222:223],v229,18432
MF v[88:91],a[228:231],v[172:175],v[88:91]
buffer_load_dwordx4 v239,s[20:23],s35 offen offset:0 lds
MF v[92:95],a[228:231],v[176:179],v[92:95]
s_waitcnt lgkmcnt(4)
buffer_load_dwordx4 a[0:3],v246,s[24:27],s62 offen offset:0 sc1
MF v[96:99],a[232:235],v[168:171],v[96:99]
TR a[224:225],v228,12352
MF v[100:103],a[232:235],v[172:175],v[100:103]
TR a[226:227],v228,18496
MF v[104:107],a[232:235],v[176:179],v[104:107]
TR a[228:229],v229,12352
MF v[108:111],a[236:239],v[168:171],v[108:111]
TR a[230:231],v229,18496
MF v[112:115],a[236:239],v[172:175],v[112:115]
buffer_load_dwordx4 a[4:7],v246,s[24:27],s62 offen offset:1024 sc1
MF v[116:119],a[236:239],v[176:179],v[116:119]
s_waitcnt lgkmcnt(4)
buffer_load_dwordx4 a[8:11],v246,s[24:27],s62 offen offset:2048 sc1
L_st113:
MF v[0:3],a[216:219],v[180:183],v[0:3]
TR a[232:233],v228,12416
MF v[4:7],a[216:219],v[184:187],v[4:7]
TR a[234:235],v228,18560
MF v[8:11],a[216:219],v[188:191],v[8:11]
TR a[236:237],v229,12416
MF v[12:15],a[220:223],v[180:183],v[12:15]
s_add_u32 s63,s80,3072
TR a[238:239],v229,18560
MF v[16:19],a[220:223],v[184:187],v[16:19]
buffer_load_dwordx4 v240,s[20:23],s35 offen offset:1024 lds
MF v[20:23],a[220:223],v[188:191],v[20:23]
s_waitcnt lgkmcnt(4)
buffer_load_dwordx4 a[12:15],v246,s[24:27],s63 offen offset:0 sc1
MF v[24:27],a[224:227],v[180:183],v[24:27]
TR a[216:217],v228,12480
MF v[28:31],a[224:227],v[184:187],v[28:31]
TR a[218:219],v228,18624
MF v[32:35],a[224:227],v[188:191],v[32:35]
TR a[220:221],v229,12480
MF v[36:39],a[228:231],v[180:183],v[36:39]
s_add_u32 s62,s80,6144
TR a[222:223],v229,18624
MF v[40:43],a[228:231],v[184:187],v[40:43]
buffer_load_dwordx4 v241,s[20:23],s35 offen offset:2048 lds
MF v[44:47],a[228:231],v[188:191],v[44:47]
s_waitcnt lgkmcnt(4)
buffer_load_dwordx4 a[24:27],v246,s[24:27],s62 offen offset:0 sc1
MF v[48:51],a[232:235],v[180:183],v[48:51]
TR a[224:225],v228,12544
MF v[52:55],a[232:235],v[184:187],v[52:55]
TR a[226:227],v228,18688
MF v[56:59],a[232:235],v[188:191],v[56:59]
TR a[228:229],v229,12544
MF v[60:63],a[236:239],v[180:183],v[60:63]
TR a[230:231],v229,18688
MF v[64:67],a[236:239],v[184:187],v[64:67]
buffer_load_dwordx4 a[28:31],v246,s[24:27],s62 offen offset:1024 sc1
MF v[68:71],a[236:239],v[188:191],v[68:71]
s_waitcnt lgkmcnt(4)
s_barrier
MF v[72:75],a[216:219],v[180:183],v[72:75]
TR a[232:233],v226,0
MF v[76:79],a[216:219],v[184:187],v[76:79]
TR a[234:235],v226,6144
MF v[80:83],a[216:219],v[188:191],v[80:83]
s_add_u32 m0,s32,61440
TR a[236:237],v227,0
MF v[84:87],a[220:223],v[180:183],v[84:87]
s_add_u32 s36,s77,204800
TR a[238:239],v227,6144
MF v[88:91],a[220:223],v[184:187],v[88:91]
buffer_load_dwordx4 v239,s[20:23],s36 offen offset:0 lds
MF v[92:95],a[220:223],v[188:191],v[92:95]
s_waitcnt lgkmcnt(4)
buffer_load_dwordx4 a[16:19],v246,s[24:27],s63 offen offset:1024 sc1
MF v[96:99],a[224:227],v[180:183],v[96:99]
TR a[216:217],v226,64
MF v[100:103],a[224:227],v[184:187],v[100:103]
TR a[218:219],v226,6208
MF v[104:107],a[224:227],v[188:191],v[104:107]
TR a[220:221],v227,64
MF v[108:111],a[228:231],v[180:183],v[108:111]
TR a[222:223],v227,6208
MF v[112:115],a[228:231],v[184:187],v[112:115]
buffer_load_dwordx4 a[32:35],v246,s[24:27],s62 offen offset:2048 sc1
MF v[116:119],a[228:231],v[188:191],v[116:119]
s_waitcnt lgkmcnt(4)
buffer_load_dwordx4 a[20:23],v246,s[24:27],s63 offen offset:2048 sc1
L_st114:
MF v[0:3],a[232:235],v[192:195],v[0:3]
TR a[224:225],v226,128
MF v[4:7],a[232:235],v[196:199],v[4:7]
TR a[226:227],v226,6272
MF v[8:11],a[232:235],v[200:203],v[8:11]
TR a[228:229],v227,128
MF v[12:15],a[236:239],v[192:195],v[12:15]
s_add_u32 s63,s80,9216
TR a[230:231],v227,6272
MF v[16:19],a[236:239],v[196:199],v[16:19]
buffer_load_dwordx4 v240,s[20:23],s36 offen offset:1024 lds
MF v[20:23],a[236:239],v[200:203],v[20:23]
s_waitcnt lgkmcnt(4)
buffer_load_dwordx4 a[36:39],v246,s[24:27],s63 offen offset:0 sc1
MF v[24:27],a[216:219],v[192:195],v[24:27]
TR a[232:233],v226,192
MF v[28:31],a[216:219],v[196:199],v[28:31]
TR a[234:235],v226,6336
MF v[32:35],a[216:219],v[200:203],v[32:35]
TR a[236:237],v227,192
MF v[36:39],a[220:223],v[192:195],v[36:39]
s_add_u32 s62,s80,12288
TR a[238:239],v227,6336
MF v[40:43],a[220:223],v[196:199],v[40:43]
buffer_load_dwordx4 v241,s[20:23],s36 offen offset:2048 lds
MF v[44:47],a[220:223],v[200:203],v[44:47]
s_waitcnt lgkmcnt(4)
buffer_load_dwordx4 a[48:51],v246,s[24:27],s62 offen offset:0 sc1
MF v[48:51],a[224:227],v[192:195],v[48:51]
TR a[216:217],v226,256
MF v[52:55],a[224:227],v[196:199],v[52:55]
TR a[218:219],v226,6400
MF v[56:59],a[224:227],v[200:203],v[56:59]
TR a[220:221],v227,256
MF v[60:63],a[228:231],v[192:195],v[60:63]
TR a[222:223],v227,6400
MF v[64:67],a[228:231],v[196:199],v[64:67]
buffer_load_dwordx4 a[52:55],v246,s[24:27],s62 offen offset:1024 sc1
MF v[68:71],a[228:231],v[200:203],v[68:71]
s_waitcnt lgkmcnt(4)
s_barrier
MF v[72:75],a[232:235],v[192:195],v[72:75]
TR a[224:225],v228,36864
MF v[76:79],a[232:235],v[196:199],v[76:79]
TR a[226:227],v228,43008
MF v[80:83],a[232:235],v[200:203],v[80:83]
s_add_u32 m0,s32,24576
TR a[228:229],v229,36864
MF v[84:87],a[236:239],v[192:195],v[84:87]
s_add_u32 s35,s77,245760
TR a[230:231],v229,43008
MF v[88:91],a[236:239],v[196:199],v[88:91]
buffer_load_dwordx4 v239,s[20:23],s35 offen offset:0 lds
MF v[92:95],a[236:239],v[200:203],v[92:95]
s_waitcnt lgkmcnt(4)
buffer_load_dwordx4 a[40:43],v246,s[24:27],s63 offen offset:1024 sc1
MF v[96:99],a[216:219],v[192:195],v[96:99]
TR a[232:233],v228,36928
MF v[100:103],a[216:219],v[196:199],v[100:103]
TR a[234:235],v228,43072
MF v[104:107],a[216:219],v[200:203],v[104:107]
TR a[236:237],v229,36928
MF v[108:111],a[220:223],v[192:195],v[108:111]
TR a[238:239],v229,43072
MF v[112:115],a[220:223],v[196:199],v[112:115]
buffer_load_dwordx4 a[56:59],v246,s[24:27],s62 offen offset:2048 sc1
MF v[116:119],a[220:223],v[200:203],v[116:119]
s_waitcnt lgkmcnt(4)
buffer_load_dwordx4 a[44:47],v246,s[24:27],s63 offen offset:2048 sc1
L_st115:
MF v[0:3],a[224:227],v[204:207],v[0:3]
TR a[216:217],v228,36992
MF v[4:7],a[224:227],v[208:211],v[4:7]
TR a[218:219],v228,43136
MF v[8:11],a[224:227],v[212:215],v[8:11]
TR a[220:221],v229,36992
MF v[12:15],a[228:231],v[204:207],v[12:15]
s_add_u32 s63,s80,15360
TR a[222:223],v229,43136
MF v[16:19],a[228:231],v[208:211],v[16:19]
buffer_load_dwordx4 v240,s[20:23],s35 offen offset:1024 lds
MF v[20:23],a[228:231],v[212:215],v[20:23]
s_waitcnt lgkmcnt(4)
buffer_load_dwordx4 a[60:63],v246,s[24:27],s63 offen offset:0 sc1
MF v[24:27],a[232:235],v[204:207],v[24:27]
TR a[224:225],v228,37056
MF v[28:31],a[232:235],v[208:211],v[28:31]
TR a[226:227],v228,43200
MF v[32:35],a[232:235],v[212:215],v[32:35]
TR a[228:229],v229,37056
MF v[36:39],a[236:239],v[204:207],v[36:39]
s_add_u32 s62,s80,73728
TR a[230:231],v229,43200
MF v[40:43],a[236:239],v[208:211],v[40:43]
buffer_load_dwordx4 v241,s[20:23],s35 offen offset:2048 lds
MF v[44:47],a[236:239],v[212:215],v[44:47]
s_waitcnt lgkmcnt(4)
buffer_load_dwordx4 a[72:75],v246,s[24:27],s62 offen offset:0 sc1
MF v[48:51],a[216:219],v[204:207],v[48:51]
TR a[232:233],v228,37120
MF v[52:55],a[216:219],v[208:211],v[52:55]
TR a[234:235],v228,43264
MF v[56:59],a[216:219],v[212:215],v[56:59]
TR a[236:237],v229,37120
MF v[60:63],a[220:223],v[204:207],v[60:63]
TR a[238:239],v229,43264
MF v[64:67],a[220:223],v[208:211],v[64:67]
buffer_load_dwordx4 a[76:79],v246,s[24:27],s62 offen offset:1024 sc1
MF v[68:71],a[220:223],v[212:215],v[68:71]
s_waitcnt vmcnt(23) lgkmcnt(4)
s_barrier
MF v[72:75],a[224:227],v[204:207],v[72:75]
TR a[216:217],v226,36864
MF v[76:79],a[224:227],v[208:211],v[76:79]
TR a[218:219],v226,43008
MF v[80:83],a[224:227],v[212:215],v[80:83]
s_add_u32 m0,s32,36864
TR a[220:221],v227,36864
MF v[84:87],a[228:231],v[204:207],v[84:87]
s_add_u32 s36,s77,286720
TR a[222:223],v227,43008
MF v[88:91],a[228:231],v[208:211],v[88:91]
buffer_load_dwordx4 v239,s[20:23],s36 offen offset:0 lds
MF v[92:95],a[228:231],v[212:215],v[92:95]
s_waitcnt lgkmcnt(4)
buffer_load_dwordx4 a[64:67],v246,s[24:27],s63 offen offset:1024 sc1
MF v[96:99],a[232:235],v[204:207],v[96:99]
TR a[224:225],v226,36928
MF v[100:103],a[232:235],v[208:211],v[100:103]
TR a[226:227],v226,43072
MF v[104:107],a[232:235],v[212:215],v[104:107]
TR a[228:229],v227,36928
MF v[108:111],a[236:239],v[204:207],v[108:111]
TR a[230:231],v227,43072
MF v[112:115],a[236:239],v[208:211],v[112:115]
buffer_load_dwordx4 a[80:83],v246,s[24:27],s62 offen offset:2048 sc1
MF v[116:119],a[236:239],v[212:215],v[116:119]
s_waitcnt lgkmcnt(4)
buffer_load_dwordx4 a[68:71],v246,s[24:27],s63 offen offset:2048 sc1
L_st116:
MF v[0:3],a[216:219],a[0:3],v[0:3]
TR a[232:233],v226,36992
MF v[4:7],a[216:219],a[4:7],v[4:7]
TR a[234:235],v226,43136
MF v[8:11],a[216:219],a[8:11],v[8:11]
TR a[236:237],v227,36992
v_add_u32 v228,73728,v228
MF v[12:15],a[220:223],a[0:3],v[12:15]
TR a[238:239],v227,43136
v_add_u32 v229,73728,v229
MF v[16:19],a[220:223],a[4:7],v[16:19]
buffer_load_dwordx4 v240,s[20:23],s36 offen offset:1024 lds
MF v[20:23],a[220:223],a[8:11],v[20:23]
s_waitcnt lgkmcnt(4)
MF v[24:27],a[224:227],a[0:3],v[24:27]
TR a[216:217],v226,37056
MF v[28:31],a[224:227],a[4:7],v[28:31]
TR a[218:219],v226,43200
MF v[32:35],a[224:227],a[8:11],v[32:35]
TR a[220:221],v227,37056
MF v[36:39],a[228:231],a[0:3],v[36:39]
s_add_u32 s63,s80,76800
TR a[222:223],v227,43200
MF v[40:43],a[228:231],a[4:7],v[40:43]
buffer_load_dwordx4 v241,s[20:23],s36 offen offset:2048 lds
MF v[44:47],a[228:231],a[8:11],v[44:47]
s_waitcnt lgkmcnt(4)
buffer_load_dwordx4 a[84:87],v246,s[24:27],s63 offen offset:0 sc1
MF v[48:51],a[232:235],a[0:3],v[48:51]
TR a[224:225],v226,37120
MF v[52:55],a[232:235],a[4:7],v[52:55]
TR a[226:227],v226,43264
MF v[56:59],a[232:235],a[8:11],v[56:59]
TR a[228:229],v227,37120
MF v[60:63],a[236:239],a[0:3],v[60:63]
TR a[230:231],v227,43264
MF v[64:67],a[236:239],a[4:7],v[64:67]
buffer_load_dwordx4 a[88:91],v246,s[24:27],s63 offen offset:1024 sc1
MF v[68:71],a[236:239],a[8:11],v[68:71]
s_waitcnt vmcnt(22) lgkmcnt(4)
s_barrier
MF v[72:75],a[216:219],a[0:3],v[72:75]
TR a[232:233],v228,0
MF v[76:79],a[216:219],a[4:7],v[76:79]
TR a[234:235],v228,6144
MF v[80:83],a[216:219],a[8:11],v[80:83]
s_add_u32 m0,s32,49152
TR a[236:237],v229,0
MF v[84:87],a[220:223],a[0:3],v[84:87]
s_add_u32 s35,s77,327680
TR a[238:239],v229,6144
MF v[88:91],a[220:223],a[4:7],v[88:91]
buffer_load_dwordx4 v239,s[20:23],s35 offen offset:0 lds
MF v[92:95],a[220:223],a[8:11],v[92:95]
s_waitcnt lgkmcnt(4)
MF v[96:99],a[224:227],a[0:3],v[96:99]
TR a[216:217],v228,64
MF v[100:103],a[224:227],a[4:7],v[100:103]
TR a[218:219],v228,6208
MF v[104:107],a[224:227],a[8:11],v[104:107]
TR a[220:221],v229,64
MF v[108:111],a[228:231],a[0:3],v[108:111]
TR a[222:223],v229,6208
MF v[112:115],a[228:231],a[4:7],v[112:115]
buffer_load_dwordx4 a[92:95],v246,s[24:27],s63 offen offset:2048 sc1
MF v[116:119],a[228:231],a[8:11],v[116:119]
s_waitcnt lgkmcnt(4)
L_st117:
MF v[0:3],a[232:235],a[12:15],v[0:3]
TR a[224:225],v228,128
MF v[4:7],a[232:235],a[16:19],v[4:7]
TR a[226:227],v228,6272
MF v[8:11],a[232:235],a[20:23],v[8:11]
TR a[228:229],v229,128
v_add_u32 v226,61440,v226
MF v[12:15],a[236:239],a[12:15],v[12:15]
TR a[230:231],v229,6272
v_add_u32 v227,61440,v227
MF v[16:19],a[236:239],a[16:19],v[16:19]
buffer_load_dwordx4 v240,s[20:23],s35 offen offset:1024 lds
MF v[20:23],a[236:239],a[20:23],v[20:23]
s_waitcnt lgkmcnt(4)
MF v[24:27],a[216:219],a[12:15],v[24:27]
TR a[232:233],v228,192
MF v[28:31],a[216:219],a[16:19],v[28:31]
TR a[234:235],v228,6336
MF v[32:35],a[216:219],a[20:23],v[32:35]
TR a[236:237],v229,192
MF v[36:39],a[220:223],a[12:15],v[36:39]
s_add_u32 s62,s80,79872
TR a[238:239],v229,6336
MF v[40:43],a[220:223],a[16:19],v[40:43]
buffer_load_dwordx4 v241,s[20:23],s35 offen offset:2048 lds
MF v[44:47],a[220:223],a[20:23],v[44:47]
s_waitcnt lgkmcnt(4)
buffer_load_dwordx4 a[96:99],v246,s[24:27],s62 offen offset:0 sc1
MF v[48:51],a[224:227],a[12:15],v[48:51]
TR a[216:217],v228,256
MF v[52:55],a[224:227],a[16:19],v[52:55]
TR a[218:219],v228,6400
MF v[56:59],a[224:227],a[20:23],v[56:59]
TR a[220:221],v229,256
MF v[60:63],a[228:231],a[12:15],v[60:63]
TR a[222:223],v229,6400
MF v[64:67],a[228:231],a[16:19],v[64:67]
buffer_load_dwordx4 a[100:103],v246,s[24:27],s62 offen offset:1024 sc1
MF v[68:71],a[228:231],a[20:23],v[68:71]
s_waitcnt lgkmcnt(4)
s_barrier
MF v[72:75],a[232:235],a[12:15],v[72:75]
TR a[224:225],v226,0
MF v[76:79],a[232:235],a[16:19],v[76:79]
TR a[226:227],v226,6144
MF v[80:83],a[232:235],a[20:23],v[80:83]
s_add_u32 m0,s32,73728
TR a[228:229],v227,0
MF v[84:87],a[236:239],a[12:15],v[84:87]
s_add_u32 s36,s77,368640
TR a[230:231],v227,6144
MF v[88:91],a[236:239],a[16:19],v[88:91]
buffer_load_dwordx4 v239,s[20:23],s36 offen offset:0 lds
MF v[92:95],a[236:239],a[20:23],v[92:95]
s_waitcnt lgkmcnt(4)
MF v[96:99],a[216:219],a[12:15],v[96:99]
TR a[232:233],v226,64
MF v[100:103],a[216:219],a[16:19],v[100:103]
TR a[234:235],v226,6208
MF v[104:107],a[216:219],a[20:23],v[104:107]
TR a[236:237],v227,64
MF v[108:111],a[220:223],a[12:15],v[108:111]
TR a[238:239],v227,6208
MF v[112:115],a[220:223],a[16:19],v[112:115]
buffer_load_dwordx4 a[104:107],v246,s[24:27],s62 offen offset:2048 sc1
MF v[116:119],a[220:223],a[20:23],v[116:119]
s_waitcnt lgkmcnt(4)
L_st118:
MF v[0:3],a[224:227],a[24:27],v[0:3]
TR a[216:217],v226,128
MF v[4:7],a[224:227],a[28:31],v[4:7]
TR a[218:219],v226,6272
MF v[8:11],a[224:227],a[32:35],v[8:11]
TR a[220:221],v227,128
v_subrev_u32 v228,86016,v228
MF v[12:15],a[228:231],a[24:27],v[12:15]
TR a[222:223],v227,6272
v_subrev_u32 v229,86016,v229
MF v[16:19],a[228:231],a[28:31],v[16:19]
buffer_load_dwordx4 v240,s[20:23],s36 offen offset:1024 lds
MF v[20:23],a[228:231],a[32:35],v[20:23]
s_waitcnt lgkmcnt(4)
MF v[24:27],a[232:235],a[24:27],v[24:27]
TR a[224:225],v226,192
MF v[28:31],a[232:235],a[28:31],v[28:31]
TR a[226:227],v226,6336
MF v[32:35],a[232:235],a[32:35],v[32:35]
TR a[228:229],v227,192
MF v[36:39],a[236:239],a[24:27],v[36:39]
s_add_u32 s63,s80,82944
TR a[230:231],v227,6336
MF v[40:43],a[236:239],a[28:31],v[40:43]
buffer_load_dwordx4 v241,s[20:23],s36 offen offset:2048 lds
MF v[44:47],a[236:239],a[32:35],v[44:47]
s_waitcnt lgkmcnt(4)
buffer_load_dwordx4 a[108:111],v246,s[24:27],s63 offen offset:0 sc1
MF v[48:51],a[216:219],a[24:27],v[48:51]
TR a[232:233],v226,256
MF v[52:55],a[216:219],a[28:31],v[52:55]
TR a[234:235],v226,6400
MF v[56:59],a[216:219],a[32:35],v[56:59]
TR a[236:237],v227,256
MF v[60:63],a[220:223],a[24:27],v[60:63]
TR a[238:239],v227,6400
MF v[64:67],a[220:223],a[28:31],v[64:67]
buffer_load_dwordx4 a[112:115],v246,s[24:27],s63 offen offset:1024 sc1
MF v[68:71],a[220:223],a[32:35],v[68:71]
s_waitcnt vmcnt(25) lgkmcnt(4)
s_barrier
MF v[72:75],a[224:227],a[24:27],v[72:75]
TR a[216:217],v228,0
MF v[76:79],a[224:227],a[28:31],v[76:79]
TR a[218:219],v228,6144
MF v[80:83],a[224:227],a[32:35],v[80:83]
s_add_u32 m0,s32,86016
TR a[220:221],v229,0
MF v[84:87],a[228:231],a[24:27],v[84:87]
s_add_u32 s35,s77,409600
TR a[222:223],v229,6144
MF v[88:91],a[228:231],a[28:31],v[88:91]
buffer_load_dwordx4 v239,s[20:23],s35 offen offset:0 lds
MF v[92:95],a[228:231],a[32:35],v[92:95]
s_waitcnt lgkmcnt(4)
MF v[96:99],a[232:235],a[24:27],v[96:99]
TR a[224:225],v228,64
MF v[100:103],a[232:235],a[28:31],v[100:103]
TR a[226:227],v228,6208
MF v[104:107],a[232:235],a[32:35],v[104:107]
TR a[228:229],v229,64
MF v[108:111],a[236:239],a[24:27],v[108:111]
TR a[230:231],v229,6208
MF v[112:115],a[236:239],a[28:31],v[112:115]
buffer_load_dwordx4 a[116:119],v246,s[24:27],s63 offen offset:2048 sc1
MF v[116:119],a[236:239],a[32:35],v[116:119]
s_waitcnt lgkmcnt(4)
L_st119:
MF v[0:3],a[216:219],a[36:39],v[0:3]
TR a[232:233],v228,128
MF v[4:7],a[216:219],a[40:43],v[4:7]
TR a[234:235],v228,6272
MF v[8:11],a[216:219],a[44:47],v[8:11]
TR a[236:237],v229,128
v_subrev_u32 v226,86016,v226
MF v[12:15],a[220:223],a[36:39],v[12:15]
TR a[238:239],v229,6272
v_subrev_u32 v227,86016,v227
MF v[16:19],a[220:223],a[40:43],v[16:19]
buffer_load_dwordx4 v240,s[20:23],s35 offen offset:1024 lds
MF v[20:23],a[220:223],a[44:47],v[20:23]
s_waitcnt lgkmcnt(4)
MF v[24:27],a[224:227],a[36:39],v[24:27]
TR a[216:217],v228,192
MF v[28:31],a[224:227],a[40:43],v[28:31]
TR a[218:219],v228,6336
MF v[32:35],a[224:227],a[44:47],v[32:35]
TR a[220:221],v229,192
MF v[36:39],a[228:231],a[36:39],v[36:39]
s_add_u32 s62,s80,86016
TR a[222:223],v229,6336
MF v[40:43],a[228:231],a[40:43],v[40:43]
buffer_load_dwordx4 v241,s[20:23],s35 offen offset:2048 lds
MF v[44:47],a[228:231],a[44:47],v[44:47]
s_waitcnt lgkmcnt(4)
buffer_load_dwordx4 a[120:123],v246,s[24:27],s62 offen offset:0 sc1
MF v[48:51],a[232:235],a[36:39],v[48:51]
TR a[224:225],v228,256
MF v[52:55],a[232:235],a[40:43],v[52:55]
TR a[226:227],v228,6400
MF v[56:59],a[232:235],a[44:47],v[56:59]
TR a[228:229],v229,256
MF v[60:63],a[236:239],a[36:39],v[60:63]
TR a[230:231],v229,6400
MF v[64:67],a[236:239],a[40:43],v[64:67]
buffer_load_dwordx4 a[124:127],v246,s[24:27],s62 offen offset:1024 sc1
MF v[68:71],a[236:239],a[44:47],v[68:71]
s_waitcnt lgkmcnt(4)
s_barrier
MF v[72:75],a[216:219],a[36:39],v[72:75]
TR a[232:233],v226,0
MF v[76:79],a[216:219],a[40:43],v[76:79]
TR a[234:235],v226,6144
MF v[80:83],a[216:219],a[44:47],v[80:83]
s_add_u32 m0,s32,98304
TR a[236:237],v227,0
MF v[84:87],a[220:223],a[36:39],v[84:87]
s_add_u32 s36,s77,450560
TR a[238:239],v227,6144
MF v[88:91],a[220:223],a[40:43],v[88:91]
buffer_load_dwordx4 v239,s[20:23],s36 offen offset:0 lds
MF v[92:95],a[220:223],a[44:47],v[92:95]
s_waitcnt lgkmcnt(4)
MF v[96:99],a[224:227],a[36:39],v[96:99]
TR a[216:217],v226,64
MF v[100:103],a[224:227],a[40:43],v[100:103]
TR a[218:219],v226,6208
MF v[104:107],a[224:227],a[44:47],v[104:107]
TR a[220:221],v227,64
MF v[108:111],a[228:231],a[36:39],v[108:111]
TR a[222:223],v227,6208
MF v[112:115],a[228:231],a[40:43],v[112:115]
buffer_load_dwordx4 a[128:131],v246,s[24:27],s62 offen offset:2048 sc1
MF v[116:119],a[228:231],a[44:47],v[116:119]
s_waitcnt lgkmcnt(4)
L_st120:
MF v[0:3],a[232:235],a[48:51],v[0:3]
TR a[224:225],v226,128
MF v[4:7],a[232:235],a[52:55],v[4:7]
TR a[226:227],v226,6272
MF v[8:11],a[232:235],a[56:59],v[8:11]
TR a[228:229],v227,128
v_add_u32 v228,36864,v228
MF v[12:15],a[236:239],a[48:51],v[12:15]
TR a[230:231],v227,6272
v_add_u32 v229,36864,v229
MF v[16:19],a[236:239],a[52:55],v[16:19]
buffer_load_dwordx4 v240,s[20:23],s36 offen offset:1024 lds
MF v[20:23],a[236:239],a[56:59],v[20:23]
s_waitcnt lgkmcnt(4)
MF v[24:27],a[216:219],a[48:51],v[24:27]
TR a[232:233],v226,192
MF v[28:31],a[216:219],a[52:55],v[28:31]
TR a[234:235],v226,6336
MF v[32:35],a[216:219],a[56:59],v[32:35]
TR a[236:237],v227,192
MF v[36:39],a[220:223],a[48:51],v[36:39]
s_add_u32 s63,s80,89088
TR a[238:239],v227,6336
MF v[40:43],a[220:223],a[52:55],v[40:43]
buffer_load_dwordx4 v241,s[20:23],s36 offen offset:2048 lds
MF v[44:47],a[220:223],a[56:59],v[44:47]
s_waitcnt lgkmcnt(4)
buffer_load_dwordx4 a[132:135],v246,s[24:27],s63 offen offset:0 sc1
MF v[48:51],a[224:227],a[48:51],v[48:51]
TR a[216:217],v226,256
MF v[52:55],a[224:227],a[52:55],v[52:55]
TR a[218:219],v226,6400
MF v[56:59],a[224:227],a[56:59],v[56:59]
TR a[220:221],v227,256
MF v[60:63],a[228:231],a[48:51],v[60:63]
TR a[222:223],v227,6400
MF v[64:67],a[228:231],a[52:55],v[64:67]
buffer_load_dwordx4 a[136:139],v246,s[24:27],s63 offen offset:1024 sc1
MF v[68:71],a[228:231],a[56:59],v[68:71]
s_waitcnt vmcnt(28) lgkmcnt(4)
s_barrier
MF v[72:75],a[232:235],a[48:51],v[72:75]
TR a[224:225],v228,24576
MF v[76:79],a[232:235],a[52:55],v[76:79]
TR a[226:227],v228,30720
MF v[80:83],a[232:235],a[56:59],v[80:83]
s_add_u32 m0,s32,0
TR a[228:229],v229,24576
MF v[84:87],a[236:239],a[48:51],v[84:87]
s_add_u32 s35,s78,0
TR a[230:231],v229,30720
MF v[88:91],a[236:239],a[52:55],v[88:91]
buffer_load_dwordx4 v239,s[20:23],s35 offen offset:0 lds
MF v[92:95],a[236:239],a[56:59],v[92:95]
s_waitcnt lgkmcnt(4)
MF v[96:99],a[216:219],a[48:51],v[96:99]
TR a[232:233],v228,24640
MF v[100:103],a[216:219],a[52:55],v[100:103]
TR a[234:235],v228,30784
MF v[104:107],a[216:219],a[56:59],v[104:107]
TR a[236:237],v229,24640
MF v[108:111],a[220:223],a[48:51],v[108:111]
TR a[238:239],v229,30784
MF v[112:115],a[220:223],a[52:55],v[112:115]
buffer_load_dwordx4 a[140:143],v246,s[24:27],s63 offen offset:2048 sc1
MF v[116:119],a[220:223],a[56:59],v[116:119]
s_waitcnt lgkmcnt(4)
L_st121:
MF v[0:3],a[224:227],a[60:63],v[0:3]
TR a[216:217],v228,24704
MF v[4:7],a[224:227],a[64:67],v[4:7]
TR a[218:219],v228,30848
MF v[8:11],a[224:227],a[68:71],v[8:11]
TR a[220:221],v229,24704
MF v[12:15],a[228:231],a[60:63],v[12:15]
TR a[222:223],v229,30848
MF v[16:19],a[228:231],a[64:67],v[16:19]
buffer_load_dwordx4 v240,s[20:23],s35 offen offset:1024 lds
MF v[20:23],a[228:231],a[68:71],v[20:23]
s_waitcnt lgkmcnt(4)
MF v[24:27],a[232:235],a[60:63],v[24:27]
TR a[224:225],v228,24768
MF v[28:31],a[232:235],a[64:67],v[28:31]
TR a[226:227],v228,30912
MF v[32:35],a[232:235],a[68:71],v[32:35]
TR a[228:229],v229,24768
MF v[36:39],a[236:239],a[60:63],v[36:39]
s_add_u32 s62,s81,0
TR a[230:231],v229,30912
MF v[40:43],a[236:239],a[64:67],v[40:43]
buffer_load_dwordx4 v241,s[20:23],s35 offen offset:2048 lds
MF v[44:47],a[236:239],a[68:71],v[44:47]
s_waitcnt lgkmcnt(4)
buffer_load_dwordx4 a[0:3],v246,s[24:27],s62 offen offset:0 sc1
MF v[48:51],a[216:219],a[60:63],v[48:51]
TR a[232:233],v228,24832
MF v[52:55],a[216:219],a[64:67],v[52:55]
TR a[234:235],v228,30976
MF v[56:59],a[216:219],a[68:71],v[56:59]
TR a[236:237],v229,24832
MF v[60:63],a[220:223],a[60:63],v[60:63]
TR a[238:239],v229,30976
MF v[64:67],a[220:223],a[64:67],v[64:67]
buffer_load_dwordx4 a[4:7],v246,s[24:27],s62 offen offset:1024 sc1
MF v[68:71],a[220:223],a[68:71],v[68:71]
s_waitcnt lgkmcnt(4)
s_barrier
MF v[72:75],a[224:227],a[60:63],v[72:75]
TR a[216:217],v226,12288
MF v[76:79],a[224:227],a[64:67],v[76:79]
TR a[218:219],v226,18432
MF v[80:83],a[224:227],a[68:71],v[80:83]
s_add_u32 m0,s32,12288
TR a[220:221],v227,12288
MF v[84:87],a[228:231],a[60:63],v[84:87]
s_add_u32 s36,s78,40960
TR a[222:223],v227,18432
MF v[88:91],a[228:231],a[64:67],v[88:91]
buffer_load_dwordx4 v239,s[20:23],s36 offen offset:0 lds
MF v[92:95],a[228:231],a[68:71],v[92:95]
s_waitcnt lgkmcnt(4)
MF v[96:99],a[232:235],a[60:63],v[96:99]
TR a[224:225],v226,12352
MF v[100:103],a[232:235],a[64:67],v[100:103]
TR a[226:227],v226,18496
MF v[104:107],a[232:235],a[68:71],v[104:107]
TR a[228:229],v227,12352
MF v[108:111],a[236:239],a[60:63],v[108:111]
TR a[230:231],v227,18496
MF v[112:115],a[236:239],a[64:67],v[112:115]
buffer_load_dwordx4 a[8:11],v246,s[24:27],s62 offen offset:2048 sc1
MF v[116:119],a[236:239],a[68:71],v[116:119]
s_waitcnt lgkmcnt(4)
L_st122:
MF v[0:3],a[216:219],a[72:75],v[0:3]
TR a[232:233],v226,12416
MF v[4:7],a[216:219],a[76:79],v[4:7]
TR a[234:235],v226,18560
MF v[8:11],a[216:219],a[80:83],v[8:11]
TR a[236:237],v227,12416
MF v[12:15],a[220:223],a[72:75],v[12:15]
TR a[238:239],v227,18560
MF v[16:19],a[220:223],a[76:79],v[16:19]
buffer_load_dwordx4 v240,s[20:23],s36 offen offset:1024 lds
MF v[20:23],a[220:223],a[80:83],v[20:23]
s_waitcnt lgkmcnt(4)
MF v[24:27],a[224:227],a[72:75],v[24:27]
TR a[216:217],v226,12480
MF v[28:31],a[224:227],a[76:79],v[28:31]
TR a[218:219],v226,18624
MF v[32:35],a[224:227],a[80:83],v[32:35]
TR a[220:221],v227,12480
MF v[36:39],a[228:231],a[72:75],v[36:39]
s_add_u32 s63,s81,3072
TR a[222:223],v227,18624
MF v[40:43],a[228:231],a[76:79],v[40:43]
buffer_load_dwordx4 v241,s[20:23],s36 offen offset:2048 lds
MF v[44:47],a[228:231],a[80:83],v[44:47]
s_waitcnt lgkmcnt(4)
buffer_load_dwordx4 a[12:15],v246,s[24:27],s63 offen offset:0 sc1
MF v[48:51],a[232:235],a[72:75],v[48:51]
TR a[224:225],v226,12544
MF v[52:55],a[232:235],a[76:79],v[52:55]
TR a[226:227],v226,18688
MF v[56:59],a[232:235],a[80:83],v[56:59]
TR a[228:229],v227,12544
MF v[60:63],a[236:239],a[72:75],v[60:63]
TR a[230:231],v227,18688
MF v[64:67],a[236:239],a[76:79],v[64:67]
buffer_load_dwordx4 a[16:19],v246,s[24:27],s63 offen offset:1024 sc1
MF v[68:71],a[236:239],a[80:83],v[68:71]
s_waitcnt vmcnt(34) lgkmcnt(4)
s_barrier
MF v[72:75],a[216:219],a[72:75],v[72:75]
TR a[232:233],v228,0
MF v[76:79],a[216:219],a[76:79],v[76:79]
TR a[234:235],v228,6144
MF v[80:83],a[216:219],a[80:83],v[80:83]
s_add_u32 m0,s32,61440
TR a[236:237],v229,0
MF v[84:87],a[220:223],a[72:75],v[84:87]
s_add_u32 s35,s78,81920
TR a[238:239],v229,6144
MF v[88:91],a[220:223],a[76:79],v[88:91]
buffer_load_dwordx4 v239,s[20:23],s35 offen offset:0 lds
MF v[92:95],a[220:223],a[80:83],v[92:95]
s_waitcnt lgkmcnt(4)
MF v[96:99],a[224:227],a[72:75],v[96:99]
TR a[216:217],v228,64
MF v[100:103],a[224:227],a[76:79],v[100:103]
TR a[218:219],v228,6208
MF v[104:107],a[224:227],a[80:83],v[104:107]
TR a[220:221],v229,64
MF v[108:111],a[228:231],a[72:75],v[108:111]
TR a[222:223],v229,6208
MF v[112:115],a[228:231],a[76:79],v[112:115]
buffer_load_dwordx4 a[20:23],v246,s[24:27],s63 offen offset:2048 sc1
MF v[116:119],a[228:231],a[80:83],v[116:119]
s_waitcnt lgkmcnt(4)
L_st123:
MF v[0:3],a[232:235],a[84:87],v[0:3]
TR a[224:225],v228,128
MF v[4:7],a[232:235],a[88:91],v[4:7]
TR a[226:227],v228,6272
MF v[8:11],a[232:235],a[92:95],v[8:11]
TR a[228:229],v229,128
MF v[12:15],a[236:239],a[84:87],v[12:15]
TR a[230:231],v229,6272
MF v[16:19],a[236:239],a[88:91],v[16:19]
buffer_load_dwordx4 v240,s[20:23],s35 offen offset:1024 lds
MF v[20:23],a[236:239],a[92:95],v[20:23]
s_waitcnt lgkmcnt(4)
MF v[24:27],a[216:219],a[84:87],v[24:27]
TR a[232:233],v228,192
MF v[28:31],a[216:219],a[88:91],v[28:31]
TR a[234:235],v228,6336
MF v[32:35],a[216:219],a[92:95],v[32:35]
TR a[236:237],v229,192
MF v[36:39],a[220:223],a[84:87],v[36:39]
s_add_u32 s62,s81,6144
TR a[238:239],v229,6336
MF v[40:43],a[220:223],a[88:91],v[40:43]
buffer_load_dwordx4 v241,s[20:23],s35 offen offset:2048 lds
MF v[44:47],a[220:223],a[92:95],v[44:47]
s_waitcnt lgkmcnt(4)
buffer_load_dwordx4 a[24:27],v246,s[24:27],s62 offen offset:0 sc1
MF v[48:51],a[224:227],a[84:87],v[48:51]
TR a[216:217],v228,256
MF v[52:55],a[224:227],a[88:91],v[52:55]
TR a[218:219],v228,6400
MF v[56:59],a[224:227],a[92:95],v[56:59]
TR a[220:221],v229,256
MF v[60:63],a[228:231],a[84:87],v[60:63]
TR a[222:223],v229,6400
MF v[64:67],a[228:231],a[88:91],v[64:67]
buffer_load_dwordx4 a[28:31],v246,s[24:27],s62 offen offset:1024 sc1
MF v[68:71],a[228:231],a[92:95],v[68:71]
s_waitcnt vmcnt(34) lgkmcnt(4)
s_barrier
MF v[72:75],a[232:235],a[84:87],v[72:75]
TR a[224:225],v226,36864
MF v[76:79],a[232:235],a[88:91],v[76:79]
TR a[226:227],v226,43008
MF v[80:83],a[232:235],a[92:95],v[80:83]
s_add_u32 m0,s32,24576
TR a[228:229],v227,36864
MF v[84:87],a[236:239],a[84:87],v[84:87]
s_add_u32 s36,s78,122880
TR a[230:231],v227,43008
MF v[88:91],a[236:239],a[88:91],v[88:91]
buffer_load_dwordx4 v239,s[20:23],s36 offen offset:0 lds
MF v[92:95],a[236:239],a[92:95],v[92:95]
s_waitcnt lgkmcnt(4)
MF v[96:99],a[216:219],a[84:87],v[96:99]
TR a[232:233],v226,36928
MF v[100:103],a[216:219],a[88:91],v[100:103]
TR a[234:235],v226,43072
MF v[104:107],a[216:219],a[92:95],v[104:107]
TR a[236:237],v227,36928
MF v[108:111],a[220:223],a[84:87],v[108:111]
TR a[238:239],v227,43072
MF v[112:115],a[220:223],a[88:91],v[112:115]
buffer_load_dwordx4 a[32:35],v246,s[24:27],s62 offen offset:2048 sc1
MF v[116:119],a[220:223],a[92:95],v[116:119]
s_waitcnt lgkmcnt(4)
L_st124:
MF v[0:3],a[224:227],a[96:99],v[0:3]
TR a[216:217],v226,36992
MF v[4:7],a[224:227],a[100:103],v[4:7]
TR a[218:219],v226,43136
MF v[8:11],a[224:227],a[104:107],v[8:11]
TR a[220:221],v227,36992
MF v[12:15],a[228:231],a[96:99],v[12:15]
TR a[222:223],v227,43136
MF v[16:19],a[228:231],a[100:103],v[16:19]
buffer_load_dwordx4 v240,s[20:23],s36 offen offset:1024 lds
MF v[20:23],a[228:231],a[104:107],v[20:23]
s_waitcnt lgkmcnt(4)
MF v[24:27],a[232:235],a[96:99],v[24:27]
TR a[224:225],v226,37056
MF v[28:31],a[232:235],a[100:103],v[28:31]
TR a[226:227],v226,43200
MF v[32:35],a[232:235],a[104:107],v[32:35]
TR a[228:229],v227,37056
MF v[36:39],a[236:239],a[96:99],v[36:39]
s_add_u32 s63,s81,9216
TR a[230:231],v227,43200
MF v[40:43],a[236:239],a[100:103],v[40:43]
buffer_load_dwordx4 v241,s[20:23],s36 offen offset:2048 lds
MF v[44:47],a[236:239],a[104:107],v[44:47]
s_waitcnt lgkmcnt(4)
buffer_load_dwordx4 a[36:39],v246,s[24:27],s63 offen offset:0 sc1
MF v[48:51],a[216:219],a[96:99],v[48:51]
TR a[232:233],v226,37120
MF v[52:55],a[216:219],a[100:103],v[52:55]
TR a[234:235],v226,43264
MF v[56:59],a[216:219],a[104:107],v[56:59]
TR a[236:237],v227,37120
MF v[60:63],a[220:223],a[96:99],v[60:63]
TR a[238:239],v227,43264
MF v[64:67],a[220:223],a[100:103],v[64:67]
buffer_load_dwordx4 a[40:43],v246,s[24:27],s63 offen offset:1024 sc1
MF v[68:71],a[220:223],a[104:107],v[68:71]
s_waitcnt vmcnt(34) lgkmcnt(4)
s_barrier
MF v[72:75],a[224:227],a[96:99],v[72:75]
TR a[216:217],v228,36864
MF v[76:79],a[224:227],a[100:103],v[76:79]
TR a[218:219],v228,43008
MF v[80:83],a[224:227],a[104:107],v[80:83]
s_add_u32 m0,s32,36864
TR a[220:221],v229,36864
MF v[84:87],a[228:231],a[96:99],v[84:87]
s_add_u32 s35,s78,163840
TR a[222:223],v229,43008
MF v[88:91],a[228:231],a[100:103],v[88:91]
buffer_load_dwordx4 v239,s[20:23],s35 offen offset:0 lds
MF v[92:95],a[228:231],a[104:107],v[92:95]
s_waitcnt lgkmcnt(4)
MF v[96:99],a[232:235],a[96:99],v[96:99]
TR a[224:225],v228,36928
MF v[100:103],a[232:235],a[100:103],v[100:103]
TR a[226:227],v228,43072
MF v[104:107],a[232:235],a[104:107],v[104:107]
TR a[228:229],v229,36928
MF v[108:111],a[236:239],a[96:99],v[108:111]
TR a[230:231],v229,43072
MF v[112:115],a[236:239],a[100:103],v[112:115]
buffer_load_dwordx4 a[44:47],v246,s[24:27],s63 offen offset:2048 sc1
MF v[116:119],a[236:239],a[104:107],v[116:119]
s_waitcnt lgkmcnt(4)
L_st125:
MF v[0:3],a[216:219],a[108:111],v[0:3]
TR a[232:233],v228,36992
MF v[4:7],a[216:219],a[112:115],v[4:7]
TR a[234:235],v228,43136
MF v[8:11],a[216:219],a[116:119],v[8:11]
TR a[236:237],v229,36992
v_add_u32 v226,73728,v226
MF v[12:15],a[220:223],a[108:111],v[12:15]
TR a[238:239],v229,43136
v_add_u32 v227,73728,v227
MF v[16:19],a[220:223],a[112:115],v[16:19]
buffer_load_dwordx4 v240,s[20:23],s35 offen offset:1024 lds
MF v[20:23],a[220:223],a[116:119],v[20:23]
s_waitcnt lgkmcnt(4)
MF v[24:27],a[224:227],a[108:111],v[24:27]
TR a[216:217],v228,37056
MF v[28:31],a[224:227],a[112:115],v[28:31]
TR a[218:219],v228,43200
MF v[32:35],a[224:227],a[116:119],v[32:35]
TR a[220:221],v229,37056
MF v[36:39],a[228:231],a[108:111],v[36:39]
s_add_u32 s62,s81,12288
TR a[222:223],v229,43200
MF v[40:43],a[228:231],a[112:115],v[40:43]
buffer_load_dwordx4 v241,s[20:23],s35 offen offset:2048 lds
MF v[44:47],a[228:231],a[116:119],v[44:47]
s_waitcnt lgkmcnt(4)
buffer_load_dwordx4 a[48:51],v246,s[24:27],s62 offen offset:0 sc1
MF v[48:51],a[232:235],a[108:111],v[48:51]
TR a[224:225],v228,37120
MF v[52:55],a[232:235],a[112:115],v[52:55]
TR a[226:227],v228,43264
MF v[56:59],a[232:235],a[116:119],v[56:59]
TR a[228:229],v229,37120
MF v[60:63],a[236:239],a[108:111],v[60:63]
TR a[230:231],v229,43264
MF v[64:67],a[236:239],a[112:115],v[64:67]
buffer_load_dwordx4 a[52:55],v246,s[24:27],s62 offen offset:1024 sc1
MF v[68:71],a[236:239],a[116:119],v[68:71]
s_waitcnt vmcnt(34) lgkmcnt(4)
s_barrier
MF v[72:75],a[216:219],a[108:111],v[72:75]
TR a[232:233],v226,0
MF v[76:79],a[216:219],a[112:115],v[76:79]
TR a[234:235],v226,6144
MF v[80:83],a[216:219],a[116:119],v[80:83]
s_add_u32 m0,s32,49152
TR a[236:237],v227,0
MF v[84:87],a[220:223],a[108:111],v[84:87]
s_add_u32 s36,s78,204800
TR a[238:239],v227,6144
MF v[88:91],a[220:223],a[112:115],v[88:91]
buffer_load_dwordx4 v239,s[20:23],s36 offen offset:0 lds
MF v[92:95],a[220:223],a[116:119],v[92:95]
s_waitcnt lgkmcnt(4)
MF v[96:99],a[224:227],a[108:111],v[96:99]
TR a[216:217],v226,64
MF v[100:103],a[224:227],a[112:115],v[100:103]
TR a[218:219],v226,6208
MF v[104:107],a[224:227],a[116:119],v[104:107]
TR a[220:221],v227,64
MF v[108:111],a[228:231],a[108:111],v[108:111]
TR a[222:223],v227,6208
MF v[112:115],a[228:231],a[112:115],v[112:115]
buffer_load_dwordx4 a[56:59],v246,s[24:27],s62 offen offset:2048 sc1
MF v[116:119],a[228:231],a[116:119],v[116:119]
s_waitcnt lgkmcnt(4)
L_st126:
MF v[0:3],a[232:235],a[120:123],v[0:3]
TR a[224:225],v226,128
MF v[4:7],a[232:235],a[124:127],v[4:7]
TR a[226:227],v226,6272
MF v[8:11],a[232:235],a[128:131],v[8:11]
TR a[228:229],v227,128
v_add_u32 v228,61440,v228
MF v[12:15],a[236:239],a[120:123],v[12:15]
TR a[230:231],v227,6272
v_add_u32 v229,61440,v229
MF v[16:19],a[236:239],a[124:127],v[16:19]
buffer_load_dwordx4 v240,s[20:23],s36 offen offset:1024 lds
MF v[20:23],a[236:239],a[128:131],v[20:23]
s_waitcnt lgkmcnt(4)
MF v[24:27],a[216:219],a[120:123],v[24:27]
TR a[232:233],v226,192
MF v[28:31],a[216:219],a[124:127],v[28:31]
TR a[234:235],v226,6336
MF v[32:35],a[216:219],a[128:131],v[32:35]
TR a[236:237],v227,192
MF v[36:39],a[220:223],a[120:123],v[36:39]
s_add_u32 s63,s81,15360
TR a[238:239],v227,6336
MF v[40:43],a[220:223],a[124:127],v[40:43]
buffer_load_dwordx4 v241,s[20:23],s36 offen offset:2048 lds
MF v[44:47],a[220:223],a[128:131],v[44:47]
s_waitcnt lgkmcnt(4)
buffer_load_dwordx4 a[60:63],v246,s[24:27],s63 offen offset:0 sc1
MF v[48:51],a[224:227],a[120:123],v[48:51]
TR a[216:217],v226,256
MF v[52:55],a[224:227],a[124:127],v[52:55]
TR a[218:219],v226,6400
MF v[56:59],a[224:227],a[128:131],v[56:59]
TR a[220:221],v227,256
MF v[60:63],a[228:231],a[120:123],v[60:63]
TR a[222:223],v227,6400
MF v[64:67],a[228:231],a[124:127],v[64:67]
buffer_load_dwordx4 a[64:67],v246,s[24:27],s63 offen offset:1024 sc1
MF v[68:71],a[228:231],a[128:131],v[68:71]
s_waitcnt vmcnt(34) lgkmcnt(4)
s_barrier
MF v[72:75],a[232:235],a[120:123],v[72:75]
TR a[224:225],v228,0
MF v[76:79],a[232:235],a[124:127],v[76:79]
TR a[226:227],v228,6144
MF v[80:83],a[232:235],a[128:131],v[80:83]
s_add_u32 m0,s32,73728
TR a[228:229],v229,0
MF v[84:87],a[236:239],a[120:123],v[84:87]
s_add_u32 s35,s78,245760
TR a[230:231],v229,6144
MF v[88:91],a[236:239],a[124:127],v[88:91]
buffer_load_dwordx4 v239,s[20:23],s35 offen offset:0 lds
MF v[92:95],a[236:239],a[128:131],v[92:95]
s_waitcnt lgkmcnt(4)
MF v[96:99],a[216:219],a[120:123],v[96:99]
TR a[232:233],v228,64
MF v[100:103],a[216:219],a[124:127],v[100:103]
TR a[234:235],v228,6208
MF v[104:107],a[216:219],a[128:131],v[104:107]
TR a[236:237],v229,64
MF v[108:111],a[220:223],a[120:123],v[108:111]
TR a[238:239],v229,6208
MF v[112:115],a[220:223],a[124:127],v[112:115]
buffer_load_dwordx4 a[68:71],v246,s[24:27],s63 offen offset:2048 sc1
MF v[116:119],a[220:223],a[128:131],v[116:119]
s_waitcnt lgkmcnt(4)
L_st127:
MF v[0:3],a[224:227],a[132:135],v[0:3]
TR a[216:217],v228,128
MF v[4:7],a[224:227],a[136:139],v[4:7]
TR a[218:219],v228,6272
MF v[8:11],a[224:227],a[140:143],v[8:11]
TR a[220:221],v229,128
v_subrev_u32 v226,86016,v226
MF v[12:15],a[228:231],a[132:135],v[12:15]
TR a[222:223],v229,6272
v_subrev_u32 v227,86016,v227
MF v[16:19],a[228:231],a[136:139],v[16:19]
buffer_load_dwordx4 v240,s[20:23],s35 offen offset:1024 lds
MF v[20:23],a[228:231],a[140:143],v[20:23]
s_waitcnt lgkmcnt(4)
MF v[24:27],a[232:235],a[132:135],v[24:27]
TR a[224:225],v228,192
MF v[28:31],a[232:235],a[136:139],v[28:31]
TR a[226:227],v228,6336
MF v[32:35],a[232:235],a[140:143],v[32:35]
TR a[228:229],v229,192
MF v[36:39],a[236:239],a[132:135],v[36:39]
s_add_u32 s62,s81,73728
TR a[230:231],v229,6336
MF v[40:43],a[236:239],a[136:139],v[40:43]
buffer_load_dwordx4 v241,s[20:23],s35 offen offset:2048 lds
MF v[44:47],a[236:239],a[140:143],v[44:47]
s_waitcnt lgkmcnt(4)
buffer_load_dwordx4 a[72:75],v246,s[24:27],s62 offen offset:0 sc1
MF v[48:51],a[216:219],a[132:135],v[48:51]
TR a[232:233],v228,256
MF v[52:55],a[216:219],a[136:139],v[52:55]
TR a[234:235],v228,6400
MF v[56:59],a[216:219],a[140:143],v[56:59]
TR a[236:237],v229,256
MF v[60:63],a[220:223],a[132:135],v[60:63]
TR a[238:239],v229,6400
MF v[64:67],a[220:223],a[136:139],v[64:67]
buffer_load_dwordx4 a[76:79],v246,s[24:27],s62 offen offset:1024 sc1
MF v[68:71],a[220:223],a[140:143],v[68:71]
s_waitcnt vmcnt(34) lgkmcnt(4)
s_barrier
MF v[72:75],a[224:227],a[132:135],v[72:75]
TR a[216:217],v226,0
MF v[76:79],a[224:227],a[136:139],v[76:79]
TR a[218:219],v226,6144
MF v[80:83],a[224:227],a[140:143],v[80:83]
s_add_u32 m0,s32,86016
TR a[220:221],v227,0
MF v[84:87],a[228:231],a[132:135],v[84:87]
s_add_u32 s36,s78,286720
TR a[222:223],v227,6144
MF v[88:91],a[228:231],a[136:139],v[88:91]
buffer_load_dwordx4 v239,s[20:23],s36 offen offset:0 lds
MF v[92:95],a[228:231],a[140:143],v[92:95]
s_waitcnt lgkmcnt(4)
MF v[96:99],a[232:235],a[132:135],v[96:99]
TR a[224:225],v226,64
MF v[100:103],a[232:235],a[136:139],v[100:103]
TR a[226:227],v226,6208
MF v[104:107],a[232:235],a[140:143],v[104:107]
TR a[228:229],v227,64
MF v[108:111],a[236:239],a[132:135],v[108:111]
TR a[230:231],v227,6208
MF v[112:115],a[236:239],a[136:139],v[112:115]
buffer_load_dwordx4 a[80:83],v246,s[24:27],s62 offen offset:2048 sc1
MF v[116:119],a[236:239],a[140:143],v[116:119]
s_waitcnt lgkmcnt(4)
L_st128:
MF v[0:3],a[216:219],a[0:3],v[0:3]
TR a[232:233],v226,128
MF v[4:7],a[216:219],a[4:7],v[4:7]
TR a[234:235],v226,6272
MF v[8:11],a[216:219],a[8:11],v[8:11]
TR a[236:237],v227,128
v_subrev_u32 v228,86016,v228
MF v[12:15],a[220:223],a[0:3],v[12:15]
TR a[238:239],v227,6272
v_subrev_u32 v229,86016,v229
MF v[16:19],a[220:223],a[4:7],v[16:19]
buffer_load_dwordx4 v240,s[20:23],s36 offen offset:1024 lds
MF v[20:23],a[220:223],a[8:11],v[20:23]
s_waitcnt lgkmcnt(4)
MF v[24:27],a[224:227],a[0:3],v[24:27]
TR a[216:217],v226,192
MF v[28:31],a[224:227],a[4:7],v[28:31]
TR a[218:219],v226,6336
MF v[32:35],a[224:227],a[8:11],v[32:35]
TR a[220:221],v227,192
MF v[36:39],a[228:231],a[0:3],v[36:39]
s_add_u32 s63,s81,76800
TR a[222:223],v227,6336
MF v[40:43],a[228:231],a[4:7],v[40:43]
buffer_load_dwordx4 v241,s[20:23],s36 offen offset:2048 lds
MF v[44:47],a[228:231],a[8:11],v[44:47]
s_waitcnt lgkmcnt(4)
buffer_load_dwordx4 a[84:87],v246,s[24:27],s63 offen offset:0 sc1
MF v[48:51],a[232:235],a[0:3],v[48:51]
TR a[224:225],v226,256
MF v[52:55],a[232:235],a[4:7],v[52:55]
TR a[226:227],v226,6400
MF v[56:59],a[232:235],a[8:11],v[56:59]
TR a[228:229],v227,256
MF v[60:63],a[236:239],a[0:3],v[60:63]
TR a[230:231],v227,6400
MF v[64:67],a[236:239],a[4:7],v[64:67]
buffer_load_dwordx4 a[88:91],v246,s[24:27],s63 offen offset:1024 sc1
MF v[68:71],a[236:239],a[8:11],v[68:71]
s_waitcnt vmcnt(34) lgkmcnt(4)
s_barrier
MF v[72:75],a[216:219],a[0:3],v[72:75]
TR a[232:233],v228,0
MF v[76:79],a[216:219],a[4:7],v[76:79]
TR a[234:235],v228,6144
MF v[80:83],a[216:219],a[8:11],v[80:83]
s_add_u32 m0,s32,98304
TR a[236:237],v229,0
MF v[84:87],a[220:223],a[0:3],v[84:87]
s_add_u32 s35,s78,327680
TR a[238:239],v229,6144
MF v[88:91],a[220:223],a[4:7],v[88:91]
buffer_load_dwordx4 v239,s[20:23],s35 offen offset:0 lds
MF v[92:95],a[220:223],a[8:11],v[92:95]
s_waitcnt lgkmcnt(4)
MF v[96:99],a[224:227],a[0:3],v[96:99]
TR a[216:217],v228,64
MF v[100:103],a[224:227],a[4:7],v[100:103]
TR a[218:219],v228,6208
MF v[104:107],a[224:227],a[8:11],v[104:107]
TR a[220:221],v229,64
MF v[108:111],a[228:231],a[0:3],v[108:111]
TR a[222:223],v229,6208
MF v[112:115],a[228:231],a[4:7],v[112:115]
buffer_load_dwordx4 a[92:95],v246,s[24:27],s63 offen offset:2048 sc1
MF v[116:119],a[228:231],a[8:11],v[116:119]
s_waitcnt lgkmcnt(4)
L_st129:
s_lshr_b32 s56,s2,3
s_and_b32 s56,s56,7
s_cmp_eq_u32 s56,0
s_cbranch_scc0 L_pcs7
s_getpc_b64 s[56:57]
L_pc7:
s_add_u32 s56,s56,L_code+98304-L_pc7
s_addc_u32 s57,s57,0
v_mov_b32 v249,s57
v_add_co_u32 v248,vcc,s56,v252
s_nop 1
v_addc_co_u32 v249,vcc,0,v249,vcc
global_load_dword a255,v[248:249],off
L_pcs7:
MF v[0:3],a[232:235],a[12:15],v[0:3]
TR a[224:225],v228,128
MF v[4:7],a[232:235],a[16:19],v[4:7]
TR a[226:227],v228,6272
MF v[8:11],a[232:235],a[20:23],v[8:11]
TR a[228:229],v229,128
v_add_u32 v226,36864,v226
MF v[12:15],a[236:239],a[12:15],v[12:15]
TR a[230:231],v229,6272
v_add_u32 v227,36864,v227
MF v[16:19],a[236:239],a[16:19],v[16:19]
buffer_load_dwordx4 v240,s[20:23],s35 offen offset:1024 lds
MF v[20:23],a[236:239],a[20:23],v[20:23]
s_waitcnt lgkmcnt(4)
MF v[24:27],a[216:219],a[12:15],v[24:27]
TR a[232:233],v228,192
MF v[28:31],a[216:219],a[16:19],v[28:31]
TR a[234:235],v228,6336
MF v[32:35],a[216:219],a[20:23],v[32:35]
TR a[236:237],v229,192
MF v[36:39],a[220:223],a[12:15],v[36:39]
s_add_u32 s62,s81,79872
TR a[238:239],v229,6336
MF v[40:43],a[220:223],a[16:19],v[40:43]
buffer_load_dwordx4 v241,s[20:23],s35 offen offset:2048 lds
MF v[44:47],a[220:223],a[20:23],v[44:47]
s_waitcnt lgkmcnt(4)
buffer_load_dwordx4 a[96:99],v246,s[24:27],s62 offen offset:0 sc1
MF v[48:51],a[224:227],a[12:15],v[48:51]
TR a[216:217],v228,256
MF v[52:55],a[224:227],a[16:19],v[52:55]
TR a[218:219],v228,6400
MF v[56:59],a[224:227],a[20:23],v[56:59]
TR a[220:221],v229,256
MF v[60:63],a[228:231],a[12:15],v[60:63]
TR a[222:223],v229,6400
MF v[64:67],a[228:231],a[16:19],v[64:67]
buffer_load_dwordx4 a[100:103],v246,s[24:27],s62 offen offset:1024 sc1
MF v[68:71],a[228:231],a[20:23],v[68:71]
s_waitcnt vmcnt(34) lgkmcnt(4)
s_barrier
MF v[72:75],a[232:235],a[12:15],v[72:75]
TR a[224:225],v226,24576
MF v[76:79],a[232:235],a[16:19],v[76:79]
TR a[226:227],v226,30720
MF v[80:83],a[232:235],a[20:23],v[80:83]
s_add_u32 m0,s32,0
TR a[228:229],v227,24576
MF v[84:87],a[236:239],a[12:15],v[84:87]
s_add_u32 s36,s78,368640
TR a[230:231],v227,30720
MF v[88:91],a[236:239],a[16:19],v[88:91]
buffer_load_dwordx4 v239,s[20:23],s36 offen offset:0 lds
MF v[92:95],a[236:239],a[20:23],v[92:95]
s_waitcnt lgkmcnt(4)
MF v[96:99],a[216:219],a[12:15],v[96:99]
TR a[232:233],v226,24640
MF v[100:103],a[216:219],a[16:19],v[100:103]
TR a[234:235],v226,30784
MF v[104:107],a[216:219],a[20:23],v[104:107]
TR a[236:237],v227,24640
MF v[108:111],a[220:223],a[12:15],v[108:111]
TR a[238:239],v227,30784
MF v[112:115],a[220:223],a[16:19],v[112:115]
buffer_load_dwordx4 a[104:107],v246,s[24:27],s62 offen offset:2048 sc1
MF v[116:119],a[220:223],a[20:23],v[116:119]
s_waitcnt lgkmcnt(4)
L_st130:
MF v[0:3],a[224:227],a[24:27],v[0:3]
TR a[216:217],v226,24704
MF v[4:7],a[224:227],a[28:31],v[4:7]
TR a[218:219],v226,30848
MF v[8:11],a[224:227],a[32:35],v[8:11]
TR a[220:221],v227,24704
MF v[12:15],a[228:231],a[24:27],v[12:15]
TR a[222:223],v227,30848
MF v[16:19],a[228:231],a[28:31],v[16:19]
buffer_load_dwordx4 v240,s[20:23],s36 offen offset:1024 lds
MF v[20:23],a[228:231],a[32:35],v[20:23]
s_waitcnt lgkmcnt(4)
MF v[24:27],a[232:235],a[24:27],v[24:27]
TR a[224:225],v226,24768
MF v[28:31],a[232:235],a[28:31],v[28:31]
TR a[226:227],v226,30912
MF v[32:35],a[232:235],a[32:35],v[32:35]
TR a[228:229],v227,24768
MF v[36:39],a[236:239],a[24:27],v[36:39]
s_add_u32 s63,s81,82944
TR a[230:231],v227,30912
MF v[40:43],a[236:239],a[28:31],v[40:43]
buffer_load_dwordx4 v241,s[20:23],s36 offen offset:2048 lds
MF v[44:47],a[236:239],a[32:35],v[44:47]
s_waitcnt lgkmcnt(4)
buffer_load_dwordx4 a[108:111],v246,s[24:27],s63 offen offset:0 sc1
MF v[48:51],a[216:219],a[24:27],v[48:51]
TR a[232:233],v226,24832
MF v[52:55],a[216:219],a[28:31],v[52:55]
TR a[234:235],v226,30976
MF v[56:59],a[216:219],a[32:35],v[56:59]
TR a[236:237],v227,24832
MF v[60:63],a[220:223],a[24:27],v[60:63]
TR a[238:239],v227,30976
MF v[64:67],a[220:223],a[28:31],v[64:67]
buffer_load_dwordx4 a[112:115],v246,s[24:27],s63 offen offset:1024 sc1
MF v[68:71],a[220:223],a[32:35],v[68:71]
s_waitcnt vmcnt(34) lgkmcnt(4)
s_barrier
MF v[72:75],a[224:227],a[24:27],v[72:75]
TR a[216:217],v228,12288
MF v[76:79],a[224:227],a[28:31],v[76:79]
TR a[218:219],v228,18432
MF v[80:83],a[224:227],a[32:35],v[80:83]
s_add_u32 m0,s32,12288
TR a[220:221],v229,12288
MF v[84:87],a[228:231],a[24:27],v[84:87]
s_add_u32 s35,s78,409600
TR a[222:223],v229,18432
MF v[88:91],a[228:231],a[28:31],v[88:91]
buffer_load_dwordx4 v239,s[20:23],s35 offen offset:0 lds
MF v[92:95],a[228:231],a[32:35],v[92:95]
s_waitcnt lgkmcnt(4)
MF v[96:99],a[232:235],a[24:27],v[96:99]
TR a[224:225],v228,12352
MF v[100:103],a[232:235],a[28:31],v[100:103]
TR a[226:227],v228,18496
MF v[104:107],a[232:235],a[32:35],v[104:107]
TR a[228:229],v229,12352
MF v[108:111],a[236:239],a[24:27],v[108:111]
TR a[230:231],v229,18496
MF v[112:115],a[236:239],a[28:31],v[112:115]
buffer_load_dwordx4 a[116:119],v246,s[24:27],s63 offen offset:2048 sc1
MF v[116:119],a[236:239],a[32:35],v[116:119]
s_waitcnt lgkmcnt(4)
L_st131:
MF v[0:3],a[216:219],a[36:39],v[0:3]
TR a[232:233],v228,12416
MF v[4:7],a[216:219],a[40:43],v[4:7]
TR a[234:235],v228,18560
MF v[8:11],a[216:219],a[44:47],v[8:11]
TR a[236:237],v229,12416
MF v[12:15],a[220:223],a[36:39],v[12:15]
TR a[238:239],v229,18560
MF v[16:19],a[220:223],a[40:43],v[16:19]
buffer_load_dwordx4 v240,s[20:23],s35 offen offset:1024 lds
MF v[20:23],a[220:223],a[44:47],v[20:23]
s_waitcnt lgkmcnt(4)
MF v[24:27],a[224:227],a[36:39],v[24:27]
TR a[216:217],v228,12480
MF v[28:31],a[224:227],a[40:43],v[28:31]
TR a[218:219],v228,18624
MF v[32:35],a[224:227],a[44:47],v[32:35]
TR a[220:221],v229,12480
MF v[36:39],a[228:231],a[36:39],v[36:39]
s_add_u32 s62,s81,86016
TR a[222:223],v229,18624
MF v[40:43],a[228:231],a[40:43],v[40:43]
buffer_load_dwordx4 v241,s[20:23],s35 offen offset:2048 lds
MF v[44:47],a[228:231],a[44:47],v[44:47]
s_waitcnt lgkmcnt(4)
buffer_load_dwordx4 a[120:123],v246,s[24:27],s62 offen offset:0 sc1
MF v[48:51],a[232:235],a[36:39],v[48:51]
TR a[224:225],v228,12544
MF v[52:55],a[232:235],a[40:43],v[52:55]
TR a[226:227],v228,18688
MF v[56:59],a[232:235],a[44:47],v[56:59]
TR a[228:229],v229,12544
MF v[60:63],a[236:239],a[36:39],v[60:63]
TR a[230:231],v229,18688
MF v[64:67],a[236:239],a[40:43],v[64:67]
buffer_load_dwordx4 a[124:127],v246,s[24:27],s62 offen offset:1024 sc1
MF v[68:71],a[236:239],a[44:47],v[68:71]
s_waitcnt vmcnt(34) lgkmcnt(4)
s_barrier
MF v[72:75],a[216:219],a[36:39],v[72:75]
TR a[232:233],v226,0
MF v[76:79],a[216:219],a[40:43],v[76:79]
TR a[234:235],v226,6144
MF v[80:83],a[216:219],a[44:47],v[80:83]
s_add_u32 m0,s32,61440
TR a[236:237],v227,0
MF v[84:87],a[220:223],a[36:39],v[84:87]
s_add_u32 s36,s78,450560
TR a[238:239],v227,6144
MF v[88:91],a[220:223],a[40:43],v[88:91]
buffer_load_dwordx4 v239,s[20:23],s36 offen offset:0 lds
MF v[92:95],a[220:223],a[44:47],v[92:95]
s_waitcnt lgkmcnt(4)
MF v[96:99],a[224:227],a[36:39],v[96:99]
TR a[216:217],v226,64
MF v[100:103],a[224:227],a[40:43],v[100:103]
TR a[218:219],v226,6208
MF v[104:107],a[224:227],a[44:47],v[104:107]
TR a[220:221],v227,64
MF v[108:111],a[228:231],a[36:39],v[108:111]
TR a[222:223],v227,6208
MF v[112:115],a[228:231],a[40:43],v[112:115]
buffer_load_dwordx4 a[128:131],v246,s[24:27],s62 offen offset:2048 sc1
MF v[116:119],a[228:231],a[44:47],v[116:119]
s_waitcnt lgkmcnt(4)
L_st132:
MF v[0:3],a[232:235],a[48:51],v[0:3]
TR a[224:225],v226,128
MF v[4:7],a[232:235],a[52:55],v[4:7]
TR a[226:227],v226,6272
MF v[8:11],a[232:235],a[56:59],v[8:11]
TR a[228:229],v227,128
MF v[12:15],a[236:239],a[48:51],v[12:15]
TR a[230:231],v227,6272
MF v[16:19],a[236:239],a[52:55],v[16:19]
buffer_load_dwordx4 v240,s[20:23],s36 offen offset:1024 lds
MF v[20:23],a[236:239],a[56:59],v[20:23]
s_waitcnt lgkmcnt(4)
MF v[24:27],a[216:219],a[48:51],v[24:27]
TR a[232:233],v226,192
MF v[28:31],a[216:219],a[52:55],v[28:31]
TR a[234:235],v226,6336
MF v[32:35],a[216:219],a[56:59],v[32:35]
TR a[236:237],v227,192
MF v[36:39],a[220:223],a[48:51],v[36:39]
s_add_u32 s63,s81,89088
TR a[238:239],v227,6336
MF v[40:43],a[220:223],a[52:55],v[40:43]
buffer_load_dwordx4 v241,s[20:23],s36 offen offset:2048 lds
MF v[44:47],a[220:223],a[56:59],v[44:47]
s_waitcnt lgkmcnt(4)
buffer_load_dwordx4 a[132:135],v246,s[24:27],s63 offen offset:0 sc1
MF v[48:51],a[224:227],a[48:51],v[48:51]
TR a[216:217],v226,256
MF v[52:55],a[224:227],a[52:55],v[52:55]
TR a[218:219],v226,6400
MF v[56:59],a[224:227],a[56:59],v[56:59]
TR a[220:221],v227,256
MF v[60:63],a[228:231],a[48:51],v[60:63]
TR a[222:223],v227,6400
MF v[64:67],a[228:231],a[52:55],v[64:67]
buffer_load_dwordx4 a[136:139],v246,s[24:27],s63 offen offset:1024 sc1
MF v[68:71],a[228:231],a[56:59],v[68:71]
s_waitcnt vmcnt(34) lgkmcnt(4)
s_barrier
MF v[72:75],a[232:235],a[48:51],v[72:75]
TR a[224:225],v228,36864
MF v[76:79],a[232:235],a[52:55],v[76:79]
TR a[226:227],v228,43008
MF v[80:83],a[232:235],a[56:59],v[80:83]
s_add_u32 m0,s32,24576
TR a[228:229],v229,36864
MF v[84:87],a[236:239],a[48:51],v[84:87]
s_add_u32 s35,s79,0
TR a[230:231],v229,43008
MF v[88:91],a[236:239],a[52:55],v[88:91]
buffer_load_dwordx4 v239,s[20:23],s35 offen offset:0 lds
MF v[92:95],a[236:239],a[56:59],v[92:95]
s_waitcnt lgkmcnt(4)
MF v[96:99],a[216:219],a[48:51],v[96:99]
TR a[232:233],v228,36928
MF v[100:103],a[216:219],a[52:55],v[100:103]
TR a[234:235],v228,43072
MF v[104:107],a[216:219],a[56:59],v[104:107]
TR a[236:237],v229,36928
MF v[108:111],a[220:223],a[48:51],v[108:111]
TR a[238:239],v229,43072
MF v[112:115],a[220:223],a[52:55],v[112:115]
buffer_load_dwordx4 a[140:143],v246,s[24:27],s63 offen offset:2048 sc1
MF v[116:119],a[220:223],a[56:59],v[116:119]
s_waitcnt lgkmcnt(4)
L_st133:
MF v[0:3],a[224:227],a[60:63],v[0:3]
TR a[216:217],v228,36992
MF v[4:7],a[224:227],a[64:67],v[4:7]
TR a[218:219],v228,43136
MF v[8:11],a[224:227],a[68:71],v[8:11]
TR a[220:221],v229,36992
MF v[12:15],a[228:231],a[60:63],v[12:15]
TR a[222:223],v229,43136
MF v[16:19],a[228:231],a[64:67],v[16:19]
buffer_load_dwordx4 v240,s[20:23],s35 offen offset:1024 lds
MF v[20:23],a[228:231],a[68:71],v[20:23]
s_waitcnt lgkmcnt(4)
MF v[24:27],a[232:235],a[60:63],v[24:27]
TR a[224:225],v228,37056
MF v[28:31],a[232:235],a[64:67],v[28:31]
TR a[226:227],v228,43200
MF v[32:35],a[232:235],a[68:71],v[32:35]
TR a[228:229],v229,37056
MF v[36:39],a[236:239],a[60:63],v[36:39]
s_add_u32 s62,s82,0
TR a[230:231],v229,43200
MF v[40:43],a[236:239],a[64:67],v[40:43]
buffer_load_dwordx4 v241,s[20:23],s35 offen offset:2048 lds
MF v[44:47],a[236:239],a[68:71],v[44:47]
s_waitcnt lgkmcnt(4)
buffer_load_dwordx4 a[0:3],v246,s[24:27],s62 offen offset:0 sc1
MF v[48:51],a[216:219],a[60:63],v[48:51]
TR a[232:233],v228,37120
MF v[52:55],a[216:219],a[64:67],v[52:55]
TR a[234:235],v228,43264
MF v[56:59],a[216:219],a[68:71],v[56:59]
TR a[236:237],v229,37120
MF v[60:63],a[220:223],a[60:63],v[60:63]
TR a[238:239],v229,43264
MF v[64:67],a[220:223],a[64:67],v[64:67]
buffer_load_dwordx4 a[4:7],v246,s[24:27],s62 offen offset:1024 sc1
MF v[68:71],a[220:223],a[68:71],v[68:71]
s_waitcnt vmcnt(34) lgkmcnt(4)
s_barrier
MF v[72:75],a[224:227],a[60:63],v[72:75]
TR a[216:217],v226,36864
MF v[76:79],a[224:227],a[64:67],v[76:79]
TR a[218:219],v226,43008
MF v[80:83],a[224:227],a[68:71],v[80:83]
s_add_u32 m0,s32,36864
TR a[220:221],v227,36864
MF v[84:87],a[228:231],a[60:63],v[84:87]
s_add_u32 s36,s79,40960
TR a[222:223],v227,43008
MF v[88:91],a[228:231],a[64:67],v[88:91]
buffer_load_dwordx4 v239,s[20:23],s36 offen offset:0 lds
MF v[92:95],a[228:231],a[68:71],v[92:95]
s_waitcnt lgkmcnt(4)
MF v[96:99],a[232:235],a[60:63],v[96:99]
TR a[224:225],v226,36928
MF v[100:103],a[232:235],a[64:67],v[100:103]
TR a[226:227],v226,43072
MF v[104:107],a[232:235],a[68:71],v[104:107]
TR a[228:229],v227,36928
MF v[108:111],a[236:239],a[60:63],v[108:111]
TR a[230:231],v227,43072
MF v[112:115],a[236:239],a[64:67],v[112:115]
buffer_load_dwordx4 a[8:11],v246,s[24:27],s62 offen offset:2048 sc1
MF v[116:119],a[236:239],a[68:71],v[116:119]
s_waitcnt lgkmcnt(4)
L_st134:
MF v[0:3],a[216:219],a[72:75],v[0:3]
TR a[232:233],v226,36992
MF v[4:7],a[216:219],a[76:79],v[4:7]
TR a[234:235],v226,43136
MF v[8:11],a[216:219],a[80:83],v[8:11]
TR a[236:237],v227,36992
v_add_u32 v228,73728,v228
MF v[12:15],a[220:223],a[72:75],v[12:15]
TR a[238:239],v227,43136
v_add_u32 v229,73728,v229
MF v[16:19],a[220:223],a[76:79],v[16:19]
buffer_load_dwordx4 v240,s[20:23],s36 offen offset:1024 lds
MF v[20:23],a[220:223],a[80:83],v[20:23]
s_waitcnt lgkmcnt(4)
MF v[24:27],a[224:227],a[72:75],v[24:27]
TR a[216:217],v226,37056
MF v[28:31],a[224:227],a[76:79],v[28:31]
TR a[218:219],v226,43200
MF v[32:35],a[224:227],a[80:83],v[32:35]
TR a[220:221],v227,37056
MF v[36:39],a[228:231],a[72:75],v[36:39]
s_add_u32 s63,s82,3072
TR a[222:223],v227,43200
MF v[40:43],a[228:231],a[76:79],v[40:43]
buffer_load_dwordx4 v241,s[20:23],s36 offen offset:2048 lds
MF v[44:47],a[228:231],a[80:83],v[44:47]
s_waitcnt lgkmcnt(4)
buffer_load_dwordx4 a[12:15],v246,s[24:27],s63 offen offset:0 sc1
MF v[48:51],a[232:235],a[72:75],v[48:51]
TR a[224:225],v226,37120
MF v[52:55],a[232:235],a[76:79],v[52:55]
TR a[226:227],v226,43264
MF v[56:59],a[232:235],a[80:83],v[56:59]
TR a[228:229],v227,37120
MF v[60:63],a[236:239],a[72:75],v[60:63]
TR a[230:231],v227,43264
MF v[64:67],a[236:239],a[76:79],v[64:67]
buffer_load_dwordx4 a[16:19],v246,s[24:27],s63 offen offset:1024 sc1
MF v[68:71],a[236:239],a[80:83],v[68:71]
s_waitcnt vmcnt(34) lgkmcnt(4)
s_barrier
MF v[72:75],a[216:219],a[72:75],v[72:75]
TR a[232:233],v228,0
MF v[76:79],a[216:219],a[76:79],v[76:79]
TR a[234:235],v228,6144
MF v[80:83],a[216:219],a[80:83],v[80:83]
s_add_u32 m0,s32,49152
TR a[236:237],v229,0
MF v[84:87],a[220:223],a[72:75],v[84:87]
s_add_u32 s35,s79,81920
TR a[238:239],v229,6144
MF v[88:91],a[220:223],a[76:79],v[88:91]
buffer_load_dwordx4 v239,s[20:23],s35 offen offset:0 lds
MF v[92:95],a[220:223],a[80:83],v[92:95]
s_waitcnt lgkmcnt(4)
MF v[96:99],a[224:227],a[72:75],v[96:99]
TR a[216:217],v228,64
MF v[100:103],a[224:227],a[76:79],v[100:103]
TR a[218:219],v228,6208
MF v[104:107],a[224:227],a[80:83],v[104:107]
TR a[220:221],v229,64
MF v[108:111],a[228:231],a[72:75],v[108:111]
TR a[222:223],v229,6208
MF v[112:115],a[228:231],a[76:79],v[112:115]
buffer_load_dwordx4 a[20:23],v246,s[24:27],s63 offen offset:2048 sc1
MF v[116:119],a[228:231],a[80:83],v[116:119]
s_waitcnt lgkmcnt(4)
L_st135:
MF v[0:3],a[232:235],a[84:87],v[0:3]
TR a[224:225],v228,128
MF v[4:7],a[232:235],a[88:91],v[4:7]
TR a[226:227],v228,6272
MF v[8:11],a[232:235],a[92:95],v[8:11]
TR a[228:229],v229,128
v_add_u32 v226,61440,v226
MF v[12:15],a[236:239],a[84:87],v[12:15]
TR a[230:231],v229,6272
v_add_u32 v227,61440,v227
MF v[16:19],a[236:239],a[88:91],v[16:19]
buffer_load_dwordx4 v240,s[20:23],s35 offen offset:1024 lds
MF v[20:23],a[236:239],a[92:95],v[20:23]
s_waitcnt lgkmcnt(4)
MF v[24:27],a[216:219],a[84:87],v[24:27]
TR a[232:233],v228,192
MF v[28:31],a[216:219],a[88:91],v[28:31]
TR a[234:235],v228,6336
MF v[32:35],a[216:219],a[92:95],v[32:35]
TR a[236:237],v229,192
MF v[36:39],a[220:223],a[84:87],v[36:39]
s_add_u32 s62,s82,6144
TR a[238:239],v229,6336
MF v[40:43],a[220:223],a[88:91],v[40:43]
buffer_load_dwordx4 v241,s[20:23],s35 offen offset:2048 lds
MF v[44:47],a[220:223],a[92:95],v[44:47]
s_waitcnt lgkmcnt(4)
buffer_load_dwordx4 a[24:27],v246,s[24:27],s62 offen offset:0 sc1
MF v[48:51],a[224:227],a[84:87],v[48:51]
TR a[216:217],v228,256
MF v[52:55],a[224:227],a[88:91],v[52:55]
TR a[218:219],v228,6400
MF v[56:59],a[224:227],a[92:95],v[56:59]
TR a[220:221],v229,256
MF v[60:63],a[228:231],a[84:87],v[60:63]
TR a[222:223],v229,6400
MF v[64:67],a[228:231],a[88:91],v[64:67]
buffer_load_dwordx4 a[28:31],v246,s[24:27],s62 offen offset:1024 sc1
MF v[68:71],a[228:231],a[92:95],v[68:71]
s_waitcnt vmcnt(34) lgkmcnt(4)
s_barrier
MF v[72:75],a[232:235],a[84:87],v[72:75]
TR a[224:225],v226,0
MF v[76:79],a[232:235],a[88:91],v[76:79]
TR a[226:227],v226,6144
MF v[80:83],a[232:235],a[92:95],v[80:83]
s_add_u32 m0,s32,73728
TR a[228:229],v227,0
MF v[84:87],a[236:239],a[84:87],v[84:87]
s_add_u32 s36,s79,122880
TR a[230:231],v227,6144
MF v[88:91],a[236:239],a[88:91],v[88:91]
buffer_load_dwordx4 v239,s[20:23],s36 offen offset:0 lds
MF v[92:95],a[236:239],a[92:95],v[92:95]
s_waitcnt lgkmcnt(4)
MF v[96:99],a[216:219],a[84:87],v[96:99]
TR a[232:233],v226,64
MF v[100:103],a[216:219],a[88:91],v[100:103]
TR a[234:235],v226,6208
MF v[104:107],a[216:219],a[92:95],v[104:107]
TR a[236:237],v227,64
MF v[108:111],a[220:223],a[84:87],v[108:111]
TR a[238:239],v227,6208
MF v[112:115],a[220:223],a[88:91],v[112:115]
buffer_load_dwordx4 a[32:35],v246,s[24:27],s62 offen offset:2048 sc1
MF v[116:119],a[220:223],a[92:95],v[116:119]
s_waitcnt lgkmcnt(4)
L_st136:
MF v[0:3],a[224:227],a[96:99],v[0:3]
TR a[216:217],v226,128
MF v[4:7],a[224:227],a[100:103],v[4:7]
TR a[218:219],v226,6272
MF v[8:11],a[224:227],a[104:107],v[8:11]
TR a[220:221],v227,128
v_subrev_u32 v228,86016,v228
MF v[12:15],a[228:231],a[96:99],v[12:15]
TR a[222:223],v227,6272
v_subrev_u32 v229,86016,v229
MF v[16:19],a[228:231],a[100:103],v[16:19]
buffer_load_dwordx4 v240,s[20:23],s36 offen offset:1024 lds
MF v[20:23],a[228:231],a[104:107],v[20:23]
s_waitcnt lgkmcnt(4)
MF v[24:27],a[232:235],a[96:99],v[24:27]
TR a[224:225],v226,192
MF v[28:31],a[232:235],a[100:103],v[28:31]
TR a[226:227],v226,6336
MF v[32:35],a[232:235],a[104:107],v[32:35]
TR a[228:229],v227,192
MF v[36:39],a[236:239],a[96:99],v[36:39]
s_add_u32 s63,s82,9216
TR a[230:231],v227,6336
MF v[40:43],a[236:239],a[100:103],v[40:43]
buffer_load_dwordx4 v241,s[20:23],s36 offen offset:2048 lds
MF v[44:47],a[236:239],a[104:107],v[44:47]
s_waitcnt lgkmcnt(4)
buffer_load_dwordx4 a[36:39],v246,s[24:27],s63 offen offset:0 sc1
MF v[48:51],a[216:219],a[96:99],v[48:51]
TR a[232:233],v226,256
MF v[52:55],a[216:219],a[100:103],v[52:55]
TR a[234:235],v226,6400
MF v[56:59],a[216:219],a[104:107],v[56:59]
TR a[236:237],v227,256
MF v[60:63],a[220:223],a[96:99],v[60:63]
TR a[238:239],v227,6400
MF v[64:67],a[220:223],a[100:103],v[64:67]
buffer_load_dwordx4 a[40:43],v246,s[24:27],s63 offen offset:1024 sc1
MF v[68:71],a[220:223],a[104:107],v[68:71]
s_waitcnt vmcnt(34) lgkmcnt(4)
s_barrier
MF v[72:75],a[224:227],a[96:99],v[72:75]
TR a[216:217],v228,0
MF v[76:79],a[224:227],a[100:103],v[76:79]
TR a[218:219],v228,6144
MF v[80:83],a[224:227],a[104:107],v[80:83]
s_add_u32 m0,s32,86016
TR a[220:221],v229,0
MF v[84:87],a[228:231],a[96:99],v[84:87]
s_add_u32 s35,s79,163840
TR a[222:223],v229,6144
MF v[88:91],a[228:231],a[100:103],v[88:91]
buffer_load_dwordx4 v239,s[20:23],s35 offen offset:0 lds
MF v[92:95],a[228:231],a[104:107],v[92:95]
s_waitcnt lgkmcnt(4)
MF v[96:99],a[232:235],a[96:99],v[96:99]
TR a[224:225],v228,64
MF v[100:103],a[232:235],a[100:103],v[100:103]
TR a[226:227],v228,6208
MF v[104:107],a[232:235],a[104:107],v[104:107]
TR a[228:229],v229,64
MF v[108:111],a[236:239],a[96:99],v[108:111]
TR a[230:231],v229,6208
MF v[112:115],a[236:239],a[100:103],v[112:115]
buffer_load_dwordx4 a[44:47],v246,s[24:27],s63 offen offset:2048 sc1
MF v[116:119],a[236:239],a[104:107],v[116:119]
s_waitcnt lgkmcnt(4)
L_st137:
MF v[0:3],a[216:219],a[108:111],v[0:3]
TR a[232:233],v228,128
MF v[4:7],a[216:219],a[112:115],v[4:7]
TR a[234:235],v228,6272
MF v[8:11],a[216:219],a[116:119],v[8:11]
TR a[236:237],v229,128
v_subrev_u32 v226,86016,v226
MF v[12:15],a[220:223],a[108:111],v[12:15]
TR a[238:239],v229,6272
v_subrev_u32 v227,86016,v227
MF v[16:19],a[220:223],a[112:115],v[16:19]
buffer_load_dwordx4 v240,s[20:23],s35 offen offset:1024 lds
MF v[20:23],a[220:223],a[116:119],v[20:23]
s_waitcnt lgkmcnt(4)
MF v[24:27],a[224:227],a[108:111],v[24:27]
TR a[216:217],v228,192
MF v[28:31],a[224:227],a[112:115],v[28:31]
TR a[218:219],v228,6336
MF v[32:35],a[224:227],a[116:119],v[32:35]
TR a[220:221],v229,192
MF v[36:39],a[228:231],a[108:111],v[36:39]
s_add_u32 s62,s82,12288
TR a[222:223],v229,6336
MF v[40:43],a[228:231],a[112:115],v[40:43]
buffer_load_dwordx4 v241,s[20:23],s35 offen offset:2048 lds
MF v[44:47],a[228:231],a[116:119],v[44:47]
s_waitcnt lgkmcnt(4)
buffer_load_dwordx4 a[48:51],v246,s[24:27],s62 offen offset:0 sc1
MF v[48:51],a[232:235],a[108:111],v[48:51]
TR a[224:225],v228,256
MF v[52:55],a[232:235],a[112:115],v[52:55]
TR a[226:227],v228,6400
MF v[56:59],a[232:235],a[116:119],v[56:59]
TR a[228:229],v229,256
MF v[60:63],a[236:239],a[108:111],v[60:63]
TR a[230:231],v229,6400
MF v[64:67],a[236:239],a[112:115],v[64:67]
buffer_load_dwordx4 a[52:55],v246,s[24:27],s62 offen offset:1024 sc1
MF v[68:71],a[236:239],a[116:119],v[68:71]
s_waitcnt vmcnt(34) lgkmcnt(4)
s_barrier
MF v[72:75],a[216:219],a[108:111],v[72:75]
TR a[232:233],v226,0
MF v[76:79],a[216:219],a[112:115],v[76:79]
TR a[234:235],v226,6144
MF v[80:83],a[216:219],a[116:119],v[80:83]
s_add_u32 m0,s32,98304
TR a[236:237],v227,0
MF v[84:87],a[220:223],a[108:111],v[84:87]
s_add_u32 s36,s79,204800
TR a[238:239],v227,6144
MF v[88:91],a[220:223],a[112:115],v[88:91]
buffer_load_dwordx4 v239,s[20:23],s36 offen offset:0 lds
MF v[92:95],a[220:223],a[116:119],v[92:95]
s_waitcnt lgkmcnt(4)
MF v[96:99],a[224:227],a[108:111],v[96:99]
TR a[216:217],v226,64
MF v[100:103],a[224:227],a[112:115],v[100:103]
TR a[218:219],v226,6208
MF v[104:107],a[224:227],a[116:119],v[104:107]
TR a[220:221],v227,64
MF v[108:111],a[228:231],a[108:111],v[108:111]
TR a[222:223],v227,6208
MF v[112:115],a[228:231],a[112:115],v[112:115]
buffer_load_dwordx4 a[56:59],v246,s[24:27],s62 offen offset:2048 sc1
MF v[116:119],a[228:231],a[116:119],v[116:119]
s_waitcnt lgkmcnt(4)
L_st138:
MF v[0:3],a[232:235],a[120:123],v[0:3]
TR a[224:225],v226,128
MF v[4:7],a[232:235],a[124:127],v[4:7]
TR a[226:227],v226,6272
MF v[8:11],a[232:235],a[128:131],v[8:11]
TR a[228:229],v227,128
v_add_u32 v228,36864,v228
MF v[12:15],a[236:239],a[120:123],v[12:15]
TR a[230:231],v227,6272
v_add_u32 v229,36864,v229
MF v[16:19],a[236:239],a[124:127],v[16:19]
buffer_load_dwordx4 v240,s[20:23],s36 offen offset:1024 lds
MF v[20:23],a[236:239],a[128:131],v[20:23]
s_waitcnt lgkmcnt(4)
MF v[24:27],a[216:219],a[120:123],v[24:27]
TR a[232:233],v226,192
MF v[28:31],a[216:219],a[124:127],v[28:31]
TR a[234:235],v226,6336
MF v[32:35],a[216:219],a[128:131],v[32:35]
TR a[236:237],v227,192
MF v[36:39],a[220:223],a[120:123],v[36:39]
s_add_u32 s63,s82,15360
TR a[238:239],v227,6336
MF v[40:43],a[220:223],a[124:127],v[40:43]
buffer_load_dwordx4 v241,s[20:23],s36 offen offset:2048 lds
MF v[44:47],a[220:223],a[128:131],v[44:47]
s_waitcnt lgkmcnt(4)
buffer_load_dwordx4 a[60:63],v246,s[24:27],s63 offen offset:0 sc1
MF v[48:51],a[224:227],a[120:123],v[48:51]
TR a[216:217],v226,256
MF v[52:55],a[224:227],a[124:127],v[52:55]
TR a[218:219],v226,6400
MF v[56:59],a[224:227],a[128:131],v[56:59]
TR a[220:221],v227,256
MF v[60:63],a[228:231],a[120:123],v[60:63]
TR a[222:223],v227,6400
MF v[64:67],a[228:231],a[124:127],v[64:67]
buffer_load_dwordx4 a[64:67],v246,s[24:27],s63 offen offset:1024 sc1
MF v[68:71],a[228:231],a[128:131],v[68:71]
s_waitcnt vmcnt(34) lgkmcnt(4)
s_barrier
MF v[72:75],a[232:235],a[120:123],v[72:75]
TR a[224:225],v228,24576
MF v[76:79],a[232:235],a[124:127],v[76:79]
TR a[226:227],v228,30720
MF v[80:83],a[232:235],a[128:131],v[80:83]
s_add_u32 m0,s32,0
TR a[228:229],v229,24576
MF v[84:87],a[236:239],a[120:123],v[84:87]
s_add_u32 s35,s79,245760
TR a[230:231],v229,30720
MF v[88:91],a[236:239],a[124:127],v[88:91]
buffer_load_dwordx4 v239,s[20:23],s35 offen offset:0 lds
MF v[92:95],a[236:239],a[128:131],v[92:95]
s_waitcnt lgkmcnt(4)
MF v[96:99],a[216:219],a[120:123],v[96:99]
TR a[232:233],v228,24640
MF v[100:103],a[216:219],a[124:127],v[100:103]
TR a[234:235],v228,30784
MF v[104:107],a[216:219],a[128:131],v[104:107]
TR a[236:237],v229,24640
MF v[108:111],a[220:223],a[120:123],v[108:111]
TR a[238:239],v229,30784
MF v[112:115],a[220:223],a[124:127],v[112:115]
buffer_load_dwordx4 a[68:71],v246,s[24:27],s63 offen offset:2048 sc1
MF v[116:119],a[220:223],a[128:131],v[116:119]
s_waitcnt lgkmcnt(4)
L_st139:
MF v[0:3],a[224:227],a[132:135],v[0:3]
TR a[216:217],v228,24704
MF v[4:7],a[224:227],a[136:139],v[4:7]
TR a[218:219],v228,30848
MF v[8:11],a[224:227],a[140:143],v[8:11]
TR a[220:221],v229,24704
MF v[12:15],a[228:231],a[132:135],v[12:15]
TR a[222:223],v229,30848
MF v[16:19],a[228:231],a[136:139],v[16:19]
buffer_load_dwordx4 v240,s[20:23],s35 offen offset:1024 lds
MF v[20:23],a[228:231],a[140:143],v[20:23]
s_waitcnt lgkmcnt(4)
MF v[24:27],a[232:235],a[132:135],v[24:27]
TR a[224:225],v228,24768
MF v[28:31],a[232:235],a[136:139],v[28:31]
TR a[226:227],v228,30912
MF v[32:35],a[232:235],a[140:143],v[32:35]
TR a[228:229],v229,24768
MF v[36:39],a[236:239],a[132:135],v[36:39]
s_add_u32 s62,s82,73728
TR a[230:231],v229,30912
MF v[40:43],a[236:239],a[136:139],v[40:43]
buffer_load_dwordx4 v241,s[20:23],s35 offen offset:2048 lds
MF v[44:47],a[236:239],a[140:143],v[44:47]
s_waitcnt lgkmcnt(4)
buffer_load_dwordx4 a[72:75],v246,s[24:27],s62 offen offset:0 sc1
MF v[48:51],a[216:219],a[132:135],v[48:51]
TR a[232:233],v228,24832
MF v[52:55],a[216:219],a[136:139],v[52:55]
TR a[234:235],v228,30976
MF v[56:59],a[216:219],a[140:143],v[56:59]
TR a[236:237],v229,24832
MF v[60:63],a[220:223],a[132:135],v[60:63]
TR a[238:239],v229,30976
MF v[64:67],a[220:223],a[136:139],v[64:67]
buffer_load_dwordx4 a[76:79],v246,s[24:27],s62 offen offset:1024 sc1
MF v[68:71],a[220:223],a[140:143],v[68:71]
s_waitcnt vmcnt(34) lgkmcnt(4)
s_barrier
MF v[72:75],a[224:227],a[132:135],v[72:75]
TR a[216:217],v226,12288
MF v[76:79],a[224:227],a[136:139],v[76:79]
TR a[218:219],v226,18432
MF v[80:83],a[224:227],a[140:143],v[80:83]
s_add_u32 m0,s32,12288
TR a[220:221],v227,12288
MF v[84:87],a[228:231],a[132:135],v[84:87]
s_add_u32 s36,s79,286720
TR a[222:223],v227,18432
MF v[88:91],a[228:231],a[136:139],v[88:91]
buffer_load_dwordx4 v239,s[20:23],s36 offen offset:0 lds
MF v[92:95],a[228:231],a[140:143],v[92:95]
s_waitcnt lgkmcnt(4)
MF v[96:99],a[232:235],a[132:135],v[96:99]
TR a[224:225],v226,12352
MF v[100:103],a[232:235],a[136:139],v[100:103]
TR a[226:227],v226,18496
MF v[104:107],a[232:235],a[140:143],v[104:107]
TR a[228:229],v227,12352
MF v[108:111],a[236:239],a[132:135],v[108:111]
TR a[230:231],v227,18496
MF v[112:115],a[236:239],a[136:139],v[112:115]
buffer_load_dwordx4 a[80:83],v246,s[24:27],s62 offen offset:2048 sc1
MF v[116:119],a[236:239],a[140:143],v[116:119]
s_waitcnt lgkmcnt(4)
L_st140:
MF v[0:3],a[216:219],a[0:3],v[0:3]
TR a[232:233],v226,12416
MF v[4:7],a[216:219],a[4:7],v[4:7]
TR a[234:235],v226,18560
MF v[8:11],a[216:219],a[8:11],v[8:11]
TR a[236:237],v227,12416
MF v[12:15],a[220:223],a[0:3],v[12:15]
TR a[238:239],v227,18560
MF v[16:19],a[220:223],a[4:7],v[16:19]
buffer_load_dwordx4 v240,s[20:23],s36 offen offset:1024 lds
MF v[20:23],a[220:223],a[8:11],v[20:23]
s_waitcnt lgkmcnt(4)
MF v[24:27],a[224:227],a[0:3],v[24:27]
TR a[216:217],v226,12480
MF v[28:31],a[224:227],a[4:7],v[28:31]
TR a[218:219],v226,18624
MF v[32:35],a[224:227],a[8:11],v[32:35]
TR a[220:221],v227,12480
MF v[36:39],a[228:231],a[0:3],v[36:39]
s_add_u32 s63,s82,76800
TR a[222:223],v227,18624
MF v[40:43],a[228:231],a[4:7],v[40:43]
buffer_load_dwordx4 v241,s[20:23],s36 offen offset:2048 lds
MF v[44:47],a[228:231],a[8:11],v[44:47]
s_waitcnt lgkmcnt(4)
buffer_load_dwordx4 a[84:87],v246,s[24:27],s63 offen offset:0 sc1
MF v[48:51],a[232:235],a[0:3],v[48:51]
TR a[224:225],v226,12544
MF v[52:55],a[232:235],a[4:7],v[52:55]
TR a[226:227],v226,18688
MF v[56:59],a[232:235],a[8:11],v[56:59]
TR a[228:229],v227,12544
MF v[60:63],a[236:239],a[0:3],v[60:63]
TR a[230:231],v227,18688
MF v[64:67],a[236:239],a[4:7],v[64:67]
buffer_load_dwordx4 a[88:91],v246,s[24:27],s63 offen offset:1024 sc1
MF v[68:71],a[236:239],a[8:11],v[68:71]
s_waitcnt vmcnt(34) lgkmcnt(4)
s_barrier
MF v[72:75],a[216:219],a[0:3],v[72:75]
TR a[232:233],v228,0
MF v[76:79],a[216:219],a[4:7],v[76:79]
TR a[234:235],v228,6144
MF v[80:83],a[216:219],a[8:11],v[80:83]
s_add_u32 m0,s32,61440
TR a[236:237],v229,0
MF v[84:87],a[220:223],a[0:3],v[84:87]
s_add_u32 s35,s79,327680
TR a[238:239],v229,6144
MF v[88:91],a[220:223],a[4:7],v[88:91]
buffer_load_dwordx4 v239,s[20:23],s35 offen offset:0 lds
MF v[92:95],a[220:223],a[8:11],v[92:95]
s_waitcnt lgkmcnt(4)
MF v[96:99],a[224:227],a[0:3],v[96:99]
TR a[216:217],v228,64
MF v[100:103],a[224:227],a[4:7],v[100:103]
TR a[218:219],v228,6208
MF v[104:107],a[224:227],a[8:11],v[104:107]
TR a[220:221],v229,64
MF v[108:111],a[228:231],a[0:3],v[108:111]
TR a[222:223],v229,6208
MF v[112:115],a[228:231],a[4:7],v[112:115]
buffer_load_dwordx4 a[92:95],v246,s[24:27],s63 offen offset:2048 sc1
MF v[116:119],a[228:231],a[8:11],v[116:119]
s_waitcnt lgkmcnt(4)
L_st141:
MF v[0:3],a[232:235],a[12:15],v[0:3]
TR a[224:225],v228,128
MF v[4:7],a[232:235],a[16:19],v[4:7]
TR a[226:227],v228,6272
MF v[8:11],a[232:235],a[20:23],v[8:11]
TR a[228:229],v229,128
MF v[12:15],a[236:239],a[12:15],v[12:15]
TR a[230:231],v229,6272
MF v[16:19],a[236:239],a[16:19],v[16:19]
buffer_load_dwordx4 v240,s[20:23],s35 offen offset:1024 lds
MF v[20:23],a[236:239],a[20:23],v[20:23]
s_waitcnt lgkmcnt(4)
MF v[24:27],a[216:219],a[12:15],v[24:27]
TR a[232:233],v228,192
MF v[28:31],a[216:219],a[16:19],v[28:31]
TR a[234:235],v228,6336
MF v[32:35],a[216:219],a[20:23],v[32:35]
TR a[236:237],v229,192
MF v[36:39],a[220:223],a[12:15],v[36:39]
s_add_u32 s62,s82,79872
TR a[238:239],v229,6336
MF v[40:43],a[220:223],a[16:19],v[40:43]
buffer_load_dwordx4 v241,s[20:23],s35 offen offset:2048 lds
MF v[44:47],a[220:223],a[20:23],v[44:47]
s_waitcnt lgkmcnt(4)
buffer_load_dwordx4 a[96:99],v246,s[24:27],s62 offen offset:0 sc1
MF v[48:51],a[224:227],a[12:15],v[48:51]
TR a[216:217],v228,256
MF v[52:55],a[224:227],a[16:19],v[52:55]
TR a[218:219],v228,6400
MF v[56:59],a[224:227],a[20:23],v[56:59]
TR a[220:221],v229,256
MF v[60:63],a[228:231],a[12:15],v[60:63]
TR a[222:223],v229,6400
MF v[64:67],a[228:231],a[16:19],v[64:67]
buffer_load_dwordx4 a[100:103],v246,s[24:27],s62 offen offset:1024 sc1
MF v[68:71],a[228:231],a[20:23],v[68:71]
s_waitcnt vmcnt(34) lgkmcnt(4)
s_barrier
MF v[72:75],a[232:235],a[12:15],v[72:75]
TR a[224:225],v226,36864
MF v[76:79],a[232:235],a[16:19],v[76:79]
TR a[226:227],v226,43008
MF v[80:83],a[232:235],a[20:23],v[80:83]
s_add_u32 m0,s32,24576
TR a[228:229],v227,36864
MF v[84:87],a[236:239],a[12:15],v[84:87]
s_add_u32 s36,s79,368640
TR a[230:231],v227,43008
MF v[88:91],a[236:239],a[16:19],v[88:91]
buffer_load_dwordx4 v239,s[20:23],s36 offen offset:0 lds
MF v[92:95],a[236:239],a[20:23],v[92:95]
s_waitcnt lgkmcnt(4)
MF v[96:99],a[216:219],a[12:15],v[96:99]
TR a[232:233],v226,36928
MF v[100:103],a[216:219],a[16:19],v[100:103]
TR a[234:235],v226,43072
MF v[104:107],a[216:219],a[20:23],v[104:107]
TR a[236:237],v227,36928
MF v[108:111],a[220:223],a[12:15],v[108:111]
TR a[238:239],v227,43072
MF v[112:115],a[220:223],a[16:19],v[112:115]
buffer_load_dwordx4 a[104:107],v246,s[24:27],s62 offen offset:2048 sc1
MF v[116:119],a[220:223],a[20:23],v[116:119]
s_waitcnt lgkmcnt(4)
L_st142:
MF v[0:3],a[224:227],a[24:27],v[0:3]
TR a[216:217],v226,36992
MF v[4:7],a[224:227],a[28:31],v[4:7]
TR a[218:219],v226,43136
MF v[8:11],a[224:227],a[32:35],v[8:11]
TR a[220:221],v227,36992
MF v[12:15],a[228:231],a[24:27],v[12:15]
TR a[222:223],v227,43136
MF v[16:19],a[228:231],a[28:31],v[16:19]
buffer_load_dwordx4 v240,s[20:23],s36 offen offset:1024 lds
MF v[20:23],a[228:231],a[32:35],v[20:23]
s_waitcnt lgkmcnt(4)
MF v[24:27],a[232:235],a[24:27],v[24:27]
TR a[224:225],v226,37056
MF v[28:31],a[232:235],a[28:31],v[28:31]
TR a[226:227],v226,43200
MF v[32:35],a[232:235],a[32:35],v[32:35]
TR a[228:229],v227,37056
MF v[36:39],a[236:239],a[24:27],v[36:39]
s_add_u32 s63,s82,82944
TR a[230:231],v227,43200
MF v[40:43],a[236:239],a[28:31],v[40:43]
buffer_load_dwordx4 v241,s[20:23],s36 offen offset:2048 lds
MF v[44:47],a[236:239],a[32:35],v[44:47]
s_waitcnt lgkmcnt(4)
buffer_load_dwordx4 a[108:111],v246,s[24:27],s63 offen offset:0 sc1
MF v[48:51],a[216:219],a[24:27],v[48:51]
TR a[232:233],v226,37120
MF v[52:55],a[216:219],a[28:31],v[52:55]
TR a[234:235],v226,43264
MF v[56:59],a[216:219],a[32:35],v[56:59]
TR a[236:237],v227,37120
MF v[60:63],a[220:223],a[24:27],v[60:63]
TR a[238:239],v227,43264
MF v[64:67],a[220:223],a[28:31],v[64:67]
buffer_load_dwordx4 a[112:115],v246,s[24:27],s63 offen offset:1024 sc1
MF v[68:71],a[220:223],a[32:35],v[68:71]
s_waitcnt vmcnt(34) lgkmcnt(4)
s_barrier
MF v[72:75],a[224:227],a[24:27],v[72:75]
TR a[216:217],v228,36864
MF v[76:79],a[224:227],a[28:31],v[76:79]
TR a[218:219],v228,43008
MF v[80:83],a[224:227],a[32:35],v[80:83]
s_add_u32 m0,s32,36864
TR a[220:221],v229,36864
MF v[84:87],a[228:231],a[24:27],v[84:87]
s_add_u32 s35,s79,409600
TR a[222:223],v229,43008
MF v[88:91],a[228:231],a[28:31],v[88:91]
buffer_load_dwordx4 v239,s[20:23],s35 offen offset:0 lds
MF v[92:95],a[228:231],a[32:35],v[92:95]
s_waitcnt lgkmcnt(4)
MF v[96:99],a[232:235],a[24:27],v[96:99]
TR a[224:225],v228,36928
MF v[100:103],a[232:235],a[28:31],v[100:103]
TR a[226:227],v228,43072
MF v[104:107],a[232:235],a[32:35],v[104:107]
TR a[228:229],v229,36928
MF v[108:111],a[236:239],a[24:27],v[108:111]
TR a[230:231],v229,43072
MF v[112:115],a[236:239],a[28:31],v[112:115]
buffer_load_dwordx4 a[116:119],v246,s[24:27],s63 offen offset:2048 sc1
MF v[116:119],a[236:239],a[32:35],v[116:119]
s_waitcnt lgkmcnt(4)
L_st143:
MF v[0:3],a[216:219],a[36:39],v[0:3]
TR a[232:233],v228,36992
MF v[4:7],a[216:219],a[40:43],v[4:7]
TR a[234:235],v228,43136
MF v[8:11],a[216:219],a[44:47],v[8:11]
TR a[236:237],v229,36992
v_add_u32 v226,73728,v226
MF v[12:15],a[220:223],a[36:39],v[12:15]
TR a[238:239],v229,43136
v_add_u32 v227,73728,v227
MF v[16:19],a[220:223],a[40:43],v[16:19]
buffer_load_dwordx4 v240,s[20:23],s35 offen offset:1024 lds
MF v[20:23],a[220:223],a[44:47],v[20:23]
s_waitcnt lgkmcnt(4)
MF v[24:27],a[224:227],a[36:39],v[24:27]
TR a[216:217],v228,37056
MF v[28:31],a[224:227],a[40:43],v[28:31]
TR a[218:219],v228,43200
MF v[32:35],a[224:227],a[44:47],v[32:35]
TR a[220:221],v229,37056
MF v[36:39],a[228:231],a[36:39],v[36:39]
s_add_u32 s62,s82,86016
TR a[222:223],v229,43200
MF v[40:43],a[228:231],a[40:43],v[40:43]
buffer_load_dwordx4 v241,s[20:23],s35 offen offset:2048 lds
MF v[44:47],a[228:231],a[44:47],v[44:47]
s_waitcnt lgkmcnt(4)
buffer_load_dwordx4 a[120:123],v246,s[24:27],s62 offen offset:0 sc1
MF v[48:51],a[232:235],a[36:39],v[48:51]
TR a[224:225],v228,37120
MF v[52:55],a[232:235],a[40:43],v[52:55]
TR a[226:227],v228,43264
MF v[56:59],a[232:235],a[44:47],v[56:59]
TR a[228:229],v229,37120
MF v[60:63],a[236:239],a[36:39],v[60:63]
TR a[230:231],v229,43264
MF v[64:67],a[236:239],a[40:43],v[64:67]
buffer_load_dwordx4 a[124:127],v246,s[24:27],s62 offen offset:1024 sc1
MF v[68:71],a[236:239],a[44:47],v[68:71]
s_waitcnt vmcnt(34) lgkmcnt(4)
s_barrier
MF v[72:75],a[216:219],a[36:39],v[72:75]
TR a[232:233],v226,0
MF v[76:79],a[216:219],a[40:43],v[76:79]
TR a[234:235],v226,6144
MF v[80:83],a[216:219],a[44:47],v[80:83]
s_add_u32 m0,s32,49152
TR a[236:237],v227,0
MF v[84:87],a[220:223],a[36:39],v[84:87]
s_add_u32 s36,s79,450560
TR a[238:239],v227,6144
MF v[88:91],a[220:223],a[40:43],v[88:91]
buffer_load_dwordx4 v239,s[20:23],s36 offen offset:0 lds
MF v[92:95],a[220:223],a[44:47],v[92:95]
s_waitcnt lgkmcnt(4)
MF v[96:99],a[224:227],a[36:39],v[96:99]
TR a[216:217],v226,64
MF v[100:103],a[224:227],a[40:43],v[100:103]
TR a[218:219],v226,6208
MF v[104:107],a[224:227],a[44:47],v[104:107]
TR a[220:221],v227,64
MF v[108:111],a[228:231],a[36:39],v[108:111]
TR a[222:223],v227,6208
MF v[112:115],a[228:231],a[40:43],v[112:115]
buffer_load_dwordx4 a[128:131],v246,s[24:27],s62 offen offset:2048 sc1
MF v[116:119],a[228:231],a[44:47],v[116:119]
s_waitcnt lgkmcnt(4)
L_st144:
MF v[0:3],a[232:235],a[48:51],v[0:3]
TR a[224:225],v226,128
MF v[4:7],a[232:235],a[52:55],v[4:7]
TR a[226:227],v226,6272
MF v[8:11],a[232:235],a[56:59],v[8:11]
TR a[228:229],v227,128
v_add_u32 v228,61440,v228
MF v[12:15],a[236:239],a[48:51],v[12:15]
TR a[230:231],v227,6272
v_add_u32 v229,61440,v229
MF v[16:19],a[236:239],a[52:55],v[16:19]
buffer_load_dwordx4 v240,s[20:23],s36 offen offset:1024 lds
MF v[20:23],a[236:239],a[56:59],v[20:23]
s_waitcnt lgkmcnt(4)
MF v[24:27],a[216:219],a[48:51],v[24:27]
TR a[232:233],v226,192
MF v[28:31],a[216:219],a[52:55],v[28:31]
TR a[234:235],v226,6336
MF v[32:35],a[216:219],a[56:59],v[32:35]
TR a[236:237],v227,192
MF v[36:39],a[220:223],a[48:51],v[36:39]
s_add_u32 s63,s82,89088
TR a[238:239],v227,6336
MF v[40:43],a[220:223],a[52:55],v[40:43]
buffer_load_dwordx4 v241,s[20:23],s36 offen offset:2048 lds
MF v[44:47],a[220:223],a[56:59],v[44:47]
s_waitcnt lgkmcnt(4)
buffer_load_dwordx4 a[132:135],v246,s[24:27],s63 offen offset:0 sc1
MF v[48:51],a[224:227],a[48:51],v[48:51]
TR a[216:217],v226,256
MF v[52:55],a[224:227],a[52:55],v[52:55]
TR a[218:219],v226,6400
MF v[56:59],a[224:227],a[56:59],v[56:59]
TR a[220:221],v227,256
MF v[60:63],a[228:231],a[48:51],v[60:63]
TR a[222:223],v227,6400
MF v[64:67],a[228:231],a[52:55],v[64:67]
buffer_load_dwordx4 a[136:139],v246,s[24:27],s63 offen offset:1024 sc1
MF v[68:71],a[228:231],a[56:59],v[68:71]
s_waitcnt vmcnt(34) lgkmcnt(4)
s_barrier
MF v[72:75],a[232:235],a[48:51],v[72:75]
TR a[224:225],v228,0
MF v[76:79],a[232:235],a[52:55],v[76:79]
TR a[226:227],v228,6144
MF v[80:83],a[232:235],a[56:59],v[80:83]
TR a[228:229],v229,0
MF v[84:87],a[236:239],a[48:51],v[84:87]
TR a[230:231],v229,6144
MF v[88:91],a[236:239],a[52:55],v[88:91]
MF v[92:95],a[236:239],a[56:59],v[92:95]
s_waitcnt lgkmcnt(4)
MF v[96:99],a[216:219],a[48:51],v[96:99]
TR a[232:233],v228,64
MF v[100:103],a[216:219],a[52:55],v[100:103]
TR a[234:235],v228,6208
MF v[104:107],a[216:219],a[56:59],v[104:107]
TR a[236:237],v229,64
MF v[108:111],a[220:223],a[48:51],v[108:111]
TR a[238:239],v229,6208
MF v[112:115],a[220:223],a[52:55],v[112:115]
buffer_load_dwordx4 a[140:143],v246,s[24:27],s63 offen offset:2048 sc1
MF v[116:119],a[220:223],a[56:59],v[116:119]
s_waitcnt lgkmcnt(4)
L_st145:
MF v[0:3],a[224:227],a[60:63],v[0:3]
TR a[216:217],v228,128
MF v[4:7],a[224:227],a[64:67],v[4:7]
TR a[218:219],v228,6272
MF v[8:11],a[224:227],a[68:71],v[8:11]
TR a[220:221],v229,128
v_subrev_u32 v226,86016,v226
MF v[12:15],a[228:231],a[60:63],v[12:15]
TR a[222:223],v229,6272
v_subrev_u32 v227,86016,v227
MF v[16:19],a[228:231],a[64:67],v[16:19]
MF v[20:23],a[228:231],a[68:71],v[20:23]
s_waitcnt lgkmcnt(4)
MF v[24:27],a[232:235],a[60:63],v[24:27]
TR a[224:225],v228,192
MF v[28:31],a[232:235],a[64:67],v[28:31]
TR a[226:227],v228,6336
MF v[32:35],a[232:235],a[68:71],v[32:35]
TR a[228:229],v229,192
MF v[36:39],a[236:239],a[60:63],v[36:39]
TR a[230:231],v229,6336
MF v[40:43],a[236:239],a[64:67],v[40:43]
MF v[44:47],a[236:239],a[68:71],v[44:47]
s_waitcnt lgkmcnt(4)
MF v[48:51],a[216:219],a[60:63],v[48:51]
TR a[232:233],v228,256
MF v[52:55],a[216:219],a[64:67],v[52:55]
TR a[234:235],v228,6400
MF v[56:59],a[216:219],a[68:71],v[56:59]
TR a[236:237],v229,256
MF v[60:63],a[220:223],a[60:63],v[60:63]
TR a[238:239],v229,6400
MF v[64:67],a[220:223],a[64:67],v[64:67]
MF v[68:71],a[220:223],a[68:71],v[68:71]
s_waitcnt vmcnt(29) lgkmcnt(4)
s_barrier
MF v[72:75],a[224:227],a[60:63],v[72:75]
TR a[216:217],v226,0
MF v[76:79],a[224:227],a[64:67],v[76:79]
TR a[218:219],v226,6144
MF v[80:83],a[224:227],a[68:71],v[80:83]
TR a[220:221],v227,0
MF v[84:87],a[228:231],a[60:63],v[84:87]
TR a[222:223],v227,6144
MF v[88:91],a[228:231],a[64:67],v[88:91]
MF v[92:95],a[228:231],a[68:71],v[92:95]
s_waitcnt lgkmcnt(4)
MF v[96:99],a[232:235],a[60:63],v[96:99]
TR a[224:225],v226,64
MF v[100:103],a[232:235],a[64:67],v[100:103]
TR a[226:227],v226,6208
MF v[104:107],a[232:235],a[68:71],v[104:107]
TR a[228:229],v227,64
MF v[108:111],a[236:239],a[60:63],v[108:111]
TR a[230:231],v227,6208
MF v[112:115],a[236:239],a[64:67],v[112:115]
MF v[116:119],a[236:239],a[68:71],v[116:119]
s_waitcnt lgkmcnt(4)
L_st146:
MF v[0:3],a[216:219],a[72:75],v[0:3]
s_add_u32 s54,s53,0
TR a[232:233],v226,128
MF v[4:7],a[216:219],a[76:79],v[4:7]
s_mul_hi_u32 s56,s54,1431655766
TR a[234:235],v226,6272
MF v[8:11],a[216:219],a[80:83],v[8:11]
s_mul_i32 s57,s56,3
TR a[236:237],v227,128
v_subrev_u32 v228,86016,v228
MF v[12:15],a[220:223],a[72:75],v[12:15]
s_sub_u32 s57,s54,s57
TR a[238:239],v227,6272
v_subrev_u32 v229,86016,v229
MF v[16:19],a[220:223],a[76:79],v[16:19]
s_lshl_b32 s57,s57,4
MF v[20:23],a[220:223],a[80:83],v[20:23]
s_waitcnt lgkmcnt(4)
MF v[24:27],a[224:227],a[72:75],v[24:27]
s_mul_i32 s76,s57,1280
TR a[216:217],v226,192
MF v[28:31],a[224:227],a[76:79],v[28:31]
s_lshl_b32 s56,s56,6
TR a[218:219],v226,6336
MF v[32:35],a[224:227],a[80:83],v[32:35]
s_add_u32 s76,s76,s56
TR a[220:221],v227,192
MF v[36:39],a[228:231],a[72:75],v[36:39]
s_add_u32 s76,s76,s61
TR a[222:223],v227,6336
MF v[40:43],a[228:231],a[76:79],v[40:43]
s_add_u32 s54,s53,4
MF v[44:47],a[228:231],a[80:83],v[44:47]
s_waitcnt lgkmcnt(4)
MF v[48:51],a[232:235],a[72:75],v[48:51]
s_mul_hi_u32 s56,s54,1431655766
TR a[224:225],v226,256
MF v[52:55],a[232:235],a[76:79],v[52:55]
s_mul_i32 s57,s56,3
TR a[226:227],v226,6400
MF v[56:59],a[232:235],a[80:83],v[56:59]
s_sub_u32 s57,s54,s57
TR a[228:229],v227,256
MF v[60:63],a[236:239],a[72:75],v[60:63]
s_lshl_b32 s57,s57,4
TR a[230:231],v227,6400
MF v[64:67],a[236:239],a[76:79],v[64:67]
s_mul_i32 s77,s57,1280
MF v[68:71],a[236:239],a[80:83],v[68:71]
s_waitcnt vmcnt(23) lgkmcnt(4)
s_barrier
MF v[72:75],a[216:219],a[72:75],v[72:75]
s_lshl_b32 s56,s56,6
TR a[232:233],v228,0
MF v[76:79],a[216:219],a[76:79],v[76:79]
s_add_u32 s77,s77,s56
TR a[234:235],v228,6144
MF v[80:83],a[216:219],a[80:83],v[80:83]
s_add_u32 s77,s77,s61
TR a[236:237],v229,0
MF v[84:87],a[220:223],a[72:75],v[84:87]
s_add_u32 s54,s53,8
TR a[238:239],v229,6144
MF v[88:91],a[220:223],a[76:79],v[88:91]
s_mul_hi_u32 s56,s54,1431655766
MF v[92:95],a[220:223],a[80:83],v[92:95]
s_waitcnt lgkmcnt(4)
MF v[96:99],a[224:227],a[72:75],v[96:99]
s_mul_i32 s57,s56,3
TR a[216:217],v228,64
MF v[100:103],a[224:227],a[76:79],v[100:103]
s_sub_u32 s57,s54,s57
TR a[218:219],v228,6208
MF v[104:107],a[224:227],a[80:83],v[104:107]
s_lshl_b32 s57,s57,4
TR a[220:221],v229,64
MF v[108:111],a[228:231],a[72:75],v[108:111]
s_mul_i32 s78,s57,1280
TR a[222:223],v229,6208
MF v[112:115],a[228:231],a[76:79],v[112:115]
s_lshl_b32 s56,s56,6
MF v[116:119],a[228:231],a[80:83],v[116:119]
s_waitcnt lgkmcnt(4)
L_st147:
MF v[0:3],a[232:235],a[84:87],v[0:3]
s_add_u32 s78,s78,s56
TR a[224:225],v228,128
MF v[4:7],a[232:235],a[88:91],v[4:7]
s_add_u32 s78,s78,s61
TR a[226:227],v228,6272
MF v[8:11],a[232:235],a[92:95],v[8:11]
s_add_u32 s54,s53,12
TR a[228:229],v229,128
v_add_u32 v226,36864,v226
MF v[12:15],a[236:239],a[84:87],v[12:15]
s_mul_hi_u32 s56,s54,1431655766
TR a[230:231],v229,6272
v_add_u32 v227,36864,v227
MF v[16:19],a[236:239],a[88:91],v[16:19]
s_mul_i32 s57,s56,3
MF v[20:23],a[236:239],a[92:95],v[20:23]
s_waitcnt lgkmcnt(4)
MF v[24:27],a[216:219],a[84:87],v[24:27]
s_sub_u32 s57,s54,s57
TR a[232:233],v228,192
MF v[28:31],a[216:219],a[88:91],v[28:31]
s_lshl_b32 s57,s57,4
TR a[234:235],v228,6336
MF v[32:35],a[216:219],a[92:95],v[32:35]
s_mul_i32 s79,s57,1280
TR a[236:237],v229,192
MF v[36:39],a[220:223],a[84:87],v[36:39]
s_lshl_b32 s56,s56,6
TR a[238:239],v229,6336
MF v[40:43],a[220:223],a[88:91],v[40:43]
s_add_u32 s79,s79,s56
MF v[44:47],a[220:223],a[92:95],v[44:47]
s_waitcnt lgkmcnt(4)
MF v[48:51],a[224:227],a[84:87],v[48:51]
s_add_u32 s79,s79,s61
TR a[216:217],v228,256
MF v[52:55],a[224:227],a[88:91],v[52:55]
s_cmp_ge_u32 s54,15
s_cselect_b32 s79,2147418112,s79
TR a[218:219],v228,6400
MF v[56:59],a[224:227],a[92:95],v[56:59]
TR a[220:221],v229,256
MF v[60:63],a[228:231],a[84:87],v[60:63]
TR a[222:223],v229,6400
MF v[64:67],a[228:231],a[88:91],v[64:67]
MF v[68:71],a[228:231],a[92:95],v[68:71]
s_waitcnt vmcnt(17) lgkmcnt(4)
s_barrier
MF v[72:75],a[232:235],a[84:87],v[72:75]
TR a[224:225],v226,24576
MF v[76:79],a[232:235],a[88:91],v[76:79]
TR a[226:227],v226,30720
MF v[80:83],a[232:235],a[92:95],v[80:83]
TR a[228:229],v227,24576
MF v[84:87],a[236:239],a[84:87],v[84:87]
TR a[230:231],v227,30720
MF v[88:91],a[236:239],a[88:91],v[88:91]
MF v[92:95],a[236:239],a[92:95],v[92:95]
s_waitcnt lgkmcnt(4)
MF v[96:99],a[216:219],a[84:87],v[96:99]
TR a[232:233],v226,24640
MF v[100:103],a[216:219],a[88:91],v[100:103]
TR a[234:235],v226,30784
MF v[104:107],a[216:219],a[92:95],v[104:107]
TR a[236:237],v227,24640
MF v[108:111],a[220:223],a[84:87],v[108:111]
TR a[238:239],v227,30784
MF v[112:115],a[220:223],a[88:91],v[112:115]
MF v[116:119],a[220:223],a[92:95],v[116:119]
s_waitcnt lgkmcnt(4)
L_st148:
MF v[0:3],a[224:227],a[96:99],v[0:3]
TR a[216:217],v226,24704
MF v[4:7],a[224:227],a[100:103],v[4:7]
TR a[218:219],v226,30848
MF v[8:11],a[224:227],a[104:107],v[8:11]
TR a[220:221],v227,24704
MF v[12:15],a[228:231],a[96:99],v[12:15]
TR a[222:223],v227,30848
MF v[16:19],a[228:231],a[100:103],v[16:19]
MF v[20:23],a[228:231],a[104:107],v[20:23]
s_waitcnt lgkmcnt(4)
MF v[24:27],a[232:235],a[96:99],v[24:27]
TR a[224:225],v226,24768
MF v[28:31],a[232:235],a[100:103],v[28:31]
TR a[226:227],v226,30912
MF v[32:35],a[232:235],a[104:107],v[32:35]
TR a[228:229],v227,24768
MF v[36:39],a[236:239],a[96:99],v[36:39]
TR a[230:231],v227,30912
MF v[40:43],a[236:239],a[100:103],v[40:43]
MF v[44:47],a[236:239],a[104:107],v[44:47]
s_waitcnt lgkmcnt(4)
MF v[48:51],a[216:219],a[96:99],v[48:51]
TR a[232:233],v226,24832
MF v[52:55],a[216:219],a[100:103],v[52:55]
TR a[234:235],v226,30976
MF v[56:59],a[216:219],a[104:107],v[56:59]
TR a[236:237],v227,24832
MF v[60:63],a[220:223],a[96:99],v[60:63]
TR a[238:239],v227,30976
MF v[64:67],a[220:223],a[100:103],v[64:67]
MF v[68:71],a[220:223],a[104:107],v[68:71]
s_waitcnt vmcnt(11) lgkmcnt(4)
s_barrier
MF v[72:75],a[224:227],a[96:99],v[72:75]
TR a[216:217],v228,12288
MF v[76:79],a[224:227],a[100:103],v[76:79]
TR a[218:219],v228,18432
MF v[80:83],a[224:227],a[104:107],v[80:83]
TR a[220:221],v229,12288
MF v[84:87],a[228:231],a[96:99],v[84:87]
TR a[222:223],v229,18432
MF v[88:91],a[228:231],a[100:103],v[88:91]
MF v[92:95],a[228:231],a[104:107],v[92:95]
s_waitcnt lgkmcnt(4)
MF v[96:99],a[232:235],a[96:99],v[96:99]
TR a[224:225],v228,12352
MF v[100:103],a[232:235],a[100:103],v[100:103]
TR a[226:227],v228,18496
MF v[104:107],a[232:235],a[104:107],v[104:107]
TR a[228:229],v229,12352
MF v[108:111],a[236:239],a[96:99],v[108:111]
TR a[230:231],v229,18496
MF v[112:115],a[236:239],a[100:103],v[112:115]
MF v[116:119],a[236:239],a[104:107],v[116:119]
s_waitcnt lgkmcnt(4)
L_st149:
MF v[0:3],a[216:219],a[108:111],v[0:3]
TR a[232:233],v228,12416
MF v[4:7],a[216:219],a[112:115],v[4:7]
TR a[234:235],v228,18560
MF v[8:11],a[216:219],a[116:119],v[8:11]
TR a[236:237],v229,12416
MF v[12:15],a[220:223],a[108:111],v[12:15]
TR a[238:239],v229,18560
MF v[16:19],a[220:223],a[112:115],v[16:19]
MF v[20:23],a[220:223],a[116:119],v[20:23]
s_waitcnt lgkmcnt(4)
MF v[24:27],a[224:227],a[108:111],v[24:27]
TR a[216:217],v228,12480
MF v[28:31],a[224:227],a[112:115],v[28:31]
TR a[218:219],v228,18624
MF v[32:35],a[224:227],a[116:119],v[32:35]
TR a[220:221],v229,12480
MF v[36:39],a[228:231],a[108:111],v[36:39]
TR a[222:223],v229,18624
MF v[40:43],a[228:231],a[112:115],v[40:43]
MF v[44:47],a[228:231],a[116:119],v[44:47]
s_waitcnt lgkmcnt(4)
MF v[48:51],a[232:235],a[108:111],v[48:51]
TR a[224:225],v228,12544
MF v[52:55],a[232:235],a[112:115],v[52:55]
TR a[226:227],v228,18688
MF v[56:59],a[232:235],a[116:119],v[56:59]
TR a[228:229],v229,12544
MF v[60:63],a[236:239],a[108:111],v[60:63]
TR a[230:231],v229,18688
MF v[64:67],a[236:239],a[112:115],v[64:67]
MF v[68:71],a[236:239],a[116:119],v[68:71]
s_waitcnt vmcnt(5) lgkmcnt(4)
s_barrier
MF v[72:75],a[216:219],a[108:111],v[72:75]
TR a[232:233],v226,0
MF v[76:79],a[216:219],a[112:115],v[76:79]
TR a[234:235],v226,6144
MF v[80:83],a[216:219],a[116:119],v[80:83]
TR a[236:237],v227,0
MF v[84:87],a[220:223],a[108:111],v[84:87]
TR a[238:239],v227,6144
MF v[88:91],a[220:223],a[112:115],v[88:91]
MF v[92:95],a[220:223],a[116:119],v[92:95]
s_waitcnt lgkmcnt(4)
MF v[96:99],a[224:227],a[108:111],v[96:99]
TR a[216:217],v226,64
MF v[100:103],a[224:227],a[112:115],v[100:103]
TR a[218:219],v226,6208
MF v[104:107],a[224:227],a[116:119],v[104:107]
TR a[220:221],v227,64
MF v[108:111],a[228:231],a[108:111],v[108:111]
TR a[222:223],v227,6208
MF v[112:115],a[228:231],a[112:115],v[112:115]
MF v[116:119],a[228:231],a[116:119],v[116:119]
s_waitcnt lgkmcnt(4)
L_st150:
MF v[0:3],a[232:235],a[120:123],v[0:3]
TR a[224:225],v226,128
MF v[4:7],a[232:235],a[124:127],v[4:7]
TR a[226:227],v226,6272
MF v[8:11],a[232:235],a[128:131],v[8:11]
TR a[228:229],v227,128
MF v[12:15],a[236:239],a[120:123],v[12:15]
TR a[230:231],v227,6272
MF v[16:19],a[236:239],a[124:127],v[16:19]
MF v[20:23],a[236:239],a[128:131],v[20:23]
s_waitcnt lgkmcnt(4)
MF v[24:27],a[216:219],a[120:123],v[24:27]
TR a[232:233],v226,192
MF v[28:31],a[216:219],a[124:127],v[28:31]
TR a[234:235],v226,6336
MF v[32:35],a[216:219],a[128:131],v[32:35]
TR a[236:237],v227,192
MF v[36:39],a[220:223],a[120:123],v[36:39]
TR a[238:239],v227,6336
MF v[40:43],a[220:223],a[124:127],v[40:43]
MF v[44:47],a[220:223],a[128:131],v[44:47]
s_waitcnt lgkmcnt(4)
MF v[48:51],a[224:227],a[120:123],v[48:51]
TR a[216:217],v226,256
MF v[52:55],a[224:227],a[124:127],v[52:55]
TR a[218:219],v226,6400
MF v[56:59],a[224:227],a[128:131],v[56:59]
TR a[220:221],v227,256
MF v[60:63],a[228:231],a[120:123],v[60:63]
TR a[222:223],v227,6400
MF v[64:67],a[228:231],a[124:127],v[64:67]
MF v[68:71],a[228:231],a[128:131],v[68:71]
s_waitcnt vmcnt(0) lgkmcnt(4)
s_barrier
MF v[72:75],a[232:235],a[120:123],v[72:75]
TR a[224:225],v228,36864
MF v[76:79],a[232:235],a[124:127],v[76:79]
TR a[226:227],v228,43008
MF v[80:83],a[232:235],a[128:131],v[80:83]
TR a[228:229],v229,36864
MF v[84:87],a[236:239],a[120:123],v[84:87]
TR a[230:231],v229,43008
MF v[88:91],a[236:239],a[124:127],v[88:91]
MF v[92:95],a[236:239],a[128:131],v[92:95]
s_waitcnt lgkmcnt(4)
MF v[96:99],a[216:219],a[120:123],v[96:99]
TR a[232:233],v228,36928
MF v[100:103],a[216:219],a[124:127],v[100:103]
TR a[234:235],v228,43072
MF v[104:107],a[216:219],a[128:131],v[104:107]
TR a[236:237],v229,36928
MF v[108:111],a[220:223],a[120:123],v[108:111]
TR a[238:239],v229,43072
MF v[112:115],a[220:223],a[124:127],v[112:115]
MF v[116:119],a[220:223],a[128:131],v[116:119]
s_waitcnt lgkmcnt(4)
L_st151:
MF v[0:3],a[224:227],a[132:135],v[0:3]
TR a[216:217],v228,36992
MF v[4:7],a[224:227],a[136:139],v[4:7]
TR a[218:219],v228,43136
MF v[8:11],a[224:227],a[140:143],v[8:11]
TR a[220:221],v229,36992
MF v[12:15],a[228:231],a[132:135],v[12:15]
TR a[222:223],v229,43136
MF v[16:19],a[228:231],a[136:139],v[16:19]
MF v[20:23],a[228:231],a[140:143],v[20:23]
s_waitcnt lgkmcnt(4)
MF v[24:27],a[232:235],a[132:135],v[24:27]
TR a[224:225],v228,37056
MF v[28:31],a[232:235],a[136:139],v[28:31]
TR a[226:227],v228,43200
MF v[32:35],a[232:235],a[140:143],v[32:35]
TR a[228:229],v229,37056
MF v[36:39],a[236:239],a[132:135],v[36:39]
TR a[230:231],v229,43200
v_cvt_pk_bf16_f32 v0,v0,v1
MF v[40:43],a[236:239],a[136:139],v[40:43]
v_cvt_pk_bf16_f32 v1,v2,v3
v_cvt_pk_bf16_f32 v2,v12,v13
MF v[44:47],a[236:239],a[140:143],v[44:47]
s_waitcnt lgkmcnt(4)
v_cvt_pk_bf16_f32 v3,v14,v15
s_add_u32 s62,s84,0
MF v[48:51],a[216:219],a[132:135],v[48:51]
TR a[232:233],v228,37120
v_cvt_pk_bf16_f32 v4,v4,v5
MF v[52:55],a[216:219],a[136:139],v[52:55]
TR a[234:235],v228,43264
v_cvt_pk_bf16_f32 v5,v6,v7
MF v[56:59],a[216:219],a[140:143],v[56:59]
TR a[236:237],v229,37120
v_cvt_pk_bf16_f32 v6,v16,v17
MF v[60:63],a[220:223],a[132:135],v[60:63]
TR a[238:239],v229,43264
v_cvt_pk_bf16_f32 v7,v18,v19
MF v[64:67],a[220:223],a[136:139],v[64:67]
buffer_store_dwordx4 v[0:3],v243,s[24:27],s62 offen offset:0 sc1
MF v[68:71],a[220:223],a[140:143],v[68:71]
s_waitcnt lgkmcnt(4)
buffer_store_dwordx4 v[4:7],v243,s[24:27],s62 offen offset:1024 sc1
MF v[72:75],a[224:227],a[132:135],v[72:75]
v_cvt_pk_bf16_f32 v8,v8,v9
v_cvt_pk_bf16_f32 v9,v10,v11
MF v[76:79],a[224:227],a[136:139],v[76:79]
v_cvt_pk_bf16_f32 v10,v20,v21
v_cvt_pk_bf16_f32 v11,v22,v23
MF v[80:83],a[224:227],a[140:143],v[80:83]
buffer_store_dwordx4 v[8:11],v243,s[24:27],s62 offen offset:2048 sc1
MF v[84:87],a[228:231],a[132:135],v[84:87]
v_cvt_pk_bf16_f32 v24,v24,v25
v_cvt_pk_bf16_f32 v25,v26,v27
MF v[88:91],a[228:231],a[136:139],v[88:91]
v_cvt_pk_bf16_f32 v26,v36,v37
v_cvt_pk_bf16_f32 v27,v38,v39
MF v[92:95],a[228:231],a[140:143],v[92:95]
s_waitcnt lgkmcnt(0)
buffer_store_dwordx4 v[24:27],v243,s[24:27],s62 offen offset:3072 sc1
MF v[96:99],a[232:235],a[132:135],v[96:99]
v_cvt_pk_bf16_f32 v28,v28,v29
v_cvt_pk_bf16_f32 v29,v30,v31
MF v[100:103],a[232:235],a[136:139],v[100:103]
v_cvt_pk_bf16_f32 v30,v40,v41
v_cvt_pk_bf16_f32 v31,v42,v43
MF v[104:107],a[232:235],a[140:143],v[104:107]
s_add_u32 s63,s84,4096
v_cvt_pk_bf16_f32 v32,v32,v33
MF v[108:111],a[236:239],a[132:135],v[108:111]
buffer_store_dwordx4 v[28:31],v243,s[24:27],s63 offen offset:0 sc1
MF v[112:115],a[236:239],a[136:139],v[112:115]
v_cvt_pk_bf16_f32 v33,v34,v35
v_cvt_pk_bf16_f32 v34,v44,v45
MF v[116:119],a[236:239],a[140:143],v[116:119]
v_cvt_pk_bf16_f32 v35,v46,v47
v_cvt_pk_bf16_f32 v48,v48,v49
s_nop 7
buffer_store_dwordx4 v[32:35],v243,s[24:27],s63 offen offset:1024 sc1
v_cvt_pk_bf16_f32 v49,v50,v51
v_cvt_pk_bf16_f32 v50,v60,v61
v_cvt_pk_bf16_f32 v51,v62,v63
buffer_store_dwordx4 v[48:51],v243,s[24:27],s63 offen offset:2048 sc1
v_cvt_pk_bf16_f32 v52,v52,v53
v_cvt_pk_bf16_f32 v53,v54,v55
v_cvt_pk_bf16_f32 v54,v64,v65
v_cvt_pk_bf16_f32 v55,v66,v67
buffer_store_dwordx4 v[52:55],v243,s[24:27],s63 offen offset:3072 sc1
v_cvt_pk_bf16_f32 v56,v56,v57
v_cvt_pk_bf16_f32 v57,v58,v59
v_cvt_pk_bf16_f32 v58,v68,v69
v_cvt_pk_bf16_f32 v59,v70,v71
s_add_u32 s62,s84,8192
buffer_store_dwordx4 v[56:59],v243,s[24:27],s62 offen offset:0 sc1
v_cvt_pk_bf16_f32 v72,v72,v73
v_cvt_pk_bf16_f32 v73,v74,v75
v_cvt_pk_bf16_f32 v74,v84,v85
v_cvt_pk_bf16_f32 v75,v86,v87
buffer_store_dwordx4 v[72:75],v243,s[24:27],s62 offen offset:1024 sc1
v_cvt_pk_bf16_f32 v76,v76,v77
v_cvt_pk_bf16_f32 v77,v78,v79
v_cvt_pk_bf16_f32 v78,v88,v89
v_cvt_pk_bf16_f32 v79,v90,v91
buffer_store_dwordx4 v[76:79],v243,s[24:27],s62 offen offset:2048 sc1
v_cvt_pk_bf16_f32 v80,v80,v81
v_cvt_pk_bf16_f32 v81,v82,v83
v_cvt_pk_bf16_f32 v82,v92,v93
v_cvt_pk_bf16_f32 v83,v94,v95
buffer_store_dwordx4 v[80:83],v243,s[24:27],s62 offen offset:3072 sc1
v_cvt_pk_bf16_f32 v96,v96,v97
v_cvt_pk_bf16_f32 v97,v98,v99
v_cvt_pk_bf16_f32 v98,v108,v109
v_cvt_pk_bf16_f32 v99,v110,v111
s_add_u32 s63,s84,12288
buffer_store_dwordx4 v[96:99],v243,s[24:27],s63 offen offset:0 sc1
v_cvt_pk_bf16_f32 v100,v100,v101
v_cvt_pk_bf16_f32 v101,v102,v103
v_cvt_pk_bf16_f32 v102,v112,v113
v_cvt_pk_bf16_f32 v103,v114,v115
buffer_store_dwordx4 v[100:103],v243,s[24:27],s63 offen offset:1024 sc1
v_cvt_pk_bf16_f32 v104,v104,v105
v_cvt_pk_bf16_f32 v105,v106,v107
v_cvt_pk_bf16_f32 v106,v116,v117
v_cvt_pk_bf16_f32 v107,v118,v119
buffer_store_dwordx4 v[104:107],v243,s[24:27],s63 offen offset:2048 sc1
s_waitcnt vmcnt(0)
s_barrier
v_mov_b32 v141,3
buffer_store_dword v141,v250,s[24:27],s59 offen offset:0 sc1
buffer_load_dword v136,v140,s[24:27],s60 offen sc1
s_waitcnt vmcnt(0)
s_cmp_eq_u32 s53,1
s_cbranch_scc0 L_spf_ok
v_cmp_le_u32 vcc,3,v136
s_nop 0
s_and_b32 s55,vcc_lo,s94
s_cmp_eq_u32 s55,s94
s_cbranch_scc1 L_spf_ok
s_mov_b32 s54,262144
L_spf_loop:
s_sub_u32 s54,s54,1
s_cbranch_scc1 L_spf_ok
s_sleep 2
buffer_load_dword v136,v140,s[24:27],s60 offen sc1
s_waitcnt vmcnt(0)
v_cmp_le_u32 vcc,3,v136
s_nop 0
s_and_b32 s55,vcc_lo,s94
s_cmp_eq_u32 s55,s94
s_cbranch_scc0 L_spf_loop
L_spf_ok:
s_barrier
s_add_u32 s85,s75,0
buffer_load_dwordx4 a[0:3],v143,s[24:27],s85 offen offset:0 sc1
s_add_u32 s85,s75,61440
buffer_load_dwordx4 a[4:7],v143,s[24:27],s85 offen offset:0 sc1
s_add_u32 s85,s75,122880
buffer_load_dwordx4 a[8:11],v143,s[24:27],s85 offen offset:0 sc1
s_add_u32 s85,s75,184320
buffer_load_dwordx4 a[12:15],v143,s[24:27],s85 offen offset:0 sc1
s_add_u32 s85,s75,4096
buffer_load_dwordx4 a[16:19],v143,s[24:27],s85 offen offset:0 sc1
s_add_u32 s85,s75,65536
buffer_load_dwordx4 a[20:23],v143,s[24:27],s85 offen offset:0 sc1
s_add_u32 s85,s75,126976
buffer_load_dwordx4 a[24:27],v143,s[24:27],s85 offen offset:0 sc1
s_add_u32 s85,s75,188416
buffer_load_dwordx4 a[28:31],v143,s[24:27],s85 offen offset:0 sc1
s_add_u32 s85,s75,8192
buffer_load_dwordx4 a[32:35],v143,s[24:27],s85 offen offset:0 sc1
s_add_u32 s85,s75,69632
buffer_load_dwordx4 a[36:39],v143,s[24:27],s85 offen offset:0 sc1
s_add_u32 s85,s75,131072
buffer_load_dwordx4 a[40:43],v143,s[24:27],s85 offen offset:0 sc1
s_add_u32 s85,s75,192512
buffer_load_dwordx4 a[44:47],v143,s[24:27],s85 offen offset:0 sc1
s_add_u32 s85,s75,12288
buffer_load_dwordx4 a[48:51],v143,s[24:27],s85 offen offset:0 sc1
s_add_u32 s85,s75,73728
buffer_load_dwordx4 a[52:55],v143,s[24:27],s85 offen offset:0 sc1
s_add_u32 s85,s75,135168
buffer_load_dwordx4 a[56:59],v143,s[24:27],s85 offen offset:0 sc1
s_add_u32 s85,s75,196608
buffer_load_dwordx4 a[60:63],v143,s[24:27],s85 offen offset:0 sc1
s_waitcnt vmcnt(12)
MF v[120:123],v[128:131],a[0:3],0
MF v[124:127],v[132:135],a[0:3],0
MF v[120:123],v[128:131],a[4:7],v[120:123]
MF v[124:127],v[132:135],a[4:7],v[124:127]
MF v[120:123],v[128:131],a[8:11],v[120:123]
MF v[124:127],v[132:135],a[8:11],v[124:127]
MF v[120:123],v[128:131],a[12:15],v[120:123]
MF v[124:127],v[132:135],a[12:15],v[124:127]
s_nop 7
v_cvt_pk_bf16_f32 v0,v120,v121
v_cvt_pk_bf16_f32 v1,v122,v123
v_cvt_pk_bf16_f32 v2,v124,v125
v_cvt_pk_bf16_f32 v3,v126,v127
buffer_store_dwordx4 v[0:3],v142,s[12:15],s76 offen offset:0
s_nop 1
s_waitcnt vmcnt(9)
MF v[120:123],v[128:131],a[16:19],0
MF v[124:127],v[132:135],a[16:19],0
MF v[120:123],v[128:131],a[20:23],v[120:123]
MF v[124:127],v[132:135],a[20:23],v[124:127]
MF v[120:123],v[128:131],a[24:27],v[120:123]
MF v[124:127],v[132:135],a[24:27],v[124:127]
MF v[120:123],v[128:131],a[28:31],v[120:123]
MF v[124:127],v[132:135],a[28:31],v[124:127]
s_nop 7
v_cvt_pk_bf16_f32 v0,v120,v121
v_cvt_pk_bf16_f32 v1,v122,v123
v_cvt_pk_bf16_f32 v2,v124,v125
v_cvt_pk_bf16_f32 v3,v126,v127
buffer_store_dwordx4 v[0:3],v142,s[12:15],s77 offen offset:0
s_nop 1
s_waitcnt vmcnt(6)
MF v[120:123],v[128:131],a[32:35],0
MF v[124:127],v[132:135],a[32:35],0
MF v[120:123],v[128:131],a[36:39],v[120:123]
MF v[124:127],v[132:135],a[36:39],v[124:127]
MF v[120:123],v[128:131],a[40:43],v[120:123]
MF v[124:127],v[132:135],a[40:43],v[124:127]
MF v[120:123],v[128:131],a[44:47],v[120:123]
MF v[124:127],v[132:135],a[44:47],v[124:127]
s_nop 7
v_cvt_pk_bf16_f32 v0,v120,v121
v_cvt_pk_bf16_f32 v1,v122,v123
v_cvt_pk_bf16_f32 v2,v124,v125
v_cvt_pk_bf16_f32 v3,v126,v127
buffer_store_dwordx4 v[0:3],v142,s[12:15],s78 offen offset:0
s_nop 1
s_waitcnt vmcnt(3)
MF v[120:123],v[128:131],a[48:51],0
MF v[124:127],v[132:135],a[48:51],0
MF v[120:123],v[128:131],a[52:55],v[120:123]
MF v[124:127],v[132:135],a[52:55],v[124:127]
MF v[120:123],v[128:131],a[56:59],v[120:123]
MF v[124:127],v[132:135],a[56:59],v[124:127]
MF v[120:123],v[128:131],a[60:63],v[120:123]
MF v[124:127],v[132:135],a[60:63],v[124:127]
s_nop 7
v_cvt_pk_bf16_f32 v0,v120,v121
v_cvt_pk_bf16_f32 v1,v122,v123
v_cvt_pk_bf16_f32 v2,v124,v125
v_cvt_pk_bf16_f32 v3,v126,v127
buffer_store_dwordx4 v[0:3],v142,s[12:15],s79 offen offset:0
s_nop 1
s_waitcnt vmcnt(0)
L_main_exit:
s_endpgm
L_rs0:
s_call_b64 s[90:91],L_rare1
s_branch L_rr0
L_rs1:
s_call_b64 s[90:91],L_rare0
s_branch L_rr1
L_rs2:
s_call_b64 s[90:91],L_rare1
s_branch L_rr2
L_rs3:
s_call_b64 s[90:91],L_rare0
s_branch L_rr3
L_rs4:
s_call_b64 s[90:91],L_rare1
s_branch L_rr4
L_rs5:
s_call_b64 s[90:91],L_rare0
s_branch L_rr5
L_rs6:
s_call_b64 s[90:91],L_rare1
s_branch L_rr6
L_rs7:
s_call_b64 s[90:91],L_rare0
s_branch L_rr7
L_rs8:
s_call_b64 s[90:91],L_rare1
s_branch L_rr8
L_rs9:
s_call_b64 s[90:91],L_rare0
s_branch L_rr9
L_rs10:
s_call_b64 s[90:91],L_rare1
s_branch L_rr10
L_rs11:
s_call_b64 s[90:91],L_rare0
s_branch L_rr11
L_rs12:
s_call_b64 s[90:91],L_rare1
s_branch L_rr12
L_rs13:
s_call_b64 s[90:91],L_rare0
s_branch L_rr13
L_rs14:
s_call_b64 s[90:91],L_rare1
s_branch L_rr14
L_rs15:
s_call_b64 s[90:91],L_rare1
s_branch L_rr15
L_rs16:
s_call_b64 s[90:91],L_rare0
s_branch L_rr16
L_rs17:
s_call_b64 s[90:91],L_rare1
s_branch L_rr17
L_rs18:
s_call_b64 s[90:91],L_rare0
s_branch L_rr18
L_rs19:
s_call_b64 s[90:91],L_rare1
s_branch L_rr19
L_rs20:
s_call_b64 s[90:91],L_rare0
s_branch L_rr20
L_rs21:
s_call_b64 s[90:91],L_rare1
s_branch L_rr21
L_rs22:
s_call_b64 s[90:91],L_rare0
s_branch L_rr22
L_rs23:
s_call_b64 s[90:91],L_rare1
s_branch L_rr23
L_rs24:
s_call_b64 s[90:91],L_rare0
s_branch L_rr24
L_rs25:
s_call_b64 s[90:91],L_rare1
s_branch L_rr25
L_rs26:
s_call_b64 s[90:91],L_rare0
s_branch L_rr26
L_rs27:
s_call_b64 s[90:91],L_rare1
s_branch L_rr27
L_rs28:
s_call_b64 s[90:91],L_rare0
s_branch L_rr28
L_rs29:
s_call_b64 s[90:91],L_rare1
s_branch L_rr29
L_rare0:
s_nop 7
s_nop 7
v_max3_f32 v98,v0,v1,v2
v_max3_f32 v98,v98,v3,v12
v_max3_f32 v98,v98,v13,v14
v_max_f32 v98,v98,v15
v_max3_f32 v99,v4,v5,v6
v_max3_f32 v99,v99,v7,v16
v_max3_f32 v99,v99,v17,v18
v_max_f32 v99,v99,v19
v_max3_f32 v100,v8,v9,v10
v_max3_f32 v100,v100,v11,v20
v_max3_f32 v100,v100,v21,v22
v_max_f32 v100,v100,v23
v_mov_b32 v101,v98
v_mov_b32 v102,v99
v_mov_b32 v103,v100
v_permlane32_swap_b32 v98,v101
v_permlane32_swap_b32 v99,v102
v_permlane32_swap_b32 v100,v103
v_max_f32 v98,v98,v101
v_max_f32 v99,v99,v102
v_max_f32 v100,v100,v103
v_mov_b32 v101,v98
v_mov_b32 v102,v99
v_mov_b32 v103,v100
v_permlane16_swap_b32 v98,v101
v_permlane16_swap_b32 v99,v102
v_permlane16_swap_b32 v100,v103
v_max_f32 v98,v98,v101
v_max_f32 v99,v99,v102
v_max_f32 v100,v100,v103
v_max_f32 v98,0,v98
v_max_f32 v99,0,v99
v_max_f32 v100,0,v100
v_sub_f32 v101,0,v98
v_sub_f32 v102,0,v99
v_sub_f32 v103,0,v100
v_exp_f32 v106,v101
v_exp_f32 v107,v102
v_exp_f32 v108,v103
v_sub_f32 v80,v80,v98
v_sub_f32 v81,v81,v98
v_sub_f32 v82,v82,v98
v_sub_f32 v83,v83,v98
v_sub_f32 v0,v0,v98
v_sub_f32 v1,v1,v98
v_sub_f32 v2,v2,v98
v_sub_f32 v3,v3,v98
v_sub_f32 v12,v12,v98
v_sub_f32 v13,v13,v98
v_sub_f32 v14,v14,v98
v_sub_f32 v15,v15,v98
v_sub_f32 v24,v24,v98
v_sub_f32 v25,v25,v98
v_sub_f32 v26,v26,v98
v_sub_f32 v27,v27,v98
v_sub_f32 v36,v36,v98
v_sub_f32 v37,v37,v98
v_sub_f32 v38,v38,v98
v_sub_f32 v39,v39,v98
v_mul_f32 v92,v92,v106
v_accvgpr_read_b32 v72,a0
v_accvgpr_read_b32 v73,a1
v_accvgpr_read_b32 v74,a2
v_accvgpr_read_b32 v75,a3
v_mul_f32 v72,v72,v106
v_mul_f32 v73,v73,v106
v_mul_f32 v74,v74,v106
v_mul_f32 v75,v75,v106
v_accvgpr_write_b32 a0,v72
v_accvgpr_write_b32 a1,v73
v_accvgpr_write_b32 a2,v74
v_accvgpr_write_b32 a3,v75
v_accvgpr_read_b32 v72,a12
v_accvgpr_read_b32 v73,a13
v_accvgpr_read_b32 v74,a14
v_accvgpr_read_b32 v75,a15
v_mul_f32 v72,v72,v106
v_mul_f32 v73,v73,v106
v_mul_f32 v74,v74,v106
v_mul_f32 v75,v75,v106
v_accvgpr_write_b32 a12,v72
v_accvgpr_write_b32 a13,v73
v_accvgpr_write_b32 a14,v74
v_accvgpr_write_b32 a15,v75
v_accvgpr_read_b32 v72,a24
v_accvgpr_read_b32 v73,a25
v_accvgpr_read_b32 v74,a26
v_accvgpr_read_b32 v75,a27
v_mul_f32 v72,v72,v106
v_mul_f32 v73,v73,v106
v_mul_f32 v74,v74,v106
v_mul_f32 v75,v75,v106
v_accvgpr_write_b32 a24,v72
v_accvgpr_write_b32 a25,v73
v_accvgpr_write_b32 a26,v74
v_accvgpr_write_b32 a27,v75
v_accvgpr_read_b32 v72,a36
v_accvgpr_read_b32 v73,a37
v_accvgpr_read_b32 v74,a38
v_accvgpr_read_b32 v75,a39
v_mul_f32 v72,v72,v106
v_mul_f32 v73,v73,v106
v_mul_f32 v74,v74,v106
v_mul_f32 v75,v75,v106
v_accvgpr_write_b32 a36,v72
v_accvgpr_write_b32 a37,v73
v_accvgpr_write_b32 a38,v74
v_accvgpr_write_b32 a39,v75
v_accvgpr_read_b32 v72,a48
v_accvgpr_read_b32 v73,a49
v_accvgpr_read_b32 v74,a50
v_accvgpr_read_b32 v75,a51
v_mul_f32 v72,v72,v106
v_mul_f32 v73,v73,v106
v_mul_f32 v74,v74,v106
v_mul_f32 v75,v75,v106
v_accvgpr_write_b32 a48,v72
v_accvgpr_write_b32 a49,v73
v_accvgpr_write_b32 a50,v74
v_accvgpr_write_b32 a51,v75
v_accvgpr_read_b32 v72,a60
v_accvgpr_read_b32 v73,a61
v_accvgpr_read_b32 v74,a62
v_accvgpr_read_b32 v75,a63
v_mul_f32 v72,v72,v106
v_mul_f32 v73,v73,v106
v_mul_f32 v74,v74,v106
v_mul_f32 v75,v75,v106
v_accvgpr_write_b32 a60,v72
v_accvgpr_write_b32 a61,v73
v_accvgpr_write_b32 a62,v74
v_accvgpr_write_b32 a63,v75
v_accvgpr_read_b32 v72,a72
v_accvgpr_read_b32 v73,a73
v_accvgpr_read_b32 v74,a74
v_accvgpr_read_b32 v75,a75
v_mul_f32 v72,v72,v106
v_mul_f32 v73,v73,v106
v_mul_f32 v74,v74,v106
v_mul_f32 v75,v75,v106
v_accvgpr_write_b32 a72,v72
v_accvgpr_write_b32 a73,v73
v_accvgpr_write_b32 a74,v74
v_accvgpr_write_b32 a75,v75
v_accvgpr_read_b32 v72,a84
v_accvgpr_read_b32 v73,a85
v_accvgpr_read_b32 v74,a86
v_accvgpr_read_b32 v75,a87
v_mul_f32 v72,v72,v106
v_mul_f32 v73,v73,v106
v_mul_f32 v74,v74,v106
v_mul_f32 v75,v75,v106
v_accvgpr_write_b32 a84,v72
v_accvgpr_write_b32 a85,v73
v_accvgpr_write_b32 a86,v74
v_accvgpr_write_b32 a87,v75
v_accvgpr_read_b32 v72,a96
v_accvgpr_read_b32 v73,a97
v_accvgpr_read_b32 v74,a98
v_accvgpr_read_b32 v75,a99
v_mul_f32 v72,v72,v106
v_mul_f32 v73,v73,v106
v_mul_f32 v74,v74,v106
v_mul_f32 v75,v75,v106
v_accvgpr_write_b32 a96,v72
v_accvgpr_write_b32 a97,v73
v_accvgpr_write_b32 a98,v74
v_accvgpr_write_b32 a99,v75
v_accvgpr_read_b32 v72,a108
v_accvgpr_read_b32 v73,a109
v_accvgpr_read_b32 v74,a110
v_accvgpr_read_b32 v75,a111
v_mul_f32 v72,v72,v106
v_mul_f32 v73,v73,v106
v_mul_f32 v74,v74,v106
v_mul_f32 v75,v75,v106
v_accvgpr_write_b32 a108,v72
v_accvgpr_write_b32 a109,v73
v_accvgpr_write_b32 a110,v74
v_accvgpr_write_b32 a111,v75
v_accvgpr_read_b32 v72,a120
v_accvgpr_read_b32 v73,a121
v_accvgpr_read_b32 v74,a122
v_accvgpr_read_b32 v75,a123
v_mul_f32 v72,v72,v106
v_mul_f32 v73,v73,v106
v_mul_f32 v74,v74,v106
v_mul_f32 v75,v75,v106
v_accvgpr_write_b32 a120,v72
v_accvgpr_write_b32 a121,v73
v_accvgpr_write_b32 a122,v74
v_accvgpr_write_b32 a123,v75
v_accvgpr_read_b32 v72,a132
v_accvgpr_read_b32 v73,a133
v_accvgpr_read_b32 v74,a134
v_accvgpr_read_b32 v75,a135
v_mul_f32 v72,v72,v106
v_mul_f32 v73,v73,v106
v_mul_f32 v74,v74,v106
v_mul_f32 v75,v75,v106
v_accvgpr_write_b32 a132,v72
v_accvgpr_write_b32 a133,v73
v_accvgpr_write_b32 a134,v74
v_accvgpr_write_b32 a135,v75
v_sub_f32 v84,v84,v99
v_sub_f32 v85,v85,v99
v_sub_f32 v86,v86,v99
v_sub_f32 v87,v87,v99
v_sub_f32 v4,v4,v99
v_sub_f32 v5,v5,v99
v_sub_f32 v6,v6,v99
v_sub_f32 v7,v7,v99
v_sub_f32 v16,v16,v99
v_sub_f32 v17,v17,v99
v_sub_f32 v18,v18,v99
v_sub_f32 v19,v19,v99
v_sub_f32 v28,v28,v99
v_sub_f32 v29,v29,v99
v_sub_f32 v30,v30,v99
v_sub_f32 v31,v31,v99
v_sub_f32 v40,v40,v99
v_sub_f32 v41,v41,v99
v_sub_f32 v42,v42,v99
v_sub_f32 v43,v43,v99
v_mul_f32 v93,v93,v107
v_accvgpr_read_b32 v72,a4
v_accvgpr_read_b32 v73,a5
v_accvgpr_read_b32 v74,a6
v_accvgpr_read_b32 v75,a7
v_mul_f32 v72,v72,v107
v_mul_f32 v73,v73,v107
v_mul_f32 v74,v74,v107
v_mul_f32 v75,v75,v107
v_accvgpr_write_b32 a4,v72
v_accvgpr_write_b32 a5,v73
v_accvgpr_write_b32 a6,v74
v_accvgpr_write_b32 a7,v75
v_accvgpr_read_b32 v72,a16
v_accvgpr_read_b32 v73,a17
v_accvgpr_read_b32 v74,a18
v_accvgpr_read_b32 v75,a19
v_mul_f32 v72,v72,v107
v_mul_f32 v73,v73,v107
v_mul_f32 v74,v74,v107
v_mul_f32 v75,v75,v107
v_accvgpr_write_b32 a16,v72
v_accvgpr_write_b32 a17,v73
v_accvgpr_write_b32 a18,v74
v_accvgpr_write_b32 a19,v75
v_accvgpr_read_b32 v72,a28
v_accvgpr_read_b32 v73,a29
v_accvgpr_read_b32 v74,a30
v_accvgpr_read_b32 v75,a31
v_mul_f32 v72,v72,v107
v_mul_f32 v73,v73,v107
v_mul_f32 v74,v74,v107
v_mul_f32 v75,v75,v107
v_accvgpr_write_b32 a28,v72
v_accvgpr_write_b32 a29,v73
v_accvgpr_write_b32 a30,v74
v_accvgpr_write_b32 a31,v75
v_accvgpr_read_b32 v72,a40
v_accvgpr_read_b32 v73,a41
v_accvgpr_read_b32 v74,a42
v_accvgpr_read_b32 v75,a43
v_mul_f32 v72,v72,v107
v_mul_f32 v73,v73,v107
v_mul_f32 v74,v74,v107
v_mul_f32 v75,v75,v107
v_accvgpr_write_b32 a40,v72
v_accvgpr_write_b32 a41,v73
v_accvgpr_write_b32 a42,v74
v_accvgpr_write_b32 a43,v75
v_accvgpr_read_b32 v72,a52
v_accvgpr_read_b32 v73,a53
v_accvgpr_read_b32 v74,a54
v_accvgpr_read_b32 v75,a55
v_mul_f32 v72,v72,v107
v_mul_f32 v73,v73,v107
v_mul_f32 v74,v74,v107
v_mul_f32 v75,v75,v107
v_accvgpr_write_b32 a52,v72
v_accvgpr_write_b32 a53,v73
v_accvgpr_write_b32 a54,v74
v_accvgpr_write_b32 a55,v75
v_accvgpr_read_b32 v72,a64
v_accvgpr_read_b32 v73,a65
v_accvgpr_read_b32 v74,a66
v_accvgpr_read_b32 v75,a67
v_mul_f32 v72,v72,v107
v_mul_f32 v73,v73,v107
v_mul_f32 v74,v74,v107
v_mul_f32 v75,v75,v107
v_accvgpr_write_b32 a64,v72
v_accvgpr_write_b32 a65,v73
v_accvgpr_write_b32 a66,v74
v_accvgpr_write_b32 a67,v75
v_accvgpr_read_b32 v72,a76
v_accvgpr_read_b32 v73,a77
v_accvgpr_read_b32 v74,a78
v_accvgpr_read_b32 v75,a79
v_mul_f32 v72,v72,v107
v_mul_f32 v73,v73,v107
v_mul_f32 v74,v74,v107
v_mul_f32 v75,v75,v107
v_accvgpr_write_b32 a76,v72
v_accvgpr_write_b32 a77,v73
v_accvgpr_write_b32 a78,v74
v_accvgpr_write_b32 a79,v75
v_accvgpr_read_b32 v72,a88
v_accvgpr_read_b32 v73,a89
v_accvgpr_read_b32 v74,a90
v_accvgpr_read_b32 v75,a91
v_mul_f32 v72,v72,v107
v_mul_f32 v73,v73,v107
v_mul_f32 v74,v74,v107
v_mul_f32 v75,v75,v107
v_accvgpr_write_b32 a88,v72
v_accvgpr_write_b32 a89,v73
v_accvgpr_write_b32 a90,v74
v_accvgpr_write_b32 a91,v75
v_accvgpr_read_b32 v72,a100
v_accvgpr_read_b32 v73,a101
v_accvgpr_read_b32 v74,a102
v_accvgpr_read_b32 v75,a103
v_mul_f32 v72,v72,v107
v_mul_f32 v73,v73,v107
v_mul_f32 v74,v74,v107
v_mul_f32 v75,v75,v107
v_accvgpr_write_b32 a100,v72
v_accvgpr_write_b32 a101,v73
v_accvgpr_write_b32 a102,v74
v_accvgpr_write_b32 a103,v75
v_accvgpr_read_b32 v72,a112
v_accvgpr_read_b32 v73,a113
v_accvgpr_read_b32 v74,a114
v_accvgpr_read_b32 v75,a115
v_mul_f32 v72,v72,v107
v_mul_f32 v73,v73,v107
v_mul_f32 v74,v74,v107
v_mul_f32 v75,v75,v107
v_accvgpr_write_b32 a112,v72
v_accvgpr_write_b32 a113,v73
v_accvgpr_write_b32 a114,v74
v_accvgpr_write_b32 a115,v75
v_accvgpr_read_b32 v72,a124
v_accvgpr_read_b32 v73,a125
v_accvgpr_read_b32 v74,a126
v_accvgpr_read_b32 v75,a127
v_mul_f32 v72,v72,v107
v_mul_f32 v73,v73,v107
v_mul_f32 v74,v74,v107
v_mul_f32 v75,v75,v107
v_accvgpr_write_b32 a124,v72
v_accvgpr_write_b32 a125,v73
v_accvgpr_write_b32 a126,v74
v_accvgpr_write_b32 a127,v75
v_accvgpr_read_b32 v72,a136
v_accvgpr_read_b32 v73,a137
v_accvgpr_read_b32 v74,a138
v_accvgpr_read_b32 v75,a139
v_mul_f32 v72,v72,v107
v_mul_f32 v73,v73,v107
v_mul_f32 v74,v74,v107
v_mul_f32 v75,v75,v107
v_accvgpr_write_b32 a136,v72
v_accvgpr_write_b32 a137,v73
v_accvgpr_write_b32 a138,v74
v_accvgpr_write_b32 a139,v75
v_sub_f32 v88,v88,v100
v_sub_f32 v89,v89,v100
v_sub_f32 v90,v90,v100
v_sub_f32 v91,v91,v100
v_sub_f32 v8,v8,v100
v_sub_f32 v9,v9,v100
v_sub_f32 v10,v10,v100
v_sub_f32 v11,v11,v100
v_sub_f32 v20,v20,v100
v_sub_f32 v21,v21,v100
v_sub_f32 v22,v22,v100
v_sub_f32 v23,v23,v100
v_sub_f32 v32,v32,v100
v_sub_f32 v33,v33,v100
v_sub_f32 v34,v34,v100
v_sub_f32 v35,v35,v100
v_sub_f32 v44,v44,v100
v_sub_f32 v45,v45,v100
v_sub_f32 v46,v46,v100
v_sub_f32 v47,v47,v100
v_mul_f32 v94,v94,v108
v_accvgpr_read_b32 v72,a8
v_accvgpr_read_b32 v73,a9
v_accvgpr_read_b32 v74,a10
v_accvgpr_read_b32 v75,a11
v_mul_f32 v72,v72,v108
v_mul_f32 v73,v73,v108
v_mul_f32 v74,v74,v108
v_mul_f32 v75,v75,v108
v_accvgpr_write_b32 a8,v72
v_accvgpr_write_b32 a9,v73
v_accvgpr_write_b32 a10,v74
v_accvgpr_write_b32 a11,v75
v_accvgpr_read_b32 v72,a20
v_accvgpr_read_b32 v73,a21
v_accvgpr_read_b32 v74,a22
v_accvgpr_read_b32 v75,a23
v_mul_f32 v72,v72,v108
v_mul_f32 v73,v73,v108
v_mul_f32 v74,v74,v108
v_mul_f32 v75,v75,v108
v_accvgpr_write_b32 a20,v72
v_accvgpr_write_b32 a21,v73
v_accvgpr_write_b32 a22,v74
v_accvgpr_write_b32 a23,v75
v_accvgpr_read_b32 v72,a32
v_accvgpr_read_b32 v73,a33
v_accvgpr_read_b32 v74,a34
v_accvgpr_read_b32 v75,a35
v_mul_f32 v72,v72,v108
v_mul_f32 v73,v73,v108
v_mul_f32 v74,v74,v108
v_mul_f32 v75,v75,v108
v_accvgpr_write_b32 a32,v72
v_accvgpr_write_b32 a33,v73
v_accvgpr_write_b32 a34,v74
v_accvgpr_write_b32 a35,v75
v_accvgpr_read_b32 v72,a44
v_accvgpr_read_b32 v73,a45
v_accvgpr_read_b32 v74,a46
v_accvgpr_read_b32 v75,a47
v_mul_f32 v72,v72,v108
v_mul_f32 v73,v73,v108
v_mul_f32 v74,v74,v108
v_mul_f32 v75,v75,v108
v_accvgpr_write_b32 a44,v72
v_accvgpr_write_b32 a45,v73
v_accvgpr_write_b32 a46,v74
v_accvgpr_write_b32 a47,v75
v_accvgpr_read_b32 v72,a56
v_accvgpr_read_b32 v73,a57
v_accvgpr_read_b32 v74,a58
v_accvgpr_read_b32 v75,a59
v_mul_f32 v72,v72,v108
v_mul_f32 v73,v73,v108
v_mul_f32 v74,v74,v108
v_mul_f32 v75,v75,v108
v_accvgpr_write_b32 a56,v72
v_accvgpr_write_b32 a57,v73
v_accvgpr_write_b32 a58,v74
v_accvgpr_write_b32 a59,v75
v_accvgpr_read_b32 v72,a68
v_accvgpr_read_b32 v73,a69
v_accvgpr_read_b32 v74,a70
v_accvgpr_read_b32 v75,a71
v_mul_f32 v72,v72,v108
v_mul_f32 v73,v73,v108
v_mul_f32 v74,v74,v108
v_mul_f32 v75,v75,v108
v_accvgpr_write_b32 a68,v72
v_accvgpr_write_b32 a69,v73
v_accvgpr_write_b32 a70,v74
v_accvgpr_write_b32 a71,v75
v_accvgpr_read_b32 v72,a80
v_accvgpr_read_b32 v73,a81
v_accvgpr_read_b32 v74,a82
v_accvgpr_read_b32 v75,a83
v_mul_f32 v72,v72,v108
v_mul_f32 v73,v73,v108
v_mul_f32 v74,v74,v108
v_mul_f32 v75,v75,v108
v_accvgpr_write_b32 a80,v72
v_accvgpr_write_b32 a81,v73
v_accvgpr_write_b32 a82,v74
v_accvgpr_write_b32 a83,v75
v_accvgpr_read_b32 v72,a92
v_accvgpr_read_b32 v73,a93
v_accvgpr_read_b32 v74,a94
v_accvgpr_read_b32 v75,a95
v_mul_f32 v72,v72,v108
v_mul_f32 v73,v73,v108
v_mul_f32 v74,v74,v108
v_mul_f32 v75,v75,v108
v_accvgpr_write_b32 a92,v72
v_accvgpr_write_b32 a93,v73
v_accvgpr_write_b32 a94,v74
v_accvgpr_write_b32 a95,v75
v_accvgpr_read_b32 v72,a104
v_accvgpr_read_b32 v73,a105
v_accvgpr_read_b32 v74,a106
v_accvgpr_read_b32 v75,a107
v_mul_f32 v72,v72,v108
v_mul_f32 v73,v73,v108
v_mul_f32 v74,v74,v108
v_mul_f32 v75,v75,v108
v_accvgpr_write_b32 a104,v72
v_accvgpr_write_b32 a105,v73
v_accvgpr_write_b32 a106,v74
v_accvgpr_write_b32 a107,v75
v_accvgpr_read_b32 v72,a116
v_accvgpr_read_b32 v73,a117
v_accvgpr_read_b32 v74,a118
v_accvgpr_read_b32 v75,a119
v_mul_f32 v72,v72,v108
v_mul_f32 v73,v73,v108
v_mul_f32 v74,v74,v108
v_mul_f32 v75,v75,v108
v_accvgpr_write_b32 a116,v72
v_accvgpr_write_b32 a117,v73
v_accvgpr_write_b32 a118,v74
v_accvgpr_write_b32 a119,v75
v_accvgpr_read_b32 v72,a128
v_accvgpr_read_b32 v73,a129
v_accvgpr_read_b32 v74,a130
v_accvgpr_read_b32 v75,a131
v_mul_f32 v72,v72,v108
v_mul_f32 v73,v73,v108
v_mul_f32 v74,v74,v108
v_mul_f32 v75,v75,v108
v_accvgpr_write_b32 a128,v72
v_accvgpr_write_b32 a129,v73
v_accvgpr_write_b32 a130,v74
v_accvgpr_write_b32 a131,v75
v_accvgpr_read_b32 v72,a140
v_accvgpr_read_b32 v73,a141
v_accvgpr_read_b32 v74,a142
v_accvgpr_read_b32 v75,a143
v_mul_f32 v72,v72,v108
v_mul_f32 v73,v73,v108
v_mul_f32 v74,v74,v108
v_mul_f32 v75,v75,v108
v_accvgpr_write_b32 a140,v72
v_accvgpr_write_b32 a141,v73
v_accvgpr_write_b32 a142,v74
v_accvgpr_write_b32 a143,v75
v_exp_f32 v72,v0
v_exp_f32 v73,v1
s_nop 0
v_add_f32 v95,v72,v73
v_cvt_pk_bf16_f32 v48,v72,v73
v_exp_f32 v74,v2
v_exp_f32 v75,v3
v_add_f32 v95,v95,v74
v_add_f32 v95,v95,v75
v_cvt_pk_bf16_f32 v49,v74,v75
v_exp_f32 v76,v4
v_exp_f32 v77,v5
s_nop 0
v_add_f32 v96,v76,v77
v_cvt_pk_bf16_f32 v52,v76,v77
v_exp_f32 v78,v6
v_exp_f32 v79,v7
v_add_f32 v96,v96,v78
v_add_f32 v96,v96,v79
v_cvt_pk_bf16_f32 v53,v78,v79
v_exp_f32 v120,v8
v_exp_f32 v121,v9
s_nop 0
v_add_f32 v97,v120,v121
v_cvt_pk_bf16_f32 v56,v120,v121
v_exp_f32 v122,v10
v_exp_f32 v123,v11
v_add_f32 v97,v97,v122
v_add_f32 v97,v97,v123
v_cvt_pk_bf16_f32 v57,v122,v123
v_exp_f32 v124,v12
v_exp_f32 v125,v13
v_add_f32 v95,v95,v124
v_add_f32 v95,v95,v125
v_cvt_pk_bf16_f32 v50,v124,v125
v_exp_f32 v126,v14
v_exp_f32 v127,v15
v_add_f32 v95,v95,v126
v_add_f32 v95,v95,v127
v_cvt_pk_bf16_f32 v51,v126,v127
v_exp_f32 v72,v16
v_exp_f32 v73,v17
v_add_f32 v96,v96,v72
v_add_f32 v96,v96,v73
v_cvt_pk_bf16_f32 v54,v72,v73
v_exp_f32 v74,v18
v_exp_f32 v75,v19
v_add_f32 v96,v96,v74
v_add_f32 v96,v96,v75
v_cvt_pk_bf16_f32 v55,v74,v75
v_exp_f32 v76,v20
v_exp_f32 v77,v21
v_add_f32 v97,v97,v76
v_add_f32 v97,v97,v77
v_cvt_pk_bf16_f32 v58,v76,v77
v_exp_f32 v78,v22
v_exp_f32 v79,v23
v_add_f32 v97,v97,v78
v_add_f32 v97,v97,v79
v_cvt_pk_bf16_f32 v59,v78,v79
s_nop 1
s_setpc_b64 s[90:91]
L_rare1:
s_nop 7
s_nop 7
v_max3_f32 v98,v24,v25,v26
v_max3_f32 v98,v98,v27,v36
v_max3_f32 v98,v98,v37,v38
v_max_f32 v98,v98,v39
v_max3_f32 v99,v28,v29,v30
v_max3_f32 v99,v99,v31,v40
v_max3_f32 v99,v99,v41,v42
v_max_f32 v99,v99,v43
v_max3_f32 v100,v32,v33,v34
v_max3_f32 v100,v100,v35,v44
v_max3_f32 v100,v100,v45,v46
v_max_f32 v100,v100,v47
v_mov_b32 v101,v98
v_mov_b32 v102,v99
v_mov_b32 v103,v100
v_permlane32_swap_b32 v98,v101
v_permlane32_swap_b32 v99,v102
v_permlane32_swap_b32 v100,v103
v_max_f32 v98,v98,v101
v_max_f32 v99,v99,v102
v_max_f32 v100,v100,v103
v_mov_b32 v101,v98
v_mov_b32 v102,v99
v_mov_b32 v103,v100
v_permlane16_swap_b32 v98,v101
v_permlane16_swap_b32 v99,v102
v_permlane16_swap_b32 v100,v103
v_max_f32 v98,v98,v101
v_max_f32 v99,v99,v102
v_max_f32 v100,v100,v103
v_max_f32 v98,0,v98
v_max_f32 v99,0,v99
v_max_f32 v100,0,v100
v_sub_f32 v101,0,v98
v_sub_f32 v102,0,v99
v_sub_f32 v103,0,v100
v_exp_f32 v106,v101
v_exp_f32 v107,v102
v_exp_f32 v108,v103
v_sub_f32 v80,v80,v98
v_sub_f32 v81,v81,v98
v_sub_f32 v82,v82,v98
v_sub_f32 v83,v83,v98
v_sub_f32 v0,v0,v98
v_sub_f32 v1,v1,v98
v_sub_f32 v2,v2,v98
v_sub_f32 v3,v3,v98
v_sub_f32 v12,v12,v98
v_sub_f32 v13,v13,v98
v_sub_f32 v14,v14,v98
v_sub_f32 v15,v15,v98
v_sub_f32 v24,v24,v98
v_sub_f32 v25,v25,v98
v_sub_f32 v26,v26,v98
v_sub_f32 v27,v27,v98
v_sub_f32 v36,v36,v98
v_sub_f32 v37,v37,v98
v_sub_f32 v38,v38,v98
v_sub_f32 v39,v39,v98
v_mul_f32 v92,v92,v106
v_accvgpr_read_b32 v72,a0
v_accvgpr_read_b32 v73,a1
v_accvgpr_read_b32 v74,a2
v_accvgpr_read_b32 v75,a3
v_mul_f32 v72,v72,v106
v_mul_f32 v73,v73,v106
v_mul_f32 v74,v74,v106
v_mul_f32 v75,v75,v106
v_accvgpr_write_b32 a0,v72
v_accvgpr_write_b32 a1,v73
v_accvgpr_write_b32 a2,v74
v_accvgpr_write_b32 a3,v75
v_accvgpr_read_b32 v72,a12
v_accvgpr_read_b32 v73,a13
v_accvgpr_read_b32 v74,a14
v_accvgpr_read_b32 v75,a15
v_mul_f32 v72,v72,v106
v_mul_f32 v73,v73,v106
v_mul_f32 v74,v74,v106
v_mul_f32 v75,v75,v106
v_accvgpr_write_b32 a12,v72
v_accvgpr_write_b32 a13,v73
v_accvgpr_write_b32 a14,v74
v_accvgpr_write_b32 a15,v75
v_accvgpr_read_b32 v72,a24
v_accvgpr_read_b32 v73,a25
v_accvgpr_read_b32 v74,a26
v_accvgpr_read_b32 v75,a27
v_mul_f32 v72,v72,v106
v_mul_f32 v73,v73,v106
v_mul_f32 v74,v74,v106
v_mul_f32 v75,v75,v106
v_accvgpr_write_b32 a24,v72
v_accvgpr_write_b32 a25,v73
v_accvgpr_write_b32 a26,v74
v_accvgpr_write_b32 a27,v75
v_accvgpr_read_b32 v72,a36
v_accvgpr_read_b32 v73,a37
v_accvgpr_read_b32 v74,a38
v_accvgpr_read_b32 v75,a39
v_mul_f32 v72,v72,v106
v_mul_f32 v73,v73,v106
v_mul_f32 v74,v74,v106
v_mul_f32 v75,v75,v106
v_accvgpr_write_b32 a36,v72
v_accvgpr_write_b32 a37,v73
v_accvgpr_write_b32 a38,v74
v_accvgpr_write_b32 a39,v75
v_accvgpr_read_b32 v72,a48
v_accvgpr_read_b32 v73,a49
v_accvgpr_read_b32 v74,a50
v_accvgpr_read_b32 v75,a51
v_mul_f32 v72,v72,v106
v_mul_f32 v73,v73,v106
v_mul_f32 v74,v74,v106
v_mul_f32 v75,v75,v106
v_accvgpr_write_b32 a48,v72
v_accvgpr_write_b32 a49,v73
v_accvgpr_write_b32 a50,v74
v_accvgpr_write_b32 a51,v75
v_accvgpr_read_b32 v72,a60
v_accvgpr_read_b32 v73,a61
v_accvgpr_read_b32 v74,a62
v_accvgpr_read_b32 v75,a63
v_mul_f32 v72,v72,v106
v_mul_f32 v73,v73,v106
v_mul_f32 v74,v74,v106
v_mul_f32 v75,v75,v106
v_accvgpr_write_b32 a60,v72
v_accvgpr_write_b32 a61,v73
v_accvgpr_write_b32 a62,v74
v_accvgpr_write_b32 a63,v75
v_accvgpr_read_b32 v72,a72
v_accvgpr_read_b32 v73,a73
v_accvgpr_read_b32 v74,a74
v_accvgpr_read_b32 v75,a75
v_mul_f32 v72,v72,v106
v_mul_f32 v73,v73,v106
v_mul_f32 v74,v74,v106
v_mul_f32 v75,v75,v106
v_accvgpr_write_b32 a72,v72
v_accvgpr_write_b32 a73,v73
v_accvgpr_write_b32 a74,v74
v_accvgpr_write_b32 a75,v75
v_accvgpr_read_b32 v72,a84
v_accvgpr_read_b32 v73,a85
v_accvgpr_read_b32 v74,a86
v_accvgpr_read_b32 v75,a87
v_mul_f32 v72,v72,v106
v_mul_f32 v73,v73,v106
v_mul_f32 v74,v74,v106
v_mul_f32 v75,v75,v106
v_accvgpr_write_b32 a84,v72
v_accvgpr_write_b32 a85,v73
v_accvgpr_write_b32 a86,v74
v_accvgpr_write_b32 a87,v75
v_accvgpr_read_b32 v72,a96
v_accvgpr_read_b32 v73,a97
v_accvgpr_read_b32 v74,a98
v_accvgpr_read_b32 v75,a99
v_mul_f32 v72,v72,v106
v_mul_f32 v73,v73,v106
v_mul_f32 v74,v74,v106
v_mul_f32 v75,v75,v106
v_accvgpr_write_b32 a96,v72
v_accvgpr_write_b32 a97,v73
v_accvgpr_write_b32 a98,v74
v_accvgpr_write_b32 a99,v75
v_accvgpr_read_b32 v72,a108
v_accvgpr_read_b32 v73,a109
v_accvgpr_read_b32 v74,a110
v_accvgpr_read_b32 v75,a111
v_mul_f32 v72,v72,v106
v_mul_f32 v73,v73,v106
v_mul_f32 v74,v74,v106
v_mul_f32 v75,v75,v106
v_accvgpr_write_b32 a108,v72
v_accvgpr_write_b32 a109,v73
v_accvgpr_write_b32 a110,v74
v_accvgpr_write_b32 a111,v75
v_accvgpr_read_b32 v72,a120
v_accvgpr_read_b32 v73,a121
v_accvgpr_read_b32 v74,a122
v_accvgpr_read_b32 v75,a123
v_mul_f32 v72,v72,v106
v_mul_f32 v73,v73,v106
v_mul_f32 v74,v74,v106
v_mul_f32 v75,v75,v106
v_accvgpr_write_b32 a120,v72
v_accvgpr_write_b32 a121,v73
v_accvgpr_write_b32 a122,v74
v_accvgpr_write_b32 a123,v75
v_accvgpr_read_b32 v72,a132
v_accvgpr_read_b32 v73,a133
v_accvgpr_read_b32 v74,a134
v_accvgpr_read_b32 v75,a135
v_mul_f32 v72,v72,v106
v_mul_f32 v73,v73,v106
v_mul_f32 v74,v74,v106
v_mul_f32 v75,v75,v106
v_accvgpr_write_b32 a132,v72
v_accvgpr_write_b32 a133,v73
v_accvgpr_write_b32 a134,v74
v_accvgpr_write_b32 a135,v75
v_sub_f32 v84,v84,v99
v_sub_f32 v85,v85,v99
v_sub_f32 v86,v86,v99
v_sub_f32 v87,v87,v99
v_sub_f32 v4,v4,v99
v_sub_f32 v5,v5,v99
v_sub_f32 v6,v6,v99
v_sub_f32 v7,v7,v99
v_sub_f32 v16,v16,v99
v_sub_f32 v17,v17,v99
v_sub_f32 v18,v18,v99
v_sub_f32 v19,v19,v99
v_sub_f32 v28,v28,v99
v_sub_f32 v29,v29,v99
v_sub_f32 v30,v30,v99
v_sub_f32 v31,v31,v99
v_sub_f32 v40,v40,v99
v_sub_f32 v41,v41,v99
v_sub_f32 v42,v42,v99
v_sub_f32 v43,v43,v99
v_mul_f32 v93,v93,v107
v_accvgpr_read_b32 v72,a4
v_accvgpr_read_b32 v73,a5
v_accvgpr_read_b32 v74,a6
v_accvgpr_read_b32 v75,a7
v_mul_f32 v72,v72,v107
v_mul_f32 v73,v73,v107
v_mul_f32 v74,v74,v107
v_mul_f32 v75,v75,v107
v_accvgpr_write_b32 a4,v72
v_accvgpr_write_b32 a5,v73
v_accvgpr_write_b32 a6,v74
v_accvgpr_write_b32 a7,v75
v_accvgpr_read_b32 v72,a16
v_accvgpr_read_b32 v73,a17
v_accvgpr_read_b32 v74,a18
v_accvgpr_read_b32 v75,a19
v_mul_f32 v72,v72,v107
v_mul_f32 v73,v73,v107
v_mul_f32 v74,v74,v107
v_mul_f32 v75,v75,v107
v_accvgpr_write_b32 a16,v72
v_accvgpr_write_b32 a17,v73
v_accvgpr_write_b32 a18,v74
v_accvgpr_write_b32 a19,v75
v_accvgpr_read_b32 v72,a28
v_accvgpr_read_b32 v73,a29
v_accvgpr_read_b32 v74,a30
v_accvgpr_read_b32 v75,a31
v_mul_f32 v72,v72,v107
v_mul_f32 v73,v73,v107
v_mul_f32 v74,v74,v107
v_mul_f32 v75,v75,v107
v_accvgpr_write_b32 a28,v72
v_accvgpr_write_b32 a29,v73
v_accvgpr_write_b32 a30,v74
v_accvgpr_write_b32 a31,v75
v_accvgpr_read_b32 v72,a40
v_accvgpr_read_b32 v73,a41
v_accvgpr_read_b32 v74,a42
v_accvgpr_read_b32 v75,a43
v_mul_f32 v72,v72,v107
v_mul_f32 v73,v73,v107
v_mul_f32 v74,v74,v107
v_mul_f32 v75,v75,v107
v_accvgpr_write_b32 a40,v72
v_accvgpr_write_b32 a41,v73
v_accvgpr_write_b32 a42,v74
v_accvgpr_write_b32 a43,v75
v_accvgpr_read_b32 v72,a52
v_accvgpr_read_b32 v73,a53
v_accvgpr_read_b32 v74,a54
v_accvgpr_read_b32 v75,a55
v_mul_f32 v72,v72,v107
v_mul_f32 v73,v73,v107
v_mul_f32 v74,v74,v107
v_mul_f32 v75,v75,v107
v_accvgpr_write_b32 a52,v72
v_accvgpr_write_b32 a53,v73
v_accvgpr_write_b32 a54,v74
v_accvgpr_write_b32 a55,v75
v_accvgpr_read_b32 v72,a64
v_accvgpr_read_b32 v73,a65
v_accvgpr_read_b32 v74,a66
v_accvgpr_read_b32 v75,a67
v_mul_f32 v72,v72,v107
v_mul_f32 v73,v73,v107
v_mul_f32 v74,v74,v107
v_mul_f32 v75,v75,v107
v_accvgpr_write_b32 a64,v72
v_accvgpr_write_b32 a65,v73
v_accvgpr_write_b32 a66,v74
v_accvgpr_write_b32 a67,v75
v_accvgpr_read_b32 v72,a76
v_accvgpr_read_b32 v73,a77
v_accvgpr_read_b32 v74,a78
v_accvgpr_read_b32 v75,a79
v_mul_f32 v72,v72,v107
v_mul_f32 v73,v73,v107
v_mul_f32 v74,v74,v107
v_mul_f32 v75,v75,v107
v_accvgpr_write_b32 a76,v72
v_accvgpr_write_b32 a77,v73
v_accvgpr_write_b32 a78,v74
v_accvgpr_write_b32 a79,v75
v_accvgpr_read_b32 v72,a88
v_accvgpr_read_b32 v73,a89
v_accvgpr_read_b32 v74,a90
v_accvgpr_read_b32 v75,a91
v_mul_f32 v72,v72,v107
v_mul_f32 v73,v73,v107
v_mul_f32 v74,v74,v107
v_mul_f32 v75,v75,v107
v_accvgpr_write_b32 a88,v72
v_accvgpr_write_b32 a89,v73
v_accvgpr_write_b32 a90,v74
v_accvgpr_write_b32 a91,v75
v_accvgpr_read_b32 v72,a100
v_accvgpr_read_b32 v73,a101
v_accvgpr_read_b32 v74,a102
v_accvgpr_read_b32 v75,a103
v_mul_f32 v72,v72,v107
v_mul_f32 v73,v73,v107
v_mul_f32 v74,v74,v107
v_mul_f32 v75,v75,v107
v_accvgpr_write_b32 a100,v72
v_accvgpr_write_b32 a101,v73
v_accvgpr_write_b32 a102,v74
v_accvgpr_write_b32 a103,v75
v_accvgpr_read_b32 v72,a112
v_accvgpr_read_b32 v73,a113
v_accvgpr_read_b32 v74,a114
v_accvgpr_read_b32 v75,a115
v_mul_f32 v72,v72,v107
v_mul_f32 v73,v73,v107
v_mul_f32 v74,v74,v107
v_mul_f32 v75,v75,v107
v_accvgpr_write_b32 a112,v72
v_accvgpr_write_b32 a113,v73
v_accvgpr_write_b32 a114,v74
v_accvgpr_write_b32 a115,v75
v_accvgpr_read_b32 v72,a124
v_accvgpr_read_b32 v73,a125
v_accvgpr_read_b32 v74,a126
v_accvgpr_read_b32 v75,a127
v_mul_f32 v72,v72,v107
v_mul_f32 v73,v73,v107
v_mul_f32 v74,v74,v107
v_mul_f32 v75,v75,v107
v_accvgpr_write_b32 a124,v72
v_accvgpr_write_b32 a125,v73
v_accvgpr_write_b32 a126,v74
v_accvgpr_write_b32 a127,v75
v_accvgpr_read_b32 v72,a136
v_accvgpr_read_b32 v73,a137
v_accvgpr_read_b32 v74,a138
v_accvgpr_read_b32 v75,a139
v_mul_f32 v72,v72,v107
v_mul_f32 v73,v73,v107
v_mul_f32 v74,v74,v107
v_mul_f32 v75,v75,v107
v_accvgpr_write_b32 a136,v72
v_accvgpr_write_b32 a137,v73
v_accvgpr_write_b32 a138,v74
v_accvgpr_write_b32 a139,v75
v_sub_f32 v88,v88,v100
v_sub_f32 v89,v89,v100
v_sub_f32 v90,v90,v100
v_sub_f32 v91,v91,v100
v_sub_f32 v8,v8,v100
v_sub_f32 v9,v9,v100
v_sub_f32 v10,v10,v100
v_sub_f32 v11,v11,v100
v_sub_f32 v20,v20,v100
v_sub_f32 v21,v21,v100
v_sub_f32 v22,v22,v100
v_sub_f32 v23,v23,v100
v_sub_f32 v32,v32,v100
v_sub_f32 v33,v33,v100
v_sub_f32 v34,v34,v100
v_sub_f32 v35,v35,v100
v_sub_f32 v44,v44,v100
v_sub_f32 v45,v45,v100
v_sub_f32 v46,v46,v100
v_sub_f32 v47,v47,v100
v_mul_f32 v94,v94,v108
v_accvgpr_read_b32 v72,a8
v_accvgpr_read_b32 v73,a9
v_accvgpr_read_b32 v74,a10
v_accvgpr_read_b32 v75,a11
v_mul_f32 v72,v72,v108
v_mul_f32 v73,v73,v108
v_mul_f32 v74,v74,v108
v_mul_f32 v75,v75,v108
v_accvgpr_write_b32 a8,v72
v_accvgpr_write_b32 a9,v73
v_accvgpr_write_b32 a10,v74
v_accvgpr_write_b32 a11,v75
v_accvgpr_read_b32 v72,a20
v_accvgpr_read_b32 v73,a21
v_accvgpr_read_b32 v74,a22
v_accvgpr_read_b32 v75,a23
v_mul_f32 v72,v72,v108
v_mul_f32 v73,v73,v108
v_mul_f32 v74,v74,v108
v_mul_f32 v75,v75,v108
v_accvgpr_write_b32 a20,v72
v_accvgpr_write_b32 a21,v73
v_accvgpr_write_b32 a22,v74
v_accvgpr_write_b32 a23,v75
v_accvgpr_read_b32 v72,a32
v_accvgpr_read_b32 v73,a33
v_accvgpr_read_b32 v74,a34
v_accvgpr_read_b32 v75,a35
v_mul_f32 v72,v72,v108
v_mul_f32 v73,v73,v108
v_mul_f32 v74,v74,v108
v_mul_f32 v75,v75,v108
v_accvgpr_write_b32 a32,v72
v_accvgpr_write_b32 a33,v73
v_accvgpr_write_b32 a34,v74
v_accvgpr_write_b32 a35,v75
v_accvgpr_read_b32 v72,a44
v_accvgpr_read_b32 v73,a45
v_accvgpr_read_b32 v74,a46
v_accvgpr_read_b32 v75,a47
v_mul_f32 v72,v72,v108
v_mul_f32 v73,v73,v108
v_mul_f32 v74,v74,v108
v_mul_f32 v75,v75,v108
v_accvgpr_write_b32 a44,v72
v_accvgpr_write_b32 a45,v73
v_accvgpr_write_b32 a46,v74
v_accvgpr_write_b32 a47,v75
v_accvgpr_read_b32 v72,a56
v_accvgpr_read_b32 v73,a57
v_accvgpr_read_b32 v74,a58
v_accvgpr_read_b32 v75,a59
v_mul_f32 v72,v72,v108
v_mul_f32 v73,v73,v108
v_mul_f32 v74,v74,v108
v_mul_f32 v75,v75,v108
v_accvgpr_write_b32 a56,v72
v_accvgpr_write_b32 a57,v73
v_accvgpr_write_b32 a58,v74
v_accvgpr_write_b32 a59,v75
v_accvgpr_read_b32 v72,a68
v_accvgpr_read_b32 v73,a69
v_accvgpr_read_b32 v74,a70
v_accvgpr_read_b32 v75,a71
v_mul_f32 v72,v72,v108
v_mul_f32 v73,v73,v108
v_mul_f32 v74,v74,v108
v_mul_f32 v75,v75,v108
v_accvgpr_write_b32 a68,v72
v_accvgpr_write_b32 a69,v73
v_accvgpr_write_b32 a70,v74
v_accvgpr_write_b32 a71,v75
v_accvgpr_read_b32 v72,a80
v_accvgpr_read_b32 v73,a81
v_accvgpr_read_b32 v74,a82
v_accvgpr_read_b32 v75,a83
v_mul_f32 v72,v72,v108
v_mul_f32 v73,v73,v108
v_mul_f32 v74,v74,v108
v_mul_f32 v75,v75,v108
v_accvgpr_write_b32 a80,v72
v_accvgpr_write_b32 a81,v73
v_accvgpr_write_b32 a82,v74
v_accvgpr_write_b32 a83,v75
v_accvgpr_read_b32 v72,a92
v_accvgpr_read_b32 v73,a93
v_accvgpr_read_b32 v74,a94
v_accvgpr_read_b32 v75,a95
v_mul_f32 v72,v72,v108
v_mul_f32 v73,v73,v108
v_mul_f32 v74,v74,v108
v_mul_f32 v75,v75,v108
v_accvgpr_write_b32 a92,v72
v_accvgpr_write_b32 a93,v73
v_accvgpr_write_b32 a94,v74
v_accvgpr_write_b32 a95,v75
v_accvgpr_read_b32 v72,a104
v_accvgpr_read_b32 v73,a105
v_accvgpr_read_b32 v74,a106
v_accvgpr_read_b32 v75,a107
v_mul_f32 v72,v72,v108
v_mul_f32 v73,v73,v108
v_mul_f32 v74,v74,v108
v_mul_f32 v75,v75,v108
v_accvgpr_write_b32 a104,v72
v_accvgpr_write_b32 a105,v73
v_accvgpr_write_b32 a106,v74
v_accvgpr_write_b32 a107,v75
v_accvgpr_read_b32 v72,a116
v_accvgpr_read_b32 v73,a117
v_accvgpr_read_b32 v74,a118
v_accvgpr_read_b32 v75,a119
v_mul_f32 v72,v72,v108
v_mul_f32 v73,v73,v108
v_mul_f32 v74,v74,v108
v_mul_f32 v75,v75,v108
v_accvgpr_write_b32 a116,v72
v_accvgpr_write_b32 a117,v73
v_accvgpr_write_b32 a118,v74
v_accvgpr_write_b32 a119,v75
v_accvgpr_read_b32 v72,a128
v_accvgpr_read_b32 v73,a129
v_accvgpr_read_b32 v74,a130
v_accvgpr_read_b32 v75,a131
v_mul_f32 v72,v72,v108
v_mul_f32 v73,v73,v108
v_mul_f32 v74,v74,v108
v_mul_f32 v75,v75,v108
v_accvgpr_write_b32 a128,v72
v_accvgpr_write_b32 a129,v73
v_accvgpr_write_b32 a130,v74
v_accvgpr_write_b32 a131,v75
v_accvgpr_read_b32 v72,a140
v_accvgpr_read_b32 v73,a141
v_accvgpr_read_b32 v74,a142
v_accvgpr_read_b32 v75,a143
v_mul_f32 v72,v72,v108
v_mul_f32 v73,v73,v108
v_mul_f32 v74,v74,v108
v_mul_f32 v75,v75,v108
v_accvgpr_write_b32 a140,v72
v_accvgpr_write_b32 a141,v73
v_accvgpr_write_b32 a142,v74
v_accvgpr_write_b32 a143,v75
v_exp_f32 v72,v24
v_exp_f32 v73,v25
s_nop 0
v_add_f32 v95,v72,v73
v_cvt_pk_bf16_f32 v60,v72,v73
v_exp_f32 v74,v26
v_exp_f32 v75,v27
v_add_f32 v95,v95,v74
v_add_f32 v95,v95,v75
v_cvt_pk_bf16_f32 v61,v74,v75
v_exp_f32 v76,v28
v_exp_f32 v77,v29
s_nop 0
v_add_f32 v96,v76,v77
v_cvt_pk_bf16_f32 v64,v76,v77
v_exp_f32 v78,v30
v_exp_f32 v79,v31
v_add_f32 v96,v96,v78
v_add_f32 v96,v96,v79
v_cvt_pk_bf16_f32 v65,v78,v79
v_exp_f32 v120,v32
v_exp_f32 v121,v33
s_nop 0
v_add_f32 v97,v120,v121
v_cvt_pk_bf16_f32 v68,v120,v121
v_exp_f32 v122,v34
v_exp_f32 v123,v35
v_add_f32 v97,v97,v122
v_add_f32 v97,v97,v123
v_cvt_pk_bf16_f32 v69,v122,v123
v_exp_f32 v124,v36
v_exp_f32 v125,v37
v_add_f32 v95,v95,v124
v_add_f32 v95,v95,v125
v_cvt_pk_bf16_f32 v62,v124,v125
v_exp_f32 v126,v38
v_exp_f32 v127,v39
v_add_f32 v95,v95,v126
v_add_f32 v95,v95,v127
v_cvt_pk_bf16_f32 v63,v126,v127
v_exp_f32 v72,v40
v_exp_f32 v73,v41
v_add_f32 v96,v96,v72
v_add_f32 v96,v96,v73
v_cvt_pk_bf16_f32 v66,v72,v73
v_exp_f32 v74,v42
v_exp_f32 v75,v43
v_add_f32 v96,v96,v74
v_add_f32 v96,v96,v75
v_cvt_pk_bf16_f32 v67,v74,v75
v_exp_f32 v76,v44
v_exp_f32 v77,v45
v_add_f32 v97,v97,v76
v_add_f32 v97,v97,v77
v_cvt_pk_bf16_f32 v70,v76,v77
v_exp_f32 v78,v46
v_exp_f32 v79,v47
v_add_f32 v97,v97,v78
v_add_f32 v97,v97,v79
v_cvt_pk_bf16_f32 v71,v78,v79
s_nop 1
s_setpc_b64 s[90:91]
.fill 5134, 4, 0xBF800000
L_text_end:
.section .rodata,"a"
.p2align 6
.amdhsa_kernel standalone__mha_block_cached__near_ridge_kernel
  .amdhsa_next_free_vgpr 512
  .amdhsa_next_free_sgpr 102
  .amdhsa_accum_offset 256
  .amdhsa_group_segment_fixed_size 0
  .amdhsa_kernarg_size 64
  .amdhsa_user_sgpr_count 2
  .amdhsa_user_sgpr_kernarg_segment_ptr 1
  .amdhsa_system_sgpr_workgroup_id_x 1
.end_amdhsa_kernel
```
